```python
import torch

def _softmax(x, axis=-1):
    return torch.softmax(x, dim=axis)

def _gelu(x):
    return torch.nn.functional.gelu(x, approximate='tanh')

def _silu(x):
    return torch.nn.functional.silu(x)

def _sigmoid(x):
    return torch.sigmoid(x)

def _layernorm(x, axis=-1, eps=1e-05):
    m = x.mean(dim=axis, keepdim=True)
    v = x.var(dim=axis, keepdim=True, unbiased=False)
    return (x - m) / torch.sqrt(v + eps)

def _scatter_add(tgt, idx, src, axis=0):
    return tgt.clone().index_add_(axis, idx, src)

def _segment_sum(src, seg, n):
    out = torch.zeros((n,) + src.shape[1:], dtype=src.dtype)
    return out.index_add_(0, seg, src)

def _pad(x, pw):
    flat = tuple((v for pair in reversed(pw) for v in pair))
    return torch.nn.functional.pad(x, flat)
kernel_name = 'sequential_preLN__memory_aug_recurrent_mem_tr__dense_activation_mish__prompt'

def setup_inputs():

    _w = lambda a: (lambda t: t.to(torch.bfloat16) if t.is_floating_point() else t)(torch.as_tensor(a))

    def _A_setup():
        B, S, Dm = (1, 2048, 640)
        H, Dh = (32, 192)
        M, seg = (8, 32)
        seg = min(seg, S)
        S = S // seg * seg
        return {'x': _w((lambda *s: torch.randn(*s, dtype=torch.bfloat16) * 0.05)(B, S, Dm)), 'mem0': _w((lambda *s: torch.randn(*s, dtype=torch.bfloat16) * 0.2)(B, M, Dm)), 'Wq': _w((lambda *s: torch.randn(*s, dtype=torch.bfloat16) * 1.6)(Dm, H, Dh) * Dm ** (-0.5)), 'Wk': _w((lambda *s: torch.randn(*s, dtype=torch.bfloat16) * 1.6)(Dm, H, Dh) * Dm ** (-0.5)), 'Wv': _w((lambda *s: torch.randn(*s, dtype=torch.bfloat16) * 0.2)(Dm, H, Dh) * Dm ** (-0.5)), 'Wo': _w((lambda *s: torch.randn(*s, dtype=torch.bfloat16) * 0.2)(H, Dh, Dm) * (H * Dh) ** (-0.5)), 'seg_len': seg}
    _A_in = _A_setup()

    def _B_setup():
        B, S, D, F = (1, 2048, 640, 1536)
        return {'x': _w((lambda *s: torch.randn(*s, dtype=torch.bfloat16) * 0.05)(B, S, D)), 'w1': _w((lambda *s: torch.randn(*s, dtype=torch.bfloat16) * 0.8)(D, F) * D ** (-0.5)), 'b1': _w((lambda *s: torch.randn(*s, dtype=torch.bfloat16) * 0.2)(F)), 'w2': _w((lambda *s: torch.randn(*s, dtype=torch.bfloat16) * 0.1)(F, D) * F ** (-0.5))}
    _B_in = _B_setup()
    return {'A_x': _A_in['x'], 'A_mem0': _A_in['mem0'], 'A_Wq': _A_in['Wq'], 'A_Wk': _A_in['Wk'], 'A_Wv': _A_in['Wv'], 'A_Wo': _A_in['Wo'], 'A_seg_len': _A_in['seg_len'], 'B_x': _B_in['x'], 'B_w1': _B_in['w1'], 'B_b1': _B_in['b1'], 'B_w2': _B_in['w2']}

def reference(A_x, A_mem0, A_Wq, A_Wk, A_Wv, A_Wo, A_seg_len, B_x, B_w1, B_b1, B_w2):

    def _A_ref(x, mem0, Wq, Wk, Wv, Wo, seg_len):
        B, S, Dm = x.shape
        H, Dh = (Wq.shape[1], Wq.shape[2])
        M = mem0.shape[1]
        scale = Dh ** (-0.5)
        n_seg = S // seg_len
        L = M + seg_len
        idx = torch.arange(L)
        mask = (idx[:, None] < M) | (idx[:, None] >= idx[None, :])
        mem = mem0
        outs = []
        for s in range(n_seg):
            xs = x[:, s * seg_len:(s + 1) * seg_len, :].clone()
            h = torch.concatenate([mem, xs], axis=1)
            q = torch.einsum('btd,dhe->bhte', h, Wq)
            k = torch.einsum('btd,dhe->bhte', h, Wk)
            v = torch.einsum('btd,dhe->bhte', h, Wv)
            scores = torch.einsum('bhqe,bhke->bhqk', q, k) * scale
            scores = torch.where(mask[None, None], scores, -1000000000.0)
            p = _softmax(scores, axis=-1)
            o = torch.einsum('bhqk,bhke->bhqe', p, v)
            o = torch.einsum('bhte,hed->btd', o, Wo)
            mem = o[:, :M, :].clone()
            outs.append(o[:, M:, :])
        return torch.concatenate(outs, axis=1)

    def _B_ref(x, w1, b1, w2):
        h = torch.einsum('bsd,df->bsf', x, w1) + b1
        sp = torch.log1p(torch.exp(-torch.abs(h))) + torch.where(h > 0, h, torch.zeros_like(h))
        act = h * torch.tanh(sp)
        return torch.einsum('bsf,fd->bsd', act, w2)
    x = A_x
    h = x + _A_ref(_layernorm(x, axis=-1), A_mem0, A_Wq, A_Wk, A_Wv, A_Wo, A_seg_len)
    h2 = h + _B_ref(_layernorm(h, axis=-1), B_w1, B_b1, B_w2)
    return h2
```

```asm
; @launch grid=(256,1,1) block=(256,1,1) lds=163840
.amdgcn_target "amdgcn-amd-amdhsa--gfx950"
.text
.p2align 8
.globl sequential_preLN__memory_aug_recurrent_mem_tr__dense_activation_mish__prompt_kernel
.type sequential_preLN__memory_aug_recurrent_mem_tr__dense_activation_mish__prompt_kernel,@function
sequential_preLN__memory_aug_recurrent_mem_tr__dense_activation_mish__prompt_kernel:
    s_cmp_ge_u32 s2, 256
    s_cbranch_scc1 M_done
    s_load_dwordx8 s[40:47], s[0:1], 16
    s_load_dwordx4 s[48:51], s[0:1], 96
    s_load_dwordx4 s[64:67], s[0:1], 0
    s_load_dwordx2 s[68:69], s[0:1], 64
    s_load_dwordx2 s[70:71], s[0:1], 80
    s_getreg_b32 s3, hwreg(HW_REG_XCC_ID)
    s_and_b32 s3, s3, 7
    s_and_b32 s30, s2, 0xf8
    s_or_b32 s3, s3, s30
    s_movk_i32 s63, 128
M_lookup:
    s_getpc_b64 s[30:31]
M_pc:
    s_lshl_b32 s32, s3, 3
    s_add_u32 s32, s32, M_table-M_pc
    s_load_dwordx2 s[22:23], s[30:31], s32
    s_lshr_b32 s33, s2, 3
    s_mul_i32 s33, s33, 20
    v_min_u32 v3, 19, v0
    v_add_u32 v3, s33, v3
    v_lshlrev_b32 v3, 7, v3
    v_min_u32 v3, M_table-M_pc, v3
    global_load_dword v253, v3, s[30:31]
    v_and_b32 v1, 63, v0
    v_lshrrev_b32 v2, 6, v0
    s_nop 0
    v_readfirstlane_b32 s16, v2
    v_lshlrev_b32 v2, 4, v1
    s_waitcnt lgkmcnt(0)
    s_add_u32 s4, s50, 0x1fffff
    s_addc_u32 s5, s51, 0
    s_and_b32 s4, s4, 0xffe00000
    s_and_b32 s5, s5, 0xffff
    s_mov_b32 s6, 266338304
    s_mov_b32 s7, 0x20000
    s_lshr_b32 s60, s22, 24
    s_cmp_lg_u32 s60, 0
    s_cbranch_scc0 M_claim
    s_sub_u32 s60, s60, 1
    s_branch I_start
M_claim:
    s_cmp_lg_u32 s16, 0
    s_cbranch_scc1 M_roles
    s_lshr_b32 s30, s3, 5
    s_lshl_b32 s30, s30, 3
    s_add_u32 s30, s30, s63
    s_lshl_b32 s31, 1, s3
    v_mov_b32 v3, s30
    v_mov_b32 v4, s31
    v_mov_b32 v5, 0x100
    s_mov_b64 exec, 1
    global_atomic_add_x2 v3, v[4:5], s[48:49] sc1
    s_mov_b64 exec, -1
M_roles:
    s_and_b32 s17, s22, 0xff
    s_bfe_u32 s18, s22, 0x80008
    s_bfe_u32 s22, s22, 0x80010
    s_cmp_eq_u32 s22, 1
    s_cbranch_scc1 M_qk
    s_cmp_eq_u32 s22, 2
    s_cbranch_scc1 M_vo
    s_cmp_eq_u32 s22, 3
    s_cbranch_scc1 M_red
    s_cmp_eq_u32 s22, 4
    s_cbranch_scc1 M_xqk
    s_cmp_eq_u32 s22, 5
    s_cbranch_scc1 M_xvo
M_second:
    s_waitcnt vmcnt(0) lgkmcnt(0)
    s_barrier
    s_and_b32 s17, s23, 0x7f
    s_bfe_u32 s19, s23, 0x70007
    s_bfe_u32 s18, s23, 0x7000e
    s_bfe_u32 s59, s23, 0x70015
    s_lshr_b32 s22, s23, 28
    s_cmp_eq_u32 s22, 1
    s_cbranch_scc1 P_a
    s_cmp_eq_u32 s22, 2
    s_cbranch_scc1 P_b
    s_cmp_eq_u32 s22, 3
    s_cbranch_scc1 P_c
    s_cmp_eq_u32 s22, 4
    s_cbranch_scc1 P_d
    s_endpgm
M_again:
    s_cmp_lg_u32 s63, 128
    s_cbranch_scc1 M_fail
    s_mov_b32 s3, s2
    s_movk_i32 s63, 192
    s_barrier
    s_branch M_lookup
M_fail:
    s_mov_b64 exec, 1
    v_mov_b32 v3, 0
    v_mov_b32 v4, 0xdead
    global_store_dword v3, v4, s[48:49]
M_done:
    s_endpgm
M_red:
    v_and_b32 v96, 1, v1
    v_cmp_eq_u32 vcc, 0, v96
    v_mov_b32 v96, 0x4444
    v_mov_b32 v97, 0xeeee
    v_cndmask_b32 v3, v97, v96, vcc
    v_and_b32 v96, 48, v1
    v_lshlrev_b32 v96, 4, v96
    v_and_b32 v97, 15, v1
    v_lshlrev_b32 v97, 3, v97
    v_add_u32 v4, v96, v97
    v_lshrrev_b32 v97, 1, v97
    v_add_u32 v13, v96, v97
    v_lshrrev_b32 v96, 4, v1
    v_mul_u32_u24 v96, 144, v96
    v_and_b32 v97, 15, v1
    v_lshlrev_b32 v97, 2, v97
    s_mul_i32 s30, s16, 1152
    v_add3_u32 v7, v96, v97, s30
    v_and_b32 v96, 4, v1
    v_lshrrev_b32 v97, 4, v1
    v_add_u32 v96, v96, v97
    v_mul_u32_u24 v96, 72, v96
    v_and_b32 v97, 3, v1
    v_lshlrev_b32 v97, 4, v97
    v_and_b32 v98, 8, v1
    v_add3_u32 v12, v96, v97, v98
    s_lshl_b32 s30, s17, 8
    v_lshlrev_b32 v5, 2, v1
    v_add_u32 v5, s30, v5
    v_lshrrev_b32 v96, 13, v5
    v_mul_u32_u24 v96, 24576, v96
    v_add_u32 v5, v5, v96
    v_add_u32 v5, 16384, v5
    v_mov_b32 v8, -1
    v_mov_b32 v9, -1
    v_mov_b32 v10, -1
    v_mov_b32 v11, -1
    ds_write2_b32 v7, v8, v8 offset0:0 offset1:18
    ds_write2_b32 v7, v8, v8 offset0:144 offset1:162
    v_mov_b32 v26, 0x6000
    v_mov_b32 v27, 0
    ds_write_b32 v26, v27
    s_mov_b32 s42, 0x11111111
    s_mov_b32 s43, 0x11111111
    s_lshl_b32 s38, s17, 14
    s_lshl_b32 s30, s16, 11
    s_add_u32 s38, s38, s30
    s_mul_i32 s39, s17, 205
    s_lshr_b32 s39, s39, 11
    s_lshl_b32 s39, s39, 7
    s_lshl_b32 s30, s16, 5
    s_add_u32 s39, s39, s30
    s_add_u32 s39, s39, 54591488
    s_lshl_b32 s40, s17, 15
    s_lshl_b32 s30, s16, 13
    s_add_u32 s40, s40, s30
    s_add_u32 s40, s40, 122683392
    s_mul_i32 s30, s16, 5
    s_add_u32 s30, s30, 0
    s_lshr_b32 s31, s30, 3
    s_mul_i32 s31, s31, 24576
    s_lshl_b32 s30, s30, 10
    s_add_u32 s66, s30, s31
    s_mul_i32 s30, s16, 5
    s_add_u32 s30, s30, 1
    s_lshr_b32 s31, s30, 3
    s_mul_i32 s31, s31, 24576
    s_lshl_b32 s30, s30, 10
    s_add_u32 s67, s30, s31
    s_mul_i32 s30, s16, 5
    s_add_u32 s30, s30, 2
    s_lshr_b32 s31, s30, 3
    s_mul_i32 s31, s31, 24576
    s_lshl_b32 s30, s30, 10
    s_add_u32 s68, s30, s31
    s_mul_i32 s30, s16, 5
    s_add_u32 s30, s30, 3
    s_lshr_b32 s31, s30, 3
    s_mul_i32 s31, s31, 24576
    s_lshl_b32 s30, s30, 10
    s_add_u32 s69, s30, s31
    s_mul_i32 s30, s16, 5
    s_add_u32 s30, s30, 4
    s_lshr_b32 s31, s30, 3
    s_mul_i32 s31, s31, 24576
    s_lshl_b32 s30, s30, 10
    s_add_u32 s70, s30, s31
    v_and_b32 v6, 7, v1
    v_lshlrev_b32 v6, 2, v6
    s_lshl_b32 s30, s16, 3
    v_add_u32 v14, s30, v1
    v_lshlrev_b32 v14, 7, v14
    s_xor_b32 s72, s21, 622592
    s_lshr_b32 s29, s20, 0
    s_and_b32 s29, s29, 1
    s_lshl_b32 s29, s29, 13
    s_add_u32 s72, s72, s29
    s_xor_b32 s71, s21, 638976
    s_lshr_b32 s29, s20, 0
    s_and_b32 s29, s29, 1
    s_lshl_b32 s29, s29, 13
    s_add_u32 s71, s71, s29
    s_lshl_b32 s30, s17, 7
    s_add_u32 s71, s71, s30
    s_cmp_eq_u32 s16, 0
    s_cselect_b32 s71, s71, 0x7ffffff0
    s_mov_b32 s19, 0
    s_waitcnt lgkmcnt(0)
    s_barrier
    v_mov_b32 v24, 0
    v_add_u32 v28, 2304, v12
    s_lshl_b32 s30, s16, 11
    s_add_u32 s30, s30, 8192
    s_mov_b32 m0, s30
    v_add_u32 v13, s30, v13
    v_add_u32 v25, 1024, v13
R_step:
    s_lshl_b32 s32, s19, 9
    s_add_u32 s32, s32, s39
    s_mov_b32 s35, 0
    s_mul_i32 s30, s19, 1310720
    s_add_u32 s30, s30, s40
    s_add_u32 s31, s30, 4096
    v_cmp_eq_u32 vcc, 0, v24
    s_cbranch_vccz R_ug
R_uf:
    buffer_load_dword v24, v6, s[4:7], s32 offen sc1
    s_waitcnt vmcnt(0)
    v_cmp_eq_u32 vcc, 0, v24
    s_cbranch_vccz R_ug
    s_sleep 2
    s_add_u32 s35, s35, 1
    s_cmp_lt_u32 s35, 200000
    s_cbranch_scc1 R_uf
    s_branch M_fail
R_ug:
    buffer_load_dwordx4 v[32:35], v2, s[4:7], s30 offen offset:0 sc1
    buffer_load_dwordx4 v[36:39], v2, s[4:7], s30 offen offset:1024 sc1
    buffer_load_dwordx4 v[40:43], v2, s[4:7], s30 offen offset:2048 sc1
    buffer_load_dwordx4 v[44:47], v2, s[4:7], s30 offen offset:3072 sc1
    buffer_load_dwordx4 v[48:51], v2, s[4:7], s31 offen offset:0 sc1
    buffer_load_dwordx4 v[52:55], v2, s[4:7], s31 offen offset:1024 sc1
    buffer_load_dwordx4 v[56:59], v2, s[4:7], s31 offen offset:2048 sc1
    buffer_load_dwordx4 v[60:63], v2, s[4:7], s31 offen offset:3072 sc1
    buffer_load_dword v24, v6, s[4:7], s32 offen offset:512 sc1
    s_add_u32 s34, s19, 1
    s_mul_i32 s28, s34, 171
    s_lshr_b32 s28, s28, 9
    s_mul_i32 s27, s28, 3
    s_sub_u32 s27, s34, s27
    s_mul_i32 s27, s27, 655360
    s_add_u32 s28, s28, 4
    s_lshl_b32 s26, s28, 21
    s_add_u32 s26, s26, s27
    s_lshr_b32 s29, s20, s28
    s_and_b32 s29, s29, 1
    s_lshl_b32 s29, s29, 13
    s_add_u32 s26, s26, s29
    s_add_u32 s26, s26, s38
    s_lshr_b32 s29, s26, 5
    s_xor_b32 s29, s29, s21
    s_not_b32 s29, s29
    s_and_b32 s29, s29, 16384
    s_xor_b32 s26, s26, s29
    buffer_store_dwordx4 v[8:11], v2, s[4:7], s26 offen offset:0 sc1
    buffer_store_dwordx4 v[8:11], v2, s[4:7], s26 offen offset:1024 sc1
    s_add_u32 s34, s19, 2
    s_cmp_ge_u32 s34, 64
    s_cbranch_scc1 R_noinit
    s_cmp_lg_u32 s16, 0
    s_cbranch_scc1 R_noinit
    s_lshr_b32 s28, s34, 4
    s_lshl_b32 s26, s34, 17
    s_lshr_b32 s29, s20, s28
    s_and_b32 s29, s29, 1
    s_lshl_b32 s29, s29, 13
    s_add_u32 s26, s26, s29
    s_lshl_b32 s29, s34, 12
    s_xor_b32 s29, s29, s21
    s_and_b32 s29, s29, 16384
    s_sub_u32 s26, s26, s29
    buffer_store_dword v8, v5, s[4:7], s26 offen sc1
R_noinit:
    s_mul_i32 s28, s19, 171
    s_lshr_b32 s28, s28, 9
    s_mul_i32 s27, s28, 3
    s_sub_u32 s27, s19, s27
    s_mul_i32 s27, s27, 655360
    s_add_u32 s28, s28, 4
    s_lshl_b32 s26, s28, 21
    s_add_u32 s26, s26, s27
    s_lshr_b32 s29, s20, s28
    s_and_b32 s29, s29, 1
    s_lshl_b32 s29, s29, 13
    s_add_u32 s26, s26, s29
    s_add_u32 s26, s26, s38
    s_lshr_b32 s29, s26, 5
    s_xor_b32 s29, s29, s21
    s_not_b32 s29, s29
    s_and_b32 s29, s29, 16384
    s_xor_b32 s26, s26, s29
    s_add_u32 s34, s19, 1
    s_mov_b32 s35, 0
    s_mov_b64 exec, 0xff
    buffer_load_dword v16, v14, s[4:7], s72 offen sc1
    s_sleep 1
    buffer_load_dword v17, v14, s[4:7], s72 offen sc1
    s_sleep 1
    buffer_load_dword v18, v14, s[4:7], s72 offen sc1
    s_sleep 1
R_hu:
    buffer_load_dword v19, v14, s[4:7], s72 offen sc1
    s_waitcnt vmcnt(3)
    v_cmp_gt_u32 vcc, s34, v16
    s_cbranch_vccz R_hud
    buffer_load_dword v16, v14, s[4:7], s72 offen sc1
    s_waitcnt vmcnt(3)
    v_cmp_gt_u32 vcc, s34, v17
    s_cbranch_vccz R_hud
    buffer_load_dword v17, v14, s[4:7], s72 offen sc1
    s_waitcnt vmcnt(3)
    v_cmp_gt_u32 vcc, s34, v18
    s_cbranch_vccz R_hud
    buffer_load_dword v18, v14, s[4:7], s72 offen sc1
    s_waitcnt vmcnt(3)
    v_cmp_gt_u32 vcc, s34, v19
    s_cbranch_vccz R_hud
    s_add_u32 s35, s35, 1
    s_cmp_lt_u32 s35, 200000
    s_cbranch_scc1 R_hu
    s_branch M_fail
R_hud:
    s_mov_b32 s35, 0
    s_mov_b64 exec, -1
    buffer_load_dwordx4 v2, s[4:7], s26 offen offset:0 sc1 lds
    buffer_load_dwordx4 v2, s[4:7], s26 offen offset:1024 sc1 lds
    s_lshr_b32 s28, s19, 4
    s_lshl_b32 s25, s19, 17
    s_lshr_b32 s29, s20, s28
    s_and_b32 s29, s29, 1
    s_lshl_b32 s29, s29, 13
    s_add_u32 s25, s25, s29
    s_lshl_b32 s29, s19, 12
    s_xor_b32 s29, s29, s21
    s_and_b32 s29, s29, 16384
    s_add_u32 s25, s25, s29
    s_add_u32 s60, s25, s66
    s_add_u32 s61, s25, s67
    s_add_u32 s62, s25, s68
    s_add_u32 s63, s25, s69
    s_add_u32 s64, s25, s70
    s_lshr_b32 s28, s34, 4
    s_lshl_b32 s24, s34, 17
    s_lshr_b32 s29, s20, s28
    s_and_b32 s29, s29, 1
    s_lshl_b32 s29, s29, 13
    s_add_u32 s24, s24, s29
    s_lshl_b32 s29, s34, 12
    s_xor_b32 s29, s29, s21
    s_and_b32 s29, s29, 16384
    s_sub_u32 s24, s24, s29
    v_xor_b32 v96, 16384, v7
    ds_write2_b32 v96, v8, v8 offset0:0 offset1:18
    ds_write2_b32 v96, v8, v8 offset0:144 offset1:162
    v_mov_b32 v15, s34
    s_mov_b32 s73, s71
    buffer_load_dwordx4 v[72:75], v2, s[4:7], s60 offen sc1
    buffer_load_dwordx4 v[76:79], v2, s[4:7], s61 offen sc1
    buffer_load_dwordx4 v[80:83], v2, s[4:7], s62 offen sc1
    buffer_load_dwordx4 v[84:87], v2, s[4:7], s63 offen sc1
    buffer_load_dwordx2 v[88:89], v4, s[4:7], s64 offen offset:0 sc1
    buffer_load_dwordx2 v[90:91], v4, s[4:7], s64 offen offset:128 sc1
    s_add_u32 s35, s35, 1
    v_mov_b64 v[92:93], 0
    v_mov_b64 v[94:95], 0
    s_barrier
    s_branch R_go
R_zp:
    buffer_load_dwordx4 v2, s[4:7], s26 offen offset:0 sc1 lds
    buffer_load_dwordx4 v2, s[4:7], s26 offen offset:1024 sc1 lds
R_pp:
    buffer_load_dwordx4 v[72:75], v2, s[4:7], s60 offen sc1
    buffer_load_dwordx4 v[76:79], v2, s[4:7], s61 offen sc1
    buffer_load_dwordx4 v[80:83], v2, s[4:7], s62 offen sc1
    buffer_load_dwordx4 v[84:87], v2, s[4:7], s63 offen sc1
    buffer_load_dwordx2 v[88:89], v4, s[4:7], s64 offen offset:0 sc1
    buffer_load_dwordx2 v[90:91], v4, s[4:7], s64 offen offset:128 sc1
    s_add_u32 s35, s35, 1
    v_mov_b64 v[92:93], 0
    v_mov_b64 v[94:95], 0
    s_cmp_ge_u32 s35, 200000
    s_cbranch_scc1 M_fail
R_go:
    s_mov_b64 exec, 1
    buffer_store_dword v15, v2, s[4:7], s73 offen sc1
    s_mov_b64 exec, -1
    s_mov_b32 s73, 0x7ffffff0
    s_waitcnt vmcnt(7)
    ds_read2_b32 v[64:65], v13 offset0:0 offset1:32
    ds_read2_b32 v[66:67], v13 offset0:16 offset1:48
    ds_read2_b32 v[68:69], v25 offset0:0 offset1:32
    ds_read2_b32 v[70:71], v25 offset0:16 offset1:48
    s_waitcnt vmcnt(6)
    v_smfmac_f32_16x16x64_bf16 v[92:95], v[72:75], v[32:39], v3
    s_waitcnt vmcnt(5)
    v_smfmac_f32_16x16x64_bf16 v[92:95], v[76:79], v[40:47], v3
    s_waitcnt vmcnt(4)
    v_smfmac_f32_16x16x64_bf16 v[92:95], v[80:83], v[48:55], v3
    s_waitcnt vmcnt(3)
    v_smfmac_f32_16x16x64_bf16 v[92:95], v[84:87], v[56:63], v3
    s_waitcnt vmcnt(1)
    s_waitcnt lgkmcnt(0)
    v_smfmac_f32_16x16x64_bf16 v[92:95], v[88:91], v[64:71], v3
    v_mov_b32 v113, 0
    v_mov_b32 v113, 0
    s_nop 5
    v_add_f32 v114, v92, v93
    v_add_f32 v115, v94, v95
    ds_write2_b32 v7, v114, v115 offset0:0 offset1:18
    ds_read_b64 v[96:97], v12 offset:0
    ds_read_b64 v[98:99], v12 offset:1152
    ds_read_b64 v[100:101], v12 offset:2304
    ds_read_b64 v[102:103], v12 offset:3456
    v_cmp_u_f32 s[44:45], v114, v115
    v_mov_b32 v113, 0
    v_mov_b32 v113, 0
    v_mov_b32 v113, 0
    s_waitcnt lgkmcnt(0)
    v_pk_add_f32 v[96:97], v[96:97], v[98:99]
    v_pk_add_f32 v[100:101], v[100:101], v[102:103]
    v_pk_add_f32 v[96:97], v[96:97], v[100:101]
    v_cmp_u_f32 vcc, v96, v97
    v_cvt_pk_bf16_f32 v112, v96, v97
    s_cbranch_vccnz R_nan
    buffer_store_dword v112, v5, s[4:7], s24 offen sc1
R_next:
    s_barrier
    ds_read_b32 v27, v26
    s_waitcnt lgkmcnt(0)
    v_cmp_eq_u32 vcc, s34, v27
    s_cbranch_vccz R_n2
    ds_read_b64 v[96:97], v12 offset:0
    ds_read_b64 v[98:99], v12 offset:1152
    ds_read_b64 v[100:101], v12 offset:2304
    ds_read_b64 v[102:103], v12 offset:3456
    s_waitcnt lgkmcnt(0)
    v_pk_add_f32 v[96:97], v[96:97], v[98:99]
    v_pk_add_f32 v[100:101], v[100:101], v[102:103]
    v_pk_add_f32 v[96:97], v[96:97], v[100:101]
    v_cmp_u_f32 vcc, v96, v97
    v_cvt_pk_bf16_f32 v112, v96, v97
    v_min_u32 v112, -2, v112
    buffer_store_dword v112, v5, s[4:7], s24 offen sc1
    s_barrier
R_n2:
    v_xor_b32 v7, 16384, v7
    v_xor_b32 v12, 16384, v12
    v_xor_b32 v28, 16384, v28
    s_add_u32 s19, s19, 1
    s_cmp_lt_u32 s19, 63
    s_cbranch_scc1 R_step
    s_endpgm
R_nan:
    s_cmp_eq_u64 s[44:45], 0
    s_cbranch_scc1 R_inf
    v_max3_u32 v96, v64, v65, v66
    v_max3_u32 v97, v67, v68, v69
    v_max_u32 v98, v70, v71
    v_max3_u32 v99, v96, v97, v98
    v_cmp_eq_u32 vcc, -1, v99
    s_cbranch_vccnz R_zp
    v_max3_u32 v96, v72, v73, v74
    v_max3_u32 v97, v75, v76, v77
    v_max3_u32 v98, v78, v79, v80
    v_max3_u32 v99, v81, v82, v83
    v_max3_u32 v100, v84, v85, v86
    v_max3_u32 v101, v87, v88, v89
    v_max_u32 v102, v90, v91
    v_max3_u32 v103, v96, v97, v98
    v_max3_u32 v104, v99, v100, v101
    v_max3_u32 v105, v103, v104, v102
    v_cmp_eq_u32 vcc, -1, v105
    s_cbranch_vccnz R_pp
R_real:
    ds_write_b32 v26, v15
    s_waitcnt lgkmcnt(0)
    s_branch R_next
R_inf:
    v_max3_f32 v114, |v92|, |v93|, |v94|
    v_max_f32 v114, v114, |v95|
    v_cmp_lt_f32 vcc, 0x7e000000, v114
    s_cbranch_vccnz R_real
    s_branch R_next
M_qk:
    s_mov_b32 s8, s40
    s_and_b32 s9, s41, 0xffff
    s_mov_b32 s10, 7864320
    s_mov_b32 s11, 0x20000
    s_mov_b32 s12, s42
    s_and_b32 s13, s43, 0xffff
    s_mov_b32 s14, 7864320
    s_mov_b32 s15, 0x20000
    s_mul_i32 s36, s17, 384
    s_mul_i32 s30, s16, 96
    s_add_u32 s36, s36, s30
    v_add_u32 v4, 0, v1
    v_mul_u32_u24 v5, 171, v4
    v_lshrrev_b32 v5, 10, v5
    v_mul_u32_u24 v6, 6, v5
    v_sub_u32 v4, v4, v6
    v_lshlrev_b32 v4, 4, v4
    v_and_b32 v6, 3, v5
    v_and_b32 v7, 12, v5
    v_lshlrev_b32 v7, 1, v7
    v_add_u32 v6, v6, v7
    v_lshrrev_b32 v7, 4, v5
    v_lshlrev_b32 v7, 2, v7
    v_add_u32 v6, v6, v7
    v_mul_u32_u24 v6, 12288, v6
    v_add_u32 v16, v6, v4
    v_add_u32 v4, 64, v1
    v_mul_u32_u24 v5, 171, v4
    v_lshrrev_b32 v5, 10, v5
    v_mul_u32_u24 v6, 6, v5
    v_sub_u32 v4, v4, v6
    v_lshlrev_b32 v4, 4, v4
    v_and_b32 v6, 3, v5
    v_and_b32 v7, 12, v5
    v_lshlrev_b32 v7, 1, v7
    v_add_u32 v6, v6, v7
    v_lshrrev_b32 v7, 4, v5
    v_lshlrev_b32 v7, 2, v7
    v_add_u32 v6, v6, v7
    v_mul_u32_u24 v6, 12288, v6
    v_add_u32 v17, v6, v4
    v_add_u32 v4, 128, v1
    v_mul_u32_u24 v5, 171, v4
    v_lshrrev_b32 v5, 10, v5
    v_mul_u32_u24 v6, 6, v5
    v_sub_u32 v4, v4, v6
    v_lshlrev_b32 v4, 4, v4
    v_and_b32 v6, 3, v5
    v_and_b32 v7, 12, v5
    v_lshlrev_b32 v7, 1, v7
    v_add_u32 v6, v6, v7
    v_lshrrev_b32 v7, 4, v5
    v_lshlrev_b32 v7, 2, v7
    v_add_u32 v6, v6, v7
    v_mul_u32_u24 v6, 12288, v6
    v_add_u32 v18, v6, v4
    s_mul_i32 s30, s16, 40960
    s_add_u32 s31, s36, 0
    s_add_u32 m0, s30, 0
    s_nop 0
    buffer_load_dwordx4 v16, s[8:11], s31 offen lds
    s_add_u32 m0, s30, 1024
    s_nop 0
    buffer_load_dwordx4 v17, s[8:11], s31 offen lds
    s_add_u32 m0, s30, 2048
    s_nop 0
    buffer_load_dwordx4 v18, s[8:11], s31 offen lds
    s_add_u32 s31, s36, 1572864
    s_add_u32 m0, s30, 3072
    s_nop 0
    buffer_load_dwordx4 v16, s[8:11], s31 offen lds
    s_add_u32 m0, s30, 4096
    s_nop 0
    buffer_load_dwordx4 v17, s[8:11], s31 offen lds
    s_add_u32 m0, s30, 5120
    s_nop 0
    buffer_load_dwordx4 v18, s[8:11], s31 offen lds
    s_add_u32 s31, s36, 3145728
    s_add_u32 m0, s30, 6144
    s_nop 0
    buffer_load_dwordx4 v16, s[8:11], s31 offen lds
    s_add_u32 m0, s30, 7168
    s_nop 0
    buffer_load_dwordx4 v17, s[8:11], s31 offen lds
    s_add_u32 m0, s30, 8192
    s_nop 0
    buffer_load_dwordx4 v18, s[8:11], s31 offen lds
    s_add_u32 s31, s36, 4718592
    s_add_u32 m0, s30, 9216
    s_nop 0
    buffer_load_dwordx4 v16, s[8:11], s31 offen lds
    s_add_u32 m0, s30, 10240
    s_nop 0
    buffer_load_dwordx4 v17, s[8:11], s31 offen lds
    s_add_u32 m0, s30, 11264
    s_nop 0
    buffer_load_dwordx4 v18, s[8:11], s31 offen lds
    s_add_u32 s31, s36, 0
    s_add_u32 m0, s30, 12288
    s_nop 0
    buffer_load_dwordx4 v16, s[12:15], s31 offen lds
    s_add_u32 m0, s30, 13312
    s_nop 0
    buffer_load_dwordx4 v17, s[12:15], s31 offen lds
    s_add_u32 m0, s30, 14336
    s_nop 0
    buffer_load_dwordx4 v18, s[12:15], s31 offen lds
    s_add_u32 s31, s36, 1572864
    s_add_u32 m0, s30, 15360
    s_nop 0
    buffer_load_dwordx4 v16, s[12:15], s31 offen lds
    s_add_u32 m0, s30, 16384
    s_nop 0
    buffer_load_dwordx4 v17, s[12:15], s31 offen lds
    s_add_u32 m0, s30, 17408
    s_nop 0
    buffer_load_dwordx4 v18, s[12:15], s31 offen lds
    s_add_u32 s31, s36, 3145728
    s_add_u32 m0, s30, 18432
    s_nop 0
    buffer_load_dwordx4 v16, s[12:15], s31 offen lds
    s_add_u32 m0, s30, 19456
    s_nop 0
    buffer_load_dwordx4 v17, s[12:15], s31 offen lds
    s_add_u32 m0, s30, 20480
    s_nop 0
    buffer_load_dwordx4 v18, s[12:15], s31 offen lds
    s_add_u32 s31, s36, 4718592
    s_add_u32 m0, s30, 21504
    s_nop 0
    buffer_load_dwordx4 v16, s[12:15], s31 offen lds
    s_add_u32 m0, s30, 22528
    s_nop 0
    buffer_load_dwordx4 v17, s[12:15], s31 offen lds
    s_add_u32 m0, s30, 23552
    s_nop 0
    buffer_load_dwordx4 v18, s[12:15], s31 offen lds
    v_lshrrev_b32 v4, 2, v1
    v_and_b32 v5, 3, v1
    v_lshlrev_b32 v5, 3, v5
    v_add_u32 v5, s30, v5
    v_mul_u32_u24 v6, 96, v4
    v_add_u32 v31, v6, v5
    v_mul_u32_u24 v6, 320, v4
    v_add_u32 v29, v6, v5
    s_xor_b32 s33, s16, 0
    s_mul_i32 s33, s33, 3072
    v_add_u32 v12, s33, v31
    s_xor_b32 s33, s16, 1
    s_mul_i32 s33, s33, 3072
    v_add_u32 v13, s33, v31
    s_xor_b32 s33, s16, 2
    s_mul_i32 s33, s33, 3072
    v_add_u32 v14, s33, v31
    s_xor_b32 s33, s16, 3
    s_mul_i32 s33, s33, 3072
    v_add_u32 v15, s33, v31
    s_mul_i32 s33, s16, 20480
    v_add_u32 v30, s33, v2
    s_waitcnt vmcnt(12)
    ds_read_b64_tr_b16 a[0:1], v12 offset:0
    ds_read_b64_tr_b16 a[2:3], v12 offset:1536
    ds_read_b64_tr_b16 a[8:9], v12 offset:32
    ds_read_b64_tr_b16 a[10:11], v12 offset:1568
    ds_read_b64_tr_b16 a[16:17], v12 offset:64
    ds_read_b64_tr_b16 a[18:19], v12 offset:1600
    ds_read_b64_tr_b16 a[80:81], v13 offset:0
    ds_read_b64_tr_b16 a[82:83], v13 offset:1536
    ds_read_b64_tr_b16 a[88:89], v13 offset:32
    ds_read_b64_tr_b16 a[90:91], v13 offset:1568
    ds_read_b64_tr_b16 a[96:97], v13 offset:64
    ds_read_b64_tr_b16 a[98:99], v13 offset:1600
    ds_read_b64_tr_b16 a[160:161], v14 offset:0
    ds_read_b64_tr_b16 a[162:163], v14 offset:1536
    ds_read_b64_tr_b16 a[168:169], v14 offset:32
    ds_read_b64_tr_b16 a[170:171], v14 offset:1568
    ds_read_b64_tr_b16 a[176:177], v14 offset:64
    ds_read_b64_tr_b16 a[178:179], v14 offset:1600
    ds_read_b64_tr_b16 a[240:241], v15 offset:0
    ds_read_b64_tr_b16 a[242:243], v15 offset:1536
    ds_read_b64_tr_b16 a[248:249], v15 offset:32
    ds_read_b64_tr_b16 a[250:251], v15 offset:1568
    ds_read_b64_tr_b16 v[112:113], v15 offset:64
    ds_read_b64_tr_b16 v[114:115], v15 offset:1600
    s_waitcnt lgkmcnt(0)
    s_add_u32 s31, s36, 393216
    s_add_u32 m0, s30, 0
    s_nop 0
    buffer_load_dwordx4 v16, s[8:11], s31 offen lds
    s_add_u32 m0, s30, 1024
    s_nop 0
    buffer_load_dwordx4 v17, s[8:11], s31 offen lds
    s_add_u32 m0, s30, 2048
    s_nop 0
    buffer_load_dwordx4 v18, s[8:11], s31 offen lds
    s_add_u32 s31, s36, 1966080
    s_add_u32 m0, s30, 3072
    s_nop 0
    buffer_load_dwordx4 v16, s[8:11], s31 offen lds
    s_add_u32 m0, s30, 4096
    s_nop 0
    buffer_load_dwordx4 v17, s[8:11], s31 offen lds
    s_add_u32 m0, s30, 5120
    s_nop 0
    buffer_load_dwordx4 v18, s[8:11], s31 offen lds
    s_add_u32 s31, s36, 3538944
    s_add_u32 m0, s30, 6144
    s_nop 0
    buffer_load_dwordx4 v16, s[8:11], s31 offen lds
    s_add_u32 m0, s30, 7168
    s_nop 0
    buffer_load_dwordx4 v17, s[8:11], s31 offen lds
    s_add_u32 m0, s30, 8192
    s_nop 0
    buffer_load_dwordx4 v18, s[8:11], s31 offen lds
    s_add_u32 s31, s36, 5111808
    s_add_u32 m0, s30, 9216
    s_nop 0
    buffer_load_dwordx4 v16, s[8:11], s31 offen lds
    s_add_u32 m0, s30, 10240
    s_nop 0
    buffer_load_dwordx4 v17, s[8:11], s31 offen lds
    s_add_u32 m0, s30, 11264
    s_nop 0
    buffer_load_dwordx4 v18, s[8:11], s31 offen lds
    s_waitcnt vmcnt(12)
    ds_read_b64_tr_b16 a[24:25], v12 offset:12288
    ds_read_b64_tr_b16 a[26:27], v12 offset:13824
    ds_read_b64_tr_b16 a[32:33], v12 offset:12320
    ds_read_b64_tr_b16 a[34:35], v12 offset:13856
    ds_read_b64_tr_b16 v[32:33], v12 offset:12352
    ds_read_b64_tr_b16 v[34:35], v12 offset:13888
    ds_read_b64_tr_b16 a[104:105], v13 offset:12288
    ds_read_b64_tr_b16 a[106:107], v13 offset:13824
    ds_read_b64_tr_b16 a[112:113], v13 offset:12320
    ds_read_b64_tr_b16 a[114:115], v13 offset:13856
    ds_read_b64_tr_b16 v[48:49], v13 offset:12352
    ds_read_b64_tr_b16 v[50:51], v13 offset:13888
    ds_read_b64_tr_b16 a[184:185], v14 offset:12288
    ds_read_b64_tr_b16 a[186:187], v14 offset:13824
    ds_read_b64_tr_b16 a[192:193], v14 offset:12320
    ds_read_b64_tr_b16 a[194:195], v14 offset:13856
    ds_read_b64_tr_b16 v[64:65], v14 offset:12352
    ds_read_b64_tr_b16 v[66:67], v14 offset:13888
    ds_read_b64_tr_b16 v[120:121], v15 offset:12288
    ds_read_b64_tr_b16 v[122:123], v15 offset:13824
    ds_read_b64_tr_b16 v[128:129], v15 offset:12320
    ds_read_b64_tr_b16 v[130:131], v15 offset:13856
    ds_read_b64_tr_b16 v[80:81], v15 offset:12352
    ds_read_b64_tr_b16 v[82:83], v15 offset:13888
    s_waitcnt lgkmcnt(0)
    s_add_u32 s31, s36, 393216
    s_add_u32 m0, s30, 12288
    s_nop 0
    buffer_load_dwordx4 v16, s[12:15], s31 offen lds
    s_add_u32 m0, s30, 13312
    s_nop 0
    buffer_load_dwordx4 v17, s[12:15], s31 offen lds
    s_add_u32 m0, s30, 14336
    s_nop 0
    buffer_load_dwordx4 v18, s[12:15], s31 offen lds
    s_add_u32 s31, s36, 1966080
    s_add_u32 m0, s30, 15360
    s_nop 0
    buffer_load_dwordx4 v16, s[12:15], s31 offen lds
    s_add_u32 m0, s30, 16384
    s_nop 0
    buffer_load_dwordx4 v17, s[12:15], s31 offen lds
    s_add_u32 m0, s30, 17408
    s_nop 0
    buffer_load_dwordx4 v18, s[12:15], s31 offen lds
    s_add_u32 s31, s36, 3538944
    s_add_u32 m0, s30, 18432
    s_nop 0
    buffer_load_dwordx4 v16, s[12:15], s31 offen lds
    s_add_u32 m0, s30, 19456
    s_nop 0
    buffer_load_dwordx4 v17, s[12:15], s31 offen lds
    s_add_u32 m0, s30, 20480
    s_nop 0
    buffer_load_dwordx4 v18, s[12:15], s31 offen lds
    s_add_u32 s31, s36, 5111808
    s_add_u32 m0, s30, 21504
    s_nop 0
    buffer_load_dwordx4 v16, s[12:15], s31 offen lds
    s_add_u32 m0, s30, 22528
    s_nop 0
    buffer_load_dwordx4 v17, s[12:15], s31 offen lds
    s_add_u32 m0, s30, 23552
    s_nop 0
    buffer_load_dwordx4 v18, s[12:15], s31 offen lds
    s_waitcnt vmcnt(12)
    ds_read_b64_tr_b16 a[4:5], v12 offset:0
    ds_read_b64_tr_b16 a[6:7], v12 offset:1536
    ds_read_b64_tr_b16 a[12:13], v12 offset:32
    ds_read_b64_tr_b16 a[14:15], v12 offset:1568
    ds_read_b64_tr_b16 a[20:21], v12 offset:64
    ds_read_b64_tr_b16 a[22:23], v12 offset:1600
    ds_read_b64_tr_b16 a[84:85], v13 offset:0
    ds_read_b64_tr_b16 a[86:87], v13 offset:1536
    ds_read_b64_tr_b16 a[92:93], v13 offset:32
    ds_read_b64_tr_b16 a[94:95], v13 offset:1568
    ds_read_b64_tr_b16 a[100:101], v13 offset:64
    ds_read_b64_tr_b16 a[102:103], v13 offset:1600
    ds_read_b64_tr_b16 a[164:165], v14 offset:0
    ds_read_b64_tr_b16 a[166:167], v14 offset:1536
    ds_read_b64_tr_b16 a[172:173], v14 offset:32
    ds_read_b64_tr_b16 a[174:175], v14 offset:1568
    ds_read_b64_tr_b16 a[180:181], v14 offset:64
    ds_read_b64_tr_b16 a[182:183], v14 offset:1600
    ds_read_b64_tr_b16 a[244:245], v15 offset:0
    ds_read_b64_tr_b16 a[246:247], v15 offset:1536
    ds_read_b64_tr_b16 a[252:253], v15 offset:32
    ds_read_b64_tr_b16 a[254:255], v15 offset:1568
    ds_read_b64_tr_b16 v[116:117], v15 offset:64
    ds_read_b64_tr_b16 v[118:119], v15 offset:1600
    s_waitcnt lgkmcnt(0)
    s_add_u32 s31, s36, 786432
    s_add_u32 m0, s30, 0
    s_nop 0
    buffer_load_dwordx4 v16, s[8:11], s31 offen lds
    s_add_u32 m0, s30, 1024
    s_nop 0
    buffer_load_dwordx4 v17, s[8:11], s31 offen lds
    s_add_u32 m0, s30, 2048
    s_nop 0
    buffer_load_dwordx4 v18, s[8:11], s31 offen lds
    s_add_u32 s31, s36, 2359296
    s_add_u32 m0, s30, 3072
    s_nop 0
    buffer_load_dwordx4 v16, s[8:11], s31 offen lds
    s_add_u32 m0, s30, 4096
    s_nop 0
    buffer_load_dwordx4 v17, s[8:11], s31 offen lds
    s_add_u32 m0, s30, 5120
    s_nop 0
    buffer_load_dwordx4 v18, s[8:11], s31 offen lds
    s_add_u32 s31, s36, 3932160
    s_add_u32 m0, s30, 6144
    s_nop 0
    buffer_load_dwordx4 v16, s[8:11], s31 offen lds
    s_add_u32 m0, s30, 7168
    s_nop 0
    buffer_load_dwordx4 v17, s[8:11], s31 offen lds
    s_add_u32 m0, s30, 8192
    s_nop 0
    buffer_load_dwordx4 v18, s[8:11], s31 offen lds
    s_add_u32 s31, s36, 5505024
    s_add_u32 m0, s30, 9216
    s_nop 0
    buffer_load_dwordx4 v16, s[8:11], s31 offen lds
    s_add_u32 m0, s30, 10240
    s_nop 0
    buffer_load_dwordx4 v17, s[8:11], s31 offen lds
    s_add_u32 m0, s30, 11264
    s_nop 0
    buffer_load_dwordx4 v18, s[8:11], s31 offen lds
    s_waitcnt vmcnt(12)
    ds_read_b64_tr_b16 a[28:29], v12 offset:12288
    ds_read_b64_tr_b16 a[30:31], v12 offset:13824
    ds_read_b64_tr_b16 a[36:37], v12 offset:12320
    ds_read_b64_tr_b16 a[38:39], v12 offset:13856
    ds_read_b64_tr_b16 v[36:37], v12 offset:12352
    ds_read_b64_tr_b16 v[38:39], v12 offset:13888
    ds_read_b64_tr_b16 a[108:109], v13 offset:12288
    ds_read_b64_tr_b16 a[110:111], v13 offset:13824
    ds_read_b64_tr_b16 a[116:117], v13 offset:12320
    ds_read_b64_tr_b16 a[118:119], v13 offset:13856
    ds_read_b64_tr_b16 v[52:53], v13 offset:12352
    ds_read_b64_tr_b16 v[54:55], v13 offset:13888
    ds_read_b64_tr_b16 a[188:189], v14 offset:12288
    ds_read_b64_tr_b16 a[190:191], v14 offset:13824
    ds_read_b64_tr_b16 a[196:197], v14 offset:12320
    ds_read_b64_tr_b16 a[198:199], v14 offset:13856
    ds_read_b64_tr_b16 v[68:69], v14 offset:12352
    ds_read_b64_tr_b16 v[70:71], v14 offset:13888
    ds_read_b64_tr_b16 v[124:125], v15 offset:12288
    ds_read_b64_tr_b16 v[126:127], v15 offset:13824
    ds_read_b64_tr_b16 v[132:133], v15 offset:12320
    ds_read_b64_tr_b16 v[134:135], v15 offset:13856
    ds_read_b64_tr_b16 v[84:85], v15 offset:12352
    ds_read_b64_tr_b16 v[86:87], v15 offset:13888
    s_waitcnt lgkmcnt(0)
    s_add_u32 s31, s36, 786432
    s_add_u32 m0, s30, 12288
    s_nop 0
    buffer_load_dwordx4 v16, s[12:15], s31 offen lds
    s_add_u32 m0, s30, 13312
    s_nop 0
    buffer_load_dwordx4 v17, s[12:15], s31 offen lds
    s_add_u32 m0, s30, 14336
    s_nop 0
    buffer_load_dwordx4 v18, s[12:15], s31 offen lds
    s_add_u32 s31, s36, 2359296
    s_add_u32 m0, s30, 15360
    s_nop 0
    buffer_load_dwordx4 v16, s[12:15], s31 offen lds
    s_add_u32 m0, s30, 16384
    s_nop 0
    buffer_load_dwordx4 v17, s[12:15], s31 offen lds
    s_add_u32 m0, s30, 17408
    s_nop 0
    buffer_load_dwordx4 v18, s[12:15], s31 offen lds
    s_add_u32 s31, s36, 3932160
    s_add_u32 m0, s30, 18432
    s_nop 0
    buffer_load_dwordx4 v16, s[12:15], s31 offen lds
    s_add_u32 m0, s30, 19456
    s_nop 0
    buffer_load_dwordx4 v17, s[12:15], s31 offen lds
    s_add_u32 m0, s30, 20480
    s_nop 0
    buffer_load_dwordx4 v18, s[12:15], s31 offen lds
    s_add_u32 s31, s36, 5505024
    s_add_u32 m0, s30, 21504
    s_nop 0
    buffer_load_dwordx4 v16, s[12:15], s31 offen lds
    s_add_u32 m0, s30, 22528
    s_nop 0
    buffer_load_dwordx4 v17, s[12:15], s31 offen lds
    s_add_u32 m0, s30, 23552
    s_nop 0
    buffer_load_dwordx4 v18, s[12:15], s31 offen lds
    s_waitcnt vmcnt(12)
    ds_read_b64_tr_b16 a[40:41], v12 offset:0
    ds_read_b64_tr_b16 a[42:43], v12 offset:1536
    ds_read_b64_tr_b16 a[48:49], v12 offset:32
    ds_read_b64_tr_b16 a[50:51], v12 offset:1568
    ds_read_b64_tr_b16 v[40:41], v12 offset:64
    ds_read_b64_tr_b16 v[42:43], v12 offset:1600
    ds_read_b64_tr_b16 a[120:121], v13 offset:0
    ds_read_b64_tr_b16 a[122:123], v13 offset:1536
    ds_read_b64_tr_b16 a[128:129], v13 offset:32
    ds_read_b64_tr_b16 a[130:131], v13 offset:1568
    ds_read_b64_tr_b16 v[56:57], v13 offset:64
    ds_read_b64_tr_b16 v[58:59], v13 offset:1600
    ds_read_b64_tr_b16 a[200:201], v14 offset:0
    ds_read_b64_tr_b16 a[202:203], v14 offset:1536
    ds_read_b64_tr_b16 a[208:209], v14 offset:32
    ds_read_b64_tr_b16 a[210:211], v14 offset:1568
    ds_read_b64_tr_b16 v[72:73], v14 offset:64
    ds_read_b64_tr_b16 v[74:75], v14 offset:1600
    ds_read_b64_tr_b16 v[136:137], v15 offset:0
    ds_read_b64_tr_b16 v[138:139], v15 offset:1536
    ds_read_b64_tr_b16 v[144:145], v15 offset:32
    ds_read_b64_tr_b16 v[146:147], v15 offset:1568
    ds_read_b64_tr_b16 v[88:89], v15 offset:64
    ds_read_b64_tr_b16 v[90:91], v15 offset:1600
    s_waitcnt lgkmcnt(0)
    s_add_u32 s31, s36, 1179648
    s_add_u32 m0, s30, 0
    s_nop 0
    buffer_load_dwordx4 v16, s[8:11], s31 offen lds
    s_add_u32 m0, s30, 1024
    s_nop 0
    buffer_load_dwordx4 v17, s[8:11], s31 offen lds
    s_add_u32 m0, s30, 2048
    s_nop 0
    buffer_load_dwordx4 v18, s[8:11], s31 offen lds
    s_add_u32 s31, s36, 2752512
    s_add_u32 m0, s30, 3072
    s_nop 0
    buffer_load_dwordx4 v16, s[8:11], s31 offen lds
    s_add_u32 m0, s30, 4096
    s_nop 0
    buffer_load_dwordx4 v17, s[8:11], s31 offen lds
    s_add_u32 m0, s30, 5120
    s_nop 0
    buffer_load_dwordx4 v18, s[8:11], s31 offen lds
    s_add_u32 s31, s36, 4325376
    s_add_u32 m0, s30, 6144
    s_nop 0
    buffer_load_dwordx4 v16, s[8:11], s31 offen lds
    s_add_u32 m0, s30, 7168
    s_nop 0
    buffer_load_dwordx4 v17, s[8:11], s31 offen lds
    s_add_u32 m0, s30, 8192
    s_nop 0
    buffer_load_dwordx4 v18, s[8:11], s31 offen lds
    s_add_u32 s31, s36, 5898240
    s_add_u32 m0, s30, 9216
    s_nop 0
    buffer_load_dwordx4 v16, s[8:11], s31 offen lds
    s_add_u32 m0, s30, 10240
    s_nop 0
    buffer_load_dwordx4 v17, s[8:11], s31 offen lds
    s_add_u32 m0, s30, 11264
    s_nop 0
    buffer_load_dwordx4 v18, s[8:11], s31 offen lds
    s_waitcnt vmcnt(12)
    ds_read_b64_tr_b16 a[56:57], v12 offset:12288
    ds_read_b64_tr_b16 a[58:59], v12 offset:13824
    ds_read_b64_tr_b16 a[64:65], v12 offset:12320
    ds_read_b64_tr_b16 a[66:67], v12 offset:13856
    ds_read_b64_tr_b16 a[72:73], v12 offset:12352
    ds_read_b64_tr_b16 a[74:75], v12 offset:13888
    ds_read_b64_tr_b16 a[136:137], v13 offset:12288
    ds_read_b64_tr_b16 a[138:139], v13 offset:13824
    ds_read_b64_tr_b16 a[144:145], v13 offset:12320
    ds_read_b64_tr_b16 a[146:147], v13 offset:13856
    ds_read_b64_tr_b16 a[152:153], v13 offset:12352
    ds_read_b64_tr_b16 a[154:155], v13 offset:13888
    ds_read_b64_tr_b16 a[216:217], v14 offset:12288
    ds_read_b64_tr_b16 a[218:219], v14 offset:13824
    ds_read_b64_tr_b16 a[224:225], v14 offset:12320
    ds_read_b64_tr_b16 a[226:227], v14 offset:13856
    ds_read_b64_tr_b16 a[232:233], v14 offset:12352
    ds_read_b64_tr_b16 a[234:235], v14 offset:13888
    ds_read_b64_tr_b16 v[152:153], v15 offset:12288
    ds_read_b64_tr_b16 v[154:155], v15 offset:13824
    ds_read_b64_tr_b16 v[160:161], v15 offset:12320
    ds_read_b64_tr_b16 v[162:163], v15 offset:13856
    ds_read_b64_tr_b16 v[168:169], v15 offset:12352
    ds_read_b64_tr_b16 v[170:171], v15 offset:13888
    s_waitcnt lgkmcnt(0)
    s_add_u32 s31, s36, 1179648
    s_add_u32 m0, s30, 12288
    s_nop 0
    buffer_load_dwordx4 v16, s[12:15], s31 offen lds
    s_add_u32 m0, s30, 13312
    s_nop 0
    buffer_load_dwordx4 v17, s[12:15], s31 offen lds
    s_add_u32 m0, s30, 14336
    s_nop 0
    buffer_load_dwordx4 v18, s[12:15], s31 offen lds
    s_add_u32 s31, s36, 2752512
    s_add_u32 m0, s30, 15360
    s_nop 0
    buffer_load_dwordx4 v16, s[12:15], s31 offen lds
    s_add_u32 m0, s30, 16384
    s_nop 0
    buffer_load_dwordx4 v17, s[12:15], s31 offen lds
    s_add_u32 m0, s30, 17408
    s_nop 0
    buffer_load_dwordx4 v18, s[12:15], s31 offen lds
    s_add_u32 s31, s36, 4325376
    s_add_u32 m0, s30, 18432
    s_nop 0
    buffer_load_dwordx4 v16, s[12:15], s31 offen lds
    s_add_u32 m0, s30, 19456
    s_nop 0
    buffer_load_dwordx4 v17, s[12:15], s31 offen lds
    s_add_u32 m0, s30, 20480
    s_nop 0
    buffer_load_dwordx4 v18, s[12:15], s31 offen lds
    s_add_u32 s31, s36, 5898240
    s_add_u32 m0, s30, 21504
    s_nop 0
    buffer_load_dwordx4 v16, s[12:15], s31 offen lds
    s_add_u32 m0, s30, 22528
    s_nop 0
    buffer_load_dwordx4 v17, s[12:15], s31 offen lds
    s_add_u32 m0, s30, 23552
    s_nop 0
    buffer_load_dwordx4 v18, s[12:15], s31 offen lds
    s_waitcnt vmcnt(12)
    ds_read_b64_tr_b16 a[44:45], v12 offset:0
    ds_read_b64_tr_b16 a[46:47], v12 offset:1536
    ds_read_b64_tr_b16 a[52:53], v12 offset:32
    ds_read_b64_tr_b16 a[54:55], v12 offset:1568
    ds_read_b64_tr_b16 v[44:45], v12 offset:64
    ds_read_b64_tr_b16 v[46:47], v12 offset:1600
    ds_read_b64_tr_b16 a[124:125], v13 offset:0
    ds_read_b64_tr_b16 a[126:127], v13 offset:1536
    ds_read_b64_tr_b16 a[132:133], v13 offset:32
    ds_read_b64_tr_b16 a[134:135], v13 offset:1568
    ds_read_b64_tr_b16 v[60:61], v13 offset:64
    ds_read_b64_tr_b16 v[62:63], v13 offset:1600
    ds_read_b64_tr_b16 a[204:205], v14 offset:0
    ds_read_b64_tr_b16 a[206:207], v14 offset:1536
    ds_read_b64_tr_b16 a[212:213], v14 offset:32
    ds_read_b64_tr_b16 a[214:215], v14 offset:1568
    ds_read_b64_tr_b16 v[76:77], v14 offset:64
    ds_read_b64_tr_b16 v[78:79], v14 offset:1600
    ds_read_b64_tr_b16 v[140:141], v15 offset:0
    ds_read_b64_tr_b16 v[142:143], v15 offset:1536
    ds_read_b64_tr_b16 v[148:149], v15 offset:32
    ds_read_b64_tr_b16 v[150:151], v15 offset:1568
    ds_read_b64_tr_b16 v[92:93], v15 offset:64
    ds_read_b64_tr_b16 v[94:95], v15 offset:1600
    s_waitcnt lgkmcnt(0)
    v_and_b32 v8, 7, v1
    v_lshlrev_b32 v8, 3, v8
    v_add_u32 v8, s63, v8
    global_load_dwordx2 v[10:11], v8, s[48:49] sc1
    s_add_u32 s31, s36, 6291456
    s_add_u32 m0, s30, 0
    s_nop 0
    buffer_load_dwordx4 v16, s[8:11], s31 offen lds
    s_add_u32 m0, s30, 1024
    s_nop 0
    buffer_load_dwordx4 v17, s[8:11], s31 offen lds
    s_add_u32 m0, s30, 2048
    s_nop 0
    buffer_load_dwordx4 v18, s[8:11], s31 offen lds
    s_add_u32 s31, s36, 7077888
    s_add_u32 m0, s30, 3072
    s_nop 0
    buffer_load_dwordx4 v16, s[8:11], s31 offen lds
    s_add_u32 m0, s30, 4096
    s_nop 0
    buffer_load_dwordx4 v17, s[8:11], s31 offen lds
    s_add_u32 m0, s30, 5120
    s_nop 0
    buffer_load_dwordx4 v18, s[8:11], s31 offen lds
    s_add_u32 s31, s36, 6291456
    s_add_u32 m0, s30, 6144
    s_nop 0
    buffer_load_dwordx4 v16, s[12:15], s31 offen lds
    s_add_u32 m0, s30, 7168
    s_nop 0
    buffer_load_dwordx4 v17, s[12:15], s31 offen lds
    s_add_u32 m0, s30, 8192
    s_nop 0
    buffer_load_dwordx4 v18, s[12:15], s31 offen lds
    s_add_u32 s31, s36, 7077888
    s_add_u32 m0, s30, 9216
    s_nop 0
    buffer_load_dwordx4 v16, s[12:15], s31 offen lds
    s_add_u32 m0, s30, 10240
    s_nop 0
    buffer_load_dwordx4 v17, s[12:15], s31 offen lds
    s_add_u32 m0, s30, 11264
    s_nop 0
    buffer_load_dwordx4 v18, s[12:15], s31 offen lds
    s_waitcnt vmcnt(13)
    ds_read_b64_tr_b16 a[60:61], v12 offset:12288
    ds_read_b64_tr_b16 a[62:63], v12 offset:13824
    ds_read_b64_tr_b16 a[68:69], v12 offset:12320
    ds_read_b64_tr_b16 a[70:71], v12 offset:13856
    ds_read_b64_tr_b16 a[76:77], v12 offset:12352
    ds_read_b64_tr_b16 a[78:79], v12 offset:13888
    ds_read_b64_tr_b16 a[140:141], v13 offset:12288
    ds_read_b64_tr_b16 a[142:143], v13 offset:13824
    ds_read_b64_tr_b16 a[148:149], v13 offset:12320
    ds_read_b64_tr_b16 a[150:151], v13 offset:13856
    ds_read_b64_tr_b16 a[156:157], v13 offset:12352
    ds_read_b64_tr_b16 a[158:159], v13 offset:13888
    ds_read_b64_tr_b16 a[220:221], v14 offset:12288
    ds_read_b64_tr_b16 a[222:223], v14 offset:13824
    ds_read_b64_tr_b16 a[228:229], v14 offset:12320
    ds_read_b64_tr_b16 a[230:231], v14 offset:13856
    ds_read_b64_tr_b16 a[236:237], v14 offset:12352
    ds_read_b64_tr_b16 a[238:239], v14 offset:13888
    ds_read_b64_tr_b16 v[156:157], v15 offset:12288
    ds_read_b64_tr_b16 v[158:159], v15 offset:13824
    ds_read_b64_tr_b16 v[164:165], v15 offset:12320
    ds_read_b64_tr_b16 v[166:167], v15 offset:13856
    ds_read_b64_tr_b16 v[172:173], v15 offset:12352
    ds_read_b64_tr_b16 v[174:175], v15 offset:13888
    s_waitcnt lgkmcnt(0)
    s_add_u32 s31, s36, 6684672
    s_add_u32 m0, s30, 12288
    s_nop 0
    buffer_load_dwordx4 v16, s[8:11], s31 offen lds
    s_add_u32 m0, s30, 13312
    s_nop 0
    buffer_load_dwordx4 v17, s[8:11], s31 offen lds
    s_add_u32 m0, s30, 14336
    s_nop 0
    buffer_load_dwordx4 v18, s[8:11], s31 offen lds
    s_add_u32 s31, s36, 7471104
    s_add_u32 m0, s30, 15360
    s_nop 0
    buffer_load_dwordx4 v16, s[8:11], s31 offen lds
    s_add_u32 m0, s30, 16384
    s_nop 0
    buffer_load_dwordx4 v17, s[8:11], s31 offen lds
    s_add_u32 m0, s30, 17408
    s_nop 0
    buffer_load_dwordx4 v18, s[8:11], s31 offen lds
    s_add_u32 s31, s36, 6684672
    s_add_u32 m0, s30, 18432
    s_nop 0
    buffer_load_dwordx4 v16, s[12:15], s31 offen lds
    s_add_u32 m0, s30, 19456
    s_nop 0
    buffer_load_dwordx4 v17, s[12:15], s31 offen lds
    s_add_u32 m0, s30, 20480
    s_nop 0
    buffer_load_dwordx4 v18, s[12:15], s31 offen lds
    s_add_u32 s31, s36, 7471104
    s_add_u32 m0, s30, 21504
    s_nop 0
    buffer_load_dwordx4 v16, s[12:15], s31 offen lds
    s_add_u32 m0, s30, 22528
    s_nop 0
    buffer_load_dwordx4 v17, s[12:15], s31 offen lds
    s_add_u32 m0, s30, 23552
    s_nop 0
    buffer_load_dwordx4 v18, s[12:15], s31 offen lds
    s_waitcnt vmcnt(21)
    ds_read_b64_tr_b16 v[176:177], v31 offset:0
    ds_read_b64_tr_b16 v[178:179], v31 offset:1536
    ds_read_b64_tr_b16 v[184:185], v31 offset:32
    ds_read_b64_tr_b16 v[186:187], v31 offset:1568
    ds_read_b64_tr_b16 v[192:193], v31 offset:64
    ds_read_b64_tr_b16 v[194:195], v31 offset:1600
    v_not_b32 v10, v10
    v_xor_b32 v9, 0x2000, v11
    v_or_b32 v10, v10, v9
    v_cmp_ne_u32 vcc, 0, v10
    s_mov_b64 s[56:57], vcc
    v_lshlrev_b32 v8, 2, v1
    s_mov_b32 s34, 54525952
    buffer_load_dword v9, v8, s[4:7], s34 offen sc1
    s_waitcnt vmcnt(19)
    ds_read_b64_tr_b16 v[216:217], v31 offset:3072
    ds_read_b64_tr_b16 v[218:219], v31 offset:4608
    ds_read_b64_tr_b16 v[224:225], v31 offset:3104
    ds_read_b64_tr_b16 v[226:227], v31 offset:4640
    ds_read_b64_tr_b16 v[104:105], v31 offset:3136
    ds_read_b64_tr_b16 v[106:107], v31 offset:4672
    s_waitcnt vmcnt(16)
    ds_read_b64_tr_b16 v[200:201], v31 offset:6144
    ds_read_b64_tr_b16 v[202:203], v31 offset:7680
    ds_read_b64_tr_b16 v[208:209], v31 offset:6176
    ds_read_b64_tr_b16 v[210:211], v31 offset:7712
    ds_read_b64_tr_b16 v[96:97], v31 offset:6208
    ds_read_b64_tr_b16 v[98:99], v31 offset:7744
    s_waitcnt vmcnt(13)
    ds_read_b64_tr_b16 v[232:233], v31 offset:9216
    ds_read_b64_tr_b16 v[234:235], v31 offset:10752
    ds_read_b64_tr_b16 v[240:241], v31 offset:9248
    ds_read_b64_tr_b16 v[242:243], v31 offset:10784
    ds_read_b64_tr_b16 v[248:249], v31 offset:9280
    ds_read_b64_tr_b16 v[250:251], v31 offset:10816
    s_waitcnt vmcnt(10)
    ds_read_b64_tr_b16 v[180:181], v31 offset:12288
    ds_read_b64_tr_b16 v[182:183], v31 offset:13824
    ds_read_b64_tr_b16 v[188:189], v31 offset:12320
    ds_read_b64_tr_b16 v[190:191], v31 offset:13856
    ds_read_b64_tr_b16 v[196:197], v31 offset:12352
    ds_read_b64_tr_b16 v[198:199], v31 offset:13888
    s_waitcnt vmcnt(7)
    ds_read_b64_tr_b16 v[220:221], v31 offset:15360
    ds_read_b64_tr_b16 v[222:223], v31 offset:16896
    ds_read_b64_tr_b16 v[228:229], v31 offset:15392
    ds_read_b64_tr_b16 v[230:231], v31 offset:16928
    ds_read_b64_tr_b16 v[108:109], v31 offset:15424
    ds_read_b64_tr_b16 v[110:111], v31 offset:16960
    s_waitcnt vmcnt(4)
    ds_read_b64_tr_b16 v[204:205], v31 offset:18432
    ds_read_b64_tr_b16 v[206:207], v31 offset:19968
    ds_read_b64_tr_b16 v[212:213], v31 offset:18464
    ds_read_b64_tr_b16 v[214:215], v31 offset:20000
    ds_read_b64_tr_b16 v[100:101], v31 offset:18496
    ds_read_b64_tr_b16 v[102:103], v31 offset:20032
    s_waitcnt vmcnt(1)
    ds_read_b64_tr_b16 v[236:237], v31 offset:21504
    ds_read_b64_tr_b16 v[238:239], v31 offset:23040
    ds_read_b64_tr_b16 v[244:245], v31 offset:21536
    ds_read_b64_tr_b16 v[246:247], v31 offset:23072
    ds_read_b64_tr_b16 v[252:253], v31 offset:21568
    ds_read_b64_tr_b16 v[254:255], v31 offset:23104
    s_waitcnt lgkmcnt(0)
    s_barrier
    ds_write_b128 v30, v[32:35] offset:0
    ds_write_b128 v30, v[36:39] offset:1024
    ds_write_b128 v30, v[40:43] offset:2048
    ds_write_b128 v30, v[44:47] offset:3072
    ds_write_b128 v30, v[48:51] offset:4096
    ds_write_b128 v30, v[52:55] offset:5120
    ds_write_b128 v30, v[56:59] offset:6144
    ds_write_b128 v30, v[60:63] offset:7168
    ds_write_b128 v30, v[64:67] offset:8192
    ds_write_b128 v30, v[68:71] offset:9216
    ds_write_b128 v30, v[72:75] offset:10240
    ds_write_b128 v30, v[76:79] offset:11264
    ds_write_b128 v30, v[80:83] offset:12288
    ds_write_b128 v30, v[84:87] offset:13312
    ds_write_b128 v30, v[88:91] offset:14336
    ds_write_b128 v30, v[92:95] offset:15360
    ds_write_b128 v30, v[96:99] offset:16384
    ds_write_b128 v30, v[100:103] offset:17408
    ds_write_b128 v30, v[104:107] offset:18432
    ds_write_b128 v30, v[108:111] offset:19456
    s_cmp_eq_u64 s[56:57], 0
    s_cbranch_scc1 LD_ok_1
    v_and_b32 v4, 7, v1
    v_lshlrev_b32 v4, 3, v4
    v_add_u32 v4, s63, v4
    s_mov_b32 s35, 0
WI_3:
    global_load_dwordx2 v[6:7], v4, s[48:49] sc1
    s_waitcnt vmcnt(0)
    v_not_b32 v6, v6
    v_xor_b32 v5, 0x2000, v7
    v_or_b32 v6, v6, v5
    v_cmp_ne_u32 vcc, 0, v6
    s_cbranch_vccz WG_4
    v_lshrrev_b32 v7, 8, v7
    s_mov_b32 s30, 0
    v_readlane_b32 s31, v7, 0
    s_add_u32 s30, s30, s31
    v_readlane_b32 s31, v7, 1
    s_add_u32 s30, s30, s31
    v_readlane_b32 s31, v7, 2
    s_add_u32 s30, s30, s31
    v_readlane_b32 s31, v7, 3
    s_add_u32 s30, s30, s31
    v_readlane_b32 s31, v7, 4
    s_add_u32 s30, s30, s31
    v_readlane_b32 s31, v7, 5
    s_add_u32 s30, s30, s31
    v_readlane_b32 s31, v7, 6
    s_add_u32 s30, s30, s31
    v_readlane_b32 s31, v7, 7
    s_add_u32 s30, s30, s31
    s_cmp_ge_u32 s30, 256
    s_cbranch_scc1 M_again
    s_sleep 20
    s_add_u32 s35, s35, 1
    s_cmp_lt_u32 s35, 200000
    s_cbranch_scc1 WI_3
    s_branch M_fail
WG_4:
    v_lshlrev_b32 v4, 2, v1
    s_mov_b32 s34, 54525952
    buffer_load_dword v5, v4, s[4:7], s34 offen sc1
    s_waitcnt vmcnt(0)
    v_and_b32 v4, 2, v5
    v_cmp_eq_u32 vcc, 2, v4
    v_and_b32 v5, 1, v5
    v_cmp_eq_u32 s[20:21], 1, v5
    s_nop 3
    s_and_b32 s20, s20, 0x3ffffff
    s_xor_b32 s21, s20, 0x1555555
    s_bcnt1_i32_b32 s21, s21
    s_cmp_le_u32 s21, 5
    s_cselect_b32 s20, 0x1555555, s20
    s_cmp_ge_u32 s21, 21
    s_cselect_b32 s20, 0x2aaaaaa, s20
    s_and_b32 s21, vcc_lo, 0x1ff
    s_bcnt1_i32_b32 s21, s21
    s_cmp_ge_u32 s21, 5
    s_cselect_b32 s21, 16384, 0
    s_branch LD_dn_2
LD_ok_1:
    s_waitcnt vmcnt(0)
    v_and_b32 v8, 2, v9
    v_cmp_eq_u32 vcc, 2, v8
    v_and_b32 v9, 1, v9
    v_cmp_eq_u32 s[20:21], 1, v9
    s_nop 3
    s_and_b32 s20, s20, 0x3ffffff
    s_xor_b32 s21, s20, 0x1555555
    s_bcnt1_i32_b32 s21, s21
    s_cmp_le_u32 s21, 5
    s_cselect_b32 s20, 0x1555555, s20
    s_cmp_ge_u32 s21, 21
    s_cselect_b32 s20, 0x2aaaaaa, s20
    s_and_b32 s21, vcc_lo, 0x1ff
    s_bcnt1_i32_b32 s21, s21
    s_cmp_ge_u32 s21, 5
    s_cselect_b32 s21, 16384, 0
LD_dn_2:
    s_waitcnt lgkmcnt(0)
    v_and_b32 v100, 2, v1
    v_cmp_eq_u32 vcc, 0, v100
    v_mov_b32 v100, 0x4444
    v_mov_b32 v101, 0xeeee
    v_cndmask_b32 v3, v101, v100, vcc
    s_lshl_b32 s30, s16, 11
    s_lshl_b32 s31, s16, 9
    v_add_u32 v4, s30, v2
    v_add_u32 v5, s31, v2
    v_add_u32 v4, 16384, v4
    v_add_u32 v5, 49152, v5
    s_add_u32 s52, s30, 81920
    s_add_u32 s53, s31, 90112
    s_xor_b32 s31, s30, 2048
    s_add_u32 s31, s31, 81920
    v_add_u32 v9, s31, v2
    s_xor_b32 s31, s30, 4096
    s_add_u32 s31, s31, 81920
    v_add_u32 v10, s31, v2
    s_xor_b32 s31, s30, 6144
    s_add_u32 s31, s31, 81920
    v_add_u32 v11, s31, v2
    v_add_u32 v13, 90112, v2
    s_mul_i32 s30, s16, 20480
    v_add_u32 v12, s30, v2
    s_lshl_b32 s30, s16, 3
    v_add_u32 v0, s30, v1
    s_lshl_b32 s30, s16, 1
    s_add_u32 s30, s30, 24
    v_add_u32 v100, s30, v1
    v_cmp_gt_u32 vcc, 8, v1
    s_nop 1
    v_cndmask_b32 v0, v100, v0, vcc
    v_lshlrev_b32 v0, 7, v0
    s_xor_b32 s70, s21, 638976
    s_lshr_b32 s29, s20, 0
    s_and_b32 s29, s29, 1
    s_lshl_b32 s29, s29, 13
    s_add_u32 s70, s70, s29
    v_lshrrev_b32 v101, 4, v1
    v_and_b32 v14, 0xff, v2
    v_lshlrev_b32 v102, 2, v101
    v_add_u32 v14, v14, v102
    s_mul_i32 s30, s16, 768
    s_add_u32 s30, s30, 119808
    v_add_u32 v14, s30, v14
    v_lshrrev_b32 v100, 2, v1
    v_lshlrev_b32 v100, 4, v100
    v_and_b32 v102, 1, v1
    v_lshlrev_b32 v102, 3, v102
    v_add_u32 v15, v100, v102
    v_add_u32 v15, 119808, v15
    v_and_b32 v100, 12, v1
    v_lshlrev_b32 v100, 5, v100
    v_and_b32 v102, 1, v1
    v_lshlrev_b32 v102, 5, v102
    v_add_u32 v100, v100, v102
    v_lshlrev_b32 v102, 3, v101
    v_and_b32 v103, 2, v1
    v_lshlrev_b32 v103, 1, v103
    v_add3_u32 v100, v100, v102, v103
    s_mul_i32 s30, s16, 3
    s_add_u32 s30, s30, 0
    s_lshr_b32 s31, s30, 1
    s_lshl_b32 s31, s31, 9
    s_and_b32 s30, s30, 1
    s_lshl_b32 s30, s30, 6
    s_add_u32 s30, s30, s31
    s_add_u32 s30, s30, 116736
    v_add_u32 v108, s30, v100
    s_mul_i32 s30, s16, 3
    s_add_u32 s30, s30, 1
    s_lshr_b32 s31, s30, 1
    s_lshl_b32 s31, s31, 9
    s_and_b32 s30, s30, 1
    s_lshl_b32 s30, s30, 6
    s_add_u32 s30, s30, s31
    s_add_u32 s30, s30, 116736
    v_add_u32 v109, s30, v100
    s_mul_i32 s30, s16, 3
    s_add_u32 s30, s30, 2
    s_lshr_b32 s31, s30, 1
    s_lshl_b32 s31, s31, 9
    s_and_b32 s30, s30, 1
    s_lshl_b32 s30, s30, 6
    s_add_u32 s30, s30, s31
    s_add_u32 s30, s30, 116736
    v_add_u32 v110, s30, v100
    v_lshlrev_b32 v100, 8, v101
    v_and_b32 v102, 15, v1
    v_lshlrev_b32 v102, 3, v102
    v_add_u32 v111, v100, v102
    v_add_u32 v111, 116736, v111
    s_lshr_b32 s30, s17, 3
    s_mul_i32 s30, s30, 5120
    s_and_b32 s31, s17, 7
    s_lshl_b32 s32, s31, 9
    s_add_u32 s32, s32, s30
    s_lshl_b32 s31, s31, 7
    s_add_u32 s31, s31, s30
    s_add_u32 s31, s31, 4096
    v_and_b32 v100, 8, v1
    v_and_b32 v102, 48, v1
    v_and_b32 v103, 7, v1
    v_lshlrev_b32 v103, 1, v103
    v_add_u32 v102, v102, v103
    s_lshl_b32 s33, s16, 6
    s_add_u32 s33, s33, s31
    v_add_u32 v8, s33, v102
    s_lshl_b32 s33, s16, 7
    s_add_u32 s33, s33, s32
    v_lshlrev_b32 v7, 5, v100
    v_lshlrev_b32 v102, 1, v102
    v_add3_u32 v7, v7, v102, s33
    v_lshrrev_b32 v103, 13, v7
    v_mul_u32_u24 v103, 24576, v103
    v_add_u32 v7, v7, v103
    v_lshrrev_b32 v103, 13, v8
    v_mul_u32_u24 v103, 24576, v103
    v_add_u32 v8, v8, v103
    s_mul_i32 s33, s16, 20
    v_add_u32 v0, s33, v1
    v_lshlrev_b32 v0, 7, v0
    s_cmp_lt_u32 s16, 2
    s_cbranch_scc1 QK_set1
    v_add_u32 v0, s32, v2
    s_sub_u32 s31, s31, 512
    v_add_u32 v8, s31, v2
    v_cmp_gt_u32 vcc, 32, v1
    s_nop 1
    v_cndmask_b32 v0, v8, v0, vcc
    v_lshrrev_b32 v103, 13, v0
    v_mul_u32_u24 v103, 24576, v103
    v_add_u32 v0, v0, v103
    v_and_b32 v100, 56, v1
    v_and_b32 v102, 4, v1
    v_lshrrev_b32 v102, 1, v102
    v_add_u32 v100, v100, v102
    v_and_b32 v102, 2, v1
    v_lshlrev_b32 v102, 1, v102
    s_and_b32 s30, s16, 1
    v_add3_u32 v100, v100, v102, s30
    v_lshlrev_b32 v100, 4, v100
    v_and_b32 v102, 1, v1
    v_mul_u32_u24 v102, 6144, v102
    v_add_u32 v7, v100, v102
    v_and_b32 v8, 1, v1
    v_lshlrev_b32 v8, 2, v8
QK_set1:
    s_mov_b32 s72, 0x7ffffff0
    s_xor_b32 s71, s21, 622592
    s_lshr_b32 s29, s20, 0
    s_and_b32 s29, s29, 1
    s_lshl_b32 s29, s29, 13
    s_add_u32 s71, s71, s29
    s_lshl_b32 s30, s17, 7
    s_add_u32 s71, s71, s30
    s_cmp_eq_u32 s16, 1
    s_cselect_b32 s71, s71, 0x7ffffff0
    s_mov_b32 s37, 0x3dd53b95
    s_mov_b32 s54, 0xff00ff00
    s_mov_b32 s55, 0xff00ff00
    s_mov_b32 s56, 0x00550055
    s_mov_b32 s57, 0x00550055
    s_mov_b32 s58, 0x42700000
    s_barrier
    s_mov_b32 s19, 0
    s_mov_b32 s24, 54722560
    s_cmp_lt_u32 s16, 2
    s_cbranch_scc1 QK_step
    s_lshl_b32 s30, s19, 5
    s_add_u32 s30, s30, s17
    s_lshl_b32 s31, s30, 4
    s_add_u32 s31, s31, 54530056
    s_mul_i32 s30, s30, 12288
    s_add_u32 s30, s30, 95420416
    s_and_b32 s32, s19, 1
    s_mul_i32 s32, s32, 12288
    s_and_b32 s33, s16, 1
    s_mul_i32 s33, s33, 6144
    s_add_u32 s32, s32, s33
    s_add_u32 s32, s32, 92160
    s_mov_b32 s35, 0
QK_k0_f:
    buffer_load_dword v106, v8, s[4:7], s31 offen sc1
    s_waitcnt vmcnt(0)
    v_cmp_eq_u32 vcc, 0, v106
    s_cbranch_vccz QK_k0_g
    s_sleep 2
    s_add_u32 s35, s35, 1
    s_cmp_lt_u32 s35, 200000
    s_cbranch_scc1 QK_k0_f
    s_branch M_fail
QK_k0_g:
    s_add_u32 m0, s32, 0
    s_nop 0
    buffer_load_dwordx4 v7, s[4:7], s30 offen sc1 lds
    s_add_u32 s30, s30, 1024
    s_add_u32 m0, s32, 1024
    s_nop 0
    buffer_load_dwordx4 v7, s[4:7], s30 offen sc1 lds
    s_add_u32 s30, s30, 1024
    s_add_u32 m0, s32, 2048
    s_nop 0
    buffer_load_dwordx4 v7, s[4:7], s30 offen sc1 lds
    s_add_u32 s30, s30, 1024
    s_add_u32 m0, s32, 3072
    s_nop 0
    buffer_load_dwordx4 v7, s[4:7], s30 offen sc1 lds
    s_add_u32 s30, s30, 1024
    s_add_u32 m0, s32, 4096
    s_nop 0
    buffer_load_dwordx4 v7, s[4:7], s30 offen sc1 lds
    s_add_u32 s30, s30, 1024
    s_add_u32 m0, s32, 5120
    s_nop 0
    buffer_load_dwordx4 v7, s[4:7], s30 offen sc1 lds
    s_add_u32 s30, s30, 1024
    buffer_load_dword v106, v8, s[4:7], s31 offen offset:512 sc1
QK_step:
    s_mov_b32 s35, 0
QK_pre:
    v_mov_b64 v[60:61], 0
    v_mov_b64 v[62:63], 0
    v_mov_b64 v[64:65], 0
    v_mov_b64 v[66:67], 0
    v_mov_b64 v[68:69], 0
    v_mov_b64 v[70:71], 0
    v_mov_b64 v[72:73], 0
    v_mov_b64 v[74:75], 0
    v_mov_b64 v[76:77], 0
    v_mov_b64 v[78:79], 0
    v_mov_b64 v[80:81], 0
    v_mov_b64 v[82:83], 0
    ds_read_b128 v[84:87], v12 offset:2048
    ds_read_b128 v[88:91], v12 offset:3072
    ds_read_b128 v[92:95], v12 offset:6144
    ds_read_b128 v[96:99], v12 offset:7168
    s_waitcnt lgkmcnt(0)
    s_cmp_lg_u32 s35, 0
    s_cbranch_scc1 QK_late
    s_cmp_ge_u32 s16, 2
    s_cbranch_scc1 QK_hub
    s_mov_b32 s35, 0
    s_mov_b64 exec, 0xfffff
    buffer_load_dword v16, v0, s[4:7], s70 offen sc1
    s_sleep 1
    buffer_load_dword v17, v0, s[4:7], s70 offen sc1
    s_sleep 1
    buffer_load_dword v18, v0, s[4:7], s70 offen sc1
    s_sleep 1
QK_hu:
    buffer_load_dword v19, v0, s[4:7], s70 offen sc1
    s_waitcnt vmcnt(3)
    v_cmp_gt_u32 vcc, s19, v16
    s_cbranch_vccz QK_hud
    buffer_load_dword v16, v0, s[4:7], s70 offen sc1
    s_waitcnt vmcnt(3)
    v_cmp_gt_u32 vcc, s19, v17
    s_cbranch_vccz QK_hud
    buffer_load_dword v17, v0, s[4:7], s70 offen sc1
    s_waitcnt vmcnt(3)
    v_cmp_gt_u32 vcc, s19, v18
    s_cbranch_vccz QK_hud
    buffer_load_dword v18, v0, s[4:7], s70 offen sc1
    s_waitcnt vmcnt(3)
    v_cmp_gt_u32 vcc, s19, v19
    s_cbranch_vccz QK_hud
    s_add_u32 s35, s35, 1
    s_cmp_lt_u32 s35, 200000
    s_cbranch_scc1 QK_hu
    s_branch M_fail
QK_hud:
    s_mov_b32 s35, 0
    s_mov_b64 exec, -1
QK_hub:
    s_barrier
QK_late:
    s_lshr_b32 s28, s19, 4
    s_lshl_b32 s25, s19, 17
    s_lshr_b32 s29, s20, s28
    s_and_b32 s29, s29, 1
    s_lshl_b32 s29, s29, 13
    s_add_u32 s25, s25, s29
    s_lshl_b32 s29, s19, 12
    s_xor_b32 s29, s29, s21
    s_and_b32 s29, s29, 16384
    s_add_u32 s25, s25, s29
    s_and_b32 s30, s19, 1
    s_mul_i32 s30, s30, 12288
    s_add_u32 s30, s30, 92160
    v_add_u32 v6, s30, v2
    v_add_u32 v24, s52, v2
    s_add_u32 s30, s19, 1
    v_mov_b32 v107, s30
QK_poll:
    s_mov_b32 m0, s52
    s_add_u32 s35, s35, 1
    buffer_load_dwordx4 v4, s[4:7], s24 offen sc1 lds
    buffer_load_dwordx4 v4, s[4:7], s24 offen offset:1024 sc1 lds
    s_mov_b32 m0, s53
    s_mov_b32 exec_hi, 0
    buffer_load_dwordx4 v5, s[4:7], s24 offen sc1 lds
    s_mov_b32 exec_hi, -1
    s_cmp_ge_u32 s35, 200000
    s_cbranch_scc1 M_fail
    s_waitcnt vmcnt(2)
    ds_read_b128 v[16:19], v24 offset:0
    s_waitcnt vmcnt(1)
    ds_read_b128 v[20:23], v24 offset:1024
    s_waitcnt lgkmcnt(1)
    v_smfmac_f32_16x16x64_bf16 v[60:63], v[16:19], a[0:7], v3
    v_smfmac_f32_16x16x64_bf16 v[64:67], v[16:19], a[8:15], v3
    s_waitcnt vmcnt(0)
    s_barrier
    ds_read_b128 v[28:31], v9 offset:0
    v_smfmac_f32_16x16x64_bf16 v[68:71], v[16:19], a[16:23], v3
    s_waitcnt lgkmcnt(1)
    ds_read_b128 v[32:35], v9 offset:1024
    v_smfmac_f32_16x16x64_bf16 v[60:63], v[20:23], a[40:47], v3
    ds_read_b128 v[36:39], v10 offset:0
    v_smfmac_f32_16x16x64_bf16 v[64:67], v[20:23], a[48:55], v3
    ds_read_b128 v[40:43], v10 offset:1024
    v_smfmac_f32_16x16x64_bf16 v[68:71], v[20:23], v[84:91], v3
    s_waitcnt lgkmcnt(3)
    ds_read_b128 v[44:47], v11 offset:0
    v_smfmac_f32_16x16x64_bf16 v[60:63], v[28:31], a[80:87], v3
    ds_read_b128 v[48:51], v11 offset:1024
    v_smfmac_f32_16x16x64_bf16 v[64:67], v[28:31], a[88:95], v3
    ds_read_b128 v[52:55], v13 offset:0
    v_max3_u32 v100, v19, v23, v31
    v_smfmac_f32_16x16x64_bf16 v[68:71], v[28:31], a[96:103], v3
    s_waitcnt lgkmcnt(5)
    ds_read_b128 v[56:59], v13 offset:1024
    v_smfmac_f32_16x16x64_bf16 v[60:63], v[32:35], a[120:127], v3
    ds_read_b128 v[84:87], v12 offset:10240
    v_smfmac_f32_16x16x64_bf16 v[64:67], v[32:35], a[128:135], v3
    ds_read_b128 v[88:91], v12 offset:11264
    s_waitcnt lgkmcnt(7)
    v_max3_u32 v100, v100, v35, v39
    v_smfmac_f32_16x16x64_bf16 v[68:71], v[32:35], v[92:99], v3
    ds_read_b128 v[92:95], v12 offset:14336
    v_smfmac_f32_16x16x64_bf16 v[60:63], v[36:39], a[160:167], v3
    ds_read_b128 v[96:99], v12 offset:15360
    v_smfmac_f32_16x16x64_bf16 v[64:67], v[36:39], a[168:175], v3
    s_waitcnt lgkmcnt(7)
    v_max3_u32 v100, v100, v43, v47
    v_smfmac_f32_16x16x64_bf16 v[68:71], v[36:39], a[176:183], v3
    s_waitcnt lgkmcnt(5)
    v_max3_u32 v100, v100, v51, v55
    v_smfmac_f32_16x16x64_bf16 v[60:63], v[40:43], a[200:207], v3
    s_waitcnt lgkmcnt(4)
    v_max_u32 v100, v100, v59
    v_smfmac_f32_16x16x64_bf16 v[64:67], v[40:43], a[208:215], v3
    s_waitcnt lgkmcnt(2)
    v_cmp_eq_u32 vcc, -1, v100
    v_smfmac_f32_16x16x64_bf16 v[68:71], v[40:43], v[84:91], v3
    ds_read_b128 v[84:87], v12 offset:18432
    v_smfmac_f32_16x16x64_bf16 v[60:63], v[44:47], a[240:247], v3
    ds_read_b128 v[88:91], v12 offset:19456
    v_smfmac_f32_16x16x64_bf16 v[64:67], v[44:47], a[248:255], v3
    s_cbranch_vccnz QK_redo
    v_smfmac_f32_16x16x64_bf16 v[68:71], v[44:47], v[112:119], v3
    v_smfmac_f32_16x16x64_bf16 v[60:63], v[48:51], v[136:143], v3
    v_smfmac_f32_16x16x64_bf16 v[64:67], v[48:51], v[144:151], v3
    s_waitcnt lgkmcnt(2)
    v_smfmac_f32_16x16x64_bf16 v[68:71], v[48:51], v[92:99], v3
    ds_read_b128 v[92:95], v12 offset:0
    v_smfmac_f32_16x16x64_bf16 v[60:63], v[52:55], v[176:183], v3
    ds_read_b128 v[96:99], v12 offset:1024
    v_smfmac_f32_16x16x64_bf16 v[64:67], v[52:55], v[184:191], v3
    v_smfmac_f32_16x16x64_bf16 v[68:71], v[52:55], v[192:199], v3
    v_smfmac_f32_16x16x64_bf16 v[60:63], v[56:59], v[216:223], v3
    v_smfmac_f32_16x16x64_bf16 v[64:67], v[56:59], v[224:231], v3
    s_waitcnt lgkmcnt(2)
    v_smfmac_f32_16x16x64_bf16 v[68:71], v[56:59], v[84:91], v3
    ds_read_b128 v[84:87], v12 offset:4096
    v_smfmac_f32_16x16x64_bf16 v[72:75], v[16:19], a[24:31], v3
    ds_read_b128 v[88:91], v12 offset:5120
    v_smfmac_f32_16x16x64_bf16 v[76:79], v[16:19], a[32:39], v3
    s_waitcnt lgkmcnt(2)
    v_smfmac_f32_16x16x64_bf16 v[80:83], v[16:19], v[92:99], v3
    ds_read_b128 v[92:95], v12 offset:8192
    v_add_f32 v60, v60, v62
    v_smfmac_f32_16x16x64_bf16 v[72:75], v[20:23], a[56:63], v3
    ds_read_b128 v[96:99], v12 offset:9216
    v_add_f32 v61, v61, v63
    v_smfmac_f32_16x16x64_bf16 v[76:79], v[20:23], a[64:71], v3
    v_cvt_pk_bf16_f32 v103, v60, v61
    v_smfmac_f32_16x16x64_bf16 v[80:83], v[20:23], a[72:79], v3
    ds_write_b32 v108, v103
    v_add_f32 v64, v64, v66
    v_smfmac_f32_16x16x64_bf16 v[72:75], v[28:31], a[104:111], v3
    v_add_f32 v65, v65, v67
    v_smfmac_f32_16x16x64_bf16 v[76:79], v[28:31], a[112:119], v3
    s_waitcnt lgkmcnt(3)
    v_cvt_pk_bf16_f32 v104, v64, v65
    v_smfmac_f32_16x16x64_bf16 v[80:83], v[28:31], v[84:91], v3
    ds_read_b128 v[84:87], v12 offset:12288
    v_add_f32 v68, v68, v70
    v_smfmac_f32_16x16x64_bf16 v[72:75], v[32:35], a[136:143], v3
    ds_read_b128 v[88:91], v12 offset:13312
    v_add_f32 v69, v69, v71
    v_smfmac_f32_16x16x64_bf16 v[76:79], v[32:35], a[144:151], v3
    ds_write_b32 v109, v104
    v_cvt_pk_bf16_f32 v105, v68, v69
    v_smfmac_f32_16x16x64_bf16 v[80:83], v[32:35], a[152:159], v3
    ds_write_b32 v110, v105
    v_cmp_u_f32 vcc, v60, v61
    v_smfmac_f32_16x16x64_bf16 v[72:75], v[36:39], a[184:191], v3
    ds_read_b128 v[28:31], v6 offset:0
    v_smfmac_f32_16x16x64_bf16 v[76:79], v[36:39], a[192:199], v3
    ds_read_b128 v[32:35], v6 offset:1024
    s_cbranch_vccnz QK_nan
QK_fine:
    s_waitcnt lgkmcnt(7)
    v_smfmac_f32_16x16x64_bf16 v[80:83], v[36:39], v[92:99], v3
    ds_read_b128 v[92:95], v12 offset:16384
    v_smfmac_f32_16x16x64_bf16 v[72:75], v[40:43], a[216:223], v3
    ds_read_b128 v[96:99], v12 offset:17408
    v_smfmac_f32_16x16x64_bf16 v[76:79], v[40:43], a[224:231], v3
    s_waitcnt lgkmcnt(4)
    s_barrier
    v_smfmac_f32_16x16x64_bf16 v[80:83], v[40:43], a[232:239], v3
    ds_read_b64_tr_b16 v[16:17], v111 offset:0
    buffer_store_dword v107, off, s[4:7], s71 sc1
    v_mov_b64 v[60:61], 0
    v_smfmac_f32_16x16x64_bf16 v[72:75], v[44:47], v[120:127], v3
    ds_read_b128 v[36:39], v6 offset:6144
    v_mov_b64 v[62:63], 0
    v_smfmac_f32_16x16x64_bf16 v[76:79], v[44:47], v[128:135], v3
    ds_read_b128 v[40:43], v6 offset:7168
    v_mov_b64 v[64:65], 0
    v_smfmac_f32_16x16x64_bf16 v[80:83], v[44:47], v[84:91], v3
    s_waitcnt lgkmcnt(3)
    ds_read_b64_tr_b16 v[18:19], v111 offset:128
    v_mov_b64 v[66:67], 0
    v_smfmac_f32_16x16x64_bf16 v[80:83], v[52:55], v[92:99], v3
    ds_read_b128 v[84:87], v6 offset:2048
    v_mov_b64 v[68:69], 0
    v_smfmac_f32_16x16x64_bf16 v[80:83], v[48:51], v[168:175], v3
    ds_read_b128 v[88:91], v6 offset:3072
    v_mov_b64 v[70:71], 0
    v_smfmac_f32_16x16x64_bf16 v[80:83], v[56:59], v[248:255], v3
    ds_read_b64_tr_b16 v[20:21], v111 offset:1024
    v_smfmac_f32_16x16x64_bf16 v[72:75], v[52:55], v[200:207], v3
    ds_read_b64_tr_b16 v[22:23], v111 offset:1152
    v_smfmac_f32_16x16x64_bf16 v[72:75], v[48:51], v[152:159], v3
    ds_read_b128 v[92:95], v6 offset:8192
    v_smfmac_f32_16x16x64_bf16 v[72:75], v[56:59], v[232:239], v3
    ds_read_b128 v[96:99], v6 offset:9216
    v_smfmac_f32_16x16x64_bf16 v[76:79], v[52:55], v[208:215], v3
    ds_read_b64_tr_b16 v[24:25], v111 offset:2048
    v_add_f32 v80, v80, v82
    v_smfmac_f32_16x16x64_bf16 v[76:79], v[48:51], v[160:167], v3
    ds_read_b64_tr_b16 v[26:27], v111 offset:2176
    v_add_f32 v81, v81, v83
    v_smfmac_f32_16x16x64_bf16 v[76:79], v[56:59], v[240:247], v3
    ds_read_b128 v[44:47], v6 offset:4096
    v_cvt_pk_bf16_f32 v105, v80, v81
    ds_write_b32 v14, v105 offset:512
    v_add_f32 v72, v72, v74
    v_add_f32 v73, v73, v75
    v_cvt_pk_bf16_f32 v103, v72, v73
    ds_write_b32 v14, v103 offset:0
    s_waitcnt lgkmcnt(11)
    v_smfmac_f32_16x16x64_bf16 v[60:63], v[16:19], v[28:35], v3
    ds_read_b128 v[48:51], v6 offset:5120
    v_add_f32 v76, v76, v78
    v_add_f32 v77, v77, v79
    v_cvt_pk_bf16_f32 v104, v76, v77
    ds_write_b32 v14, v104 offset:256
    v_smfmac_f32_16x16x64_bf16 v[64:67], v[16:19], v[36:43], v3
    s_waitcnt lgkmcnt(9)
    ds_read_b128 v[52:55], v6 offset:10240
    v_smfmac_f32_16x16x64_bf16 v[60:63], v[20:23], v[84:91], v3
    s_waitcnt lgkmcnt(8)
    ds_read_b128 v[56:59], v6 offset:11264
    v_smfmac_f32_16x16x64_bf16 v[64:67], v[20:23], v[92:99], v3
    s_cmp_ge_u32 s16, 2
    s_waitcnt lgkmcnt(2)
    s_barrier
    s_cbranch_scc1 QK_side
    ds_read_b64_tr_b16 v[28:29], v15 offset:0
    ds_read_b64_tr_b16 v[30:31], v15 offset:256
    v_smfmac_f32_16x16x64_bf16 v[60:63], v[24:27], v[44:51], v3
    s_cmp_eq_u32 s19, 63
    ds_read_b64_tr_b16 v[32:33], v15 offset:512
    ds_read_b64_tr_b16 v[34:35], v15 offset:768
    s_waitcnt lgkmcnt(4)
    v_smfmac_f32_16x16x64_bf16 v[64:67], v[24:27], v[52:59], v3
    s_cbranch_scc1 M_done
    ds_read_b64_tr_b16 v[36:37], v15 offset:1024
    ds_read_b64_tr_b16 v[38:39], v15 offset:1280
    ds_read_b64_tr_b16 v[40:41], v15 offset:1536
    ds_read_b64_tr_b16 v[42:43], v15 offset:1792
    ds_read_b64_tr_b16 v[84:85], v15 offset:2048
    ds_read_b64_tr_b16 v[86:87], v15 offset:2304
    ds_read_b64_tr_b16 v[88:89], v15 offset:2560
    ds_read_b64_tr_b16 v[90:91], v15 offset:2816
    s_cmp_eq_u32 s16, 1
    s_waitcnt lgkmcnt(8)
    v_smfmac_f32_16x16x64_bf16 v[68:71], v[16:19], v[28:35], v3
    s_cbranch_scc1 QK_b1
    v_add_f32 v60, v60, v62
    s_waitcnt lgkmcnt(4)
    v_smfmac_f32_16x16x64_bf16 v[68:71], v[20:23], v[36:43], v3
    v_add_f32 v64, v64, v66
    s_waitcnt lgkmcnt(0)
    v_smfmac_f32_16x16x64_bf16 v[68:71], v[24:27], v[84:91], v3
    v_mul_f32 v60, s37, v60
    v_mul_f32 v64, s37, v64
    v_exp_f32 v100, v60
    v_exp_f32 v101, v64
    v_max_f32 v73, |v60|, |v64|
    v_add_f32 v72, v100, v101
    s_nop 1
    v_add_f32 v68, v68, v70
    v_mul_f32 v68, s37, v68
    v_exp_f32 v102, v68
    v_add_f32_dpp v72, v72, v72 row_ror:8 row_mask:0xf bank_mask:0xf
    v_add_f32 v72, v72, v102
    v_max_f32 v73, v73, |v68|
    v_cmp_nge_f32 vcc, s58, v73
    v_add_f32_dpp v72, v72, v72 row_ror:4 row_mask:0xf bank_mask:0xf
    s_cbranch_vccnz QK_truemax0
QK_sum0:
    s_nop 0
    v_add_f32_dpp v72, v72, v72 row_ror:2 row_mask:0xf bank_mask:0xf
    s_nop 1
    v_add_f32_dpp v72, v72, v72 row_ror:1 row_mask:0xf bank_mask:0xf
    v_rcp_f32 v72, v72
    s_nop 0
    v_mul_f32 v102, v102, v72
    v_mul_f32 v100, v100, v72
    v_mul_f32 v101, v101, v72
    v_mov_b32_dpp v74, v102 quad_perm:[1,0,3,2] row_mask:0xf bank_mask:0xf
    v_cvt_pk_bf16_f32 v76, v100, v101
    buffer_store_dword v76, v7, s[4:7], s25 offen sc1
    v_cvt_pk_bf16_f32 v77, v102, v74
    s_mov_b64 exec, s[56:57]
    buffer_store_dword v77, v8, s[4:7], s25 offen sc1
    s_mov_b64 exec, -1
    s_barrier
    s_branch QK_next
QK_b1:
    v_add_f32 v61, v61, v63
    s_waitcnt lgkmcnt(4)
    v_smfmac_f32_16x16x64_bf16 v[68:71], v[20:23], v[36:43], v3
    v_add_f32 v65, v65, v67
    s_waitcnt lgkmcnt(0)
    v_smfmac_f32_16x16x64_bf16 v[68:71], v[24:27], v[84:91], v3
    v_mul_f32 v61, s37, v61
    v_mul_f32 v65, s37, v65
    v_exp_f32 v100, v61
    v_exp_f32 v101, v65
    v_max_f32 v73, |v61|, |v65|
    v_add_f32 v72, v100, v101
    s_nop 1
    v_add_f32 v69, v69, v71
    v_mul_f32 v69, s37, v69
    v_exp_f32 v102, v69
    v_add_f32_dpp v72, v72, v72 row_ror:8 row_mask:0xf bank_mask:0xf
    v_add_f32 v72, v72, v102
    v_max_f32 v73, v73, |v69|
    v_cmp_nge_f32 vcc, s58, v73
    v_add_f32_dpp v72, v72, v72 row_ror:4 row_mask:0xf bank_mask:0xf
    s_cbranch_vccnz QK_truemax1
QK_sum1:
    s_nop 0
    v_add_f32_dpp v72, v72, v72 row_ror:2 row_mask:0xf bank_mask:0xf
    s_nop 1
    v_add_f32_dpp v72, v72, v72 row_ror:1 row_mask:0xf bank_mask:0xf
    v_rcp_f32 v72, v72
    s_nop 0
    v_mul_f32 v102, v102, v72
    v_mul_f32 v100, v100, v72
    v_mul_f32 v101, v101, v72
    v_mov_b32_dpp v74, v102 quad_perm:[1,0,3,2] row_mask:0xf bank_mask:0xf
    v_cvt_pk_bf16_f32 v76, v100, v101
    buffer_store_dword v76, v7, s[4:7], s25 offen sc1
    v_cvt_pk_bf16_f32 v77, v102, v74
    s_mov_b64 exec, s[56:57]
    buffer_store_dword v77, v8, s[4:7], s25 offen sc1
    s_mov_b64 exec, -1
    s_barrier
QK_next:
    s_add_u32 s19, s19, 1
    s_lshr_b32 s28, s19, 4
    s_lshl_b32 s24, s19, 17
    s_lshr_b32 s29, s20, s28
    s_and_b32 s29, s29, 1
    s_lshl_b32 s29, s29, 13
    s_add_u32 s24, s24, s29
    s_lshl_b32 s29, s19, 12
    s_xor_b32 s29, s29, s21
    s_and_b32 s29, s29, 16384
    s_sub_u32 s24, s24, s29
    s_branch QK_step
QK_side:
    s_cmp_eq_u32 s16, 2
    s_cbranch_scc1 QK_w2
    s_mov_b32 s77, s72
    s_mul_i32 s28, s19, 171
    s_lshr_b32 s28, s28, 9
    s_mul_i32 s76, s28, 3
    s_sub_u32 s76, s19, s76
    s_lshl_b32 s76, s76, 15
    s_add_u32 s28, s28, 4
    s_lshl_b32 s72, s28, 21
    s_add_u32 s72, s72, s76
    s_add_u32 s72, s72, 1966080
    s_lshr_b32 s29, s20, s28
    s_and_b32 s29, s29, 1
    s_lshl_b32 s29, s29, 13
    s_add_u32 s72, s72, s29
    s_lshl_b32 s30, s19, 5
    s_add_u32 s30, s30, s17
    s_lshl_b32 s31, s17, 7
    s_add_u32 s72, s72, s31
    s_mul_i32 s30, s30, 6144
    s_add_u32 s26, s30, 55574528
    ds_read_b64_tr_b16 v[28:29], v15 offset:0
    ds_read_b64_tr_b16 v[30:31], v15 offset:256
    ds_read_b64_tr_b16 v[32:33], v15 offset:512
    ds_read_b64_tr_b16 v[34:35], v15 offset:768
    ds_read_b64_tr_b16 v[36:37], v15 offset:1024
    ds_read_b64_tr_b16 v[38:39], v15 offset:1280
    ds_read_b64_tr_b16 v[40:41], v15 offset:1536
    ds_read_b64_tr_b16 v[42:43], v15 offset:1792
    ds_read_b64_tr_b16 v[44:45], v15 offset:2048
    ds_read_b64_tr_b16 v[46:47], v15 offset:2304
    ds_read_b64_tr_b16 v[48:49], v15 offset:2560
    ds_read_b64_tr_b16 v[50:51], v15 offset:2816
    s_waitcnt lgkmcnt(0)
    s_cmp_eq_u32 s19, 63
    s_cbranch_scc1 QK_km
    s_barrier
QK_km:
    s_mov_b64 exec, 1
    buffer_store_dword v107, v2, s[4:7], s77 offen sc1
    s_mov_b64 exec, -1
    buffer_store_dwordx4 v[28:31], v2, s[4:7], s26 offen sc1
    s_add_u32 s26, s26, 1024
    buffer_store_dwordx4 v[32:35], v2, s[4:7], s26 offen sc1
    s_add_u32 s26, s26, 1024
    buffer_store_dwordx4 v[36:39], v2, s[4:7], s26 offen sc1
    s_add_u32 s26, s26, 1024
    buffer_store_dwordx4 v[40:43], v2, s[4:7], s26 offen sc1
    s_add_u32 s26, s26, 1024
    buffer_store_dwordx4 v[44:47], v2, s[4:7], s26 offen sc1
    s_add_u32 s26, s26, 1024
    buffer_store_dwordx4 v[48:51], v2, s[4:7], s26 offen sc1
    s_add_u32 s26, s26, 1024
    s_cmp_ge_u32 s19, 60
    s_cselect_b32 s33, s72, 0x7ffffff0
    v_mov_b32 v100, 1
    s_mov_b64 exec, 1
    buffer_store_dword v100, v2, s[4:7], s33 offen sc1
    s_mov_b64 exec, -1
    s_cmp_lt_u32 s19, 63
    s_cbranch_scc1 QK_w23
    v_mov_b32 v100, 2
    s_waitcnt vmcnt(0)
    s_mov_b64 exec, 1
    buffer_store_dword v100, v2, s[4:7], s72 offen sc1
    s_mov_b64 exec, -1
    s_endpgm
QK_w2:
    s_cmp_eq_u32 s19, 63
    s_cbranch_scc1 M_done
    s_add_u32 s34, s19, 2
    s_min_u32 s34, s34, 63
    s_lshr_b32 s28, s34, 4
    s_lshl_b32 s26, s34, 17
    s_lshr_b32 s29, s20, s28
    s_and_b32 s29, s29, 1
    s_lshl_b32 s29, s29, 13
    s_add_u32 s26, s26, s29
    s_lshl_b32 s29, s34, 12
    s_xor_b32 s29, s29, s21
    s_and_b32 s29, s29, 16384
    s_add_u32 s26, s26, s29
    v_mov_b32 v100, -1
    v_mov_b32 v101, -1
    v_mov_b32 v102, -1
    v_mov_b32 v103, -1
    s_barrier
    s_mov_b32 exec_hi, 0xff
    buffer_store_dwordx4 v[100:103], v0, s[4:7], s26 offen sc1
    s_mov_b32 exec_hi, -1
QK_w23:
    s_add_u32 s34, s19, 1
    s_lshl_b32 s30, s34, 5
    s_add_u32 s30, s30, s17
    s_lshl_b32 s31, s30, 4
    s_add_u32 s31, s31, 54530056
    s_mul_i32 s30, s30, 12288
    s_add_u32 s30, s30, 95420416
    s_and_b32 s32, s34, 1
    s_mul_i32 s32, s32, 12288
    s_and_b32 s33, s16, 1
    s_mul_i32 s33, s33, 6144
    s_add_u32 s32, s32, s33
    s_add_u32 s32, s32, 92160
    s_mov_b32 s35, 0
    v_cmp_eq_u32 vcc, 0, v106
    s_cbranch_vccz QK_kn_g
QK_kn_f:
    buffer_load_dword v106, v8, s[4:7], s31 offen sc1
    s_waitcnt vmcnt(0)
    v_cmp_eq_u32 vcc, 0, v106
    s_cbranch_vccz QK_kn_g
    s_sleep 2
    s_add_u32 s35, s35, 1
    s_cmp_lt_u32 s35, 200000
    s_cbranch_scc1 QK_kn_f
    s_branch M_fail
QK_kn_g:
    s_add_u32 m0, s32, 0
    s_nop 0
    buffer_load_dwordx4 v7, s[4:7], s30 offen sc1 lds
    s_add_u32 s30, s30, 1024
    s_add_u32 m0, s32, 1024
    s_nop 0
    buffer_load_dwordx4 v7, s[4:7], s30 offen sc1 lds
    s_add_u32 s30, s30, 1024
    s_add_u32 m0, s32, 2048
    s_nop 0
    buffer_load_dwordx4 v7, s[4:7], s30 offen sc1 lds
    s_add_u32 s30, s30, 1024
    s_add_u32 m0, s32, 3072
    s_nop 0
    buffer_load_dwordx4 v7, s[4:7], s30 offen sc1 lds
    s_add_u32 s30, s30, 1024
    s_add_u32 m0, s32, 4096
    s_nop 0
    buffer_load_dwordx4 v7, s[4:7], s30 offen sc1 lds
    s_add_u32 s30, s30, 1024
    s_add_u32 m0, s32, 5120
    s_nop 0
    buffer_load_dwordx4 v7, s[4:7], s30 offen sc1 lds
    s_add_u32 s30, s30, 1024
    buffer_load_dword v106, v8, s[4:7], s31 offen offset:512 sc1
    s_branch QK_next
QK_redo:
    s_waitcnt lgkmcnt(0)
    s_barrier
    s_branch QK_pre
QK_nan:
    s_waitcnt lgkmcnt(0)
    v_add_u32 v100, 81920, v2
    v_mov_b32 v101, 0
    ds_read_b32 v102, v100 offset:0
    s_waitcnt lgkmcnt(0)
    v_max_u32 v101, v101, v102
    ds_read_b32 v102, v100 offset:4
    s_waitcnt lgkmcnt(0)
    v_max_u32 v101, v101, v102
    ds_read_b32 v102, v100 offset:8
    s_waitcnt lgkmcnt(0)
    v_max_u32 v101, v101, v102
    ds_read_b32 v102, v100 offset:12
    s_waitcnt lgkmcnt(0)
    v_max_u32 v101, v101, v102
    ds_read_b32 v102, v100 offset:1024
    s_waitcnt lgkmcnt(0)
    v_max_u32 v101, v101, v102
    ds_read_b32 v102, v100 offset:1028
    s_waitcnt lgkmcnt(0)
    v_max_u32 v101, v101, v102
    ds_read_b32 v102, v100 offset:1032
    s_waitcnt lgkmcnt(0)
    v_max_u32 v101, v101, v102
    ds_read_b32 v102, v100 offset:1036
    s_waitcnt lgkmcnt(0)
    v_max_u32 v101, v101, v102
    ds_read_b32 v102, v100 offset:2048
    s_waitcnt lgkmcnt(0)
    v_max_u32 v101, v101, v102
    ds_read_b32 v102, v100 offset:2052
    s_waitcnt lgkmcnt(0)
    v_max_u32 v101, v101, v102
    ds_read_b32 v102, v100 offset:2056
    s_waitcnt lgkmcnt(0)
    v_max_u32 v101, v101, v102
    ds_read_b32 v102, v100 offset:2060
    s_waitcnt lgkmcnt(0)
    v_max_u32 v101, v101, v102
    ds_read_b32 v102, v100 offset:3072
    s_waitcnt lgkmcnt(0)
    v_max_u32 v101, v101, v102
    ds_read_b32 v102, v100 offset:3076
    s_waitcnt lgkmcnt(0)
    v_max_u32 v101, v101, v102
    ds_read_b32 v102, v100 offset:3080
    s_waitcnt lgkmcnt(0)
    v_max_u32 v101, v101, v102
    ds_read_b32 v102, v100 offset:3084
    s_waitcnt lgkmcnt(0)
    v_max_u32 v101, v101, v102
    ds_read_b32 v102, v100 offset:4096
    s_waitcnt lgkmcnt(0)
    v_max_u32 v101, v101, v102
    ds_read_b32 v102, v100 offset:4100
    s_waitcnt lgkmcnt(0)
    v_max_u32 v101, v101, v102
    ds_read_b32 v102, v100 offset:4104
    s_waitcnt lgkmcnt(0)
    v_max_u32 v101, v101, v102
    ds_read_b32 v102, v100 offset:4108
    s_waitcnt lgkmcnt(0)
    v_max_u32 v101, v101, v102
    ds_read_b32 v102, v100 offset:5120
    s_waitcnt lgkmcnt(0)
    v_max_u32 v101, v101, v102
    ds_read_b32 v102, v100 offset:5124
    s_waitcnt lgkmcnt(0)
    v_max_u32 v101, v101, v102
    ds_read_b32 v102, v100 offset:5128
    s_waitcnt lgkmcnt(0)
    v_max_u32 v101, v101, v102
    ds_read_b32 v102, v100 offset:5132
    s_waitcnt lgkmcnt(0)
    v_max_u32 v101, v101, v102
    ds_read_b32 v102, v100 offset:6144
    s_waitcnt lgkmcnt(0)
    v_max_u32 v101, v101, v102
    ds_read_b32 v102, v100 offset:6148
    s_waitcnt lgkmcnt(0)
    v_max_u32 v101, v101, v102
    ds_read_b32 v102, v100 offset:6152
    s_waitcnt lgkmcnt(0)
    v_max_u32 v101, v101, v102
    ds_read_b32 v102, v100 offset:6156
    s_waitcnt lgkmcnt(0)
    v_max_u32 v101, v101, v102
    ds_read_b32 v102, v100 offset:7168
    s_waitcnt lgkmcnt(0)
    v_max_u32 v101, v101, v102
    ds_read_b32 v102, v100 offset:7172
    s_waitcnt lgkmcnt(0)
    v_max_u32 v101, v101, v102
    ds_read_b32 v102, v100 offset:7176
    s_waitcnt lgkmcnt(0)
    v_max_u32 v101, v101, v102
    ds_read_b32 v102, v100 offset:7180
    s_waitcnt lgkmcnt(0)
    v_max_u32 v101, v101, v102
    ds_read_b32 v102, v100 offset:8192
    s_waitcnt lgkmcnt(0)
    v_max_u32 v101, v101, v102
    ds_read_b32 v102, v100 offset:8196
    s_waitcnt lgkmcnt(0)
    v_max_u32 v101, v101, v102
    ds_read_b32 v102, v100 offset:8200
    s_waitcnt lgkmcnt(0)
    v_max_u32 v101, v101, v102
    ds_read_b32 v102, v100 offset:8204
    s_waitcnt lgkmcnt(0)
    v_max_u32 v101, v101, v102
    ds_read_b32 v102, v100 offset:9216
    s_waitcnt lgkmcnt(0)
    v_max_u32 v101, v101, v102
    ds_read_b32 v102, v100 offset:9220
    s_waitcnt lgkmcnt(0)
    v_max_u32 v101, v101, v102
    ds_read_b32 v102, v100 offset:9224
    s_waitcnt lgkmcnt(0)
    v_max_u32 v101, v101, v102
    ds_read_b32 v102, v100 offset:9228
    s_waitcnt lgkmcnt(0)
    v_max_u32 v101, v101, v102
    v_cmp_eq_u32 vcc, -1, v101
    s_cbranch_vccnz QK_redo
    s_branch QK_fine
QK_truemax0:
    v_max3_f32 v73, v60, v64, v68
    s_nop 1
    v_max_f32_dpp v73, v73, v73 row_ror:8 row_mask:0xf bank_mask:0xf
    s_nop 1
    v_max_f32_dpp v73, v73, v73 row_ror:4 row_mask:0xf bank_mask:0xf
    s_nop 1
    v_max_f32_dpp v73, v73, v73 row_ror:2 row_mask:0xf bank_mask:0xf
    s_nop 1
    v_max_f32_dpp v73, v73, v73 row_ror:1 row_mask:0xf bank_mask:0xf
    v_sub_f32 v100, v60, v73
    v_sub_f32 v101, v64, v73
    v_sub_f32 v102, v68, v73
    v_exp_f32 v100, v100
    v_exp_f32 v101, v101
    v_exp_f32 v102, v102
    v_add_f32 v72, v100, v101
    s_nop 1
    v_add_f32_dpp v72, v72, v72 row_ror:8 row_mask:0xf bank_mask:0xf
    v_add_f32 v72, v72, v102
    s_nop 1
    v_add_f32_dpp v72, v72, v72 row_ror:4 row_mask:0xf bank_mask:0xf
    s_nop 1
    s_branch QK_sum0
QK_truemax1:
    v_max3_f32 v73, v61, v65, v69
    s_nop 1
    v_max_f32_dpp v73, v73, v73 row_ror:8 row_mask:0xf bank_mask:0xf
    s_nop 1
    v_max_f32_dpp v73, v73, v73 row_ror:4 row_mask:0xf bank_mask:0xf
    s_nop 1
    v_max_f32_dpp v73, v73, v73 row_ror:2 row_mask:0xf bank_mask:0xf
    s_nop 1
    v_max_f32_dpp v73, v73, v73 row_ror:1 row_mask:0xf bank_mask:0xf
    v_sub_f32 v100, v61, v73
    v_sub_f32 v101, v65, v73
    v_sub_f32 v102, v69, v73
    v_exp_f32 v100, v100
    v_exp_f32 v101, v101
    v_exp_f32 v102, v102
    v_add_f32 v72, v100, v101
    s_nop 1
    v_add_f32_dpp v72, v72, v72 row_ror:8 row_mask:0xf bank_mask:0xf
    v_add_f32 v72, v72, v102
    s_nop 1
    v_add_f32_dpp v72, v72, v72 row_ror:4 row_mask:0xf bank_mask:0xf
    s_nop 1
    s_branch QK_sum1
M_vo:
    s_mov_b32 s8, s44
    s_and_b32 s9, s45, 0xffff
    s_mov_b32 s10, 7864320
    s_mov_b32 s11, 0x20000
    s_mov_b32 s12, s46
    s_and_b32 s13, s47, 0xffff
    s_mov_b32 s14, 7864320
    s_mov_b32 s15, 0x20000
    s_mul_i32 s36, s17, 384
    s_mul_i32 s30, s16, 96
    s_add_u32 s36, s36, s30
    s_mul_i32 s37, s17, 245760
    s_mul_i32 s30, s16, 320
    s_add_u32 s37, s37, s30
    v_add_u32 v4, 0, v1
    v_mul_u32_u24 v5, 171, v4
    v_lshrrev_b32 v5, 10, v5
    v_mul_u32_u24 v6, 6, v5
    v_sub_u32 v4, v4, v6
    v_lshlrev_b32 v4, 4, v4
    v_and_b32 v6, 3, v5
    v_and_b32 v7, 12, v5
    v_lshlrev_b32 v7, 1, v7
    v_add_u32 v6, v6, v7
    v_lshrrev_b32 v7, 4, v5
    v_lshlrev_b32 v7, 2, v7
    v_add_u32 v6, v6, v7
    v_mul_u32_u24 v6, 12288, v6
    v_add_u32 v16, v6, v4
    v_add_u32 v4, 64, v1
    v_mul_u32_u24 v5, 171, v4
    v_lshrrev_b32 v5, 10, v5
    v_mul_u32_u24 v6, 6, v5
    v_sub_u32 v4, v4, v6
    v_lshlrev_b32 v4, 4, v4
    v_and_b32 v6, 3, v5
    v_and_b32 v7, 12, v5
    v_lshlrev_b32 v7, 1, v7
    v_add_u32 v6, v6, v7
    v_lshrrev_b32 v7, 4, v5
    v_lshlrev_b32 v7, 2, v7
    v_add_u32 v6, v6, v7
    v_mul_u32_u24 v6, 12288, v6
    v_add_u32 v17, v6, v4
    v_add_u32 v4, 128, v1
    v_mul_u32_u24 v5, 171, v4
    v_lshrrev_b32 v5, 10, v5
    v_mul_u32_u24 v6, 6, v5
    v_sub_u32 v4, v4, v6
    v_lshlrev_b32 v4, 4, v4
    v_and_b32 v6, 3, v5
    v_and_b32 v7, 12, v5
    v_lshlrev_b32 v7, 1, v7
    v_add_u32 v6, v6, v7
    v_lshrrev_b32 v7, 4, v5
    v_lshlrev_b32 v7, 2, v7
    v_add_u32 v6, v6, v7
    v_mul_u32_u24 v6, 12288, v6
    v_add_u32 v18, v6, v4
    s_mul_i32 s30, s16, 40960
    s_add_u32 s31, s36, 0
    s_add_u32 m0, s30, 0
    s_nop 0
    buffer_load_dwordx4 v16, s[8:11], s31 offen lds
    s_add_u32 m0, s30, 1024
    s_nop 0
    buffer_load_dwordx4 v17, s[8:11], s31 offen lds
    s_add_u32 m0, s30, 2048
    s_nop 0
    buffer_load_dwordx4 v18, s[8:11], s31 offen lds
    s_add_u32 s31, s36, 1572864
    s_add_u32 m0, s30, 3072
    s_nop 0
    buffer_load_dwordx4 v16, s[8:11], s31 offen lds
    s_add_u32 m0, s30, 4096
    s_nop 0
    buffer_load_dwordx4 v17, s[8:11], s31 offen lds
    s_add_u32 m0, s30, 5120
    s_nop 0
    buffer_load_dwordx4 v18, s[8:11], s31 offen lds
    s_add_u32 s31, s36, 3145728
    s_add_u32 m0, s30, 6144
    s_nop 0
    buffer_load_dwordx4 v16, s[8:11], s31 offen lds
    s_add_u32 m0, s30, 7168
    s_nop 0
    buffer_load_dwordx4 v17, s[8:11], s31 offen lds
    s_add_u32 m0, s30, 8192
    s_nop 0
    buffer_load_dwordx4 v18, s[8:11], s31 offen lds
    s_add_u32 s31, s36, 4718592
    s_add_u32 m0, s30, 9216
    s_nop 0
    buffer_load_dwordx4 v16, s[8:11], s31 offen lds
    s_add_u32 m0, s30, 10240
    s_nop 0
    buffer_load_dwordx4 v17, s[8:11], s31 offen lds
    s_add_u32 m0, s30, 11264
    s_nop 0
    buffer_load_dwordx4 v18, s[8:11], s31 offen lds
    s_add_u32 s31, s36, 393216
    s_add_u32 m0, s30, 12288
    s_nop 0
    buffer_load_dwordx4 v16, s[8:11], s31 offen lds
    s_add_u32 m0, s30, 13312
    s_nop 0
    buffer_load_dwordx4 v17, s[8:11], s31 offen lds
    s_add_u32 m0, s30, 14336
    s_nop 0
    buffer_load_dwordx4 v18, s[8:11], s31 offen lds
    s_add_u32 s31, s36, 1966080
    s_add_u32 m0, s30, 15360
    s_nop 0
    buffer_load_dwordx4 v16, s[8:11], s31 offen lds
    s_add_u32 m0, s30, 16384
    s_nop 0
    buffer_load_dwordx4 v17, s[8:11], s31 offen lds
    s_add_u32 m0, s30, 17408
    s_nop 0
    buffer_load_dwordx4 v18, s[8:11], s31 offen lds
    s_add_u32 s31, s36, 3538944
    s_add_u32 m0, s30, 18432
    s_nop 0
    buffer_load_dwordx4 v16, s[8:11], s31 offen lds
    s_add_u32 m0, s30, 19456
    s_nop 0
    buffer_load_dwordx4 v17, s[8:11], s31 offen lds
    s_add_u32 m0, s30, 20480
    s_nop 0
    buffer_load_dwordx4 v18, s[8:11], s31 offen lds
    s_add_u32 s31, s36, 5111808
    s_add_u32 m0, s30, 21504
    s_nop 0
    buffer_load_dwordx4 v16, s[8:11], s31 offen lds
    s_add_u32 m0, s30, 22528
    s_nop 0
    buffer_load_dwordx4 v17, s[8:11], s31 offen lds
    s_add_u32 m0, s30, 23552
    s_nop 0
    buffer_load_dwordx4 v18, s[8:11], s31 offen lds
    v_add_u32 v4, 0, v1
    v_mul_u32_u24 v5, 205, v4
    v_lshrrev_b32 v5, 12, v5
    v_mul_u32_u24 v6, 20, v5
    v_sub_u32 v4, v4, v6
    v_lshlrev_b32 v4, 4, v4
    v_and_b32 v6, 3, v5
    v_and_b32 v7, 12, v5
    v_lshlrev_b32 v7, 1, v7
    v_add_u32 v6, v6, v7
    v_lshrrev_b32 v7, 4, v5
    v_lshlrev_b32 v7, 2, v7
    v_add_u32 v6, v6, v7
    v_mul_u32_u24 v6, 1280, v6
    v_add_u32 v19, v6, v4
    v_add_u32 v4, 64, v1
    v_mul_u32_u24 v5, 205, v4
    v_lshrrev_b32 v5, 12, v5
    v_mul_u32_u24 v6, 20, v5
    v_sub_u32 v4, v4, v6
    v_lshlrev_b32 v4, 4, v4
    v_and_b32 v6, 3, v5
    v_and_b32 v7, 12, v5
    v_lshlrev_b32 v7, 1, v7
    v_add_u32 v6, v6, v7
    v_lshrrev_b32 v7, 4, v5
    v_lshlrev_b32 v7, 2, v7
    v_add_u32 v6, v6, v7
    v_mul_u32_u24 v6, 1280, v6
    v_add_u32 v20, v6, v4
    v_add_u32 v4, 128, v1
    v_mul_u32_u24 v5, 205, v4
    v_lshrrev_b32 v5, 12, v5
    v_mul_u32_u24 v6, 20, v5
    v_sub_u32 v4, v4, v6
    v_lshlrev_b32 v4, 4, v4
    v_and_b32 v6, 3, v5
    v_and_b32 v7, 12, v5
    v_lshlrev_b32 v7, 1, v7
    v_add_u32 v6, v6, v7
    v_lshrrev_b32 v7, 4, v5
    v_lshlrev_b32 v7, 2, v7
    v_add_u32 v6, v6, v7
    v_mul_u32_u24 v6, 1280, v6
    v_add_u32 v21, v6, v4
    v_add_u32 v4, 192, v1
    v_mul_u32_u24 v5, 205, v4
    v_lshrrev_b32 v5, 12, v5
    v_mul_u32_u24 v6, 20, v5
    v_sub_u32 v4, v4, v6
    v_lshlrev_b32 v4, 4, v4
    v_and_b32 v6, 3, v5
    v_and_b32 v7, 12, v5
    v_lshlrev_b32 v7, 1, v7
    v_add_u32 v6, v6, v7
    v_lshrrev_b32 v7, 4, v5
    v_lshlrev_b32 v7, 2, v7
    v_add_u32 v6, v6, v7
    v_mul_u32_u24 v6, 1280, v6
    v_add_u32 v22, v6, v4
    v_add_u32 v4, 256, v1
    v_mul_u32_u24 v5, 205, v4
    v_lshrrev_b32 v5, 12, v5
    v_mul_u32_u24 v6, 20, v5
    v_sub_u32 v4, v4, v6
    v_lshlrev_b32 v4, 4, v4
    v_and_b32 v6, 3, v5
    v_and_b32 v7, 12, v5
    v_lshlrev_b32 v7, 1, v7
    v_add_u32 v6, v6, v7
    v_lshrrev_b32 v7, 4, v5
    v_lshlrev_b32 v7, 2, v7
    v_add_u32 v6, v6, v7
    v_mul_u32_u24 v6, 1280, v6
    v_add_u32 v23, v6, v4
    v_add_u32 v4, 320, v1
    v_mul_u32_u24 v5, 205, v4
    v_lshrrev_b32 v5, 12, v5
    v_mul_u32_u24 v6, 20, v5
    v_sub_u32 v4, v4, v6
    v_lshlrev_b32 v4, 4, v4
    v_and_b32 v6, 3, v5
    v_and_b32 v7, 12, v5
    v_lshlrev_b32 v7, 1, v7
    v_add_u32 v6, v6, v7
    v_lshrrev_b32 v7, 4, v5
    v_lshlrev_b32 v7, 2, v7
    v_add_u32 v6, v6, v7
    v_mul_u32_u24 v6, 1280, v6
    v_add_u32 v24, v6, v4
    v_add_u32 v4, 384, v1
    v_mul_u32_u24 v5, 205, v4
    v_lshrrev_b32 v5, 12, v5
    v_mul_u32_u24 v6, 20, v5
    v_sub_u32 v4, v4, v6
    v_lshlrev_b32 v4, 4, v4
    v_and_b32 v6, 3, v5
    v_and_b32 v7, 12, v5
    v_lshlrev_b32 v7, 1, v7
    v_add_u32 v6, v6, v7
    v_lshrrev_b32 v7, 4, v5
    v_lshlrev_b32 v7, 2, v7
    v_add_u32 v6, v6, v7
    v_mul_u32_u24 v6, 1280, v6
    v_add_u32 v25, v6, v4
    v_add_u32 v4, 448, v1
    v_mul_u32_u24 v5, 205, v4
    v_lshrrev_b32 v5, 12, v5
    v_mul_u32_u24 v6, 20, v5
    v_sub_u32 v4, v4, v6
    v_lshlrev_b32 v4, 4, v4
    v_and_b32 v6, 3, v5
    v_and_b32 v7, 12, v5
    v_lshlrev_b32 v7, 1, v7
    v_add_u32 v6, v6, v7
    v_lshrrev_b32 v7, 4, v5
    v_lshlrev_b32 v7, 2, v7
    v_add_u32 v6, v6, v7
    v_mul_u32_u24 v6, 1280, v6
    v_add_u32 v26, v6, v4
    v_add_u32 v4, 512, v1
    v_mul_u32_u24 v5, 205, v4
    v_lshrrev_b32 v5, 12, v5
    v_mul_u32_u24 v6, 20, v5
    v_sub_u32 v4, v4, v6
    v_lshlrev_b32 v4, 4, v4
    v_and_b32 v6, 3, v5
    v_and_b32 v7, 12, v5
    v_lshlrev_b32 v7, 1, v7
    v_add_u32 v6, v6, v7
    v_lshrrev_b32 v7, 4, v5
    v_lshlrev_b32 v7, 2, v7
    v_add_u32 v6, v6, v7
    v_mul_u32_u24 v6, 1280, v6
    v_add_u32 v27, v6, v4
    v_add_u32 v4, 576, v1
    v_mul_u32_u24 v5, 205, v4
    v_lshrrev_b32 v5, 12, v5
    v_mul_u32_u24 v6, 20, v5
    v_sub_u32 v4, v4, v6
    v_lshlrev_b32 v4, 4, v4
    v_and_b32 v6, 3, v5
    v_and_b32 v7, 12, v5
    v_lshlrev_b32 v7, 1, v7
    v_add_u32 v6, v6, v7
    v_lshrrev_b32 v7, 4, v5
    v_lshlrev_b32 v7, 2, v7
    v_add_u32 v6, v6, v7
    v_mul_u32_u24 v6, 1280, v6
    v_add_u32 v28, v6, v4
    v_lshrrev_b32 v4, 2, v1
    v_and_b32 v5, 3, v1
    v_lshlrev_b32 v5, 3, v5
    v_add_u32 v5, s30, v5
    v_mul_u32_u24 v6, 96, v4
    v_add_u32 v31, v6, v5
    v_mul_u32_u24 v6, 320, v4
    v_add_u32 v29, v6, v5
    s_xor_b32 s33, s16, 0
    s_mul_i32 s33, s33, 3072
    v_add_u32 v12, s33, v31
    s_xor_b32 s33, s16, 1
    s_mul_i32 s33, s33, 3072
    v_add_u32 v13, s33, v31
    s_xor_b32 s33, s16, 2
    s_mul_i32 s33, s33, 3072
    v_add_u32 v14, s33, v31
    s_xor_b32 s33, s16, 3
    s_mul_i32 s33, s33, 3072
    v_add_u32 v15, s33, v31
    s_mul_i32 s33, s16, 20480
    v_add_u32 v30, s33, v2
    s_waitcnt vmcnt(12)
    ds_read_b64_tr_b16 a[0:1], v12 offset:0
    ds_read_b64_tr_b16 a[2:3], v12 offset:1536
    ds_read_b64_tr_b16 a[8:9], v12 offset:32
    ds_read_b64_tr_b16 a[10:11], v12 offset:1568
    ds_read_b64_tr_b16 v[32:33], v12 offset:64
    ds_read_b64_tr_b16 v[34:35], v12 offset:1600
    ds_read_b64_tr_b16 a[32:33], v13 offset:0
    ds_read_b64_tr_b16 a[34:35], v13 offset:1536
    ds_read_b64_tr_b16 a[40:41], v13 offset:32
    ds_read_b64_tr_b16 a[42:43], v13 offset:1568
    ds_read_b64_tr_b16 a[48:49], v13 offset:64
    ds_read_b64_tr_b16 a[50:51], v13 offset:1600
    ds_read_b64_tr_b16 a[72:73], v14 offset:0
    ds_read_b64_tr_b16 a[74:75], v14 offset:1536
    ds_read_b64_tr_b16 a[80:81], v14 offset:32
    ds_read_b64_tr_b16 a[82:83], v14 offset:1568
    ds_read_b64_tr_b16 a[88:89], v14 offset:64
    ds_read_b64_tr_b16 a[90:91], v14 offset:1600
    ds_read_b64_tr_b16 a[120:121], v15 offset:0
    ds_read_b64_tr_b16 a[122:123], v15 offset:1536
    ds_read_b64_tr_b16 a[128:129], v15 offset:32
    ds_read_b64_tr_b16 a[130:131], v15 offset:1568
    ds_read_b64_tr_b16 v[56:57], v15 offset:64
    ds_read_b64_tr_b16 v[58:59], v15 offset:1600
    s_waitcnt lgkmcnt(0)
    s_add_u32 s31, s36, 786432
    s_add_u32 m0, s30, 0
    s_nop 0
    buffer_load_dwordx4 v16, s[8:11], s31 offen lds
    s_add_u32 m0, s30, 1024
    s_nop 0
    buffer_load_dwordx4 v17, s[8:11], s31 offen lds
    s_add_u32 m0, s30, 2048
    s_nop 0
    buffer_load_dwordx4 v18, s[8:11], s31 offen lds
    s_add_u32 s31, s36, 2359296
    s_add_u32 m0, s30, 3072
    s_nop 0
    buffer_load_dwordx4 v16, s[8:11], s31 offen lds
    s_add_u32 m0, s30, 4096
    s_nop 0
    buffer_load_dwordx4 v17, s[8:11], s31 offen lds
    s_add_u32 m0, s30, 5120
    s_nop 0
    buffer_load_dwordx4 v18, s[8:11], s31 offen lds
    s_add_u32 s31, s36, 3932160
    s_add_u32 m0, s30, 6144
    s_nop 0
    buffer_load_dwordx4 v16, s[8:11], s31 offen lds
    s_add_u32 m0, s30, 7168
    s_nop 0
    buffer_load_dwordx4 v17, s[8:11], s31 offen lds
    s_add_u32 m0, s30, 8192
    s_nop 0
    buffer_load_dwordx4 v18, s[8:11], s31 offen lds
    s_add_u32 s31, s36, 5505024
    s_add_u32 m0, s30, 9216
    s_nop 0
    buffer_load_dwordx4 v16, s[8:11], s31 offen lds
    s_add_u32 m0, s30, 10240
    s_nop 0
    buffer_load_dwordx4 v17, s[8:11], s31 offen lds
    s_add_u32 m0, s30, 11264
    s_nop 0
    buffer_load_dwordx4 v18, s[8:11], s31 offen lds
    s_waitcnt vmcnt(12)
    ds_read_b64_tr_b16 a[4:5], v12 offset:12288
    ds_read_b64_tr_b16 a[6:7], v12 offset:13824
    ds_read_b64_tr_b16 a[12:13], v12 offset:12320
    ds_read_b64_tr_b16 a[14:15], v12 offset:13856
    ds_read_b64_tr_b16 v[36:37], v12 offset:12352
    ds_read_b64_tr_b16 v[38:39], v12 offset:13888
    ds_read_b64_tr_b16 a[36:37], v13 offset:12288
    ds_read_b64_tr_b16 a[38:39], v13 offset:13824
    ds_read_b64_tr_b16 a[44:45], v13 offset:12320
    ds_read_b64_tr_b16 a[46:47], v13 offset:13856
    ds_read_b64_tr_b16 a[52:53], v13 offset:12352
    ds_read_b64_tr_b16 a[54:55], v13 offset:13888
    ds_read_b64_tr_b16 a[76:77], v14 offset:12288
    ds_read_b64_tr_b16 a[78:79], v14 offset:13824
    ds_read_b64_tr_b16 a[84:85], v14 offset:12320
    ds_read_b64_tr_b16 a[86:87], v14 offset:13856
    ds_read_b64_tr_b16 a[92:93], v14 offset:12352
    ds_read_b64_tr_b16 a[94:95], v14 offset:13888
    ds_read_b64_tr_b16 a[124:125], v15 offset:12288
    ds_read_b64_tr_b16 a[126:127], v15 offset:13824
    ds_read_b64_tr_b16 a[132:133], v15 offset:12320
    ds_read_b64_tr_b16 a[134:135], v15 offset:13856
    ds_read_b64_tr_b16 v[60:61], v15 offset:12352
    ds_read_b64_tr_b16 v[62:63], v15 offset:13888
    s_waitcnt lgkmcnt(0)
    s_add_u32 s31, s36, 1179648
    s_add_u32 m0, s30, 12288
    s_nop 0
    buffer_load_dwordx4 v16, s[8:11], s31 offen lds
    s_add_u32 m0, s30, 13312
    s_nop 0
    buffer_load_dwordx4 v17, s[8:11], s31 offen lds
    s_add_u32 m0, s30, 14336
    s_nop 0
    buffer_load_dwordx4 v18, s[8:11], s31 offen lds
    s_add_u32 s31, s36, 2752512
    s_add_u32 m0, s30, 15360
    s_nop 0
    buffer_load_dwordx4 v16, s[8:11], s31 offen lds
    s_add_u32 m0, s30, 16384
    s_nop 0
    buffer_load_dwordx4 v17, s[8:11], s31 offen lds
    s_add_u32 m0, s30, 17408
    s_nop 0
    buffer_load_dwordx4 v18, s[8:11], s31 offen lds
    s_add_u32 s31, s36, 4325376
    s_add_u32 m0, s30, 18432
    s_nop 0
    buffer_load_dwordx4 v16, s[8:11], s31 offen lds
    s_add_u32 m0, s30, 19456
    s_nop 0
    buffer_load_dwordx4 v17, s[8:11], s31 offen lds
    s_add_u32 m0, s30, 20480
    s_nop 0
    buffer_load_dwordx4 v18, s[8:11], s31 offen lds
    s_add_u32 s31, s36, 5898240
    s_add_u32 m0, s30, 21504
    s_nop 0
    buffer_load_dwordx4 v16, s[8:11], s31 offen lds
    s_add_u32 m0, s30, 22528
    s_nop 0
    buffer_load_dwordx4 v17, s[8:11], s31 offen lds
    s_add_u32 m0, s30, 23552
    s_nop 0
    buffer_load_dwordx4 v18, s[8:11], s31 offen lds
    s_waitcnt vmcnt(12)
    ds_read_b64_tr_b16 a[16:17], v12 offset:0
    ds_read_b64_tr_b16 a[18:19], v12 offset:1536
    ds_read_b64_tr_b16 a[24:25], v12 offset:32
    ds_read_b64_tr_b16 a[26:27], v12 offset:1568
    ds_read_b64_tr_b16 v[40:41], v12 offset:64
    ds_read_b64_tr_b16 v[42:43], v12 offset:1600
    ds_read_b64_tr_b16 a[56:57], v13 offset:0
    ds_read_b64_tr_b16 a[58:59], v13 offset:1536
    ds_read_b64_tr_b16 a[64:65], v13 offset:32
    ds_read_b64_tr_b16 a[66:67], v13 offset:1568
    ds_read_b64_tr_b16 v[48:49], v13 offset:64
    ds_read_b64_tr_b16 v[50:51], v13 offset:1600
    ds_read_b64_tr_b16 a[96:97], v14 offset:0
    ds_read_b64_tr_b16 a[98:99], v14 offset:1536
    ds_read_b64_tr_b16 a[104:105], v14 offset:32
    ds_read_b64_tr_b16 a[106:107], v14 offset:1568
    ds_read_b64_tr_b16 a[112:113], v14 offset:64
    ds_read_b64_tr_b16 a[114:115], v14 offset:1600
    ds_read_b64_tr_b16 a[136:137], v15 offset:0
    ds_read_b64_tr_b16 a[138:139], v15 offset:1536
    ds_read_b64_tr_b16 a[144:145], v15 offset:32
    ds_read_b64_tr_b16 a[146:147], v15 offset:1568
    ds_read_b64_tr_b16 a[152:153], v15 offset:64
    ds_read_b64_tr_b16 a[154:155], v15 offset:1600
    s_waitcnt lgkmcnt(0)
    s_add_u32 s31, s36, 6291456
    s_add_u32 m0, s30, 0
    s_nop 0
    buffer_load_dwordx4 v16, s[8:11], s31 offen lds
    s_add_u32 m0, s30, 1024
    s_nop 0
    buffer_load_dwordx4 v17, s[8:11], s31 offen lds
    s_add_u32 m0, s30, 2048
    s_nop 0
    buffer_load_dwordx4 v18, s[8:11], s31 offen lds
    s_add_u32 s31, s36, 7077888
    s_add_u32 m0, s30, 3072
    s_nop 0
    buffer_load_dwordx4 v16, s[8:11], s31 offen lds
    s_add_u32 m0, s30, 4096
    s_nop 0
    buffer_load_dwordx4 v17, s[8:11], s31 offen lds
    s_add_u32 m0, s30, 5120
    s_nop 0
    buffer_load_dwordx4 v18, s[8:11], s31 offen lds
    s_add_u32 s31, s36, 6684672
    s_add_u32 m0, s30, 6144
    s_nop 0
    buffer_load_dwordx4 v16, s[8:11], s31 offen lds
    s_add_u32 m0, s30, 7168
    s_nop 0
    buffer_load_dwordx4 v17, s[8:11], s31 offen lds
    s_add_u32 m0, s30, 8192
    s_nop 0
    buffer_load_dwordx4 v18, s[8:11], s31 offen lds
    s_add_u32 s31, s36, 7471104
    s_add_u32 m0, s30, 9216
    s_nop 0
    buffer_load_dwordx4 v16, s[8:11], s31 offen lds
    s_add_u32 m0, s30, 10240
    s_nop 0
    buffer_load_dwordx4 v17, s[8:11], s31 offen lds
    s_add_u32 m0, s30, 11264
    s_nop 0
    buffer_load_dwordx4 v18, s[8:11], s31 offen lds
    s_waitcnt vmcnt(12)
    ds_read_b64_tr_b16 a[20:21], v12 offset:12288
    ds_read_b64_tr_b16 a[22:23], v12 offset:13824
    ds_read_b64_tr_b16 a[28:29], v12 offset:12320
    ds_read_b64_tr_b16 a[30:31], v12 offset:13856
    ds_read_b64_tr_b16 v[44:45], v12 offset:12352
    ds_read_b64_tr_b16 v[46:47], v12 offset:13888
    ds_read_b64_tr_b16 a[60:61], v13 offset:12288
    ds_read_b64_tr_b16 a[62:63], v13 offset:13824
    ds_read_b64_tr_b16 a[68:69], v13 offset:12320
    ds_read_b64_tr_b16 a[70:71], v13 offset:13856
    ds_read_b64_tr_b16 v[52:53], v13 offset:12352
    ds_read_b64_tr_b16 v[54:55], v13 offset:13888
    ds_read_b64_tr_b16 a[100:101], v14 offset:12288
    ds_read_b64_tr_b16 a[102:103], v14 offset:13824
    ds_read_b64_tr_b16 a[108:109], v14 offset:12320
    ds_read_b64_tr_b16 a[110:111], v14 offset:13856
    ds_read_b64_tr_b16 a[116:117], v14 offset:12352
    ds_read_b64_tr_b16 a[118:119], v14 offset:13888
    ds_read_b64_tr_b16 a[140:141], v15 offset:12288
    ds_read_b64_tr_b16 a[142:143], v15 offset:13824
    ds_read_b64_tr_b16 a[148:149], v15 offset:12320
    ds_read_b64_tr_b16 a[150:151], v15 offset:13856
    ds_read_b64_tr_b16 a[156:157], v15 offset:12352
    ds_read_b64_tr_b16 a[158:159], v15 offset:13888
    s_waitcnt lgkmcnt(0)
    s_waitcnt vmcnt(9)
    ds_read_b64_tr_b16 a[160:161], v31 offset:0
    ds_read_b64_tr_b16 a[162:163], v31 offset:1536
    ds_read_b64_tr_b16 a[168:169], v31 offset:32
    ds_read_b64_tr_b16 a[170:171], v31 offset:1568
    ds_read_b64_tr_b16 v[64:65], v31 offset:64
    ds_read_b64_tr_b16 v[66:67], v31 offset:1600
    s_waitcnt lgkmcnt(0)
    s_waitcnt vmcnt(6)
    ds_read_b64_tr_b16 a[176:177], v31 offset:3072
    ds_read_b64_tr_b16 a[178:179], v31 offset:4608
    ds_read_b64_tr_b16 a[184:185], v31 offset:3104
    ds_read_b64_tr_b16 a[186:187], v31 offset:4640
    ds_read_b64_tr_b16 a[192:193], v31 offset:3136
    ds_read_b64_tr_b16 a[194:195], v31 offset:4672
    s_waitcnt lgkmcnt(0)
    s_waitcnt vmcnt(3)
    ds_read_b64_tr_b16 a[164:165], v31 offset:6144
    ds_read_b64_tr_b16 a[166:167], v31 offset:7680
    ds_read_b64_tr_b16 a[172:173], v31 offset:6176
    ds_read_b64_tr_b16 a[174:175], v31 offset:7712
    ds_read_b64_tr_b16 v[68:69], v31 offset:6208
    ds_read_b64_tr_b16 v[70:71], v31 offset:7744
    s_waitcnt lgkmcnt(0)
    s_waitcnt vmcnt(0)
    ds_read_b64_tr_b16 a[180:181], v31 offset:9216
    ds_read_b64_tr_b16 a[182:183], v31 offset:10752
    ds_read_b64_tr_b16 a[188:189], v31 offset:9248
    ds_read_b64_tr_b16 a[190:191], v31 offset:10784
    ds_read_b64_tr_b16 a[196:197], v31 offset:9280
    ds_read_b64_tr_b16 a[198:199], v31 offset:10816
    s_waitcnt lgkmcnt(0)
    s_add_u32 s31, s37, 0
    s_add_u32 m0, s30, 0
    s_nop 0
    buffer_load_dwordx4 v19, s[12:15], s31 offen lds
    s_add_u32 m0, s30, 1024
    s_nop 0
    buffer_load_dwordx4 v20, s[12:15], s31 offen lds
    s_add_u32 m0, s30, 2048
    s_nop 0
    buffer_load_dwordx4 v21, s[12:15], s31 offen lds
    s_add_u32 m0, s30, 3072
    s_nop 0
    buffer_load_dwordx4 v22, s[12:15], s31 offen lds
    s_add_u32 m0, s30, 4096
    s_nop 0
    buffer_load_dwordx4 v23, s[12:15], s31 offen lds
    s_add_u32 m0, s30, 5120
    s_nop 0
    buffer_load_dwordx4 v24, s[12:15], s31 offen lds
    s_add_u32 m0, s30, 6144
    s_nop 0
    buffer_load_dwordx4 v25, s[12:15], s31 offen lds
    s_add_u32 m0, s30, 7168
    s_nop 0
    buffer_load_dwordx4 v26, s[12:15], s31 offen lds
    s_add_u32 m0, s30, 8192
    s_nop 0
    buffer_load_dwordx4 v27, s[12:15], s31 offen lds
    s_add_u32 m0, s30, 9216
    s_nop 0
    buffer_load_dwordx4 v28, s[12:15], s31 offen lds
    s_add_u32 s31, s37, 40960
    s_add_u32 m0, s30, 10240
    s_nop 0
    buffer_load_dwordx4 v19, s[12:15], s31 offen lds
    s_add_u32 m0, s30, 11264
    s_nop 0
    buffer_load_dwordx4 v20, s[12:15], s31 offen lds
    s_add_u32 m0, s30, 12288
    s_nop 0
    buffer_load_dwordx4 v21, s[12:15], s31 offen lds
    s_add_u32 m0, s30, 13312
    s_nop 0
    buffer_load_dwordx4 v22, s[12:15], s31 offen lds
    s_add_u32 m0, s30, 14336
    s_nop 0
    buffer_load_dwordx4 v23, s[12:15], s31 offen lds
    s_add_u32 m0, s30, 15360
    s_nop 0
    buffer_load_dwordx4 v24, s[12:15], s31 offen lds
    s_add_u32 m0, s30, 16384
    s_nop 0
    buffer_load_dwordx4 v25, s[12:15], s31 offen lds
    s_add_u32 m0, s30, 17408
    s_nop 0
    buffer_load_dwordx4 v26, s[12:15], s31 offen lds
    s_add_u32 m0, s30, 18432
    s_nop 0
    buffer_load_dwordx4 v27, s[12:15], s31 offen lds
    s_add_u32 m0, s30, 19456
    s_nop 0
    buffer_load_dwordx4 v28, s[12:15], s31 offen lds
    s_add_u32 s31, s37, 81920
    s_add_u32 m0, s30, 20480
    s_nop 0
    buffer_load_dwordx4 v19, s[12:15], s31 offen lds
    s_add_u32 m0, s30, 21504
    s_nop 0
    buffer_load_dwordx4 v20, s[12:15], s31 offen lds
    s_add_u32 m0, s30, 22528
    s_nop 0
    buffer_load_dwordx4 v21, s[12:15], s31 offen lds
    s_add_u32 m0, s30, 23552
    s_nop 0
    buffer_load_dwordx4 v22, s[12:15], s31 offen lds
    s_add_u32 m0, s30, 24576
    s_nop 0
    buffer_load_dwordx4 v23, s[12:15], s31 offen lds
    s_add_u32 m0, s30, 25600
    s_nop 0
    buffer_load_dwordx4 v24, s[12:15], s31 offen lds
    s_add_u32 m0, s30, 26624
    s_nop 0
    buffer_load_dwordx4 v25, s[12:15], s31 offen lds
    s_add_u32 m0, s30, 27648
    s_nop 0
    buffer_load_dwordx4 v26, s[12:15], s31 offen lds
    s_add_u32 m0, s30, 28672
    s_nop 0
    buffer_load_dwordx4 v27, s[12:15], s31 offen lds
    s_add_u32 m0, s30, 29696
    s_nop 0
    buffer_load_dwordx4 v28, s[12:15], s31 offen lds
    s_add_u32 s31, s37, 122880
    s_add_u32 m0, s30, 30720
    s_nop 0
    buffer_load_dwordx4 v19, s[12:15], s31 offen lds
    s_add_u32 m0, s30, 31744
    s_nop 0
    buffer_load_dwordx4 v20, s[12:15], s31 offen lds
    s_add_u32 m0, s30, 32768
    s_nop 0
    buffer_load_dwordx4 v21, s[12:15], s31 offen lds
    s_add_u32 m0, s30, 33792
    s_nop 0
    buffer_load_dwordx4 v22, s[12:15], s31 offen lds
    s_add_u32 m0, s30, 34816
    s_nop 0
    buffer_load_dwordx4 v23, s[12:15], s31 offen lds
    s_add_u32 m0, s30, 35840
    s_nop 0
    buffer_load_dwordx4 v24, s[12:15], s31 offen lds
    s_add_u32 m0, s30, 36864
    s_nop 0
    buffer_load_dwordx4 v25, s[12:15], s31 offen lds
    s_add_u32 m0, s30, 37888
    s_nop 0
    buffer_load_dwordx4 v26, s[12:15], s31 offen lds
    s_add_u32 m0, s30, 38912
    s_nop 0
    buffer_load_dwordx4 v27, s[12:15], s31 offen lds
    s_add_u32 m0, s30, 39936
    s_nop 0
    buffer_load_dwordx4 v28, s[12:15], s31 offen lds
    s_waitcnt vmcnt(30)
    ds_read_b64_tr_b16 a[200:201], v29 offset:0
    ds_read_b64_tr_b16 a[202:203], v29 offset:5120
    ds_read_b64_tr_b16 a[216:217], v29 offset:32
    ds_read_b64_tr_b16 a[218:219], v29 offset:5152
    ds_read_b64_tr_b16 a[232:233], v29 offset:64
    ds_read_b64_tr_b16 a[234:235], v29 offset:5184
    ds_read_b64_tr_b16 v[112:113], v29 offset:96
    ds_read_b64_tr_b16 v[114:115], v29 offset:5216
    ds_read_b64_tr_b16 v[136:137], v29 offset:128
    ds_read_b64_tr_b16 v[138:139], v29 offset:5248
    ds_read_b64_tr_b16 v[152:153], v29 offset:160
    ds_read_b64_tr_b16 v[154:155], v29 offset:5280
    ds_read_b64_tr_b16 v[168:169], v29 offset:192
    ds_read_b64_tr_b16 v[170:171], v29 offset:5312
    ds_read_b64_tr_b16 v[192:193], v29 offset:224
    ds_read_b64_tr_b16 v[194:195], v29 offset:5344
    ds_read_b64_tr_b16 v[216:217], v29 offset:256
    ds_read_b64_tr_b16 v[218:219], v29 offset:5376
    ds_read_b64_tr_b16 v[232:233], v29 offset:288
    ds_read_b64_tr_b16 v[234:235], v29 offset:5408
    s_waitcnt lgkmcnt(0)
    s_add_u32 s31, s37, 163840
    s_add_u32 m0, s30, 0
    s_nop 0
    buffer_load_dwordx4 v19, s[12:15], s31 offen lds
    s_add_u32 m0, s30, 1024
    s_nop 0
    buffer_load_dwordx4 v20, s[12:15], s31 offen lds
    s_add_u32 m0, s30, 2048
    s_nop 0
    buffer_load_dwordx4 v21, s[12:15], s31 offen lds
    s_add_u32 m0, s30, 3072
    s_nop 0
    buffer_load_dwordx4 v22, s[12:15], s31 offen lds
    s_add_u32 m0, s30, 4096
    s_nop 0
    buffer_load_dwordx4 v23, s[12:15], s31 offen lds
    s_add_u32 m0, s30, 5120
    s_nop 0
    buffer_load_dwordx4 v24, s[12:15], s31 offen lds
    s_add_u32 m0, s30, 6144
    s_nop 0
    buffer_load_dwordx4 v25, s[12:15], s31 offen lds
    s_add_u32 m0, s30, 7168
    s_nop 0
    buffer_load_dwordx4 v26, s[12:15], s31 offen lds
    s_add_u32 m0, s30, 8192
    s_nop 0
    buffer_load_dwordx4 v27, s[12:15], s31 offen lds
    s_add_u32 m0, s30, 9216
    s_nop 0
    buffer_load_dwordx4 v28, s[12:15], s31 offen lds
    s_waitcnt vmcnt(30)
    ds_read_b64_tr_b16 a[204:205], v29 offset:10240
    ds_read_b64_tr_b16 a[206:207], v29 offset:15360
    ds_read_b64_tr_b16 a[220:221], v29 offset:10272
    ds_read_b64_tr_b16 a[222:223], v29 offset:15392
    ds_read_b64_tr_b16 a[236:237], v29 offset:10304
    ds_read_b64_tr_b16 a[238:239], v29 offset:15424
    ds_read_b64_tr_b16 v[116:117], v29 offset:10336
    ds_read_b64_tr_b16 v[118:119], v29 offset:15456
    ds_read_b64_tr_b16 v[140:141], v29 offset:10368
    ds_read_b64_tr_b16 v[142:143], v29 offset:15488
    ds_read_b64_tr_b16 v[156:157], v29 offset:10400
    ds_read_b64_tr_b16 v[158:159], v29 offset:15520
    ds_read_b64_tr_b16 v[172:173], v29 offset:10432
    ds_read_b64_tr_b16 v[174:175], v29 offset:15552
    ds_read_b64_tr_b16 v[196:197], v29 offset:10464
    ds_read_b64_tr_b16 v[198:199], v29 offset:15584
    ds_read_b64_tr_b16 v[220:221], v29 offset:10496
    ds_read_b64_tr_b16 v[222:223], v29 offset:15616
    ds_read_b64_tr_b16 v[236:237], v29 offset:10528
    ds_read_b64_tr_b16 v[238:239], v29 offset:15648
    s_waitcnt lgkmcnt(0)
    v_and_b32 v8, 7, v1
    v_lshlrev_b32 v8, 3, v8
    v_add_u32 v8, s63, v8
    global_load_dwordx2 v[10:11], v8, s[48:49] sc1
    s_add_u32 s31, s37, 204800
    s_add_u32 m0, s30, 10240
    s_nop 0
    buffer_load_dwordx4 v19, s[12:15], s31 offen lds
    s_add_u32 m0, s30, 11264
    s_nop 0
    buffer_load_dwordx4 v20, s[12:15], s31 offen lds
    s_add_u32 m0, s30, 12288
    s_nop 0
    buffer_load_dwordx4 v21, s[12:15], s31 offen lds
    s_add_u32 m0, s30, 13312
    s_nop 0
    buffer_load_dwordx4 v22, s[12:15], s31 offen lds
    s_add_u32 m0, s30, 14336
    s_nop 0
    buffer_load_dwordx4 v23, s[12:15], s31 offen lds
    s_add_u32 m0, s30, 15360
    s_nop 0
    buffer_load_dwordx4 v24, s[12:15], s31 offen lds
    s_add_u32 m0, s30, 16384
    s_nop 0
    buffer_load_dwordx4 v25, s[12:15], s31 offen lds
    s_add_u32 m0, s30, 17408
    s_nop 0
    buffer_load_dwordx4 v26, s[12:15], s31 offen lds
    s_add_u32 m0, s30, 18432
    s_nop 0
    buffer_load_dwordx4 v27, s[12:15], s31 offen lds
    s_add_u32 m0, s30, 19456
    s_nop 0
    buffer_load_dwordx4 v28, s[12:15], s31 offen lds
    s_waitcnt vmcnt(31)
    ds_read_b64_tr_b16 a[208:209], v29 offset:20480
    ds_read_b64_tr_b16 a[210:211], v29 offset:25600
    ds_read_b64_tr_b16 a[224:225], v29 offset:20512
    ds_read_b64_tr_b16 a[226:227], v29 offset:25632
    ds_read_b64_tr_b16 a[240:241], v29 offset:20544
    ds_read_b64_tr_b16 a[242:243], v29 offset:25664
    ds_read_b64_tr_b16 v[120:121], v29 offset:20576
    ds_read_b64_tr_b16 v[122:123], v29 offset:25696
    ds_read_b64_tr_b16 v[144:145], v29 offset:20608
    ds_read_b64_tr_b16 v[146:147], v29 offset:25728
    ds_read_b64_tr_b16 v[160:161], v29 offset:20640
    ds_read_b64_tr_b16 v[162:163], v29 offset:25760
    ds_read_b64_tr_b16 v[176:177], v29 offset:20672
    ds_read_b64_tr_b16 v[178:179], v29 offset:25792
    ds_read_b64_tr_b16 v[200:201], v29 offset:20704
    ds_read_b64_tr_b16 v[202:203], v29 offset:25824
    ds_read_b64_tr_b16 v[224:225], v29 offset:20736
    ds_read_b64_tr_b16 v[226:227], v29 offset:25856
    ds_read_b64_tr_b16 v[240:241], v29 offset:20768
    ds_read_b64_tr_b16 v[242:243], v29 offset:25888
    s_waitcnt vmcnt(21)
    ds_read_b64_tr_b16 a[212:213], v29 offset:30720
    ds_read_b64_tr_b16 a[214:215], v29 offset:35840
    ds_read_b64_tr_b16 a[228:229], v29 offset:30752
    ds_read_b64_tr_b16 a[230:231], v29 offset:35872
    ds_read_b64_tr_b16 a[244:245], v29 offset:30784
    ds_read_b64_tr_b16 a[246:247], v29 offset:35904
    ds_read_b64_tr_b16 v[124:125], v29 offset:30816
    ds_read_b64_tr_b16 v[126:127], v29 offset:35936
    ds_read_b64_tr_b16 v[148:149], v29 offset:30848
    ds_read_b64_tr_b16 v[150:151], v29 offset:35968
    ds_read_b64_tr_b16 v[164:165], v29 offset:30880
    ds_read_b64_tr_b16 v[166:167], v29 offset:36000
    ds_read_b64_tr_b16 v[180:181], v29 offset:30912
    ds_read_b64_tr_b16 v[182:183], v29 offset:36032
    ds_read_b64_tr_b16 v[204:205], v29 offset:30944
    ds_read_b64_tr_b16 v[206:207], v29 offset:36064
    ds_read_b64_tr_b16 v[228:229], v29 offset:30976
    ds_read_b64_tr_b16 v[230:231], v29 offset:36096
    ds_read_b64_tr_b16 v[244:245], v29 offset:31008
    ds_read_b64_tr_b16 v[246:247], v29 offset:36128
    s_waitcnt vmcnt(11)
    ds_read_b64_tr_b16 v[72:73], v29 offset:0
    ds_read_b64_tr_b16 v[74:75], v29 offset:5120
    ds_read_b64_tr_b16 v[80:81], v29 offset:32
    ds_read_b64_tr_b16 v[82:83], v29 offset:5152
    ds_read_b64_tr_b16 a[248:249], v29 offset:64
    ds_read_b64_tr_b16 a[250:251], v29 offset:5184
    ds_read_b64_tr_b16 v[128:129], v29 offset:96
    ds_read_b64_tr_b16 v[130:131], v29 offset:5216
    ds_read_b64_tr_b16 v[88:89], v29 offset:128
    ds_read_b64_tr_b16 v[90:91], v29 offset:5248
    ds_read_b64_tr_b16 v[96:97], v29 offset:160
    ds_read_b64_tr_b16 v[98:99], v29 offset:5280
    ds_read_b64_tr_b16 v[184:185], v29 offset:192
    ds_read_b64_tr_b16 v[186:187], v29 offset:5312
    ds_read_b64_tr_b16 v[208:209], v29 offset:224
    ds_read_b64_tr_b16 v[210:211], v29 offset:5344
    ds_read_b64_tr_b16 v[104:105], v29 offset:256
    ds_read_b64_tr_b16 v[106:107], v29 offset:5376
    ds_read_b64_tr_b16 v[248:249], v29 offset:288
    ds_read_b64_tr_b16 v[250:251], v29 offset:5408
    s_waitcnt vmcnt(0)
    ds_read_b64_tr_b16 v[76:77], v29 offset:10240
    ds_read_b64_tr_b16 v[78:79], v29 offset:15360
    ds_read_b64_tr_b16 v[84:85], v29 offset:10272
    ds_read_b64_tr_b16 v[86:87], v29 offset:15392
    ds_read_b64_tr_b16 a[252:253], v29 offset:10304
    ds_read_b64_tr_b16 a[254:255], v29 offset:15424
    ds_read_b64_tr_b16 v[132:133], v29 offset:10336
    ds_read_b64_tr_b16 v[134:135], v29 offset:15456
    ds_read_b64_tr_b16 v[92:93], v29 offset:10368
    ds_read_b64_tr_b16 v[94:95], v29 offset:15488
    ds_read_b64_tr_b16 v[100:101], v29 offset:10400
    ds_read_b64_tr_b16 v[102:103], v29 offset:15520
    ds_read_b64_tr_b16 v[188:189], v29 offset:10432
    ds_read_b64_tr_b16 v[190:191], v29 offset:15552
    ds_read_b64_tr_b16 v[212:213], v29 offset:10464
    ds_read_b64_tr_b16 v[214:215], v29 offset:15584
    ds_read_b64_tr_b16 v[108:109], v29 offset:10496
    ds_read_b64_tr_b16 v[110:111], v29 offset:15616
    ds_read_b64_tr_b16 v[252:253], v29 offset:10528
    ds_read_b64_tr_b16 v[254:255], v29 offset:15648
    v_not_b32 v10, v10
    v_xor_b32 v9, 0x2000, v11
    v_or_b32 v10, v10, v9
    v_cmp_ne_u32 vcc, 0, v10
    s_mov_b64 s[56:57], vcc
    v_lshlrev_b32 v8, 2, v1
    s_mov_b32 s34, 54525952
    buffer_load_dword v9, v8, s[4:7], s34 offen sc1
    s_waitcnt lgkmcnt(0)
    s_barrier
    ds_write_b128 v30, v[32:35] offset:0
    ds_write_b128 v30, v[36:39] offset:1024
    ds_write_b128 v30, v[40:43] offset:2048
    ds_write_b128 v30, v[44:47] offset:3072
    ds_write_b128 v30, v[48:51] offset:4096
    ds_write_b128 v30, v[52:55] offset:5120
    ds_write_b128 v30, v[56:59] offset:6144
    ds_write_b128 v30, v[60:63] offset:7168
    ds_write_b128 v30, v[64:67] offset:8192
    ds_write_b128 v30, v[68:71] offset:9216
    ds_write_b128 v30, v[72:75] offset:10240
    ds_write_b128 v30, v[76:79] offset:11264
    ds_write_b128 v30, v[80:83] offset:12288
    ds_write_b128 v30, v[84:87] offset:13312
    ds_write_b128 v30, v[88:91] offset:14336
    ds_write_b128 v30, v[92:95] offset:15360
    ds_write_b128 v30, v[96:99] offset:16384
    ds_write_b128 v30, v[100:103] offset:17408
    ds_write_b128 v30, v[104:107] offset:18432
    ds_write_b128 v30, v[108:111] offset:19456
    s_cmp_eq_u64 s[56:57], 0
    s_cbranch_scc1 LD_ok_5
    v_and_b32 v4, 7, v1
    v_lshlrev_b32 v4, 3, v4
    v_add_u32 v4, s63, v4
    s_mov_b32 s35, 0
WI_7:
    global_load_dwordx2 v[6:7], v4, s[48:49] sc1
    s_waitcnt vmcnt(0)
    v_not_b32 v6, v6
    v_xor_b32 v5, 0x2000, v7
    v_or_b32 v6, v6, v5
    v_cmp_ne_u32 vcc, 0, v6
    s_cbranch_vccz WG_8
    v_lshrrev_b32 v7, 8, v7
    s_mov_b32 s30, 0
    v_readlane_b32 s31, v7, 0
    s_add_u32 s30, s30, s31
    v_readlane_b32 s31, v7, 1
    s_add_u32 s30, s30, s31
    v_readlane_b32 s31, v7, 2
    s_add_u32 s30, s30, s31
    v_readlane_b32 s31, v7, 3
    s_add_u32 s30, s30, s31
    v_readlane_b32 s31, v7, 4
    s_add_u32 s30, s30, s31
    v_readlane_b32 s31, v7, 5
    s_add_u32 s30, s30, s31
    v_readlane_b32 s31, v7, 6
    s_add_u32 s30, s30, s31
    v_readlane_b32 s31, v7, 7
    s_add_u32 s30, s30, s31
    s_cmp_ge_u32 s30, 256
    s_cbranch_scc1 M_again
    s_sleep 20
    s_add_u32 s35, s35, 1
    s_cmp_lt_u32 s35, 200000
    s_cbranch_scc1 WI_7
    s_branch M_fail
WG_8:
    v_lshlrev_b32 v4, 2, v1
    s_mov_b32 s34, 54525952
    buffer_load_dword v5, v4, s[4:7], s34 offen sc1
    s_waitcnt vmcnt(0)
    v_and_b32 v4, 2, v5
    v_cmp_eq_u32 vcc, 2, v4
    v_and_b32 v5, 1, v5
    v_cmp_eq_u32 s[20:21], 1, v5
    s_nop 3
    s_and_b32 s20, s20, 0x3ffffff
    s_xor_b32 s21, s20, 0x1555555
    s_bcnt1_i32_b32 s21, s21
    s_cmp_le_u32 s21, 5
    s_cselect_b32 s20, 0x1555555, s20
    s_cmp_ge_u32 s21, 21
    s_cselect_b32 s20, 0x2aaaaaa, s20
    s_and_b32 s21, vcc_lo, 0x1ff
    s_bcnt1_i32_b32 s21, s21
    s_cmp_ge_u32 s21, 5
    s_cselect_b32 s21, 16384, 0
    s_branch LD_dn_6
LD_ok_5:
    s_waitcnt vmcnt(0)
    v_and_b32 v8, 2, v9
    v_cmp_eq_u32 vcc, 2, v8
    v_and_b32 v9, 1, v9
    v_cmp_eq_u32 s[20:21], 1, v9
    s_nop 3
    s_and_b32 s20, s20, 0x3ffffff
    s_xor_b32 s21, s20, 0x1555555
    s_bcnt1_i32_b32 s21, s21
    s_cmp_le_u32 s21, 5
    s_cselect_b32 s20, 0x1555555, s20
    s_cmp_ge_u32 s21, 21
    s_cselect_b32 s20, 0x2aaaaaa, s20
    s_and_b32 s21, vcc_lo, 0x1ff
    s_bcnt1_i32_b32 s21, s21
    s_cmp_ge_u32 s21, 5
    s_cselect_b32 s21, 16384, 0
LD_dn_6:
    s_waitcnt lgkmcnt(0)
    v_and_b32 v104, 2, v1
    v_cmp_eq_u32 vcc, 0, v104
    v_mov_b32 v104, 0x4444
    v_mov_b32 v105, 0xeeee
    v_cndmask_b32 v3, v105, v104, vcc
    s_lshl_b32 s30, s16, 11
    s_lshl_b32 s31, s16, 9
    v_add_u32 v4, s30, v2
    v_add_u32 v5, s31, v2
    v_add_u32 v4, 16384, v4
    v_add_u32 v5, 49152, v5
    s_add_u32 s52, s30, 81920
    s_add_u32 s53, s31, 90112
    s_xor_b32 s31, s30, 2048
    s_add_u32 s31, s31, 81920
    v_add_u32 v9, s31, v2
    s_xor_b32 s31, s30, 4096
    s_add_u32 s31, s31, 81920
    v_add_u32 v10, s31, v2
    s_xor_b32 s31, s30, 6144
    s_add_u32 s31, s31, 81920
    v_add_u32 v11, s31, v2
    v_add_u32 v13, 90112, v2
    s_mul_i32 s30, s16, 20480
    v_add_u32 v12, s30, v2
    s_lshl_b32 s30, s16, 3
    v_add_u32 v0, s30, v1
    s_lshl_b32 s30, s16, 1
    s_add_u32 s30, s30, 24
    v_add_u32 v104, s30, v1
    v_cmp_gt_u32 vcc, 8, v1
    s_nop 1
    v_cndmask_b32 v0, v104, v0, vcc
    v_lshlrev_b32 v0, 7, v0
    s_xor_b32 s70, s21, 638976
    s_lshr_b32 s29, s20, 0
    s_and_b32 s29, s29, 1
    s_lshl_b32 s29, s29, 13
    s_add_u32 s70, s70, s29
    v_and_b32 v104, 12, v1
    v_lshlrev_b32 v104, 4, v104
    v_and_b32 v105, 1, v1
    v_lshlrev_b32 v105, 5, v105
    v_add_u32 v104, v104, v105
    v_and_b32 v105, 48, v1
    v_lshrrev_b32 v105, 1, v105
    v_and_b32 v106, 2, v1
    v_lshlrev_b32 v106, 1, v106
    v_add3_u32 v14, v104, v105, v106
    s_mul_i32 s30, s16, 768
    s_add_u32 s30, s30, 92160
    v_add_u32 v14, s30, v14
    v_and_b32 v104, 48, v1
    v_lshlrev_b32 v104, 4, v104
    v_and_b32 v105, 15, v1
    v_lshlrev_b32 v105, 3, v105
    v_add_u32 v15, v104, v105
    v_add_u32 v15, 92160, v15
    v_lshlrev_b32 v6, 2, v1
    s_or_b32 s30, s17, s16
    s_mov_b32 s71, 236978176
    s_cselect_b32 s71, 0x7ffffff0, s71
    s_mul_i32 s38, s16, 163840
    s_lshl_b32 s30, s17, 8
    s_add_u32 s38, s38, s30
    s_barrier
    s_mov_b32 s19, 0
    s_mov_b32 s24, 54722560
VO_step:
    s_mul_i32 s28, s19, 171
    s_lshr_b32 s28, s28, 9
    s_mul_i32 s27, s28, 3
    s_sub_u32 s27, s19, s27
    s_mul_i32 s27, s27, 655360
    s_add_u32 s28, s28, 4
    s_lshl_b32 s25, s28, 21
    s_add_u32 s25, s25, s27
    s_lshr_b32 s29, s20, s28
    s_and_b32 s29, s29, 1
    s_lshl_b32 s29, s29, 13
    s_add_u32 s25, s25, s29
    s_add_u32 s25, s25, s38
    s_add_u32 s64, s25, 65536
    s_lshr_b32 s29, s64, 5
    s_xor_b32 s29, s29, s21
    s_not_b32 s29, s29
    s_and_b32 s29, s29, 16384
    s_xor_b32 s64, s64, s29
    s_add_u32 s65, s25, 81920
    s_lshr_b32 s29, s65, 5
    s_xor_b32 s29, s29, s21
    s_not_b32 s29, s29
    s_and_b32 s29, s29, 16384
    s_xor_b32 s65, s65, s29
    s_add_u32 s66, s25, 98304
    s_lshr_b32 s29, s66, 5
    s_xor_b32 s29, s29, s21
    s_not_b32 s29, s29
    s_and_b32 s29, s29, 16384
    s_xor_b32 s66, s66, s29
    s_add_u32 s67, s25, 114688
    s_lshr_b32 s29, s67, 5
    s_xor_b32 s29, s29, s21
    s_not_b32 s29, s29
    s_and_b32 s29, s29, 16384
    s_xor_b32 s67, s67, s29
    s_add_u32 s68, s25, 131072
    s_lshr_b32 s29, s68, 5
    s_xor_b32 s29, s29, s21
    s_not_b32 s29, s29
    s_and_b32 s29, s29, 16384
    s_xor_b32 s68, s68, s29
    s_add_u32 s69, s25, 147456
    s_lshr_b32 s29, s69, 5
    s_xor_b32 s29, s29, s21
    s_not_b32 s29, s29
    s_and_b32 s29, s29, 16384
    s_xor_b32 s69, s69, s29
    s_mov_b32 s35, 0
    v_add_u32 v24, s52, v2
VO_pre:
    v_mov_b64 v[60:61], 0
    v_mov_b64 v[62:63], 0
    v_mov_b64 v[64:65], 0
    v_mov_b64 v[66:67], 0
    v_mov_b64 v[68:69], 0
    v_mov_b64 v[70:71], 0
    v_mov_b64 v[72:73], 0
    v_mov_b64 v[74:75], 0
    v_mov_b64 v[76:77], 0
    v_mov_b64 v[78:79], 0
    ds_read_b128 v[80:83], v12 offset:0
    ds_read_b128 v[84:87], v12 offset:1024
    ds_read_b128 v[88:91], v12 offset:2048
    ds_read_b128 v[92:95], v12 offset:3072
    ds_read_b128 v[96:99], v12 offset:4096
    ds_read_b128 v[100:103], v12 offset:5120
    s_waitcnt lgkmcnt(0)
    s_cmp_lg_u32 s35, 0
    s_cbranch_scc1 VO_late
    s_mov_b32 s35, 0
    s_mov_b64 exec, 0x3ff
    buffer_load_dword v16, v0, s[4:7], s70 offen sc1
    s_sleep 1
    buffer_load_dword v17, v0, s[4:7], s70 offen sc1
    s_sleep 1
    buffer_load_dword v18, v0, s[4:7], s70 offen sc1
    s_sleep 1
VO_hu:
    buffer_load_dword v19, v0, s[4:7], s70 offen sc1
    s_waitcnt vmcnt(3)
    v_cmp_gt_u32 vcc, s19, v16
    s_cbranch_vccz VO_hud
    buffer_load_dword v16, v0, s[4:7], s70 offen sc1
    s_waitcnt vmcnt(3)
    v_cmp_gt_u32 vcc, s19, v17
    s_cbranch_vccz VO_hud
    buffer_load_dword v17, v0, s[4:7], s70 offen sc1
    s_waitcnt vmcnt(3)
    v_cmp_gt_u32 vcc, s19, v18
    s_cbranch_vccz VO_hud
    buffer_load_dword v18, v0, s[4:7], s70 offen sc1
    s_waitcnt vmcnt(3)
    v_cmp_gt_u32 vcc, s19, v19
    s_cbranch_vccz VO_hud
    s_add_u32 s35, s35, 1
    s_cmp_lt_u32 s35, 200000
    s_cbranch_scc1 VO_hu
    s_branch M_fail
VO_hud:
    s_mov_b32 s35, 0
    s_mov_b64 exec, -1
VO_late:
    s_add_u32 s60, s25, 0
    s_lshr_b32 s29, s60, 5
    s_xor_b32 s29, s29, s21
    s_not_b32 s29, s29
    s_and_b32 s29, s29, 16384
    s_xor_b32 s60, s60, s29
    s_add_u32 s61, s25, 16384
    s_lshr_b32 s29, s61, 5
    s_xor_b32 s29, s29, s21
    s_not_b32 s29, s29
    s_and_b32 s29, s29, 16384
    s_xor_b32 s61, s61, s29
    s_add_u32 s62, s25, 32768
    s_lshr_b32 s29, s62, 5
    s_xor_b32 s29, s29, s21
    s_not_b32 s29, s29
    s_and_b32 s29, s29, 16384
    s_xor_b32 s62, s62, s29
    s_add_u32 s63, s25, 49152
    s_lshr_b32 s29, s63, 5
    s_xor_b32 s29, s29, s21
    s_not_b32 s29, s29
    s_and_b32 s29, s29, 16384
    s_xor_b32 s63, s63, s29
VO_poll:
    s_mov_b32 m0, s52
    s_add_u32 s35, s35, 1
    buffer_load_dwordx4 v4, s[4:7], s24 offen sc1 lds
    buffer_load_dwordx4 v4, s[4:7], s24 offen offset:1024 sc1 lds
    s_mov_b32 m0, s53
    s_mov_b32 exec_hi, 0
    buffer_load_dwordx4 v5, s[4:7], s24 offen sc1 lds
    s_mov_b32 exec_hi, -1
    s_cmp_ge_u32 s35, 200000
    s_cbranch_scc1 M_fail
    s_waitcnt vmcnt(2)
    ds_read_b128 v[16:19], v24 offset:0
    s_waitcnt vmcnt(1)
    ds_read_b128 v[20:23], v24 offset:1024
    s_waitcnt lgkmcnt(1)
    v_smfmac_f32_16x16x64_bf16 v[60:63], v[16:19], a[0:7], v3
    v_smfmac_f32_16x16x64_bf16 v[64:67], v[16:19], a[8:15], v3
    s_waitcnt vmcnt(0)
    s_barrier
    ds_read_b128 v[28:31], v9 offset:0
    v_smfmac_f32_16x16x64_bf16 v[68:71], v[16:19], v[80:87], v3
    s_waitcnt lgkmcnt(1)
    ds_read_b128 v[32:35], v9 offset:1024
    v_smfmac_f32_16x16x64_bf16 v[60:63], v[20:23], a[16:23], v3
    ds_read_b128 v[36:39], v10 offset:0
    v_smfmac_f32_16x16x64_bf16 v[64:67], v[20:23], a[24:31], v3
    ds_read_b128 v[40:43], v10 offset:1024
    v_smfmac_f32_16x16x64_bf16 v[68:71], v[20:23], v[88:95], v3
    s_waitcnt lgkmcnt(3)
    ds_read_b128 v[44:47], v11 offset:0
    v_smfmac_f32_16x16x64_bf16 v[60:63], v[28:31], a[32:39], v3
    ds_read_b128 v[48:51], v11 offset:1024
    v_max3_u32 v107, v19, v23, v31
    v_smfmac_f32_16x16x64_bf16 v[64:67], v[28:31], a[40:47], v3
    ds_read_b128 v[52:55], v13 offset:0
    v_smfmac_f32_16x16x64_bf16 v[68:71], v[28:31], a[48:55], v3
    s_waitcnt lgkmcnt(5)
    ds_read_b128 v[56:59], v13 offset:1024
    s_waitcnt lgkmcnt(5)
    v_max3_u32 v107, v107, v35, v39
    v_smfmac_f32_16x16x64_bf16 v[60:63], v[32:35], a[56:63], v3
    ds_read_b128 v[80:83], v12 offset:6144
    v_mov_b64 v[28:29], 0
    v_smfmac_f32_16x16x64_bf16 v[64:67], v[32:35], a[64:71], v3
    ds_read_b128 v[84:87], v12 offset:7168
    v_mov_b64 v[30:31], 0
    v_smfmac_f32_16x16x64_bf16 v[68:71], v[32:35], v[96:103], v3
    ds_read_b128 v[88:91], v12 offset:8192
    s_waitcnt lgkmcnt(6)
    v_max3_u32 v107, v107, v43, v47
    v_smfmac_f32_16x16x64_bf16 v[60:63], v[36:39], a[72:79], v3
    ds_read_b128 v[92:95], v12 offset:9216
    v_mov_b64 v[32:33], 0
    v_smfmac_f32_16x16x64_bf16 v[64:67], v[36:39], a[80:87], v3
    ds_read_b128 v[96:99], v12 offset:18432
    v_mov_b64 v[34:35], 0
    v_smfmac_f32_16x16x64_bf16 v[68:71], v[36:39], a[88:95], v3
    ds_read_b128 v[100:103], v12 offset:19456
    s_waitcnt lgkmcnt(7)
    v_max3_u32 v107, v107, v51, v55
    v_smfmac_f32_16x16x64_bf16 v[60:63], v[40:43], a[96:103], v3
    v_mov_b64 v[36:37], 0
    v_smfmac_f32_16x16x64_bf16 v[64:67], v[40:43], a[104:111], v3
    v_mov_b64 v[38:39], 0
    v_smfmac_f32_16x16x64_bf16 v[68:71], v[40:43], a[112:119], v3
    s_waitcnt lgkmcnt(6)
    v_max_u32 v107, v107, v59
    v_cmp_eq_u32 vcc, -1, v107
    v_smfmac_f32_16x16x64_bf16 v[60:63], v[44:47], a[120:127], v3
    s_cbranch_vccnz VO_redo
    v_mov_b64 v[40:41], 0
    v_smfmac_f32_16x16x64_bf16 v[64:67], v[44:47], a[128:135], v3
    s_waitcnt lgkmcnt(4)
    v_mov_b64 v[42:43], 0
    v_smfmac_f32_16x16x64_bf16 v[68:71], v[44:47], v[80:87], v3
    ds_read_b128 v[80:83], v12 offset:10240
    v_smfmac_f32_16x16x64_bf16 v[68:71], v[48:51], a[152:159], v3
    s_waitcnt lgkmcnt(3)
    ds_read_b128 v[84:87], v12 offset:11264
    v_mov_b64 v[44:45], 0
    v_smfmac_f32_16x16x64_bf16 v[68:71], v[52:55], v[88:95], v3
    ds_read_b128 v[88:91], v12 offset:14336
    v_mov_b64 v[46:47], 0
    v_smfmac_f32_16x16x64_bf16 v[68:71], v[56:59], a[192:199], v3
    ds_read_b128 v[92:95], v12 offset:15360
    v_smfmac_f32_16x16x64_bf16 v[60:63], v[48:51], a[136:143], v3
    s_nop 0
    v_smfmac_f32_16x16x64_bf16 v[60:63], v[52:55], a[160:167], v3
    s_nop 0
    v_smfmac_f32_16x16x64_bf16 v[60:63], v[56:59], a[176:183], v3
    s_nop 0
    v_smfmac_f32_16x16x64_bf16 v[64:67], v[48:51], a[144:151], v3
    s_nop 0
    v_add_f32 v68, v68, v70
    v_smfmac_f32_16x16x64_bf16 v[64:67], v[52:55], a[168:175], v3
    s_nop 0
    v_add_f32 v69, v69, v71
    v_smfmac_f32_16x16x64_bf16 v[64:67], v[56:59], a[184:191], v3
    v_cvt_pk_bf16_f32 v106, v68, v69
    ds_write_b32 v14, v106 offset:512
    v_add_f32 v60, v60, v62
    v_add_f32 v61, v61, v63
    v_cvt_pk_bf16_f32 v104, v60, v61
    ds_write_b32 v14, v104 offset:0
    v_cmp_u_f32 vcc, v60, v61
    s_nop 0
    v_add_f32 v64, v64, v66
    v_add_f32 v65, v65, v67
    v_cvt_pk_bf16_f32 v105, v64, v65
    ds_write_b32 v14, v105 offset:256
    v_mov_b64 v[48:49], 0
    v_mov_b64 v[50:51], 0
    v_mov_b64 v[52:53], 0
    v_mov_b64 v[54:55], 0
    v_mov_b64 v[56:57], 0
    v_mov_b64 v[58:59], 0
    s_cbranch_vccnz VO_nan
VO_fine:
    s_waitcnt lgkmcnt(0)
    s_barrier
    ds_read_b64_tr_b16 v[16:17], v15 offset:0
    ds_read_b64_tr_b16 v[18:19], v15 offset:128
    ds_read_b64_tr_b16 v[20:21], v15 offset:1024
    ds_read_b64_tr_b16 v[22:23], v15 offset:1152
    ds_read_b64_tr_b16 v[24:25], v15 offset:2048
    ds_read_b64_tr_b16 v[26:27], v15 offset:2176
    s_waitcnt lgkmcnt(4)
    v_smfmac_f32_16x16x64_bf16 v[72:75], v[16:19], v[216:223], v3
    s_waitcnt lgkmcnt(2)
    v_smfmac_f32_16x16x64_bf16 v[72:75], v[20:23], v[224:231], v3
    s_waitcnt lgkmcnt(0)
    v_smfmac_f32_16x16x64_bf16 v[72:75], v[24:27], v[96:103], v3
    ds_read_b128 v[96:99], v12 offset:12288
    v_smfmac_f32_16x16x64_bf16 v[28:31], v[16:19], a[200:207], v3
    ds_read_b128 v[100:103], v12 offset:13312
    v_smfmac_f32_16x16x64_bf16 v[28:31], v[20:23], a[208:215], v3
    s_nop 1
    v_smfmac_f32_16x16x64_bf16 v[28:31], v[24:27], v[80:87], v3
    ds_read_b128 v[80:83], v12 offset:16384
    v_add_f32 v72, v72, v74
    v_smfmac_f32_16x16x64_bf16 v[36:39], v[16:19], a[232:239], v3
    ds_read_b128 v[84:87], v12 offset:17408
    v_add_f32 v73, v73, v75
    v_smfmac_f32_16x16x64_bf16 v[36:39], v[20:23], a[240:247], v3
    v_cvt_pk_bf16_f32 v60, v72, v73
    v_smfmac_f32_16x16x64_bf16 v[36:39], v[24:27], a[248:255], v3
    buffer_store_dword v60, v6, s[4:7], s68 offen sc1
    v_add_f32 v28, v28, v30
    v_smfmac_f32_16x16x64_bf16 v[44:47], v[16:19], v[136:143], v3
    v_add_f32 v29, v29, v31
    v_smfmac_f32_16x16x64_bf16 v[44:47], v[20:23], v[144:151], v3
    v_cvt_pk_bf16_f32 v61, v28, v29
    v_smfmac_f32_16x16x64_bf16 v[44:47], v[24:27], v[88:95], v3
    buffer_store_dword v61, v6, s[4:7], s60 offen sc1
    v_add_f32 v36, v36, v38
    v_smfmac_f32_16x16x64_bf16 v[52:55], v[16:19], v[168:175], v3
    v_add_f32 v37, v37, v39
    v_smfmac_f32_16x16x64_bf16 v[52:55], v[20:23], v[176:183], v3
    v_cvt_pk_bf16_f32 v62, v36, v37
    v_smfmac_f32_16x16x64_bf16 v[52:55], v[24:27], v[184:191], v3
    buffer_store_dword v62, v6, s[4:7], s62 offen sc1
    v_add_f32 v44, v44, v46
    v_smfmac_f32_16x16x64_bf16 v[76:79], v[16:19], v[232:239], v3
    v_add_f32 v45, v45, v47
    v_smfmac_f32_16x16x64_bf16 v[76:79], v[20:23], v[240:247], v3
    v_cvt_pk_bf16_f32 v63, v44, v45
    v_smfmac_f32_16x16x64_bf16 v[76:79], v[24:27], v[248:255], v3
    buffer_store_dword v63, v6, s[4:7], s64 offen sc1
    v_add_f32 v52, v52, v54
    v_smfmac_f32_16x16x64_bf16 v[32:35], v[16:19], a[216:223], v3
    v_add_f32 v53, v53, v55
    v_smfmac_f32_16x16x64_bf16 v[32:35], v[20:23], a[224:231], v3
    s_waitcnt lgkmcnt(2)
    v_cvt_pk_bf16_f32 v64, v52, v53
    v_smfmac_f32_16x16x64_bf16 v[32:35], v[24:27], v[96:103], v3
    buffer_store_dword v64, v6, s[4:7], s66 offen sc1
    v_add_f32 v76, v76, v78
    v_smfmac_f32_16x16x64_bf16 v[40:43], v[16:19], v[112:119], v3
    v_add_f32 v77, v77, v79
    v_smfmac_f32_16x16x64_bf16 v[40:43], v[20:23], v[120:127], v3
    v_cvt_pk_bf16_f32 v65, v76, v77
    v_smfmac_f32_16x16x64_bf16 v[40:43], v[24:27], v[128:135], v3
    buffer_store_dword v65, v6, s[4:7], s69 offen sc1
    v_add_f32 v32, v32, v34
    v_smfmac_f32_16x16x64_bf16 v[48:51], v[16:19], v[152:159], v3
    v_add_f32 v33, v33, v35
    v_smfmac_f32_16x16x64_bf16 v[48:51], v[20:23], v[160:167], v3
    s_waitcnt lgkmcnt(0)
    v_cvt_pk_bf16_f32 v66, v32, v33
    v_smfmac_f32_16x16x64_bf16 v[48:51], v[24:27], v[80:87], v3
    buffer_store_dword v66, v6, s[4:7], s61 offen sc1
    v_add_f32 v40, v40, v42
    v_smfmac_f32_16x16x64_bf16 v[56:59], v[16:19], v[192:199], v3
    v_add_f32 v41, v41, v43
    v_smfmac_f32_16x16x64_bf16 v[56:59], v[20:23], v[200:207], v3
    v_cvt_pk_bf16_f32 v67, v40, v41
    v_smfmac_f32_16x16x64_bf16 v[56:59], v[24:27], v[208:215], v3
    buffer_store_dword v67, v6, s[4:7], s63 offen sc1
    v_add_f32 v48, v48, v50
    v_add_f32 v49, v49, v51
    v_cvt_pk_bf16_f32 v68, v48, v49
    buffer_store_dword v68, v6, s[4:7], s65 offen sc1
    s_nop 2
    v_add_f32 v56, v56, v58
    v_add_f32 v57, v57, v59
    v_cvt_pk_bf16_f32 v69, v56, v57
    buffer_store_dword v69, v6, s[4:7], s67 offen sc1
    s_add_u32 s30, s19, 1
    v_mov_b32 v104, s30
    buffer_store_dword v104, off, s[4:7], s71 sc1
    s_add_u32 s19, s19, 1
    s_lshr_b32 s28, s19, 4
    s_lshl_b32 s24, s19, 17
    s_lshr_b32 s29, s20, s28
    s_and_b32 s29, s29, 1
    s_lshl_b32 s29, s29, 13
    s_add_u32 s24, s24, s29
    s_lshl_b32 s29, s19, 12
    s_xor_b32 s29, s29, s21
    s_and_b32 s29, s29, 16384
    s_sub_u32 s24, s24, s29
    s_cmp_lt_u32 s19, 64
    s_cbranch_scc1 VO_step
    s_endpgm
VO_redo:
    s_waitcnt lgkmcnt(0)
    s_barrier
    s_branch VO_pre
VO_nan:
    s_waitcnt lgkmcnt(0)
    v_add_u32 v107, 81920, v2
    v_mov_b32 v108, 0
    ds_read_b32 v109, v107 offset:0
    s_waitcnt lgkmcnt(0)
    v_max_u32 v108, v108, v109
    ds_read_b32 v109, v107 offset:4
    s_waitcnt lgkmcnt(0)
    v_max_u32 v108, v108, v109
    ds_read_b32 v109, v107 offset:8
    s_waitcnt lgkmcnt(0)
    v_max_u32 v108, v108, v109
    ds_read_b32 v109, v107 offset:12
    s_waitcnt lgkmcnt(0)
    v_max_u32 v108, v108, v109
    ds_read_b32 v109, v107 offset:1024
    s_waitcnt lgkmcnt(0)
    v_max_u32 v108, v108, v109
    ds_read_b32 v109, v107 offset:1028
    s_waitcnt lgkmcnt(0)
    v_max_u32 v108, v108, v109
    ds_read_b32 v109, v107 offset:1032
    s_waitcnt lgkmcnt(0)
    v_max_u32 v108, v108, v109
    ds_read_b32 v109, v107 offset:1036
    s_waitcnt lgkmcnt(0)
    v_max_u32 v108, v108, v109
    ds_read_b32 v109, v107 offset:2048
    s_waitcnt lgkmcnt(0)
    v_max_u32 v108, v108, v109
    ds_read_b32 v109, v107 offset:2052
    s_waitcnt lgkmcnt(0)
    v_max_u32 v108, v108, v109
    ds_read_b32 v109, v107 offset:2056
    s_waitcnt lgkmcnt(0)
    v_max_u32 v108, v108, v109
    ds_read_b32 v109, v107 offset:2060
    s_waitcnt lgkmcnt(0)
    v_max_u32 v108, v108, v109
    ds_read_b32 v109, v107 offset:3072
    s_waitcnt lgkmcnt(0)
    v_max_u32 v108, v108, v109
    ds_read_b32 v109, v107 offset:3076
    s_waitcnt lgkmcnt(0)
    v_max_u32 v108, v108, v109
    ds_read_b32 v109, v107 offset:3080
    s_waitcnt lgkmcnt(0)
    v_max_u32 v108, v108, v109
    ds_read_b32 v109, v107 offset:3084
    s_waitcnt lgkmcnt(0)
    v_max_u32 v108, v108, v109
    ds_read_b32 v109, v107 offset:4096
    s_waitcnt lgkmcnt(0)
    v_max_u32 v108, v108, v109
    ds_read_b32 v109, v107 offset:4100
    s_waitcnt lgkmcnt(0)
    v_max_u32 v108, v108, v109
    ds_read_b32 v109, v107 offset:4104
    s_waitcnt lgkmcnt(0)
    v_max_u32 v108, v108, v109
    ds_read_b32 v109, v107 offset:4108
    s_waitcnt lgkmcnt(0)
    v_max_u32 v108, v108, v109
    ds_read_b32 v109, v107 offset:5120
    s_waitcnt lgkmcnt(0)
    v_max_u32 v108, v108, v109
    ds_read_b32 v109, v107 offset:5124
    s_waitcnt lgkmcnt(0)
    v_max_u32 v108, v108, v109
    ds_read_b32 v109, v107 offset:5128
    s_waitcnt lgkmcnt(0)
    v_max_u32 v108, v108, v109
    ds_read_b32 v109, v107 offset:5132
    s_waitcnt lgkmcnt(0)
    v_max_u32 v108, v108, v109
    ds_read_b32 v109, v107 offset:6144
    s_waitcnt lgkmcnt(0)
    v_max_u32 v108, v108, v109
    ds_read_b32 v109, v107 offset:6148
    s_waitcnt lgkmcnt(0)
    v_max_u32 v108, v108, v109
    ds_read_b32 v109, v107 offset:6152
    s_waitcnt lgkmcnt(0)
    v_max_u32 v108, v108, v109
    ds_read_b32 v109, v107 offset:6156
    s_waitcnt lgkmcnt(0)
    v_max_u32 v108, v108, v109
    ds_read_b32 v109, v107 offset:7168
    s_waitcnt lgkmcnt(0)
    v_max_u32 v108, v108, v109
    ds_read_b32 v109, v107 offset:7172
    s_waitcnt lgkmcnt(0)
    v_max_u32 v108, v108, v109
    ds_read_b32 v109, v107 offset:7176
    s_waitcnt lgkmcnt(0)
    v_max_u32 v108, v108, v109
    ds_read_b32 v109, v107 offset:7180
    s_waitcnt lgkmcnt(0)
    v_max_u32 v108, v108, v109
    ds_read_b32 v109, v107 offset:8192
    s_waitcnt lgkmcnt(0)
    v_max_u32 v108, v108, v109
    ds_read_b32 v109, v107 offset:8196
    s_waitcnt lgkmcnt(0)
    v_max_u32 v108, v108, v109
    ds_read_b32 v109, v107 offset:8200
    s_waitcnt lgkmcnt(0)
    v_max_u32 v108, v108, v109
    ds_read_b32 v109, v107 offset:8204
    s_waitcnt lgkmcnt(0)
    v_max_u32 v108, v108, v109
    ds_read_b32 v109, v107 offset:9216
    s_waitcnt lgkmcnt(0)
    v_max_u32 v108, v108, v109
    ds_read_b32 v109, v107 offset:9220
    s_waitcnt lgkmcnt(0)
    v_max_u32 v108, v108, v109
    ds_read_b32 v109, v107 offset:9224
    s_waitcnt lgkmcnt(0)
    v_max_u32 v108, v108, v109
    ds_read_b32 v109, v107 offset:9228
    s_waitcnt lgkmcnt(0)
    v_max_u32 v108, v108, v109
    v_cmp_eq_u32 vcc, -1, v108
    s_cbranch_vccnz VO_redo
    s_branch VO_fine
M_xqk:
    s_cmp_lt_u32 s16, 2
    s_cselect_b32 s30, s40, s42
    s_cselect_b32 s31, s41, s43
    s_mov_b32 s8, s30
    s_and_b32 s9, s31, 0xffff
    s_mov_b32 s10, 7864320
    s_mov_b32 s11, 0x20000
    s_mul_i32 s36, s17, 384
    s_and_b32 s30, s16, 1
    s_mul_i32 s30, s30, 192
    s_add_u32 s36, s36, s30
    s_mul_i32 s19, s18, 1
    s_cmp_eq_u32 s18, 0
    s_cselect_b32 s55, 64, 26
    v_add_u32 v4, 0, v1
    v_mul_u32_u24 v5, 171, v4
    v_lshrrev_b32 v5, 11, v5
    v_mul_u32_u24 v6, 12, v5
    v_sub_u32 v4, v4, v6
    v_lshlrev_b32 v4, 4, v4
    v_and_b32 v6, 3, v5
    v_and_b32 v7, 12, v5
    v_lshlrev_b32 v7, 1, v7
    v_add_u32 v6, v6, v7
    v_lshrrev_b32 v7, 4, v5
    v_lshlrev_b32 v7, 2, v7
    v_add_u32 v6, v6, v7
    v_mul_u32_u24 v6, 12288, v6
    v_add_u32 v16, v6, v4
    v_add_u32 v4, 64, v1
    v_mul_u32_u24 v5, 171, v4
    v_lshrrev_b32 v5, 11, v5
    v_mul_u32_u24 v6, 12, v5
    v_sub_u32 v4, v4, v6
    v_lshlrev_b32 v4, 4, v4
    v_and_b32 v6, 3, v5
    v_and_b32 v7, 12, v5
    v_lshlrev_b32 v7, 1, v7
    v_add_u32 v6, v6, v7
    v_lshrrev_b32 v7, 4, v5
    v_lshlrev_b32 v7, 2, v7
    v_add_u32 v6, v6, v7
    v_mul_u32_u24 v6, 12288, v6
    v_add_u32 v17, v6, v4
    v_add_u32 v4, 128, v1
    v_mul_u32_u24 v5, 171, v4
    v_lshrrev_b32 v5, 11, v5
    v_mul_u32_u24 v6, 12, v5
    v_sub_u32 v4, v4, v6
    v_lshlrev_b32 v4, 4, v4
    v_and_b32 v6, 3, v5
    v_and_b32 v7, 12, v5
    v_lshlrev_b32 v7, 1, v7
    v_add_u32 v6, v6, v7
    v_lshrrev_b32 v7, 4, v5
    v_lshlrev_b32 v7, 2, v7
    v_add_u32 v6, v6, v7
    v_mul_u32_u24 v6, 12288, v6
    v_add_u32 v18, v6, v4
    v_add_u32 v4, 192, v1
    v_mul_u32_u24 v5, 171, v4
    v_lshrrev_b32 v5, 11, v5
    v_mul_u32_u24 v6, 12, v5
    v_sub_u32 v4, v4, v6
    v_lshlrev_b32 v4, 4, v4
    v_and_b32 v6, 3, v5
    v_and_b32 v7, 12, v5
    v_lshlrev_b32 v7, 1, v7
    v_add_u32 v6, v6, v7
    v_lshrrev_b32 v7, 4, v5
    v_lshlrev_b32 v7, 2, v7
    v_add_u32 v6, v6, v7
    v_mul_u32_u24 v6, 12288, v6
    v_add_u32 v19, v6, v4
    v_add_u32 v4, 256, v1
    v_mul_u32_u24 v5, 171, v4
    v_lshrrev_b32 v5, 11, v5
    v_mul_u32_u24 v6, 12, v5
    v_sub_u32 v4, v4, v6
    v_lshlrev_b32 v4, 4, v4
    v_and_b32 v6, 3, v5
    v_and_b32 v7, 12, v5
    v_lshlrev_b32 v7, 1, v7
    v_add_u32 v6, v6, v7
    v_lshrrev_b32 v7, 4, v5
    v_lshlrev_b32 v7, 2, v7
    v_add_u32 v6, v6, v7
    v_mul_u32_u24 v6, 12288, v6
    v_add_u32 v20, v6, v4
    v_add_u32 v4, 320, v1
    v_mul_u32_u24 v5, 171, v4
    v_lshrrev_b32 v5, 11, v5
    v_mul_u32_u24 v6, 12, v5
    v_sub_u32 v4, v4, v6
    v_lshlrev_b32 v4, 4, v4
    v_and_b32 v6, 3, v5
    v_and_b32 v7, 12, v5
    v_lshlrev_b32 v7, 1, v7
    v_add_u32 v6, v6, v7
    v_lshrrev_b32 v7, 4, v5
    v_lshlrev_b32 v7, 2, v7
    v_add_u32 v6, v6, v7
    v_mul_u32_u24 v6, 12288, v6
    v_add_u32 v21, v6, v4
    s_mul_i32 s30, s16, 20480
    s_add_u32 s31, s36, 0
    s_add_u32 m0, s30, 0
    s_nop 0
    buffer_load_dwordx4 v16, s[8:11], s31 offen lds
    s_add_u32 m0, s30, 1024
    s_nop 0
    buffer_load_dwordx4 v17, s[8:11], s31 offen lds
    s_add_u32 m0, s30, 2048
    s_nop 0
    buffer_load_dwordx4 v18, s[8:11], s31 offen lds
    s_add_u32 m0, s30, 3072
    s_nop 0
    buffer_load_dwordx4 v19, s[8:11], s31 offen lds
    s_add_u32 m0, s30, 4096
    s_nop 0
    buffer_load_dwordx4 v20, s[8:11], s31 offen lds
    s_add_u32 m0, s30, 5120
    s_nop 0
    buffer_load_dwordx4 v21, s[8:11], s31 offen lds
    s_add_u32 s31, s36, 1572864
    s_add_u32 m0, s30, 6144
    s_nop 0
    buffer_load_dwordx4 v16, s[8:11], s31 offen lds
    s_add_u32 m0, s30, 7168
    s_nop 0
    buffer_load_dwordx4 v17, s[8:11], s31 offen lds
    s_add_u32 m0, s30, 8192
    s_nop 0
    buffer_load_dwordx4 v18, s[8:11], s31 offen lds
    s_add_u32 m0, s30, 9216
    s_nop 0
    buffer_load_dwordx4 v19, s[8:11], s31 offen lds
    s_add_u32 m0, s30, 10240
    s_nop 0
    buffer_load_dwordx4 v20, s[8:11], s31 offen lds
    s_add_u32 m0, s30, 11264
    s_nop 0
    buffer_load_dwordx4 v21, s[8:11], s31 offen lds
    s_add_u32 s31, s36, 3145728
    s_add_u32 m0, s30, 12288
    s_nop 0
    buffer_load_dwordx4 v16, s[8:11], s31 offen lds
    s_add_u32 m0, s30, 13312
    s_nop 0
    buffer_load_dwordx4 v17, s[8:11], s31 offen lds
    s_add_u32 m0, s30, 14336
    s_nop 0
    buffer_load_dwordx4 v18, s[8:11], s31 offen lds
    s_add_u32 m0, s30, 15360
    s_nop 0
    buffer_load_dwordx4 v19, s[8:11], s31 offen lds
    s_add_u32 m0, s30, 16384
    s_nop 0
    buffer_load_dwordx4 v20, s[8:11], s31 offen lds
    s_add_u32 m0, s30, 17408
    s_nop 0
    buffer_load_dwordx4 v21, s[8:11], s31 offen lds
    v_lshrrev_b32 v4, 2, v1
    v_and_b32 v5, 3, v1
    v_lshlrev_b32 v5, 3, v5
    v_add_u32 v5, s30, v5
    v_mul_u32_u24 v6, 192, v4
    v_add_u32 v31, v6, v5
    v_mul_u32_u24 v6, 320, v4
    v_add_u32 v29, v6, v5
    s_mul_i32 s33, s16, 20480
    v_add_u32 v30, s33, v2
    s_waitcnt vmcnt(12)
    ds_read_b64_tr_b16 a[0:1], v31 offset:0
    ds_read_b64_tr_b16 a[2:3], v31 offset:3072
    ds_read_b64_tr_b16 a[8:9], v31 offset:32
    ds_read_b64_tr_b16 a[10:11], v31 offset:3104
    ds_read_b64_tr_b16 a[16:17], v31 offset:64
    ds_read_b64_tr_b16 a[18:19], v31 offset:3136
    ds_read_b64_tr_b16 a[24:25], v31 offset:96
    ds_read_b64_tr_b16 a[26:27], v31 offset:3168
    ds_read_b64_tr_b16 a[32:33], v31 offset:128
    ds_read_b64_tr_b16 a[34:35], v31 offset:3200
    ds_read_b64_tr_b16 v[32:33], v31 offset:160
    ds_read_b64_tr_b16 v[34:35], v31 offset:3232
    s_waitcnt lgkmcnt(0)
    s_add_u32 s31, s36, 4718592
    s_add_u32 m0, s30, 0
    s_nop 0
    buffer_load_dwordx4 v16, s[8:11], s31 offen lds
    s_add_u32 m0, s30, 1024
    s_nop 0
    buffer_load_dwordx4 v17, s[8:11], s31 offen lds
    s_add_u32 m0, s30, 2048
    s_nop 0
    buffer_load_dwordx4 v18, s[8:11], s31 offen lds
    s_add_u32 m0, s30, 3072
    s_nop 0
    buffer_load_dwordx4 v19, s[8:11], s31 offen lds
    s_add_u32 m0, s30, 4096
    s_nop 0
    buffer_load_dwordx4 v20, s[8:11], s31 offen lds
    s_add_u32 m0, s30, 5120
    s_nop 0
    buffer_load_dwordx4 v21, s[8:11], s31 offen lds
    s_waitcnt vmcnt(12)
    ds_read_b64_tr_b16 a[80:81], v31 offset:6144
    ds_read_b64_tr_b16 a[82:83], v31 offset:9216
    ds_read_b64_tr_b16 a[88:89], v31 offset:6176
    ds_read_b64_tr_b16 a[90:91], v31 offset:9248
    ds_read_b64_tr_b16 a[96:97], v31 offset:6208
    ds_read_b64_tr_b16 a[98:99], v31 offset:9280
    ds_read_b64_tr_b16 a[104:105], v31 offset:6240
    ds_read_b64_tr_b16 a[106:107], v31 offset:9312
    ds_read_b64_tr_b16 a[112:113], v31 offset:6272
    ds_read_b64_tr_b16 a[114:115], v31 offset:9344
    ds_read_b64_tr_b16 v[48:49], v31 offset:6304
    ds_read_b64_tr_b16 v[50:51], v31 offset:9376
    s_waitcnt lgkmcnt(0)
    s_add_u32 s31, s36, 393216
    s_add_u32 m0, s30, 6144
    s_nop 0
    buffer_load_dwordx4 v16, s[8:11], s31 offen lds
    s_add_u32 m0, s30, 7168
    s_nop 0
    buffer_load_dwordx4 v17, s[8:11], s31 offen lds
    s_add_u32 m0, s30, 8192
    s_nop 0
    buffer_load_dwordx4 v18, s[8:11], s31 offen lds
    s_add_u32 m0, s30, 9216
    s_nop 0
    buffer_load_dwordx4 v19, s[8:11], s31 offen lds
    s_add_u32 m0, s30, 10240
    s_nop 0
    buffer_load_dwordx4 v20, s[8:11], s31 offen lds
    s_add_u32 m0, s30, 11264
    s_nop 0
    buffer_load_dwordx4 v21, s[8:11], s31 offen lds
    s_waitcnt vmcnt(12)
    ds_read_b64_tr_b16 a[160:161], v31 offset:12288
    ds_read_b64_tr_b16 a[162:163], v31 offset:15360
    ds_read_b64_tr_b16 a[168:169], v31 offset:12320
    ds_read_b64_tr_b16 a[170:171], v31 offset:15392
    ds_read_b64_tr_b16 a[176:177], v31 offset:12352
    ds_read_b64_tr_b16 a[178:179], v31 offset:15424
    ds_read_b64_tr_b16 a[184:185], v31 offset:12384
    ds_read_b64_tr_b16 a[186:187], v31 offset:15456
    ds_read_b64_tr_b16 a[192:193], v31 offset:12416
    ds_read_b64_tr_b16 a[194:195], v31 offset:15488
    ds_read_b64_tr_b16 v[64:65], v31 offset:12448
    ds_read_b64_tr_b16 v[66:67], v31 offset:15520
    s_waitcnt lgkmcnt(0)
    s_add_u32 s31, s36, 1966080
    s_add_u32 m0, s30, 12288
    s_nop 0
    buffer_load_dwordx4 v16, s[8:11], s31 offen lds
    s_add_u32 m0, s30, 13312
    s_nop 0
    buffer_load_dwordx4 v17, s[8:11], s31 offen lds
    s_add_u32 m0, s30, 14336
    s_nop 0
    buffer_load_dwordx4 v18, s[8:11], s31 offen lds
    s_add_u32 m0, s30, 15360
    s_nop 0
    buffer_load_dwordx4 v19, s[8:11], s31 offen lds
    s_add_u32 m0, s30, 16384
    s_nop 0
    buffer_load_dwordx4 v20, s[8:11], s31 offen lds
    s_add_u32 m0, s30, 17408
    s_nop 0
    buffer_load_dwordx4 v21, s[8:11], s31 offen lds
    s_waitcnt vmcnt(12)
    ds_read_b64_tr_b16 a[240:241], v31 offset:0
    ds_read_b64_tr_b16 a[242:243], v31 offset:3072
    ds_read_b64_tr_b16 a[248:249], v31 offset:32
    ds_read_b64_tr_b16 a[250:251], v31 offset:3104
    ds_read_b64_tr_b16 v[112:113], v31 offset:64
    ds_read_b64_tr_b16 v[114:115], v31 offset:3136
    ds_read_b64_tr_b16 v[120:121], v31 offset:96
    ds_read_b64_tr_b16 v[122:123], v31 offset:3168
    ds_read_b64_tr_b16 v[128:129], v31 offset:128
    ds_read_b64_tr_b16 v[130:131], v31 offset:3200
    ds_read_b64_tr_b16 v[80:81], v31 offset:160
    ds_read_b64_tr_b16 v[82:83], v31 offset:3232
    s_waitcnt lgkmcnt(0)
    s_add_u32 s31, s36, 3538944
    s_add_u32 m0, s30, 0
    s_nop 0
    buffer_load_dwordx4 v16, s[8:11], s31 offen lds
    s_add_u32 m0, s30, 1024
    s_nop 0
    buffer_load_dwordx4 v17, s[8:11], s31 offen lds
    s_add_u32 m0, s30, 2048
    s_nop 0
    buffer_load_dwordx4 v18, s[8:11], s31 offen lds
    s_add_u32 m0, s30, 3072
    s_nop 0
    buffer_load_dwordx4 v19, s[8:11], s31 offen lds
    s_add_u32 m0, s30, 4096
    s_nop 0
    buffer_load_dwordx4 v20, s[8:11], s31 offen lds
    s_add_u32 m0, s30, 5120
    s_nop 0
    buffer_load_dwordx4 v21, s[8:11], s31 offen lds
    s_waitcnt vmcnt(12)
    ds_read_b64_tr_b16 a[4:5], v31 offset:6144
    ds_read_b64_tr_b16 a[6:7], v31 offset:9216
    ds_read_b64_tr_b16 a[12:13], v31 offset:6176
    ds_read_b64_tr_b16 a[14:15], v31 offset:9248
    ds_read_b64_tr_b16 a[20:21], v31 offset:6208
    ds_read_b64_tr_b16 a[22:23], v31 offset:9280
    ds_read_b64_tr_b16 a[28:29], v31 offset:6240
    ds_read_b64_tr_b16 a[30:31], v31 offset:9312
    ds_read_b64_tr_b16 a[36:37], v31 offset:6272
    ds_read_b64_tr_b16 a[38:39], v31 offset:9344
    ds_read_b64_tr_b16 v[36:37], v31 offset:6304
    ds_read_b64_tr_b16 v[38:39], v31 offset:9376
    s_waitcnt lgkmcnt(0)
    s_add_u32 s31, s36, 5111808
    s_add_u32 m0, s30, 6144
    s_nop 0
    buffer_load_dwordx4 v16, s[8:11], s31 offen lds
    s_add_u32 m0, s30, 7168
    s_nop 0
    buffer_load_dwordx4 v17, s[8:11], s31 offen lds
    s_add_u32 m0, s30, 8192
    s_nop 0
    buffer_load_dwordx4 v18, s[8:11], s31 offen lds
    s_add_u32 m0, s30, 9216
    s_nop 0
    buffer_load_dwordx4 v19, s[8:11], s31 offen lds
    s_add_u32 m0, s30, 10240
    s_nop 0
    buffer_load_dwordx4 v20, s[8:11], s31 offen lds
    s_add_u32 m0, s30, 11264
    s_nop 0
    buffer_load_dwordx4 v21, s[8:11], s31 offen lds
    s_waitcnt vmcnt(12)
    ds_read_b64_tr_b16 a[84:85], v31 offset:12288
    ds_read_b64_tr_b16 a[86:87], v31 offset:15360
    ds_read_b64_tr_b16 a[92:93], v31 offset:12320
    ds_read_b64_tr_b16 a[94:95], v31 offset:15392
    ds_read_b64_tr_b16 a[100:101], v31 offset:12352
    ds_read_b64_tr_b16 a[102:103], v31 offset:15424
    ds_read_b64_tr_b16 a[108:109], v31 offset:12384
    ds_read_b64_tr_b16 a[110:111], v31 offset:15456
    ds_read_b64_tr_b16 a[116:117], v31 offset:12416
    ds_read_b64_tr_b16 a[118:119], v31 offset:15488
    ds_read_b64_tr_b16 v[52:53], v31 offset:12448
    ds_read_b64_tr_b16 v[54:55], v31 offset:15520
    s_waitcnt lgkmcnt(0)
    s_add_u32 s31, s36, 786432
    s_add_u32 m0, s30, 12288
    s_nop 0
    buffer_load_dwordx4 v16, s[8:11], s31 offen lds
    s_add_u32 m0, s30, 13312
    s_nop 0
    buffer_load_dwordx4 v17, s[8:11], s31 offen lds
    s_add_u32 m0, s30, 14336
    s_nop 0
    buffer_load_dwordx4 v18, s[8:11], s31 offen lds
    s_add_u32 m0, s30, 15360
    s_nop 0
    buffer_load_dwordx4 v19, s[8:11], s31 offen lds
    s_add_u32 m0, s30, 16384
    s_nop 0
    buffer_load_dwordx4 v20, s[8:11], s31 offen lds
    s_add_u32 m0, s30, 17408
    s_nop 0
    buffer_load_dwordx4 v21, s[8:11], s31 offen lds
    s_waitcnt vmcnt(12)
    ds_read_b64_tr_b16 a[164:165], v31 offset:0
    ds_read_b64_tr_b16 a[166:167], v31 offset:3072
    ds_read_b64_tr_b16 a[172:173], v31 offset:32
    ds_read_b64_tr_b16 a[174:175], v31 offset:3104
    ds_read_b64_tr_b16 a[180:181], v31 offset:64
    ds_read_b64_tr_b16 a[182:183], v31 offset:3136
    ds_read_b64_tr_b16 a[188:189], v31 offset:96
    ds_read_b64_tr_b16 a[190:191], v31 offset:3168
    ds_read_b64_tr_b16 a[196:197], v31 offset:128
    ds_read_b64_tr_b16 a[198:199], v31 offset:3200
    ds_read_b64_tr_b16 v[68:69], v31 offset:160
    ds_read_b64_tr_b16 v[70:71], v31 offset:3232
    s_waitcnt lgkmcnt(0)
    s_add_u32 s31, s36, 2359296
    s_add_u32 m0, s30, 0
    s_nop 0
    buffer_load_dwordx4 v16, s[8:11], s31 offen lds
    s_add_u32 m0, s30, 1024
    s_nop 0
    buffer_load_dwordx4 v17, s[8:11], s31 offen lds
    s_add_u32 m0, s30, 2048
    s_nop 0
    buffer_load_dwordx4 v18, s[8:11], s31 offen lds
    s_add_u32 m0, s30, 3072
    s_nop 0
    buffer_load_dwordx4 v19, s[8:11], s31 offen lds
    s_add_u32 m0, s30, 4096
    s_nop 0
    buffer_load_dwordx4 v20, s[8:11], s31 offen lds
    s_add_u32 m0, s30, 5120
    s_nop 0
    buffer_load_dwordx4 v21, s[8:11], s31 offen lds
    s_waitcnt vmcnt(12)
    ds_read_b64_tr_b16 a[244:245], v31 offset:6144
    ds_read_b64_tr_b16 a[246:247], v31 offset:9216
    ds_read_b64_tr_b16 a[252:253], v31 offset:6176
    ds_read_b64_tr_b16 a[254:255], v31 offset:9248
    ds_read_b64_tr_b16 v[116:117], v31 offset:6208
    ds_read_b64_tr_b16 v[118:119], v31 offset:9280
    ds_read_b64_tr_b16 v[124:125], v31 offset:6240
    ds_read_b64_tr_b16 v[126:127], v31 offset:9312
    ds_read_b64_tr_b16 v[132:133], v31 offset:6272
    ds_read_b64_tr_b16 v[134:135], v31 offset:9344
    ds_read_b64_tr_b16 v[84:85], v31 offset:6304
    ds_read_b64_tr_b16 v[86:87], v31 offset:9376
    s_waitcnt lgkmcnt(0)
    s_add_u32 s31, s36, 3932160
    s_add_u32 m0, s30, 6144
    s_nop 0
    buffer_load_dwordx4 v16, s[8:11], s31 offen lds
    s_add_u32 m0, s30, 7168
    s_nop 0
    buffer_load_dwordx4 v17, s[8:11], s31 offen lds
    s_add_u32 m0, s30, 8192
    s_nop 0
    buffer_load_dwordx4 v18, s[8:11], s31 offen lds
    s_add_u32 m0, s30, 9216
    s_nop 0
    buffer_load_dwordx4 v19, s[8:11], s31 offen lds
    s_add_u32 m0, s30, 10240
    s_nop 0
    buffer_load_dwordx4 v20, s[8:11], s31 offen lds
    s_add_u32 m0, s30, 11264
    s_nop 0
    buffer_load_dwordx4 v21, s[8:11], s31 offen lds
    s_waitcnt vmcnt(12)
    ds_read_b64_tr_b16 a[40:41], v31 offset:12288
    ds_read_b64_tr_b16 a[42:43], v31 offset:15360
    ds_read_b64_tr_b16 a[48:49], v31 offset:12320
    ds_read_b64_tr_b16 a[50:51], v31 offset:15392
    ds_read_b64_tr_b16 a[56:57], v31 offset:12352
    ds_read_b64_tr_b16 a[58:59], v31 offset:15424
    ds_read_b64_tr_b16 a[64:65], v31 offset:12384
    ds_read_b64_tr_b16 a[66:67], v31 offset:15456
    ds_read_b64_tr_b16 a[72:73], v31 offset:12416
    ds_read_b64_tr_b16 a[74:75], v31 offset:15488
    ds_read_b64_tr_b16 v[40:41], v31 offset:12448
    ds_read_b64_tr_b16 v[42:43], v31 offset:15520
    s_waitcnt lgkmcnt(0)
    s_add_u32 s31, s36, 5505024
    s_add_u32 m0, s30, 12288
    s_nop 0
    buffer_load_dwordx4 v16, s[8:11], s31 offen lds
    s_add_u32 m0, s30, 13312
    s_nop 0
    buffer_load_dwordx4 v17, s[8:11], s31 offen lds
    s_add_u32 m0, s30, 14336
    s_nop 0
    buffer_load_dwordx4 v18, s[8:11], s31 offen lds
    s_add_u32 m0, s30, 15360
    s_nop 0
    buffer_load_dwordx4 v19, s[8:11], s31 offen lds
    s_add_u32 m0, s30, 16384
    s_nop 0
    buffer_load_dwordx4 v20, s[8:11], s31 offen lds
    s_add_u32 m0, s30, 17408
    s_nop 0
    buffer_load_dwordx4 v21, s[8:11], s31 offen lds
    s_waitcnt vmcnt(12)
    ds_read_b64_tr_b16 a[120:121], v31 offset:0
    ds_read_b64_tr_b16 a[122:123], v31 offset:3072
    ds_read_b64_tr_b16 a[128:129], v31 offset:32
    ds_read_b64_tr_b16 a[130:131], v31 offset:3104
    ds_read_b64_tr_b16 a[136:137], v31 offset:64
    ds_read_b64_tr_b16 a[138:139], v31 offset:3136
    ds_read_b64_tr_b16 a[144:145], v31 offset:96
    ds_read_b64_tr_b16 a[146:147], v31 offset:3168
    ds_read_b64_tr_b16 a[152:153], v31 offset:128
    ds_read_b64_tr_b16 a[154:155], v31 offset:3200
    ds_read_b64_tr_b16 v[56:57], v31 offset:160
    ds_read_b64_tr_b16 v[58:59], v31 offset:3232
    s_waitcnt lgkmcnt(0)
    s_add_u32 s31, s36, 1179648
    s_add_u32 m0, s30, 0
    s_nop 0
    buffer_load_dwordx4 v16, s[8:11], s31 offen lds
    s_add_u32 m0, s30, 1024
    s_nop 0
    buffer_load_dwordx4 v17, s[8:11], s31 offen lds
    s_add_u32 m0, s30, 2048
    s_nop 0
    buffer_load_dwordx4 v18, s[8:11], s31 offen lds
    s_add_u32 m0, s30, 3072
    s_nop 0
    buffer_load_dwordx4 v19, s[8:11], s31 offen lds
    s_add_u32 m0, s30, 4096
    s_nop 0
    buffer_load_dwordx4 v20, s[8:11], s31 offen lds
    s_add_u32 m0, s30, 5120
    s_nop 0
    buffer_load_dwordx4 v21, s[8:11], s31 offen lds
    s_waitcnt vmcnt(12)
    ds_read_b64_tr_b16 a[200:201], v31 offset:6144
    ds_read_b64_tr_b16 a[202:203], v31 offset:9216
    ds_read_b64_tr_b16 a[208:209], v31 offset:6176
    ds_read_b64_tr_b16 a[210:211], v31 offset:9248
    ds_read_b64_tr_b16 a[216:217], v31 offset:6208
    ds_read_b64_tr_b16 a[218:219], v31 offset:9280
    ds_read_b64_tr_b16 a[224:225], v31 offset:6240
    ds_read_b64_tr_b16 a[226:227], v31 offset:9312
    ds_read_b64_tr_b16 a[232:233], v31 offset:6272
    ds_read_b64_tr_b16 a[234:235], v31 offset:9344
    ds_read_b64_tr_b16 v[72:73], v31 offset:6304
    ds_read_b64_tr_b16 v[74:75], v31 offset:9376
    s_waitcnt lgkmcnt(0)
    s_add_u32 s31, s36, 2752512
    s_add_u32 m0, s30, 6144
    s_nop 0
    buffer_load_dwordx4 v16, s[8:11], s31 offen lds
    s_add_u32 m0, s30, 7168
    s_nop 0
    buffer_load_dwordx4 v17, s[8:11], s31 offen lds
    s_add_u32 m0, s30, 8192
    s_nop 0
    buffer_load_dwordx4 v18, s[8:11], s31 offen lds
    s_add_u32 m0, s30, 9216
    s_nop 0
    buffer_load_dwordx4 v19, s[8:11], s31 offen lds
    s_add_u32 m0, s30, 10240
    s_nop 0
    buffer_load_dwordx4 v20, s[8:11], s31 offen lds
    s_add_u32 m0, s30, 11264
    s_nop 0
    buffer_load_dwordx4 v21, s[8:11], s31 offen lds
    s_waitcnt vmcnt(12)
    ds_read_b64_tr_b16 v[136:137], v31 offset:12288
    ds_read_b64_tr_b16 v[138:139], v31 offset:15360
    ds_read_b64_tr_b16 v[144:145], v31 offset:12320
    ds_read_b64_tr_b16 v[146:147], v31 offset:15392
    ds_read_b64_tr_b16 v[152:153], v31 offset:12352
    ds_read_b64_tr_b16 v[154:155], v31 offset:15424
    ds_read_b64_tr_b16 v[160:161], v31 offset:12384
    ds_read_b64_tr_b16 v[162:163], v31 offset:15456
    ds_read_b64_tr_b16 v[168:169], v31 offset:12416
    ds_read_b64_tr_b16 v[170:171], v31 offset:15488
    ds_read_b64_tr_b16 v[88:89], v31 offset:12448
    ds_read_b64_tr_b16 v[90:91], v31 offset:15520
    s_waitcnt lgkmcnt(0)
    s_add_u32 s31, s36, 4325376
    s_add_u32 m0, s30, 12288
    s_nop 0
    buffer_load_dwordx4 v16, s[8:11], s31 offen lds
    s_add_u32 m0, s30, 13312
    s_nop 0
    buffer_load_dwordx4 v17, s[8:11], s31 offen lds
    s_add_u32 m0, s30, 14336
    s_nop 0
    buffer_load_dwordx4 v18, s[8:11], s31 offen lds
    s_add_u32 m0, s30, 15360
    s_nop 0
    buffer_load_dwordx4 v19, s[8:11], s31 offen lds
    s_add_u32 m0, s30, 16384
    s_nop 0
    buffer_load_dwordx4 v20, s[8:11], s31 offen lds
    s_add_u32 m0, s30, 17408
    s_nop 0
    buffer_load_dwordx4 v21, s[8:11], s31 offen lds
    s_waitcnt vmcnt(12)
    ds_read_b64_tr_b16 a[44:45], v31 offset:0
    ds_read_b64_tr_b16 a[46:47], v31 offset:3072
    ds_read_b64_tr_b16 a[52:53], v31 offset:32
    ds_read_b64_tr_b16 a[54:55], v31 offset:3104
    ds_read_b64_tr_b16 a[60:61], v31 offset:64
    ds_read_b64_tr_b16 a[62:63], v31 offset:3136
    ds_read_b64_tr_b16 a[68:69], v31 offset:96
    ds_read_b64_tr_b16 a[70:71], v31 offset:3168
    ds_read_b64_tr_b16 a[76:77], v31 offset:128
    ds_read_b64_tr_b16 a[78:79], v31 offset:3200
    ds_read_b64_tr_b16 v[44:45], v31 offset:160
    ds_read_b64_tr_b16 v[46:47], v31 offset:3232
    s_waitcnt lgkmcnt(0)
    s_add_u32 s31, s36, 5898240
    s_add_u32 m0, s30, 0
    s_nop 0
    buffer_load_dwordx4 v16, s[8:11], s31 offen lds
    s_add_u32 m0, s30, 1024
    s_nop 0
    buffer_load_dwordx4 v17, s[8:11], s31 offen lds
    s_add_u32 m0, s30, 2048
    s_nop 0
    buffer_load_dwordx4 v18, s[8:11], s31 offen lds
    s_add_u32 m0, s30, 3072
    s_nop 0
    buffer_load_dwordx4 v19, s[8:11], s31 offen lds
    s_add_u32 m0, s30, 4096
    s_nop 0
    buffer_load_dwordx4 v20, s[8:11], s31 offen lds
    s_add_u32 m0, s30, 5120
    s_nop 0
    buffer_load_dwordx4 v21, s[8:11], s31 offen lds
    s_waitcnt vmcnt(12)
    ds_read_b64_tr_b16 a[124:125], v31 offset:6144
    ds_read_b64_tr_b16 a[126:127], v31 offset:9216
    ds_read_b64_tr_b16 a[132:133], v31 offset:6176
    ds_read_b64_tr_b16 a[134:135], v31 offset:9248
    ds_read_b64_tr_b16 a[140:141], v31 offset:6208
    ds_read_b64_tr_b16 a[142:143], v31 offset:9280
    ds_read_b64_tr_b16 a[148:149], v31 offset:6240
    ds_read_b64_tr_b16 a[150:151], v31 offset:9312
    ds_read_b64_tr_b16 a[156:157], v31 offset:6272
    ds_read_b64_tr_b16 a[158:159], v31 offset:9344
    ds_read_b64_tr_b16 v[60:61], v31 offset:6304
    ds_read_b64_tr_b16 v[62:63], v31 offset:9376
    s_waitcnt lgkmcnt(0)
    v_and_b32 v8, 7, v1
    v_lshlrev_b32 v8, 3, v8
    v_add_u32 v8, s63, v8
    global_load_dwordx2 v[10:11], v8, s[48:49] sc1
    s_add_u32 s31, s36, 6291456
    s_add_u32 m0, s30, 6144
    s_nop 0
    buffer_load_dwordx4 v16, s[8:11], s31 offen lds
    s_add_u32 m0, s30, 7168
    s_nop 0
    buffer_load_dwordx4 v17, s[8:11], s31 offen lds
    s_add_u32 m0, s30, 8192
    s_nop 0
    buffer_load_dwordx4 v18, s[8:11], s31 offen lds
    s_add_u32 m0, s30, 9216
    s_nop 0
    buffer_load_dwordx4 v19, s[8:11], s31 offen lds
    s_add_u32 m0, s30, 10240
    s_nop 0
    buffer_load_dwordx4 v20, s[8:11], s31 offen lds
    s_add_u32 m0, s30, 11264
    s_nop 0
    buffer_load_dwordx4 v21, s[8:11], s31 offen lds
    s_waitcnt vmcnt(13)
    ds_read_b64_tr_b16 a[204:205], v31 offset:12288
    ds_read_b64_tr_b16 a[206:207], v31 offset:15360
    ds_read_b64_tr_b16 a[212:213], v31 offset:12320
    ds_read_b64_tr_b16 a[214:215], v31 offset:15392
    ds_read_b64_tr_b16 a[220:221], v31 offset:12352
    ds_read_b64_tr_b16 a[222:223], v31 offset:15424
    ds_read_b64_tr_b16 a[228:229], v31 offset:12384
    ds_read_b64_tr_b16 a[230:231], v31 offset:15456
    ds_read_b64_tr_b16 a[236:237], v31 offset:12416
    ds_read_b64_tr_b16 a[238:239], v31 offset:15488
    ds_read_b64_tr_b16 v[76:77], v31 offset:12448
    ds_read_b64_tr_b16 v[78:79], v31 offset:15520
    s_waitcnt lgkmcnt(0)
    s_add_u32 s31, s36, 7077888
    s_add_u32 m0, s30, 12288
    s_nop 0
    buffer_load_dwordx4 v16, s[8:11], s31 offen lds
    s_add_u32 m0, s30, 13312
    s_nop 0
    buffer_load_dwordx4 v17, s[8:11], s31 offen lds
    s_add_u32 m0, s30, 14336
    s_nop 0
    buffer_load_dwordx4 v18, s[8:11], s31 offen lds
    s_add_u32 m0, s30, 15360
    s_nop 0
    buffer_load_dwordx4 v19, s[8:11], s31 offen lds
    s_add_u32 m0, s30, 16384
    s_nop 0
    buffer_load_dwordx4 v20, s[8:11], s31 offen lds
    s_add_u32 m0, s30, 17408
    s_nop 0
    buffer_load_dwordx4 v21, s[8:11], s31 offen lds
    s_waitcnt vmcnt(13)
    ds_read_b64_tr_b16 v[140:141], v31 offset:0
    ds_read_b64_tr_b16 v[142:143], v31 offset:3072
    ds_read_b64_tr_b16 v[148:149], v31 offset:32
    ds_read_b64_tr_b16 v[150:151], v31 offset:3104
    ds_read_b64_tr_b16 v[156:157], v31 offset:64
    ds_read_b64_tr_b16 v[158:159], v31 offset:3136
    ds_read_b64_tr_b16 v[164:165], v31 offset:96
    ds_read_b64_tr_b16 v[166:167], v31 offset:3168
    ds_read_b64_tr_b16 v[172:173], v31 offset:128
    ds_read_b64_tr_b16 v[174:175], v31 offset:3200
    ds_read_b64_tr_b16 v[92:93], v31 offset:160
    ds_read_b64_tr_b16 v[94:95], v31 offset:3232
    s_waitcnt lgkmcnt(0)
    s_add_u32 s31, s36, 6684672
    s_add_u32 m0, s30, 0
    s_nop 0
    buffer_load_dwordx4 v16, s[8:11], s31 offen lds
    s_add_u32 m0, s30, 1024
    s_nop 0
    buffer_load_dwordx4 v17, s[8:11], s31 offen lds
    s_add_u32 m0, s30, 2048
    s_nop 0
    buffer_load_dwordx4 v18, s[8:11], s31 offen lds
    s_add_u32 m0, s30, 3072
    s_nop 0
    buffer_load_dwordx4 v19, s[8:11], s31 offen lds
    s_add_u32 m0, s30, 4096
    s_nop 0
    buffer_load_dwordx4 v20, s[8:11], s31 offen lds
    s_add_u32 m0, s30, 5120
    s_nop 0
    buffer_load_dwordx4 v21, s[8:11], s31 offen lds
    s_waitcnt vmcnt(12)
    ds_read_b64_tr_b16 v[176:177], v31 offset:6144
    ds_read_b64_tr_b16 v[178:179], v31 offset:9216
    ds_read_b64_tr_b16 v[184:185], v31 offset:6176
    ds_read_b64_tr_b16 v[186:187], v31 offset:9248
    ds_read_b64_tr_b16 v[192:193], v31 offset:6208
    ds_read_b64_tr_b16 v[194:195], v31 offset:9280
    ds_read_b64_tr_b16 v[200:201], v31 offset:6240
    ds_read_b64_tr_b16 v[202:203], v31 offset:9312
    ds_read_b64_tr_b16 v[208:209], v31 offset:6272
    ds_read_b64_tr_b16 v[210:211], v31 offset:9344
    ds_read_b64_tr_b16 v[96:97], v31 offset:6304
    ds_read_b64_tr_b16 v[98:99], v31 offset:9376
    s_waitcnt lgkmcnt(0)
    v_not_b32 v10, v10
    v_xor_b32 v9, 0x2000, v11
    v_or_b32 v10, v10, v9
    v_cmp_ne_u32 vcc, 0, v10
    s_mov_b64 s[56:57], vcc
    v_lshlrev_b32 v8, 2, v1
    s_mov_b32 s34, 54525952
    buffer_load_dword v9, v8, s[4:7], s34 offen sc1
    s_min_u32 s52, s19, 63
    s_mul_i32 s52, s52, 40960
    s_mul_i32 s53, s16, 5120
    s_add_u32 s52, s52, s53
    s_add_u32 s52, s52, 251658240
    s_add_u32 s53, s53, 81920
    s_add_u32 m0, s53, 0
    s_add_u32 s54, s52, 0
    buffer_load_dwordx4 v2, s[4:7], s54 offen sc1 lds
    s_add_u32 m0, s53, 1024
    s_add_u32 s54, s52, 1024
    buffer_load_dwordx4 v2, s[4:7], s54 offen sc1 lds
    s_add_u32 m0, s53, 2048
    s_add_u32 s54, s52, 2048
    buffer_load_dwordx4 v2, s[4:7], s54 offen sc1 lds
    s_add_u32 m0, s53, 3072
    s_add_u32 s54, s52, 3072
    buffer_load_dwordx4 v2, s[4:7], s54 offen sc1 lds
    s_add_u32 m0, s53, 4096
    s_add_u32 s54, s52, 4096
    buffer_load_dwordx4 v2, s[4:7], s54 offen sc1 lds
    s_add_u32 m0, s53, 20480
    s_add_u32 s54, s52, 20480
    buffer_load_dwordx4 v2, s[4:7], s54 offen sc1 lds
    s_add_u32 m0, s53, 21504
    s_add_u32 s54, s52, 21504
    buffer_load_dwordx4 v2, s[4:7], s54 offen sc1 lds
    s_add_u32 m0, s53, 22528
    s_add_u32 s54, s52, 22528
    buffer_load_dwordx4 v2, s[4:7], s54 offen sc1 lds
    s_add_u32 m0, s53, 23552
    s_add_u32 s54, s52, 23552
    buffer_load_dwordx4 v2, s[4:7], s54 offen sc1 lds
    s_add_u32 m0, s53, 24576
    s_add_u32 s54, s52, 24576
    buffer_load_dwordx4 v2, s[4:7], s54 offen sc1 lds
    s_add_u32 s31, s36, 7471104
    s_add_u32 m0, s30, 6144
    s_nop 0
    buffer_load_dwordx4 v16, s[8:11], s31 offen lds
    s_add_u32 m0, s30, 7168
    s_nop 0
    buffer_load_dwordx4 v17, s[8:11], s31 offen lds
    s_add_u32 m0, s30, 8192
    s_nop 0
    buffer_load_dwordx4 v18, s[8:11], s31 offen lds
    s_add_u32 m0, s30, 9216
    s_nop 0
    buffer_load_dwordx4 v19, s[8:11], s31 offen lds
    s_add_u32 m0, s30, 10240
    s_nop 0
    buffer_load_dwordx4 v20, s[8:11], s31 offen lds
    s_add_u32 m0, s30, 11264
    s_nop 0
    buffer_load_dwordx4 v21, s[8:11], s31 offen lds
    s_waitcnt vmcnt(23)
    ds_read_b64_tr_b16 v[216:217], v31 offset:12288
    ds_read_b64_tr_b16 v[218:219], v31 offset:15360
    ds_read_b64_tr_b16 v[224:225], v31 offset:12320
    ds_read_b64_tr_b16 v[226:227], v31 offset:15392
    ds_read_b64_tr_b16 v[232:233], v31 offset:12352
    ds_read_b64_tr_b16 v[234:235], v31 offset:15424
    ds_read_b64_tr_b16 v[240:241], v31 offset:12384
    ds_read_b64_tr_b16 v[242:243], v31 offset:15456
    ds_read_b64_tr_b16 v[248:249], v31 offset:12416
    ds_read_b64_tr_b16 v[250:251], v31 offset:15488
    ds_read_b64_tr_b16 v[104:105], v31 offset:12448
    ds_read_b64_tr_b16 v[106:107], v31 offset:15520
    s_waitcnt vmcnt(17)
    ds_read_b64_tr_b16 v[180:181], v31 offset:0
    ds_read_b64_tr_b16 v[182:183], v31 offset:3072
    ds_read_b64_tr_b16 v[188:189], v31 offset:32
    ds_read_b64_tr_b16 v[190:191], v31 offset:3104
    ds_read_b64_tr_b16 v[196:197], v31 offset:64
    ds_read_b64_tr_b16 v[198:199], v31 offset:3136
    ds_read_b64_tr_b16 v[204:205], v31 offset:96
    ds_read_b64_tr_b16 v[206:207], v31 offset:3168
    ds_read_b64_tr_b16 v[212:213], v31 offset:128
    ds_read_b64_tr_b16 v[214:215], v31 offset:3200
    ds_read_b64_tr_b16 v[100:101], v31 offset:160
    ds_read_b64_tr_b16 v[102:103], v31 offset:3232
    s_waitcnt vmcnt(0)
    ds_read_b64_tr_b16 v[220:221], v31 offset:6144
    ds_read_b64_tr_b16 v[222:223], v31 offset:9216
    ds_read_b64_tr_b16 v[228:229], v31 offset:6176
    ds_read_b64_tr_b16 v[230:231], v31 offset:9248
    ds_read_b64_tr_b16 v[236:237], v31 offset:6208
    ds_read_b64_tr_b16 v[238:239], v31 offset:9280
    ds_read_b64_tr_b16 v[244:245], v31 offset:6240
    ds_read_b64_tr_b16 v[246:247], v31 offset:9312
    ds_read_b64_tr_b16 v[252:253], v31 offset:6272
    ds_read_b64_tr_b16 v[254:255], v31 offset:9344
    ds_read_b64_tr_b16 v[108:109], v31 offset:6304
    ds_read_b64_tr_b16 v[110:111], v31 offset:9376
    s_waitcnt lgkmcnt(0)
    ds_write_b128 v30, v[32:35] offset:0
    ds_write_b128 v30, v[36:39] offset:1024
    ds_write_b128 v30, v[40:43] offset:2048
    ds_write_b128 v30, v[44:47] offset:3072
    ds_write_b128 v30, v[48:51] offset:4096
    ds_write_b128 v30, v[52:55] offset:5120
    ds_write_b128 v30, v[56:59] offset:6144
    ds_write_b128 v30, v[60:63] offset:7168
    ds_write_b128 v30, v[64:67] offset:8192
    ds_write_b128 v30, v[68:71] offset:9216
    ds_write_b128 v30, v[72:75] offset:10240
    ds_write_b128 v30, v[76:79] offset:11264
    ds_write_b128 v30, v[80:83] offset:12288
    ds_write_b128 v30, v[84:87] offset:13312
    ds_write_b128 v30, v[88:91] offset:14336
    ds_write_b128 v30, v[92:95] offset:15360
    ds_write_b128 v30, v[96:99] offset:16384
    ds_write_b128 v30, v[100:103] offset:17408
    ds_write_b128 v30, v[104:107] offset:18432
    ds_write_b128 v30, v[108:111] offset:19456
    s_cmp_eq_u64 s[56:57], 0
    s_cbranch_scc1 LD_ok_9
    v_and_b32 v4, 7, v1
    v_lshlrev_b32 v4, 3, v4
    v_add_u32 v4, s63, v4
    s_mov_b32 s35, 0
WI_11:
    global_load_dwordx2 v[6:7], v4, s[48:49] sc1
    s_waitcnt vmcnt(0)
    v_not_b32 v6, v6
    v_xor_b32 v5, 0x2000, v7
    v_or_b32 v6, v6, v5
    v_cmp_ne_u32 vcc, 0, v6
    s_cbranch_vccz WG_12
    v_lshrrev_b32 v7, 8, v7
    s_mov_b32 s30, 0
    v_readlane_b32 s31, v7, 0
    s_add_u32 s30, s30, s31
    v_readlane_b32 s31, v7, 1
    s_add_u32 s30, s30, s31
    v_readlane_b32 s31, v7, 2
    s_add_u32 s30, s30, s31
    v_readlane_b32 s31, v7, 3
    s_add_u32 s30, s30, s31
    v_readlane_b32 s31, v7, 4
    s_add_u32 s30, s30, s31
    v_readlane_b32 s31, v7, 5
    s_add_u32 s30, s30, s31
    v_readlane_b32 s31, v7, 6
    s_add_u32 s30, s30, s31
    v_readlane_b32 s31, v7, 7
    s_add_u32 s30, s30, s31
    s_cmp_ge_u32 s30, 256
    s_cbranch_scc1 M_again
    s_sleep 20
    s_add_u32 s35, s35, 1
    s_cmp_lt_u32 s35, 200000
    s_cbranch_scc1 WI_11
    s_branch M_fail
WG_12:
    v_lshlrev_b32 v4, 2, v1
    s_mov_b32 s34, 54525952
    buffer_load_dword v5, v4, s[4:7], s34 offen sc1
    s_waitcnt vmcnt(0)
    v_and_b32 v4, 2, v5
    v_cmp_eq_u32 vcc, 2, v4
    v_and_b32 v5, 1, v5
    v_cmp_eq_u32 s[20:21], 1, v5
    s_nop 3
    s_and_b32 s20, s20, 0x3ffffff
    s_xor_b32 s21, s20, 0x1555555
    s_bcnt1_i32_b32 s21, s21
    s_cmp_le_u32 s21, 5
    s_cselect_b32 s20, 0x1555555, s20
    s_cmp_ge_u32 s21, 21
    s_cselect_b32 s20, 0x2aaaaaa, s20
    s_and_b32 s21, vcc_lo, 0x1ff
    s_bcnt1_i32_b32 s21, s21
    s_cmp_ge_u32 s21, 5
    s_cselect_b32 s21, 16384, 0
    s_min_u32 s52, s19, 63
    s_mul_i32 s52, s52, 40960
    s_mul_i32 s53, s16, 5120
    s_add_u32 s52, s52, s53
    s_add_u32 s52, s52, 251658240
    s_add_u32 s53, s53, 81920
    s_add_u32 m0, s53, 0
    s_add_u32 s54, s52, 0
    buffer_load_dwordx4 v2, s[4:7], s54 offen sc1 lds
    s_add_u32 m0, s53, 1024
    s_add_u32 s54, s52, 1024
    buffer_load_dwordx4 v2, s[4:7], s54 offen sc1 lds
    s_add_u32 m0, s53, 2048
    s_add_u32 s54, s52, 2048
    buffer_load_dwordx4 v2, s[4:7], s54 offen sc1 lds
    s_add_u32 m0, s53, 3072
    s_add_u32 s54, s52, 3072
    buffer_load_dwordx4 v2, s[4:7], s54 offen sc1 lds
    s_add_u32 m0, s53, 4096
    s_add_u32 s54, s52, 4096
    buffer_load_dwordx4 v2, s[4:7], s54 offen sc1 lds
    s_add_u32 m0, s53, 20480
    s_add_u32 s54, s52, 20480
    buffer_load_dwordx4 v2, s[4:7], s54 offen sc1 lds
    s_add_u32 m0, s53, 21504
    s_add_u32 s54, s52, 21504
    buffer_load_dwordx4 v2, s[4:7], s54 offen sc1 lds
    s_add_u32 m0, s53, 22528
    s_add_u32 s54, s52, 22528
    buffer_load_dwordx4 v2, s[4:7], s54 offen sc1 lds
    s_add_u32 m0, s53, 23552
    s_add_u32 s54, s52, 23552
    buffer_load_dwordx4 v2, s[4:7], s54 offen sc1 lds
    s_add_u32 m0, s53, 24576
    s_add_u32 s54, s52, 24576
    buffer_load_dwordx4 v2, s[4:7], s54 offen sc1 lds
    s_branch LD_dn_10
LD_ok_9:
    v_and_b32 v8, 2, v9
    v_cmp_eq_u32 vcc, 2, v8
    v_and_b32 v9, 1, v9
    v_cmp_eq_u32 s[20:21], 1, v9
    s_nop 3
    s_and_b32 s20, s20, 0x3ffffff
    s_xor_b32 s21, s20, 0x1555555
    s_bcnt1_i32_b32 s21, s21
    s_cmp_le_u32 s21, 5
    s_cselect_b32 s20, 0x1555555, s20
    s_cmp_ge_u32 s21, 21
    s_cselect_b32 s20, 0x2aaaaaa, s20
    s_and_b32 s21, vcc_lo, 0x1ff
    s_bcnt1_i32_b32 s21, s21
    s_cmp_ge_u32 s21, 5
    s_cselect_b32 s21, 16384, 0
LD_dn_10:
    s_waitcnt lgkmcnt(0)
    s_mul_i32 s30, s16, 20480
    v_add_u32 v5, s30, v2
    v_mov_b32 v7, 2
    s_mov_b32 s38, 68157440
    s_mov_b32 s30, 95420416
    s_cmp_lt_u32 s16, 2
    s_cselect_b32 s38, s38, s30
    s_and_b32 s30, s16, 1
    s_mul_i32 s30, s30, 3072
    s_add_u32 s38, s38, s30
    s_mov_b32 s26, 81920
    s_mov_b32 s39, 0x7ffffff0
    s_mov_b32 s37, 0x7ffffff0
    v_add_u32 v4, 81920, v2
    v_add_u32 v6, 122880, v2
    s_waitcnt vmcnt(0)
    s_barrier
    ds_read_b128 v[64:67], v4 offset:0
    ds_read_b128 v[80:83], v5 offset:0
    ds_read_b128 v[68:71], v4 offset:1024
    ds_read_b128 v[84:87], v5 offset:1024
    ds_read_b128 v[72:75], v4 offset:2048
    ds_read_b128 v[88:91], v5 offset:2048
XQ_seg:
    s_waitcnt lgkmcnt(4)
    v_mfma_f32_16x16x32_bf16 v[16:19], a[0:3], v[64:67], 0
    ds_read_b128 v[76:79], v4 offset:3072
    v_mfma_f32_16x16x32_bf16 v[20:23], a[8:11], v[64:67], 0
    ds_read_b128 v[92:95], v5 offset:3072
    v_mfma_f32_16x16x32_bf16 v[24:27], a[16:19], v[64:67], 0
    s_xor_b32 s26, s26, 40960
    v_mfma_f32_16x16x32_bf16 v[28:31], a[24:27], v[64:67], 0
    s_sub_u32 s34, s19, 0
    v_mfma_f32_16x16x32_bf16 v[32:35], a[32:35], v[64:67], 0
    s_cmp_lt_u32 s34, 25
    v_mfma_f32_16x16x32_bf16 v[36:39], v[80:83], v[64:67], 0
    s_waitcnt lgkmcnt(4)
    v_mfma_f32_16x16x32_bf16 v[16:19], a[4:7], v[68:71], v[16:19]
    ds_read_b128 v[64:67], v4 offset:4096
    v_mfma_f32_16x16x32_bf16 v[20:23], a[12:15], v[68:71], v[20:23]
    ds_read_b128 v[80:83], v5 offset:4096
    v_mfma_f32_16x16x32_bf16 v[24:27], a[20:23], v[68:71], v[24:27]
    s_cselect_b32 s34, 2, 1
    v_cvt_pk_bf16_f32 v96, v40, v41
    v_mfma_f32_16x16x32_bf16 v[28:31], a[28:31], v[68:71], v[28:31]
    s_add_u32 s34, s34, s19
    v_cvt_pk_bf16_f32 v97, v42, v43
    v_mfma_f32_16x16x32_bf16 v[32:35], a[36:39], v[68:71], v[32:35]
    s_min_u32 s52, s34, 63
    v_cvt_pk_bf16_f32 v98, v44, v45
    v_mfma_f32_16x16x32_bf16 v[36:39], v[84:87], v[68:71], v[36:39]
    s_waitcnt lgkmcnt(4)
    v_cvt_pk_bf16_f32 v99, v46, v47
    v_mfma_f32_16x16x32_bf16 v[16:19], a[40:43], v[72:75], v[16:19]
    ds_read_b128 v[68:71], v4 offset:5120
    buffer_store_dwordx4 v[96:99], v2, s[4:7], s37 offen offset:0 sc1
    v_mfma_f32_16x16x32_bf16 v[20:23], a[48:51], v[72:75], v[20:23]
    ds_read_b128 v[84:87], v5 offset:5120
    v_cvt_pk_bf16_f32 v100, v48, v49
    v_mfma_f32_16x16x32_bf16 v[24:27], a[56:59], v[72:75], v[24:27]
    s_mul_i32 s52, s52, 40960
    v_cvt_pk_bf16_f32 v101, v50, v51
    v_mfma_f32_16x16x32_bf16 v[28:31], a[64:67], v[72:75], v[28:31]
    s_mul_i32 s53, s16, 5120
    v_cvt_pk_bf16_f32 v102, v52, v53
    v_mfma_f32_16x16x32_bf16 v[32:35], a[72:75], v[72:75], v[32:35]
    s_add_u32 s52, s52, s53
    v_cvt_pk_bf16_f32 v103, v54, v55
    v_mfma_f32_16x16x32_bf16 v[36:39], v[88:91], v[72:75], v[36:39]
    s_waitcnt lgkmcnt(4)
    buffer_store_dwordx4 v[100:103], v2, s[4:7], s37 offen offset:1024 sc1
    v_mfma_f32_16x16x32_bf16 v[16:19], a[44:47], v[76:79], v[16:19]
    ds_read_b128 v[72:75], v4 offset:6144
    v_cvt_pk_bf16_f32 v104, v56, v57
    v_mfma_f32_16x16x32_bf16 v[20:23], a[52:55], v[76:79], v[20:23]
    ds_read_b128 v[88:91], v5 offset:6144
    v_cvt_pk_bf16_f32 v105, v58, v59
    v_mfma_f32_16x16x32_bf16 v[24:27], a[60:63], v[76:79], v[24:27]
    s_add_u32 s52, s52, 251658240
    v_cvt_pk_bf16_f32 v106, v60, v61
    v_mfma_f32_16x16x32_bf16 v[28:31], a[68:71], v[76:79], v[28:31]
    s_add_u32 s53, s53, s26
    v_cvt_pk_bf16_f32 v107, v62, v63
    v_mfma_f32_16x16x32_bf16 v[32:35], a[76:79], v[76:79], v[32:35]
    buffer_store_dwordx4 v[104:107], v2, s[4:7], s37 offen offset:2048 sc1
    v_mfma_f32_16x16x32_bf16 v[36:39], v[92:95], v[76:79], v[36:39]
    s_waitcnt lgkmcnt(4)
    v_mfma_f32_16x16x32_bf16 v[16:19], a[80:83], v[64:67], v[16:19]
    ds_read_b128 v[76:79], v4 offset:7168
    v_mfma_f32_16x16x32_bf16 v[20:23], a[88:91], v[64:67], v[20:23]
    ds_read_b128 v[92:95], v5 offset:7168
    v_mfma_f32_16x16x32_bf16 v[24:27], a[96:99], v[64:67], v[24:27]
    v_mfma_f32_16x16x32_bf16 v[28:31], a[104:107], v[64:67], v[28:31]
    v_mfma_f32_16x16x32_bf16 v[32:35], a[112:115], v[64:67], v[32:35]
    s_barrier
    v_mfma_f32_16x16x32_bf16 v[36:39], v[80:83], v[64:67], v[36:39]
    s_waitcnt lgkmcnt(4)
    v_mfma_f32_16x16x32_bf16 v[16:19], a[84:87], v[68:71], v[16:19]
    ds_read_b128 v[64:67], v4 offset:8192
    v_mfma_f32_16x16x32_bf16 v[20:23], a[92:95], v[68:71], v[20:23]
    ds_read_b128 v[80:83], v5 offset:8192
    v_mfma_f32_16x16x32_bf16 v[24:27], a[100:103], v[68:71], v[24:27]
    v_mfma_f32_16x16x32_bf16 v[28:31], a[108:111], v[68:71], v[28:31]
    v_mfma_f32_16x16x32_bf16 v[32:35], a[116:119], v[68:71], v[32:35]
    v_mfma_f32_16x16x32_bf16 v[36:39], v[84:87], v[68:71], v[36:39]
    s_waitcnt lgkmcnt(4)
    v_mfma_f32_16x16x32_bf16 v[16:19], a[120:123], v[72:75], v[16:19]
    ds_read_b128 v[68:71], v4 offset:9216
    v_mfma_f32_16x16x32_bf16 v[20:23], a[128:131], v[72:75], v[20:23]
    ds_read_b128 v[84:87], v5 offset:9216
    v_mfma_f32_16x16x32_bf16 v[24:27], a[136:139], v[72:75], v[24:27]
    v_mfma_f32_16x16x32_bf16 v[28:31], a[144:147], v[72:75], v[28:31]
    v_mfma_f32_16x16x32_bf16 v[32:35], a[152:155], v[72:75], v[32:35]
    v_mfma_f32_16x16x32_bf16 v[36:39], v[88:91], v[72:75], v[36:39]
    s_waitcnt lgkmcnt(4)
    v_mfma_f32_16x16x32_bf16 v[16:19], a[124:127], v[76:79], v[16:19]
    ds_read_b128 v[72:75], v4 offset:10240
    v_mfma_f32_16x16x32_bf16 v[20:23], a[132:135], v[76:79], v[20:23]
    ds_read_b128 v[88:91], v5 offset:10240
    v_mfma_f32_16x16x32_bf16 v[24:27], a[140:143], v[76:79], v[24:27]
    v_mfma_f32_16x16x32_bf16 v[28:31], a[148:151], v[76:79], v[28:31]
    v_mfma_f32_16x16x32_bf16 v[32:35], a[156:159], v[76:79], v[32:35]
    v_mfma_f32_16x16x32_bf16 v[36:39], v[92:95], v[76:79], v[36:39]
    s_waitcnt lgkmcnt(4)
    v_mfma_f32_16x16x32_bf16 v[16:19], a[160:163], v[64:67], v[16:19]
    ds_read_b128 v[76:79], v4 offset:11264
    v_mfma_f32_16x16x32_bf16 v[20:23], a[168:171], v[64:67], v[20:23]
    ds_read_b128 v[92:95], v5 offset:11264
    v_mfma_f32_16x16x32_bf16 v[24:27], a[176:179], v[64:67], v[24:27]
    v_mfma_f32_16x16x32_bf16 v[28:31], a[184:187], v[64:67], v[28:31]
    v_mfma_f32_16x16x32_bf16 v[32:35], a[192:195], v[64:67], v[32:35]
    v_mfma_f32_16x16x32_bf16 v[36:39], v[80:83], v[64:67], v[36:39]
    s_waitcnt lgkmcnt(4)
    v_mfma_f32_16x16x32_bf16 v[16:19], a[164:167], v[68:71], v[16:19]
    ds_read_b128 v[64:67], v4 offset:12288
    v_mfma_f32_16x16x32_bf16 v[20:23], a[172:175], v[68:71], v[20:23]
    ds_read_b128 v[80:83], v5 offset:12288
    v_mfma_f32_16x16x32_bf16 v[24:27], a[180:183], v[68:71], v[24:27]
    v_mfma_f32_16x16x32_bf16 v[28:31], a[188:191], v[68:71], v[28:31]
    v_mfma_f32_16x16x32_bf16 v[32:35], a[196:199], v[68:71], v[32:35]
    v_mfma_f32_16x16x32_bf16 v[36:39], v[84:87], v[68:71], v[36:39]
    s_waitcnt lgkmcnt(4)
    v_mfma_f32_16x16x32_bf16 v[16:19], a[200:203], v[72:75], v[16:19]
    ds_read_b128 v[68:71], v4 offset:13312
    v_mfma_f32_16x16x32_bf16 v[20:23], a[208:211], v[72:75], v[20:23]
    ds_read_b128 v[84:87], v5 offset:13312
    v_mfma_f32_16x16x32_bf16 v[24:27], a[216:219], v[72:75], v[24:27]
    s_waitcnt vmcnt(0)
    v_mfma_f32_16x16x32_bf16 v[28:31], a[224:227], v[72:75], v[28:31]
    s_mov_b64 exec, 1
    buffer_store_dword v7, v2, s[4:7], s39 offen sc1
    s_mov_b64 exec, -1
    v_mfma_f32_16x16x32_bf16 v[32:35], a[232:235], v[72:75], v[32:35]
    v_mfma_f32_16x16x32_bf16 v[36:39], v[88:91], v[72:75], v[36:39]
    s_waitcnt lgkmcnt(4)
    v_mfma_f32_16x16x32_bf16 v[16:19], a[204:207], v[76:79], v[16:19]
    ds_read_b128 v[72:75], v4 offset:14336
    v_mfma_f32_16x16x32_bf16 v[20:23], a[212:215], v[76:79], v[20:23]
    ds_read_b128 v[88:91], v5 offset:14336
    v_mfma_f32_16x16x32_bf16 v[24:27], a[220:223], v[76:79], v[24:27]
    s_add_u32 m0, s53, 0
    s_add_u32 s54, s52, 0
    v_mfma_f32_16x16x32_bf16 v[28:31], a[228:231], v[76:79], v[28:31]
    buffer_load_dwordx4 v2, s[4:7], s54 offen sc1 lds
    v_mfma_f32_16x16x32_bf16 v[32:35], a[236:239], v[76:79], v[32:35]
    s_lshl_b32 s30, s19, 5
    v_mfma_f32_16x16x32_bf16 v[36:39], v[92:95], v[76:79], v[36:39]
    s_waitcnt lgkmcnt(4)
    v_mfma_f32_16x16x32_bf16 v[16:19], a[240:243], v[64:67], v[16:19]
    ds_read_b128 v[76:79], v4 offset:15360
    v_mfma_f32_16x16x32_bf16 v[20:23], a[248:251], v[64:67], v[20:23]
    ds_read_b128 v[92:95], v5 offset:15360
    v_mfma_f32_16x16x32_bf16 v[24:27], v[112:115], v[64:67], v[24:27]
    s_add_u32 m0, s53, 1024
    s_add_u32 s54, s52, 1024
    v_mfma_f32_16x16x32_bf16 v[28:31], v[120:123], v[64:67], v[28:31]
    buffer_load_dwordx4 v2, s[4:7], s54 offen sc1 lds
    v_mfma_f32_16x16x32_bf16 v[32:35], v[128:131], v[64:67], v[32:35]
    s_add_u32 s30, s30, s17
    v_mfma_f32_16x16x32_bf16 v[36:39], v[80:83], v[64:67], v[36:39]
    s_waitcnt lgkmcnt(4)
    v_mfma_f32_16x16x32_bf16 v[16:19], a[244:247], v[68:71], v[16:19]
    ds_read_b128 v[64:67], v4 offset:16384
    v_mfma_f32_16x16x32_bf16 v[20:23], a[252:255], v[68:71], v[20:23]
    ds_read_b128 v[80:83], v5 offset:16384
    v_mfma_f32_16x16x32_bf16 v[24:27], v[116:119], v[68:71], v[24:27]
    s_add_u32 m0, s53, 2048
    s_add_u32 s54, s52, 2048
    v_mfma_f32_16x16x32_bf16 v[28:31], v[124:127], v[68:71], v[28:31]
    buffer_load_dwordx4 v2, s[4:7], s54 offen sc1 lds
    v_mfma_f32_16x16x32_bf16 v[32:35], v[132:135], v[68:71], v[32:35]
    s_lshl_b32 s39, s30, 4
    v_mfma_f32_16x16x32_bf16 v[36:39], v[84:87], v[68:71], v[36:39]
    s_waitcnt lgkmcnt(4)
    v_mfma_f32_16x16x32_bf16 v[16:19], v[136:139], v[72:75], v[16:19]
    ds_read_b128 v[68:71], v4 offset:17408
    v_mfma_f32_16x16x32_bf16 v[20:23], v[144:147], v[72:75], v[20:23]
    ds_read_b128 v[84:87], v5 offset:17408
    v_mfma_f32_16x16x32_bf16 v[24:27], v[152:155], v[72:75], v[24:27]
    s_add_u32 m0, s53, 3072
    s_add_u32 s54, s52, 3072
    v_mfma_f32_16x16x32_bf16 v[28:31], v[160:163], v[72:75], v[28:31]
    buffer_load_dwordx4 v2, s[4:7], s54 offen sc1 lds
    v_mfma_f32_16x16x32_bf16 v[32:35], v[168:171], v[72:75], v[32:35]
    s_mul_i32 s30, s30, 12288
    v_mfma_f32_16x16x32_bf16 v[36:39], v[88:91], v[72:75], v[36:39]
    s_waitcnt lgkmcnt(4)
    v_mfma_f32_16x16x32_bf16 v[16:19], v[140:143], v[76:79], v[16:19]
    ds_read_b128 v[72:75], v4 offset:18432
    v_mfma_f32_16x16x32_bf16 v[20:23], v[148:151], v[76:79], v[20:23]
    ds_read_b128 v[88:91], v5 offset:18432
    v_mfma_f32_16x16x32_bf16 v[24:27], v[156:159], v[76:79], v[24:27]
    s_add_u32 m0, s53, 4096
    s_add_u32 s54, s52, 4096
    v_mfma_f32_16x16x32_bf16 v[28:31], v[164:167], v[76:79], v[28:31]
    buffer_load_dwordx4 v2, s[4:7], s54 offen sc1 lds
    v_mfma_f32_16x16x32_bf16 v[32:35], v[172:175], v[76:79], v[32:35]
    s_add_u32 s36, s30, s38
    v_mfma_f32_16x16x32_bf16 v[36:39], v[92:95], v[76:79], v[36:39]
    s_waitcnt lgkmcnt(4)
    v_mfma_f32_16x16x32_bf16 v[16:19], v[176:179], v[64:67], v[16:19]
    ds_read_b128 v[76:79], v4 offset:19456
    v_mfma_f32_16x16x32_bf16 v[20:23], v[184:187], v[64:67], v[20:23]
    ds_read_b128 v[92:95], v5 offset:19456
    v_mfma_f32_16x16x32_bf16 v[24:27], v[192:195], v[64:67], v[24:27]
    s_add_u32 m0, s53, 20480
    s_add_u32 s54, s52, 20480
    v_mfma_f32_16x16x32_bf16 v[28:31], v[200:203], v[64:67], v[28:31]
    buffer_load_dwordx4 v2, s[4:7], s54 offen sc1 lds
    v_mfma_f32_16x16x32_bf16 v[32:35], v[208:211], v[64:67], v[32:35]
    s_lshl_b32 s32, s16, 2
    v_mfma_f32_16x16x32_bf16 v[36:39], v[80:83], v[64:67], v[36:39]
    s_waitcnt lgkmcnt(4)
    v_mfma_f32_16x16x32_bf16 v[16:19], v[180:183], v[68:71], v[16:19]
    ds_read_b128 v[64:67], v4 offset:20480
    v_mfma_f32_16x16x32_bf16 v[20:23], v[188:191], v[68:71], v[20:23]
    ds_read_b128 v[80:83], v5 offset:0
    v_mfma_f32_16x16x32_bf16 v[24:27], v[196:199], v[68:71], v[24:27]
    s_add_u32 m0, s53, 21504
    s_add_u32 s54, s52, 21504
    v_mfma_f32_16x16x32_bf16 v[28:31], v[204:207], v[68:71], v[28:31]
    buffer_load_dwordx4 v2, s[4:7], s54 offen sc1 lds
    v_mfma_f32_16x16x32_bf16 v[32:35], v[212:215], v[68:71], v[32:35]
    s_add_u32 s39, s39, s32
    v_mfma_f32_16x16x32_bf16 v[36:39], v[84:87], v[68:71], v[36:39]
    s_waitcnt lgkmcnt(4)
    v_mfma_f32_16x16x32_bf16 v[16:19], v[216:219], v[72:75], v[16:19]
    ds_read_b128 v[68:71], v4 offset:21504
    v_mfma_f32_16x16x32_bf16 v[20:23], v[224:227], v[72:75], v[20:23]
    ds_read_b128 v[84:87], v5 offset:1024
    v_mfma_f32_16x16x32_bf16 v[24:27], v[232:235], v[72:75], v[24:27]
    s_add_u32 m0, s53, 22528
    s_add_u32 s54, s52, 22528
    v_mfma_f32_16x16x32_bf16 v[28:31], v[240:243], v[72:75], v[28:31]
    buffer_load_dwordx4 v2, s[4:7], s54 offen sc1 lds
    v_mfma_f32_16x16x32_bf16 v[32:35], v[248:251], v[72:75], v[32:35]
    s_add_u32 s39, s39, 54530048
    v_mfma_f32_16x16x32_bf16 v[36:39], v[88:91], v[72:75], v[36:39]
    s_waitcnt lgkmcnt(4)
    v_mfma_f32_16x16x32_bf16 v[16:19], v[220:223], v[76:79], v[16:19]
    ds_read_b128 v[72:75], v4 offset:22528
    v_mfma_f32_16x16x32_bf16 v[20:23], v[228:231], v[76:79], v[20:23]
    ds_read_b128 v[88:91], v5 offset:2048
    v_mfma_f32_16x16x32_bf16 v[24:27], v[236:239], v[76:79], v[24:27]
    s_add_u32 m0, s53, 23552
    s_add_u32 s54, s52, 23552
    v_mfma_f32_16x16x32_bf16 v[28:31], v[244:247], v[76:79], v[28:31]
    buffer_load_dwordx4 v2, s[4:7], s54 offen sc1 lds
    v_mfma_f32_16x16x32_bf16 v[32:35], v[252:255], v[76:79], v[32:35]
    s_add_u32 s37, s36, 6144
    v_mfma_f32_16x16x32_bf16 v[36:39], v[92:95], v[76:79], v[36:39]
    s_waitcnt lgkmcnt(4)
    v_mfma_f32_16x16x32_bf16 v[40:43], a[0:3], v[64:67], 0
    ds_read_b128 v[76:79], v4 offset:23552
    v_mfma_f32_16x16x32_bf16 v[44:47], a[8:11], v[64:67], 0
    ds_read_b128 v[92:95], v5 offset:3072
    v_mfma_f32_16x16x32_bf16 v[48:51], a[16:19], v[64:67], 0
    s_add_u32 m0, s53, 24576
    s_add_u32 s54, s52, 24576
    v_mfma_f32_16x16x32_bf16 v[52:55], a[24:27], v[64:67], 0
    buffer_load_dwordx4 v2, s[4:7], s54 offen sc1 lds
    v_mfma_f32_16x16x32_bf16 v[56:59], a[32:35], v[64:67], 0
    v_mfma_f32_16x16x32_bf16 v[60:63], v[80:83], v[64:67], 0
    s_waitcnt lgkmcnt(4)
    v_mfma_f32_16x16x32_bf16 v[40:43], a[4:7], v[68:71], v[40:43]
    ds_read_b128 v[64:67], v4 offset:24576
    v_mfma_f32_16x16x32_bf16 v[44:47], a[12:15], v[68:71], v[44:47]
    ds_read_b128 v[80:83], v5 offset:4096
    v_mfma_f32_16x16x32_bf16 v[48:51], a[20:23], v[68:71], v[48:51]
    v_mfma_f32_16x16x32_bf16 v[52:55], a[28:31], v[68:71], v[52:55]
    v_mfma_f32_16x16x32_bf16 v[56:59], a[36:39], v[68:71], v[56:59]
    v_mfma_f32_16x16x32_bf16 v[60:63], v[84:87], v[68:71], v[60:63]
    s_waitcnt lgkmcnt(4)
    v_mfma_f32_16x16x32_bf16 v[40:43], a[40:43], v[72:75], v[40:43]
    ds_read_b128 v[68:71], v4 offset:25600
    v_mfma_f32_16x16x32_bf16 v[44:47], a[48:51], v[72:75], v[44:47]
    ds_read_b128 v[84:87], v5 offset:5120
    v_mfma_f32_16x16x32_bf16 v[48:51], a[56:59], v[72:75], v[48:51]
    v_cvt_pk_bf16_f32 v96, v16, v17
    v_mfma_f32_16x16x32_bf16 v[52:55], a[64:67], v[72:75], v[52:55]
    v_cvt_pk_bf16_f32 v97, v18, v19
    v_mfma_f32_16x16x32_bf16 v[56:59], a[72:75], v[72:75], v[56:59]
    v_cvt_pk_bf16_f32 v98, v20, v21
    v_mfma_f32_16x16x32_bf16 v[60:63], v[88:91], v[72:75], v[60:63]
    s_waitcnt lgkmcnt(4)
    v_cvt_pk_bf16_f32 v99, v22, v23
    v_mfma_f32_16x16x32_bf16 v[40:43], a[44:47], v[76:79], v[40:43]
    ds_read_b128 v[72:75], v4 offset:26624
    buffer_store_dwordx4 v[96:99], v2, s[4:7], s36 offen offset:0 sc1
    v_mfma_f32_16x16x32_bf16 v[44:47], a[52:55], v[76:79], v[44:47]
    ds_read_b128 v[88:91], v5 offset:6144
    v_cvt_pk_bf16_f32 v100, v24, v25
    v_mfma_f32_16x16x32_bf16 v[48:51], a[60:63], v[76:79], v[48:51]
    v_cvt_pk_bf16_f32 v101, v26, v27
    v_mfma_f32_16x16x32_bf16 v[52:55], a[68:71], v[76:79], v[52:55]
    v_cvt_pk_bf16_f32 v102, v28, v29
    v_mfma_f32_16x16x32_bf16 v[56:59], a[76:79], v[76:79], v[56:59]
    v_cvt_pk_bf16_f32 v103, v30, v31
    v_mfma_f32_16x16x32_bf16 v[60:63], v[92:95], v[76:79], v[60:63]
    s_waitcnt lgkmcnt(4)
    buffer_store_dwordx4 v[100:103], v2, s[4:7], s36 offen offset:1024 sc1
    v_mfma_f32_16x16x32_bf16 v[40:43], a[80:83], v[64:67], v[40:43]
    ds_read_b128 v[76:79], v4 offset:27648
    v_cvt_pk_bf16_f32 v104, v32, v33
    v_mfma_f32_16x16x32_bf16 v[44:47], a[88:91], v[64:67], v[44:47]
    ds_read_b128 v[92:95], v5 offset:7168
    v_cvt_pk_bf16_f32 v105, v34, v35
    v_mfma_f32_16x16x32_bf16 v[48:51], a[96:99], v[64:67], v[48:51]
    v_cvt_pk_bf16_f32 v106, v36, v37
    v_mfma_f32_16x16x32_bf16 v[52:55], a[104:107], v[64:67], v[52:55]
    v_cvt_pk_bf16_f32 v107, v38, v39
    v_mfma_f32_16x16x32_bf16 v[56:59], a[112:115], v[64:67], v[56:59]
    buffer_store_dwordx4 v[104:107], v2, s[4:7], s36 offen offset:2048 sc1
    v_mfma_f32_16x16x32_bf16 v[60:63], v[80:83], v[64:67], v[60:63]
    s_waitcnt lgkmcnt(4)
    v_mfma_f32_16x16x32_bf16 v[40:43], a[84:87], v[68:71], v[40:43]
    ds_read_b128 v[64:67], v4 offset:28672
    v_mfma_f32_16x16x32_bf16 v[44:47], a[92:95], v[68:71], v[44:47]
    ds_read_b128 v[80:83], v5 offset:8192
    v_mfma_f32_16x16x32_bf16 v[48:51], a[100:103], v[68:71], v[48:51]
    v_mfma_f32_16x16x32_bf16 v[52:55], a[108:111], v[68:71], v[52:55]
    v_mfma_f32_16x16x32_bf16 v[56:59], a[116:119], v[68:71], v[56:59]
    v_mfma_f32_16x16x32_bf16 v[60:63], v[84:87], v[68:71], v[60:63]
    s_waitcnt lgkmcnt(4)
    v_mfma_f32_16x16x32_bf16 v[40:43], a[120:123], v[72:75], v[40:43]
    ds_read_b128 v[68:71], v4 offset:29696
    v_mfma_f32_16x16x32_bf16 v[44:47], a[128:131], v[72:75], v[44:47]
    ds_read_b128 v[84:87], v5 offset:9216
    v_mfma_f32_16x16x32_bf16 v[48:51], a[136:139], v[72:75], v[48:51]
    v_mfma_f32_16x16x32_bf16 v[52:55], a[144:147], v[72:75], v[52:55]
    v_mfma_f32_16x16x32_bf16 v[56:59], a[152:155], v[72:75], v[56:59]
    v_mfma_f32_16x16x32_bf16 v[60:63], v[88:91], v[72:75], v[60:63]
    s_waitcnt lgkmcnt(4)
    v_mfma_f32_16x16x32_bf16 v[40:43], a[124:127], v[76:79], v[40:43]
    ds_read_b128 v[72:75], v4 offset:30720
    v_mfma_f32_16x16x32_bf16 v[44:47], a[132:135], v[76:79], v[44:47]
    ds_read_b128 v[88:91], v5 offset:10240
    v_mfma_f32_16x16x32_bf16 v[48:51], a[140:143], v[76:79], v[48:51]
    v_mfma_f32_16x16x32_bf16 v[52:55], a[148:151], v[76:79], v[52:55]
    v_mfma_f32_16x16x32_bf16 v[56:59], a[156:159], v[76:79], v[56:59]
    v_mfma_f32_16x16x32_bf16 v[60:63], v[92:95], v[76:79], v[60:63]
    s_waitcnt lgkmcnt(4)
    v_mfma_f32_16x16x32_bf16 v[40:43], a[160:163], v[64:67], v[40:43]
    ds_read_b128 v[76:79], v4 offset:31744
    v_mfma_f32_16x16x32_bf16 v[44:47], a[168:171], v[64:67], v[44:47]
    ds_read_b128 v[92:95], v5 offset:11264
    v_mfma_f32_16x16x32_bf16 v[48:51], a[176:179], v[64:67], v[48:51]
    v_mfma_f32_16x16x32_bf16 v[52:55], a[184:187], v[64:67], v[52:55]
    v_mfma_f32_16x16x32_bf16 v[56:59], a[192:195], v[64:67], v[56:59]
    v_mfma_f32_16x16x32_bf16 v[60:63], v[80:83], v[64:67], v[60:63]
    s_waitcnt lgkmcnt(4)
    v_mfma_f32_16x16x32_bf16 v[40:43], a[164:167], v[68:71], v[40:43]
    ds_read_b128 v[64:67], v4 offset:32768
    v_mfma_f32_16x16x32_bf16 v[44:47], a[172:175], v[68:71], v[44:47]
    ds_read_b128 v[80:83], v5 offset:12288
    v_mfma_f32_16x16x32_bf16 v[48:51], a[180:183], v[68:71], v[48:51]
    v_mfma_f32_16x16x32_bf16 v[52:55], a[188:191], v[68:71], v[52:55]
    v_mfma_f32_16x16x32_bf16 v[56:59], a[196:199], v[68:71], v[56:59]
    v_mfma_f32_16x16x32_bf16 v[60:63], v[84:87], v[68:71], v[60:63]
    s_waitcnt lgkmcnt(4)
    v_mfma_f32_16x16x32_bf16 v[40:43], a[200:203], v[72:75], v[40:43]
    ds_read_b128 v[68:71], v4 offset:33792
    v_mfma_f32_16x16x32_bf16 v[44:47], a[208:211], v[72:75], v[44:47]
    ds_read_b128 v[84:87], v5 offset:13312
    v_mfma_f32_16x16x32_bf16 v[48:51], a[216:219], v[72:75], v[48:51]
    v_mfma_f32_16x16x32_bf16 v[52:55], a[224:227], v[72:75], v[52:55]
    v_mfma_f32_16x16x32_bf16 v[56:59], a[232:235], v[72:75], v[56:59]
    v_mfma_f32_16x16x32_bf16 v[60:63], v[88:91], v[72:75], v[60:63]
    s_waitcnt lgkmcnt(4)
    v_mfma_f32_16x16x32_bf16 v[40:43], a[204:207], v[76:79], v[40:43]
    ds_read_b128 v[72:75], v4 offset:34816
    v_mfma_f32_16x16x32_bf16 v[44:47], a[212:215], v[76:79], v[44:47]
    ds_read_b128 v[88:91], v5 offset:14336
    v_mfma_f32_16x16x32_bf16 v[48:51], a[220:223], v[76:79], v[48:51]
    v_mfma_f32_16x16x32_bf16 v[52:55], a[228:231], v[76:79], v[52:55]
    v_mfma_f32_16x16x32_bf16 v[56:59], a[236:239], v[76:79], v[56:59]
    v_mfma_f32_16x16x32_bf16 v[60:63], v[92:95], v[76:79], v[60:63]
    s_waitcnt lgkmcnt(4)
    v_mfma_f32_16x16x32_bf16 v[40:43], a[240:243], v[64:67], v[40:43]
    ds_read_b128 v[76:79], v4 offset:35840
    v_mfma_f32_16x16x32_bf16 v[44:47], a[248:251], v[64:67], v[44:47]
    ds_read_b128 v[92:95], v5 offset:15360
    v_mfma_f32_16x16x32_bf16 v[48:51], v[112:115], v[64:67], v[48:51]
    v_mfma_f32_16x16x32_bf16 v[52:55], v[120:123], v[64:67], v[52:55]
    v_mfma_f32_16x16x32_bf16 v[56:59], v[128:131], v[64:67], v[56:59]
    v_mfma_f32_16x16x32_bf16 v[60:63], v[80:83], v[64:67], v[60:63]
    s_waitcnt lgkmcnt(4)
    v_mfma_f32_16x16x32_bf16 v[40:43], a[244:247], v[68:71], v[40:43]
    ds_read_b128 v[64:67], v4 offset:36864
    v_mfma_f32_16x16x32_bf16 v[44:47], a[252:255], v[68:71], v[44:47]
    ds_read_b128 v[80:83], v5 offset:16384
    v_mfma_f32_16x16x32_bf16 v[48:51], v[116:119], v[68:71], v[48:51]
    v_mfma_f32_16x16x32_bf16 v[52:55], v[124:127], v[68:71], v[52:55]
    v_mfma_f32_16x16x32_bf16 v[56:59], v[132:135], v[68:71], v[56:59]
    v_mfma_f32_16x16x32_bf16 v[60:63], v[84:87], v[68:71], v[60:63]
    s_waitcnt lgkmcnt(4)
    v_mfma_f32_16x16x32_bf16 v[40:43], v[136:139], v[72:75], v[40:43]
    ds_read_b128 v[68:71], v4 offset:37888
    v_mfma_f32_16x16x32_bf16 v[44:47], v[144:147], v[72:75], v[44:47]
    ds_read_b128 v[84:87], v5 offset:17408
    v_mfma_f32_16x16x32_bf16 v[48:51], v[152:155], v[72:75], v[48:51]
    v_mfma_f32_16x16x32_bf16 v[52:55], v[160:163], v[72:75], v[52:55]
    v_mfma_f32_16x16x32_bf16 v[56:59], v[168:171], v[72:75], v[56:59]
    v_mfma_f32_16x16x32_bf16 v[60:63], v[88:91], v[72:75], v[60:63]
    s_waitcnt lgkmcnt(4)
    v_mfma_f32_16x16x32_bf16 v[40:43], v[140:143], v[76:79], v[40:43]
    ds_read_b128 v[72:75], v4 offset:38912
    v_mfma_f32_16x16x32_bf16 v[44:47], v[148:151], v[76:79], v[44:47]
    ds_read_b128 v[88:91], v5 offset:18432
    v_mfma_f32_16x16x32_bf16 v[48:51], v[156:159], v[76:79], v[48:51]
    v_mfma_f32_16x16x32_bf16 v[52:55], v[164:167], v[76:79], v[52:55]
    v_mfma_f32_16x16x32_bf16 v[56:59], v[172:175], v[76:79], v[56:59]
    v_mfma_f32_16x16x32_bf16 v[60:63], v[92:95], v[76:79], v[60:63]
    s_waitcnt lgkmcnt(4)
    v_mfma_f32_16x16x32_bf16 v[40:43], v[176:179], v[64:67], v[40:43]
    ds_read_b128 v[76:79], v4 offset:39936
    v_mfma_f32_16x16x32_bf16 v[44:47], v[184:187], v[64:67], v[44:47]
    ds_read_b128 v[92:95], v5 offset:19456
    v_mfma_f32_16x16x32_bf16 v[48:51], v[192:195], v[64:67], v[48:51]
    v_mfma_f32_16x16x32_bf16 v[52:55], v[200:203], v[64:67], v[52:55]
    s_waitcnt vmcnt(3)
    s_barrier
    v_mfma_f32_16x16x32_bf16 v[56:59], v[208:211], v[64:67], v[56:59]
    v_mfma_f32_16x16x32_bf16 v[60:63], v[80:83], v[64:67], v[60:63]
    s_waitcnt lgkmcnt(4)
    v_mfma_f32_16x16x32_bf16 v[40:43], v[180:183], v[68:71], v[40:43]
    ds_read_b128 v[64:67], v6 offset:0
    v_mfma_f32_16x16x32_bf16 v[44:47], v[188:191], v[68:71], v[44:47]
    ds_read_b128 v[80:83], v5 offset:0
    v_mfma_f32_16x16x32_bf16 v[48:51], v[196:199], v[68:71], v[48:51]
    v_mfma_f32_16x16x32_bf16 v[52:55], v[204:207], v[68:71], v[52:55]
    v_mfma_f32_16x16x32_bf16 v[56:59], v[212:215], v[68:71], v[56:59]
    v_mfma_f32_16x16x32_bf16 v[60:63], v[84:87], v[68:71], v[60:63]
    s_waitcnt lgkmcnt(4)
    v_mfma_f32_16x16x32_bf16 v[40:43], v[216:219], v[72:75], v[40:43]
    ds_read_b128 v[68:71], v6 offset:1024
    v_mfma_f32_16x16x32_bf16 v[44:47], v[224:227], v[72:75], v[44:47]
    ds_read_b128 v[84:87], v5 offset:1024
    v_mfma_f32_16x16x32_bf16 v[48:51], v[232:235], v[72:75], v[48:51]
    v_mfma_f32_16x16x32_bf16 v[52:55], v[240:243], v[72:75], v[52:55]
    v_mfma_f32_16x16x32_bf16 v[56:59], v[248:251], v[72:75], v[56:59]
    v_mfma_f32_16x16x32_bf16 v[60:63], v[88:91], v[72:75], v[60:63]
    s_waitcnt lgkmcnt(4)
    v_mfma_f32_16x16x32_bf16 v[40:43], v[220:223], v[76:79], v[40:43]
    ds_read_b128 v[72:75], v6 offset:2048
    v_mfma_f32_16x16x32_bf16 v[44:47], v[228:231], v[76:79], v[44:47]
    ds_read_b128 v[88:91], v5 offset:2048
    v_mfma_f32_16x16x32_bf16 v[48:51], v[236:239], v[76:79], v[48:51]
    s_cmp_lt_u32 s19, 2
    s_cselect_b32 s30, 0, s55
    v_mfma_f32_16x16x32_bf16 v[52:55], v[244:247], v[76:79], v[52:55]
    v_swap_b32 v4, v6
    v_mfma_f32_16x16x32_bf16 v[56:59], v[252:255], v[76:79], v[56:59]
    s_mov_b32 s19, s34
    s_cmp_lt_u32 s19, s30
    v_mfma_f32_16x16x32_bf16 v[60:63], v[92:95], v[76:79], v[60:63]
    s_cbranch_scc1 XQ_seg
    v_cvt_pk_bf16_f32 v96, v40, v41
    v_cvt_pk_bf16_f32 v97, v42, v43
    v_cvt_pk_bf16_f32 v98, v44, v45
    v_cvt_pk_bf16_f32 v99, v46, v47
    buffer_store_dwordx4 v[96:99], v2, s[4:7], s37 offen offset:0 sc1
    v_cvt_pk_bf16_f32 v100, v48, v49
    v_cvt_pk_bf16_f32 v101, v50, v51
    v_cvt_pk_bf16_f32 v102, v52, v53
    v_cvt_pk_bf16_f32 v103, v54, v55
    buffer_store_dwordx4 v[100:103], v2, s[4:7], s37 offen offset:1024 sc1
    v_cvt_pk_bf16_f32 v104, v56, v57
    v_cvt_pk_bf16_f32 v105, v58, v59
    v_cvt_pk_bf16_f32 v106, v60, v61
    v_cvt_pk_bf16_f32 v107, v62, v63
    buffer_store_dwordx4 v[104:107], v2, s[4:7], s37 offen offset:2048 sc1
    v_mov_b32 v7, 2
    s_waitcnt vmcnt(0)
    s_mov_b64 exec, 1
    buffer_store_dword v7, v2, s[4:7], s39 offen sc1
    s_mov_b64 exec, -1
    s_mov_b32 s37, 0x7ffffff0
    s_mov_b32 s39, 0x7ffffff0
    s_cmp_lt_u32 s19, s55
    s_cbranch_scc1 XQ_seg
    s_branch M_second
M_xvo:
    s_mov_b32 s8, s44
    s_and_b32 s9, s45, 0xffff
    s_mov_b32 s10, 7864320
    s_mov_b32 s11, 0x20000
    s_mov_b32 s12, s46
    s_and_b32 s13, s47, 0xffff
    s_mov_b32 s14, 7864320
    s_mov_b32 s15, 0x20000
    s_mul_i32 s36, s17, 384
    s_mul_i32 s30, s16, 96
    s_add_u32 s36, s36, s30
    s_mul_i32 s37, s17, 245760
    s_mul_i32 s30, s16, 320
    s_add_u32 s37, s37, s30
    s_mul_i32 s19, s18, 1
    s_cmp_eq_u32 s18, 0
    s_cselect_b32 s55, 64, 44
    v_add_u32 v4, 0, v1
    v_mul_u32_u24 v5, 171, v4
    v_lshrrev_b32 v5, 10, v5
    v_mul_u32_u24 v6, 6, v5
    v_sub_u32 v4, v4, v6
    v_lshlrev_b32 v4, 4, v4
    v_and_b32 v6, 3, v5
    v_and_b32 v7, 12, v5
    v_lshlrev_b32 v7, 1, v7
    v_add_u32 v6, v6, v7
    v_lshrrev_b32 v7, 4, v5
    v_lshlrev_b32 v7, 2, v7
    v_add_u32 v6, v6, v7
    v_mul_u32_u24 v6, 12288, v6
    v_add_u32 v16, v6, v4
    v_add_u32 v4, 64, v1
    v_mul_u32_u24 v5, 171, v4
    v_lshrrev_b32 v5, 10, v5
    v_mul_u32_u24 v6, 6, v5
    v_sub_u32 v4, v4, v6
    v_lshlrev_b32 v4, 4, v4
    v_and_b32 v6, 3, v5
    v_and_b32 v7, 12, v5
    v_lshlrev_b32 v7, 1, v7
    v_add_u32 v6, v6, v7
    v_lshrrev_b32 v7, 4, v5
    v_lshlrev_b32 v7, 2, v7
    v_add_u32 v6, v6, v7
    v_mul_u32_u24 v6, 12288, v6
    v_add_u32 v17, v6, v4
    v_add_u32 v4, 128, v1
    v_mul_u32_u24 v5, 171, v4
    v_lshrrev_b32 v5, 10, v5
    v_mul_u32_u24 v6, 6, v5
    v_sub_u32 v4, v4, v6
    v_lshlrev_b32 v4, 4, v4
    v_and_b32 v6, 3, v5
    v_and_b32 v7, 12, v5
    v_lshlrev_b32 v7, 1, v7
    v_add_u32 v6, v6, v7
    v_lshrrev_b32 v7, 4, v5
    v_lshlrev_b32 v7, 2, v7
    v_add_u32 v6, v6, v7
    v_mul_u32_u24 v6, 12288, v6
    v_add_u32 v18, v6, v4
    s_mul_i32 s30, s16, 20480
    s_add_u32 s31, s36, 0
    s_add_u32 m0, s30, 0
    s_nop 0
    buffer_load_dwordx4 v16, s[8:11], s31 offen lds
    s_add_u32 m0, s30, 1024
    s_nop 0
    buffer_load_dwordx4 v17, s[8:11], s31 offen lds
    s_add_u32 m0, s30, 2048
    s_nop 0
    buffer_load_dwordx4 v18, s[8:11], s31 offen lds
    s_add_u32 s31, s36, 1572864
    s_add_u32 m0, s30, 3072
    s_nop 0
    buffer_load_dwordx4 v16, s[8:11], s31 offen lds
    s_add_u32 m0, s30, 4096
    s_nop 0
    buffer_load_dwordx4 v17, s[8:11], s31 offen lds
    s_add_u32 m0, s30, 5120
    s_nop 0
    buffer_load_dwordx4 v18, s[8:11], s31 offen lds
    s_add_u32 s31, s36, 3145728
    s_add_u32 m0, s30, 6144
    s_nop 0
    buffer_load_dwordx4 v16, s[8:11], s31 offen lds
    s_add_u32 m0, s30, 7168
    s_nop 0
    buffer_load_dwordx4 v17, s[8:11], s31 offen lds
    s_add_u32 m0, s30, 8192
    s_nop 0
    buffer_load_dwordx4 v18, s[8:11], s31 offen lds
    s_add_u32 s31, s36, 4718592
    s_add_u32 m0, s30, 9216
    s_nop 0
    buffer_load_dwordx4 v16, s[8:11], s31 offen lds
    s_add_u32 m0, s30, 10240
    s_nop 0
    buffer_load_dwordx4 v17, s[8:11], s31 offen lds
    s_add_u32 m0, s30, 11264
    s_nop 0
    buffer_load_dwordx4 v18, s[8:11], s31 offen lds
    s_add_u32 s31, s36, 393216
    s_add_u32 m0, s30, 12288
    s_nop 0
    buffer_load_dwordx4 v16, s[8:11], s31 offen lds
    s_add_u32 m0, s30, 13312
    s_nop 0
    buffer_load_dwordx4 v17, s[8:11], s31 offen lds
    s_add_u32 m0, s30, 14336
    s_nop 0
    buffer_load_dwordx4 v18, s[8:11], s31 offen lds
    s_add_u32 s31, s36, 1966080
    s_add_u32 m0, s30, 15360
    s_nop 0
    buffer_load_dwordx4 v16, s[8:11], s31 offen lds
    s_add_u32 m0, s30, 16384
    s_nop 0
    buffer_load_dwordx4 v17, s[8:11], s31 offen lds
    s_add_u32 m0, s30, 17408
    s_nop 0
    buffer_load_dwordx4 v18, s[8:11], s31 offen lds
    v_add_u32 v4, 0, v1
    v_mul_u32_u24 v5, 205, v4
    v_lshrrev_b32 v5, 12, v5
    v_mul_u32_u24 v6, 20, v5
    v_sub_u32 v4, v4, v6
    v_lshlrev_b32 v4, 4, v4
    v_and_b32 v6, 3, v5
    v_and_b32 v7, 12, v5
    v_lshlrev_b32 v7, 1, v7
    v_add_u32 v6, v6, v7
    v_lshrrev_b32 v7, 4, v5
    v_lshlrev_b32 v7, 2, v7
    v_add_u32 v6, v6, v7
    v_mul_u32_u24 v6, 1280, v6
    v_add_u32 v19, v6, v4
    v_add_u32 v4, 64, v1
    v_mul_u32_u24 v5, 205, v4
    v_lshrrev_b32 v5, 12, v5
    v_mul_u32_u24 v6, 20, v5
    v_sub_u32 v4, v4, v6
    v_lshlrev_b32 v4, 4, v4
    v_and_b32 v6, 3, v5
    v_and_b32 v7, 12, v5
    v_lshlrev_b32 v7, 1, v7
    v_add_u32 v6, v6, v7
    v_lshrrev_b32 v7, 4, v5
    v_lshlrev_b32 v7, 2, v7
    v_add_u32 v6, v6, v7
    v_mul_u32_u24 v6, 1280, v6
    v_add_u32 v20, v6, v4
    v_add_u32 v4, 128, v1
    v_mul_u32_u24 v5, 205, v4
    v_lshrrev_b32 v5, 12, v5
    v_mul_u32_u24 v6, 20, v5
    v_sub_u32 v4, v4, v6
    v_lshlrev_b32 v4, 4, v4
    v_and_b32 v6, 3, v5
    v_and_b32 v7, 12, v5
    v_lshlrev_b32 v7, 1, v7
    v_add_u32 v6, v6, v7
    v_lshrrev_b32 v7, 4, v5
    v_lshlrev_b32 v7, 2, v7
    v_add_u32 v6, v6, v7
    v_mul_u32_u24 v6, 1280, v6
    v_add_u32 v21, v6, v4
    v_add_u32 v4, 192, v1
    v_mul_u32_u24 v5, 205, v4
    v_lshrrev_b32 v5, 12, v5
    v_mul_u32_u24 v6, 20, v5
    v_sub_u32 v4, v4, v6
    v_lshlrev_b32 v4, 4, v4
    v_and_b32 v6, 3, v5
    v_and_b32 v7, 12, v5
    v_lshlrev_b32 v7, 1, v7
    v_add_u32 v6, v6, v7
    v_lshrrev_b32 v7, 4, v5
    v_lshlrev_b32 v7, 2, v7
    v_add_u32 v6, v6, v7
    v_mul_u32_u24 v6, 1280, v6
    v_add_u32 v22, v6, v4
    v_add_u32 v4, 256, v1
    v_mul_u32_u24 v5, 205, v4
    v_lshrrev_b32 v5, 12, v5
    v_mul_u32_u24 v6, 20, v5
    v_sub_u32 v4, v4, v6
    v_lshlrev_b32 v4, 4, v4
    v_and_b32 v6, 3, v5
    v_and_b32 v7, 12, v5
    v_lshlrev_b32 v7, 1, v7
    v_add_u32 v6, v6, v7
    v_lshrrev_b32 v7, 4, v5
    v_lshlrev_b32 v7, 2, v7
    v_add_u32 v6, v6, v7
    v_mul_u32_u24 v6, 1280, v6
    v_add_u32 v23, v6, v4
    v_add_u32 v4, 320, v1
    v_mul_u32_u24 v5, 205, v4
    v_lshrrev_b32 v5, 12, v5
    v_mul_u32_u24 v6, 20, v5
    v_sub_u32 v4, v4, v6
    v_lshlrev_b32 v4, 4, v4
    v_and_b32 v6, 3, v5
    v_and_b32 v7, 12, v5
    v_lshlrev_b32 v7, 1, v7
    v_add_u32 v6, v6, v7
    v_lshrrev_b32 v7, 4, v5
    v_lshlrev_b32 v7, 2, v7
    v_add_u32 v6, v6, v7
    v_mul_u32_u24 v6, 1280, v6
    v_add_u32 v24, v6, v4
    v_add_u32 v4, 384, v1
    v_mul_u32_u24 v5, 205, v4
    v_lshrrev_b32 v5, 12, v5
    v_mul_u32_u24 v6, 20, v5
    v_sub_u32 v4, v4, v6
    v_lshlrev_b32 v4, 4, v4
    v_and_b32 v6, 3, v5
    v_and_b32 v7, 12, v5
    v_lshlrev_b32 v7, 1, v7
    v_add_u32 v6, v6, v7
    v_lshrrev_b32 v7, 4, v5
    v_lshlrev_b32 v7, 2, v7
    v_add_u32 v6, v6, v7
    v_mul_u32_u24 v6, 1280, v6
    v_add_u32 v25, v6, v4
    v_add_u32 v4, 448, v1
    v_mul_u32_u24 v5, 205, v4
    v_lshrrev_b32 v5, 12, v5
    v_mul_u32_u24 v6, 20, v5
    v_sub_u32 v4, v4, v6
    v_lshlrev_b32 v4, 4, v4
    v_and_b32 v6, 3, v5
    v_and_b32 v7, 12, v5
    v_lshlrev_b32 v7, 1, v7
    v_add_u32 v6, v6, v7
    v_lshrrev_b32 v7, 4, v5
    v_lshlrev_b32 v7, 2, v7
    v_add_u32 v6, v6, v7
    v_mul_u32_u24 v6, 1280, v6
    v_add_u32 v26, v6, v4
    v_add_u32 v4, 512, v1
    v_mul_u32_u24 v5, 205, v4
    v_lshrrev_b32 v5, 12, v5
    v_mul_u32_u24 v6, 20, v5
    v_sub_u32 v4, v4, v6
    v_lshlrev_b32 v4, 4, v4
    v_and_b32 v6, 3, v5
    v_and_b32 v7, 12, v5
    v_lshlrev_b32 v7, 1, v7
    v_add_u32 v6, v6, v7
    v_lshrrev_b32 v7, 4, v5
    v_lshlrev_b32 v7, 2, v7
    v_add_u32 v6, v6, v7
    v_mul_u32_u24 v6, 1280, v6
    v_add_u32 v27, v6, v4
    v_add_u32 v4, 576, v1
    v_mul_u32_u24 v5, 205, v4
    v_lshrrev_b32 v5, 12, v5
    v_mul_u32_u24 v6, 20, v5
    v_sub_u32 v4, v4, v6
    v_lshlrev_b32 v4, 4, v4
    v_and_b32 v6, 3, v5
    v_and_b32 v7, 12, v5
    v_lshlrev_b32 v7, 1, v7
    v_add_u32 v6, v6, v7
    v_lshrrev_b32 v7, 4, v5
    v_lshlrev_b32 v7, 2, v7
    v_add_u32 v6, v6, v7
    v_mul_u32_u24 v6, 1280, v6
    v_add_u32 v28, v6, v4
    v_lshrrev_b32 v4, 2, v1
    v_and_b32 v5, 3, v1
    v_lshlrev_b32 v5, 3, v5
    v_add_u32 v5, s30, v5
    v_mul_u32_u24 v6, 96, v4
    v_add_u32 v31, v6, v5
    v_mul_u32_u24 v6, 320, v4
    v_add_u32 v29, v6, v5
    s_mul_i32 s33, s16, 20480
    v_add_u32 v30, s33, v2
    s_waitcnt vmcnt(15)
    ds_read_b64_tr_b16 a[0:1], v31 offset:0
    ds_read_b64_tr_b16 a[2:3], v31 offset:1536
    ds_read_b64_tr_b16 a[8:9], v31 offset:32
    ds_read_b64_tr_b16 a[10:11], v31 offset:1568
    ds_read_b64_tr_b16 a[16:17], v31 offset:64
    ds_read_b64_tr_b16 a[18:19], v31 offset:1600
    s_waitcnt lgkmcnt(0)
    s_add_u32 s31, s36, 3538944
    s_add_u32 m0, s30, 0
    s_nop 0
    buffer_load_dwordx4 v16, s[8:11], s31 offen lds
    s_add_u32 m0, s30, 1024
    s_nop 0
    buffer_load_dwordx4 v17, s[8:11], s31 offen lds
    s_add_u32 m0, s30, 2048
    s_nop 0
    buffer_load_dwordx4 v18, s[8:11], s31 offen lds
    s_waitcnt vmcnt(15)
    ds_read_b64_tr_b16 a[48:49], v31 offset:3072
    ds_read_b64_tr_b16 a[50:51], v31 offset:4608
    ds_read_b64_tr_b16 a[56:57], v31 offset:3104
    ds_read_b64_tr_b16 a[58:59], v31 offset:4640
    ds_read_b64_tr_b16 a[64:65], v31 offset:3136
    ds_read_b64_tr_b16 a[66:67], v31 offset:4672
    s_waitcnt lgkmcnt(0)
    s_add_u32 s31, s36, 5111808
    s_add_u32 m0, s30, 3072
    s_nop 0
    buffer_load_dwordx4 v16, s[8:11], s31 offen lds
    s_add_u32 m0, s30, 4096
    s_nop 0
    buffer_load_dwordx4 v17, s[8:11], s31 offen lds
    s_add_u32 m0, s30, 5120
    s_nop 0
    buffer_load_dwordx4 v18, s[8:11], s31 offen lds
    s_waitcnt vmcnt(15)
    ds_read_b64_tr_b16 a[96:97], v31 offset:6144
    ds_read_b64_tr_b16 a[98:99], v31 offset:7680
    ds_read_b64_tr_b16 a[104:105], v31 offset:6176
    ds_read_b64_tr_b16 a[106:107], v31 offset:7712
    ds_read_b64_tr_b16 a[112:113], v31 offset:6208
    ds_read_b64_tr_b16 a[114:115], v31 offset:7744
    s_waitcnt lgkmcnt(0)
    s_add_u32 s31, s36, 786432
    s_add_u32 m0, s30, 6144
    s_nop 0
    buffer_load_dwordx4 v16, s[8:11], s31 offen lds
    s_add_u32 m0, s30, 7168
    s_nop 0
    buffer_load_dwordx4 v17, s[8:11], s31 offen lds
    s_add_u32 m0, s30, 8192
    s_nop 0
    buffer_load_dwordx4 v18, s[8:11], s31 offen lds
    s_waitcnt vmcnt(15)
    ds_read_b64_tr_b16 a[144:145], v31 offset:9216
    ds_read_b64_tr_b16 a[146:147], v31 offset:10752
    ds_read_b64_tr_b16 a[152:153], v31 offset:9248
    ds_read_b64_tr_b16 a[154:155], v31 offset:10784
    ds_read_b64_tr_b16 a[160:161], v31 offset:9280
    ds_read_b64_tr_b16 a[162:163], v31 offset:10816
    s_waitcnt lgkmcnt(0)
    s_add_u32 s31, s36, 2359296
    s_add_u32 m0, s30, 9216
    s_nop 0
    buffer_load_dwordx4 v16, s[8:11], s31 offen lds
    s_add_u32 m0, s30, 10240
    s_nop 0
    buffer_load_dwordx4 v17, s[8:11], s31 offen lds
    s_add_u32 m0, s30, 11264
    s_nop 0
    buffer_load_dwordx4 v18, s[8:11], s31 offen lds
    s_waitcnt vmcnt(15)
    ds_read_b64_tr_b16 a[4:5], v31 offset:12288
    ds_read_b64_tr_b16 a[6:7], v31 offset:13824
    ds_read_b64_tr_b16 a[12:13], v31 offset:12320
    ds_read_b64_tr_b16 a[14:15], v31 offset:13856
    ds_read_b64_tr_b16 a[20:21], v31 offset:12352
    ds_read_b64_tr_b16 a[22:23], v31 offset:13888
    s_waitcnt lgkmcnt(0)
    s_add_u32 s31, s36, 3932160
    s_add_u32 m0, s30, 12288
    s_nop 0
    buffer_load_dwordx4 v16, s[8:11], s31 offen lds
    s_add_u32 m0, s30, 13312
    s_nop 0
    buffer_load_dwordx4 v17, s[8:11], s31 offen lds
    s_add_u32 m0, s30, 14336
    s_nop 0
    buffer_load_dwordx4 v18, s[8:11], s31 offen lds
    s_waitcnt vmcnt(15)
    ds_read_b64_tr_b16 a[52:53], v31 offset:15360
    ds_read_b64_tr_b16 a[54:55], v31 offset:16896
    ds_read_b64_tr_b16 a[60:61], v31 offset:15392
    ds_read_b64_tr_b16 a[62:63], v31 offset:16928
    ds_read_b64_tr_b16 a[68:69], v31 offset:15424
    ds_read_b64_tr_b16 a[70:71], v31 offset:16960
    s_waitcnt lgkmcnt(0)
    s_add_u32 s31, s36, 5505024
    s_add_u32 m0, s30, 15360
    s_nop 0
    buffer_load_dwordx4 v16, s[8:11], s31 offen lds
    s_add_u32 m0, s30, 16384
    s_nop 0
    buffer_load_dwordx4 v17, s[8:11], s31 offen lds
    s_add_u32 m0, s30, 17408
    s_nop 0
    buffer_load_dwordx4 v18, s[8:11], s31 offen lds
    s_waitcnt vmcnt(15)
    ds_read_b64_tr_b16 a[100:101], v31 offset:0
    ds_read_b64_tr_b16 a[102:103], v31 offset:1536
    ds_read_b64_tr_b16 a[108:109], v31 offset:32
    ds_read_b64_tr_b16 a[110:111], v31 offset:1568
    ds_read_b64_tr_b16 a[116:117], v31 offset:64
    ds_read_b64_tr_b16 a[118:119], v31 offset:1600
    s_waitcnt lgkmcnt(0)
    s_add_u32 s31, s36, 1179648
    s_add_u32 m0, s30, 0
    s_nop 0
    buffer_load_dwordx4 v16, s[8:11], s31 offen lds
    s_add_u32 m0, s30, 1024
    s_nop 0
    buffer_load_dwordx4 v17, s[8:11], s31 offen lds
    s_add_u32 m0, s30, 2048
    s_nop 0
    buffer_load_dwordx4 v18, s[8:11], s31 offen lds
    s_waitcnt vmcnt(15)
    ds_read_b64_tr_b16 a[148:149], v31 offset:3072
    ds_read_b64_tr_b16 a[150:151], v31 offset:4608
    ds_read_b64_tr_b16 a[156:157], v31 offset:3104
    ds_read_b64_tr_b16 a[158:159], v31 offset:4640
    ds_read_b64_tr_b16 a[164:165], v31 offset:3136
    ds_read_b64_tr_b16 a[166:167], v31 offset:4672
    s_waitcnt lgkmcnt(0)
    s_add_u32 s31, s36, 2752512
    s_add_u32 m0, s30, 3072
    s_nop 0
    buffer_load_dwordx4 v16, s[8:11], s31 offen lds
    s_add_u32 m0, s30, 4096
    s_nop 0
    buffer_load_dwordx4 v17, s[8:11], s31 offen lds
    s_add_u32 m0, s30, 5120
    s_nop 0
    buffer_load_dwordx4 v18, s[8:11], s31 offen lds
    s_waitcnt vmcnt(15)
    ds_read_b64_tr_b16 a[24:25], v31 offset:6144
    ds_read_b64_tr_b16 a[26:27], v31 offset:7680
    ds_read_b64_tr_b16 a[32:33], v31 offset:6176
    ds_read_b64_tr_b16 a[34:35], v31 offset:7712
    ds_read_b64_tr_b16 a[40:41], v31 offset:6208
    ds_read_b64_tr_b16 a[42:43], v31 offset:7744
    s_waitcnt lgkmcnt(0)
    s_add_u32 s31, s36, 4325376
    s_add_u32 m0, s30, 6144
    s_nop 0
    buffer_load_dwordx4 v16, s[8:11], s31 offen lds
    s_add_u32 m0, s30, 7168
    s_nop 0
    buffer_load_dwordx4 v17, s[8:11], s31 offen lds
    s_add_u32 m0, s30, 8192
    s_nop 0
    buffer_load_dwordx4 v18, s[8:11], s31 offen lds
    s_waitcnt vmcnt(15)
    ds_read_b64_tr_b16 a[72:73], v31 offset:9216
    ds_read_b64_tr_b16 a[74:75], v31 offset:10752
    ds_read_b64_tr_b16 a[80:81], v31 offset:9248
    ds_read_b64_tr_b16 a[82:83], v31 offset:10784
    ds_read_b64_tr_b16 a[88:89], v31 offset:9280
    ds_read_b64_tr_b16 a[90:91], v31 offset:10816
    s_waitcnt lgkmcnt(0)
    s_add_u32 s31, s36, 5898240
    s_add_u32 m0, s30, 9216
    s_nop 0
    buffer_load_dwordx4 v16, s[8:11], s31 offen lds
    s_add_u32 m0, s30, 10240
    s_nop 0
    buffer_load_dwordx4 v17, s[8:11], s31 offen lds
    s_add_u32 m0, s30, 11264
    s_nop 0
    buffer_load_dwordx4 v18, s[8:11], s31 offen lds
    s_waitcnt vmcnt(15)
    ds_read_b64_tr_b16 a[120:121], v31 offset:12288
    ds_read_b64_tr_b16 a[122:123], v31 offset:13824
    ds_read_b64_tr_b16 a[128:129], v31 offset:12320
    ds_read_b64_tr_b16 a[130:131], v31 offset:13856
    ds_read_b64_tr_b16 a[136:137], v31 offset:12352
    ds_read_b64_tr_b16 a[138:139], v31 offset:13888
    s_waitcnt lgkmcnt(0)
    s_add_u32 s31, s36, 6291456
    s_add_u32 m0, s30, 12288
    s_nop 0
    buffer_load_dwordx4 v16, s[8:11], s31 offen lds
    s_add_u32 m0, s30, 13312
    s_nop 0
    buffer_load_dwordx4 v17, s[8:11], s31 offen lds
    s_add_u32 m0, s30, 14336
    s_nop 0
    buffer_load_dwordx4 v18, s[8:11], s31 offen lds
    s_waitcnt vmcnt(15)
    ds_read_b64_tr_b16 a[168:169], v31 offset:15360
    ds_read_b64_tr_b16 a[170:171], v31 offset:16896
    ds_read_b64_tr_b16 a[176:177], v31 offset:15392
    ds_read_b64_tr_b16 a[178:179], v31 offset:16928
    ds_read_b64_tr_b16 a[184:185], v31 offset:15424
    ds_read_b64_tr_b16 a[186:187], v31 offset:16960
    s_waitcnt lgkmcnt(0)
    s_add_u32 s31, s36, 7077888
    s_add_u32 m0, s30, 15360
    s_nop 0
    buffer_load_dwordx4 v16, s[8:11], s31 offen lds
    s_add_u32 m0, s30, 16384
    s_nop 0
    buffer_load_dwordx4 v17, s[8:11], s31 offen lds
    s_add_u32 m0, s30, 17408
    s_nop 0
    buffer_load_dwordx4 v18, s[8:11], s31 offen lds
    s_waitcnt vmcnt(15)
    ds_read_b64_tr_b16 a[28:29], v31 offset:0
    ds_read_b64_tr_b16 a[30:31], v31 offset:1536
    ds_read_b64_tr_b16 a[36:37], v31 offset:32
    ds_read_b64_tr_b16 a[38:39], v31 offset:1568
    ds_read_b64_tr_b16 a[44:45], v31 offset:64
    ds_read_b64_tr_b16 a[46:47], v31 offset:1600
    s_waitcnt lgkmcnt(0)
    s_add_u32 s31, s36, 6684672
    s_add_u32 m0, s30, 0
    s_nop 0
    buffer_load_dwordx4 v16, s[8:11], s31 offen lds
    s_add_u32 m0, s30, 1024
    s_nop 0
    buffer_load_dwordx4 v17, s[8:11], s31 offen lds
    s_add_u32 m0, s30, 2048
    s_nop 0
    buffer_load_dwordx4 v18, s[8:11], s31 offen lds
    s_waitcnt vmcnt(15)
    ds_read_b64_tr_b16 a[76:77], v31 offset:3072
    ds_read_b64_tr_b16 a[78:79], v31 offset:4608
    ds_read_b64_tr_b16 a[84:85], v31 offset:3104
    ds_read_b64_tr_b16 a[86:87], v31 offset:4640
    ds_read_b64_tr_b16 a[92:93], v31 offset:3136
    ds_read_b64_tr_b16 a[94:95], v31 offset:4672
    s_waitcnt lgkmcnt(0)
    s_add_u32 s31, s36, 7471104
    s_add_u32 m0, s30, 3072
    s_nop 0
    buffer_load_dwordx4 v16, s[8:11], s31 offen lds
    s_add_u32 m0, s30, 4096
    s_nop 0
    buffer_load_dwordx4 v17, s[8:11], s31 offen lds
    s_add_u32 m0, s30, 5120
    s_nop 0
    buffer_load_dwordx4 v18, s[8:11], s31 offen lds
    s_waitcnt vmcnt(15)
    ds_read_b64_tr_b16 a[124:125], v31 offset:6144
    ds_read_b64_tr_b16 a[126:127], v31 offset:7680
    ds_read_b64_tr_b16 a[132:133], v31 offset:6176
    ds_read_b64_tr_b16 a[134:135], v31 offset:7712
    ds_read_b64_tr_b16 a[140:141], v31 offset:6208
    ds_read_b64_tr_b16 a[142:143], v31 offset:7744
    s_waitcnt lgkmcnt(0)
    s_waitcnt vmcnt(12)
    ds_read_b64_tr_b16 a[172:173], v31 offset:9216
    ds_read_b64_tr_b16 a[174:175], v31 offset:10752
    ds_read_b64_tr_b16 a[180:181], v31 offset:9248
    ds_read_b64_tr_b16 a[182:183], v31 offset:10784
    ds_read_b64_tr_b16 a[188:189], v31 offset:9280
    ds_read_b64_tr_b16 a[190:191], v31 offset:10816
    s_waitcnt lgkmcnt(0)
    s_waitcnt vmcnt(9)
    ds_read_b64_tr_b16 a[192:193], v31 offset:12288
    ds_read_b64_tr_b16 a[194:195], v31 offset:13824
    ds_read_b64_tr_b16 a[200:201], v31 offset:12320
    ds_read_b64_tr_b16 a[202:203], v31 offset:13856
    ds_read_b64_tr_b16 a[208:209], v31 offset:12352
    ds_read_b64_tr_b16 a[210:211], v31 offset:13888
    s_waitcnt lgkmcnt(0)
    s_waitcnt vmcnt(6)
    ds_read_b64_tr_b16 a[216:217], v31 offset:15360
    ds_read_b64_tr_b16 a[218:219], v31 offset:16896
    ds_read_b64_tr_b16 a[224:225], v31 offset:15392
    ds_read_b64_tr_b16 a[226:227], v31 offset:16928
    ds_read_b64_tr_b16 a[232:233], v31 offset:15424
    ds_read_b64_tr_b16 a[234:235], v31 offset:16960
    s_waitcnt lgkmcnt(0)
    s_add_u32 s31, s37, 0
    s_add_u32 m0, s30, 10240
    s_nop 0
    buffer_load_dwordx4 v19, s[12:15], s31 offen lds
    s_add_u32 m0, s30, 11264
    s_nop 0
    buffer_load_dwordx4 v20, s[12:15], s31 offen lds
    s_add_u32 m0, s30, 12288
    s_nop 0
    buffer_load_dwordx4 v21, s[12:15], s31 offen lds
    s_add_u32 m0, s30, 13312
    s_nop 0
    buffer_load_dwordx4 v22, s[12:15], s31 offen lds
    s_add_u32 m0, s30, 14336
    s_nop 0
    buffer_load_dwordx4 v23, s[12:15], s31 offen lds
    s_add_u32 m0, s30, 15360
    s_nop 0
    buffer_load_dwordx4 v24, s[12:15], s31 offen lds
    s_add_u32 m0, s30, 16384
    s_nop 0
    buffer_load_dwordx4 v25, s[12:15], s31 offen lds
    s_add_u32 m0, s30, 17408
    s_nop 0
    buffer_load_dwordx4 v26, s[12:15], s31 offen lds
    s_add_u32 m0, s30, 18432
    s_nop 0
    buffer_load_dwordx4 v27, s[12:15], s31 offen lds
    s_add_u32 m0, s30, 19456
    s_nop 0
    buffer_load_dwordx4 v28, s[12:15], s31 offen lds
    s_waitcnt vmcnt(13)
    ds_read_b64_tr_b16 a[196:197], v31 offset:0
    ds_read_b64_tr_b16 a[198:199], v31 offset:1536
    ds_read_b64_tr_b16 a[204:205], v31 offset:32
    ds_read_b64_tr_b16 a[206:207], v31 offset:1568
    ds_read_b64_tr_b16 a[212:213], v31 offset:64
    ds_read_b64_tr_b16 a[214:215], v31 offset:1600
    s_waitcnt lgkmcnt(0)
    s_waitcnt vmcnt(10)
    ds_read_b64_tr_b16 a[220:221], v31 offset:3072
    ds_read_b64_tr_b16 a[222:223], v31 offset:4608
    ds_read_b64_tr_b16 a[228:229], v31 offset:3104
    ds_read_b64_tr_b16 a[230:231], v31 offset:4640
    ds_read_b64_tr_b16 a[236:237], v31 offset:3136
    ds_read_b64_tr_b16 a[238:239], v31 offset:4672
    s_waitcnt lgkmcnt(0)
    s_add_u32 s31, s37, 40960
    s_add_u32 m0, s30, 0
    s_nop 0
    buffer_load_dwordx4 v19, s[12:15], s31 offen lds
    s_add_u32 m0, s30, 1024
    s_nop 0
    buffer_load_dwordx4 v20, s[12:15], s31 offen lds
    s_add_u32 m0, s30, 2048
    s_nop 0
    buffer_load_dwordx4 v21, s[12:15], s31 offen lds
    s_add_u32 m0, s30, 3072
    s_nop 0
    buffer_load_dwordx4 v22, s[12:15], s31 offen lds
    s_add_u32 m0, s30, 4096
    s_nop 0
    buffer_load_dwordx4 v23, s[12:15], s31 offen lds
    s_add_u32 m0, s30, 5120
    s_nop 0
    buffer_load_dwordx4 v24, s[12:15], s31 offen lds
    s_add_u32 m0, s30, 6144
    s_nop 0
    buffer_load_dwordx4 v25, s[12:15], s31 offen lds
    s_add_u32 m0, s30, 7168
    s_nop 0
    buffer_load_dwordx4 v26, s[12:15], s31 offen lds
    s_add_u32 m0, s30, 8192
    s_nop 0
    buffer_load_dwordx4 v27, s[12:15], s31 offen lds
    s_add_u32 m0, s30, 9216
    s_nop 0
    buffer_load_dwordx4 v28, s[12:15], s31 offen lds
    s_waitcnt vmcnt(10)
    ds_read_b64_tr_b16 a[240:241], v29 offset:10240
    ds_read_b64_tr_b16 a[242:243], v29 offset:15360
    ds_read_b64_tr_b16 v[112:113], v29 offset:10272
    ds_read_b64_tr_b16 v[114:115], v29 offset:15392
    ds_read_b64_tr_b16 v[128:129], v29 offset:10304
    ds_read_b64_tr_b16 v[130:131], v29 offset:15424
    ds_read_b64_tr_b16 v[144:145], v29 offset:10336
    ds_read_b64_tr_b16 v[146:147], v29 offset:15456
    ds_read_b64_tr_b16 v[160:161], v29 offset:10368
    ds_read_b64_tr_b16 v[162:163], v29 offset:15488
    ds_read_b64_tr_b16 v[176:177], v29 offset:10400
    ds_read_b64_tr_b16 v[178:179], v29 offset:15520
    ds_read_b64_tr_b16 v[192:193], v29 offset:10432
    ds_read_b64_tr_b16 v[194:195], v29 offset:15552
    ds_read_b64_tr_b16 v[208:209], v29 offset:10464
    ds_read_b64_tr_b16 v[210:211], v29 offset:15584
    ds_read_b64_tr_b16 v[224:225], v29 offset:10496
    ds_read_b64_tr_b16 v[226:227], v29 offset:15616
    ds_read_b64_tr_b16 v[240:241], v29 offset:10528
    ds_read_b64_tr_b16 v[242:243], v29 offset:15648
    s_waitcnt lgkmcnt(0)
    s_add_u32 s31, s37, 81920
    s_add_u32 m0, s30, 10240
    s_nop 0
    buffer_load_dwordx4 v19, s[12:15], s31 offen lds
    s_add_u32 m0, s30, 11264
    s_nop 0
    buffer_load_dwordx4 v20, s[12:15], s31 offen lds
    s_add_u32 m0, s30, 12288
    s_nop 0
    buffer_load_dwordx4 v21, s[12:15], s31 offen lds
    s_add_u32 m0, s30, 13312
    s_nop 0
    buffer_load_dwordx4 v22, s[12:15], s31 offen lds
    s_add_u32 m0, s30, 14336
    s_nop 0
    buffer_load_dwordx4 v23, s[12:15], s31 offen lds
    s_add_u32 m0, s30, 15360
    s_nop 0
    buffer_load_dwordx4 v24, s[12:15], s31 offen lds
    s_add_u32 m0, s30, 16384
    s_nop 0
    buffer_load_dwordx4 v25, s[12:15], s31 offen lds
    s_add_u32 m0, s30, 17408
    s_nop 0
    buffer_load_dwordx4 v26, s[12:15], s31 offen lds
    s_add_u32 m0, s30, 18432
    s_nop 0
    buffer_load_dwordx4 v27, s[12:15], s31 offen lds
    s_add_u32 m0, s30, 19456
    s_nop 0
    buffer_load_dwordx4 v28, s[12:15], s31 offen lds
    s_waitcnt vmcnt(10)
    ds_read_b64_tr_b16 a[244:245], v29 offset:0
    ds_read_b64_tr_b16 a[246:247], v29 offset:5120
    ds_read_b64_tr_b16 v[116:117], v29 offset:32
    ds_read_b64_tr_b16 v[118:119], v29 offset:5152
    ds_read_b64_tr_b16 v[132:133], v29 offset:64
    ds_read_b64_tr_b16 v[134:135], v29 offset:5184
    ds_read_b64_tr_b16 v[148:149], v29 offset:96
    ds_read_b64_tr_b16 v[150:151], v29 offset:5216
    ds_read_b64_tr_b16 v[164:165], v29 offset:128
    ds_read_b64_tr_b16 v[166:167], v29 offset:5248
    ds_read_b64_tr_b16 v[180:181], v29 offset:160
    ds_read_b64_tr_b16 v[182:183], v29 offset:5280
    ds_read_b64_tr_b16 v[196:197], v29 offset:192
    ds_read_b64_tr_b16 v[198:199], v29 offset:5312
    ds_read_b64_tr_b16 v[212:213], v29 offset:224
    ds_read_b64_tr_b16 v[214:215], v29 offset:5344
    ds_read_b64_tr_b16 v[228:229], v29 offset:256
    ds_read_b64_tr_b16 v[230:231], v29 offset:5376
    ds_read_b64_tr_b16 v[244:245], v29 offset:288
    ds_read_b64_tr_b16 v[246:247], v29 offset:5408
    s_waitcnt lgkmcnt(0)
    s_add_u32 s31, s37, 122880
    s_add_u32 m0, s30, 0
    s_nop 0
    buffer_load_dwordx4 v19, s[12:15], s31 offen lds
    s_add_u32 m0, s30, 1024
    s_nop 0
    buffer_load_dwordx4 v20, s[12:15], s31 offen lds
    s_add_u32 m0, s30, 2048
    s_nop 0
    buffer_load_dwordx4 v21, s[12:15], s31 offen lds
    s_add_u32 m0, s30, 3072
    s_nop 0
    buffer_load_dwordx4 v22, s[12:15], s31 offen lds
    s_add_u32 m0, s30, 4096
    s_nop 0
    buffer_load_dwordx4 v23, s[12:15], s31 offen lds
    s_add_u32 m0, s30, 5120
    s_nop 0
    buffer_load_dwordx4 v24, s[12:15], s31 offen lds
    s_add_u32 m0, s30, 6144
    s_nop 0
    buffer_load_dwordx4 v25, s[12:15], s31 offen lds
    s_add_u32 m0, s30, 7168
    s_nop 0
    buffer_load_dwordx4 v26, s[12:15], s31 offen lds
    s_add_u32 m0, s30, 8192
    s_nop 0
    buffer_load_dwordx4 v27, s[12:15], s31 offen lds
    s_add_u32 m0, s30, 9216
    s_nop 0
    buffer_load_dwordx4 v28, s[12:15], s31 offen lds
    s_waitcnt vmcnt(10)
    ds_read_b64_tr_b16 a[248:249], v29 offset:10240
    ds_read_b64_tr_b16 a[250:251], v29 offset:15360
    ds_read_b64_tr_b16 v[120:121], v29 offset:10272
    ds_read_b64_tr_b16 v[122:123], v29 offset:15392
    ds_read_b64_tr_b16 v[136:137], v29 offset:10304
    ds_read_b64_tr_b16 v[138:139], v29 offset:15424
    ds_read_b64_tr_b16 v[152:153], v29 offset:10336
    ds_read_b64_tr_b16 v[154:155], v29 offset:15456
    ds_read_b64_tr_b16 v[168:169], v29 offset:10368
    ds_read_b64_tr_b16 v[170:171], v29 offset:15488
    ds_read_b64_tr_b16 v[184:185], v29 offset:10400
    ds_read_b64_tr_b16 v[186:187], v29 offset:15520
    ds_read_b64_tr_b16 v[200:201], v29 offset:10432
    ds_read_b64_tr_b16 v[202:203], v29 offset:15552
    ds_read_b64_tr_b16 v[216:217], v29 offset:10464
    ds_read_b64_tr_b16 v[218:219], v29 offset:15584
    ds_read_b64_tr_b16 v[232:233], v29 offset:10496
    ds_read_b64_tr_b16 v[234:235], v29 offset:15616
    ds_read_b64_tr_b16 v[248:249], v29 offset:10528
    ds_read_b64_tr_b16 v[250:251], v29 offset:15648
    s_waitcnt lgkmcnt(0)
    v_and_b32 v8, 7, v1
    v_lshlrev_b32 v8, 3, v8
    v_add_u32 v8, s63, v8
    global_load_dwordx2 v[10:11], v8, s[48:49] sc1
    s_add_u32 s31, s37, 163840
    s_add_u32 m0, s30, 10240
    s_nop 0
    buffer_load_dwordx4 v19, s[12:15], s31 offen lds
    s_add_u32 m0, s30, 11264
    s_nop 0
    buffer_load_dwordx4 v20, s[12:15], s31 offen lds
    s_add_u32 m0, s30, 12288
    s_nop 0
    buffer_load_dwordx4 v21, s[12:15], s31 offen lds
    s_add_u32 m0, s30, 13312
    s_nop 0
    buffer_load_dwordx4 v22, s[12:15], s31 offen lds
    s_add_u32 m0, s30, 14336
    s_nop 0
    buffer_load_dwordx4 v23, s[12:15], s31 offen lds
    s_add_u32 m0, s30, 15360
    s_nop 0
    buffer_load_dwordx4 v24, s[12:15], s31 offen lds
    s_add_u32 m0, s30, 16384
    s_nop 0
    buffer_load_dwordx4 v25, s[12:15], s31 offen lds
    s_add_u32 m0, s30, 17408
    s_nop 0
    buffer_load_dwordx4 v26, s[12:15], s31 offen lds
    s_add_u32 m0, s30, 18432
    s_nop 0
    buffer_load_dwordx4 v27, s[12:15], s31 offen lds
    s_add_u32 m0, s30, 19456
    s_nop 0
    buffer_load_dwordx4 v28, s[12:15], s31 offen lds
    s_waitcnt vmcnt(11)
    ds_read_b64_tr_b16 a[252:253], v29 offset:0
    ds_read_b64_tr_b16 a[254:255], v29 offset:5120
    ds_read_b64_tr_b16 v[124:125], v29 offset:32
    ds_read_b64_tr_b16 v[126:127], v29 offset:5152
    ds_read_b64_tr_b16 v[140:141], v29 offset:64
    ds_read_b64_tr_b16 v[142:143], v29 offset:5184
    ds_read_b64_tr_b16 v[156:157], v29 offset:96
    ds_read_b64_tr_b16 v[158:159], v29 offset:5216
    ds_read_b64_tr_b16 v[172:173], v29 offset:128
    ds_read_b64_tr_b16 v[174:175], v29 offset:5248
    ds_read_b64_tr_b16 v[188:189], v29 offset:160
    ds_read_b64_tr_b16 v[190:191], v29 offset:5280
    ds_read_b64_tr_b16 v[204:205], v29 offset:192
    ds_read_b64_tr_b16 v[206:207], v29 offset:5312
    ds_read_b64_tr_b16 v[220:221], v29 offset:224
    ds_read_b64_tr_b16 v[222:223], v29 offset:5344
    ds_read_b64_tr_b16 v[236:237], v29 offset:256
    ds_read_b64_tr_b16 v[238:239], v29 offset:5376
    ds_read_b64_tr_b16 v[252:253], v29 offset:288
    ds_read_b64_tr_b16 v[254:255], v29 offset:5408
    s_waitcnt lgkmcnt(0)
    s_add_u32 s31, s37, 204800
    s_add_u32 m0, s30, 0
    s_nop 0
    buffer_load_dwordx4 v19, s[12:15], s31 offen lds
    s_add_u32 m0, s30, 1024
    s_nop 0
    buffer_load_dwordx4 v20, s[12:15], s31 offen lds
    s_add_u32 m0, s30, 2048
    s_nop 0
    buffer_load_dwordx4 v21, s[12:15], s31 offen lds
    s_add_u32 m0, s30, 3072
    s_nop 0
    buffer_load_dwordx4 v22, s[12:15], s31 offen lds
    s_add_u32 m0, s30, 4096
    s_nop 0
    buffer_load_dwordx4 v23, s[12:15], s31 offen lds
    s_add_u32 m0, s30, 5120
    s_nop 0
    buffer_load_dwordx4 v24, s[12:15], s31 offen lds
    s_add_u32 m0, s30, 6144
    s_nop 0
    buffer_load_dwordx4 v25, s[12:15], s31 offen lds
    s_add_u32 m0, s30, 7168
    s_nop 0
    buffer_load_dwordx4 v26, s[12:15], s31 offen lds
    s_add_u32 m0, s30, 8192
    s_nop 0
    buffer_load_dwordx4 v27, s[12:15], s31 offen lds
    s_add_u32 m0, s30, 9216
    s_nop 0
    buffer_load_dwordx4 v28, s[12:15], s31 offen lds
    s_waitcnt vmcnt(10)
    ds_read_b64_tr_b16 v[32:33], v29 offset:10240
    ds_read_b64_tr_b16 v[34:35], v29 offset:15360
    ds_read_b64_tr_b16 v[40:41], v29 offset:10272
    ds_read_b64_tr_b16 v[42:43], v29 offset:15392
    ds_read_b64_tr_b16 v[48:49], v29 offset:10304
    ds_read_b64_tr_b16 v[50:51], v29 offset:15424
    ds_read_b64_tr_b16 v[56:57], v29 offset:10336
    ds_read_b64_tr_b16 v[58:59], v29 offset:15456
    ds_read_b64_tr_b16 v[64:65], v29 offset:10368
    ds_read_b64_tr_b16 v[66:67], v29 offset:15488
    ds_read_b64_tr_b16 v[72:73], v29 offset:10400
    ds_read_b64_tr_b16 v[74:75], v29 offset:15520
    ds_read_b64_tr_b16 v[80:81], v29 offset:10432
    ds_read_b64_tr_b16 v[82:83], v29 offset:15552
    ds_read_b64_tr_b16 v[88:89], v29 offset:10464
    ds_read_b64_tr_b16 v[90:91], v29 offset:15584
    ds_read_b64_tr_b16 v[96:97], v29 offset:10496
    ds_read_b64_tr_b16 v[98:99], v29 offset:15616
    ds_read_b64_tr_b16 v[104:105], v29 offset:10528
    ds_read_b64_tr_b16 v[106:107], v29 offset:15648
    v_not_b32 v10, v10
    v_xor_b32 v9, 0x2000, v11
    v_or_b32 v10, v10, v9
    v_cmp_ne_u32 vcc, 0, v10
    s_mov_b64 s[56:57], vcc
    v_lshlrev_b32 v8, 2, v1
    s_mov_b32 s34, 54525952
    buffer_load_dword v9, v8, s[4:7], s34 offen sc1
    s_min_u32 s52, s19, 63
    s_mul_i32 s52, s52, 40960
    s_mul_i32 s53, s16, 5120
    s_add_u32 s52, s52, s53
    s_add_u32 s52, s52, 251658240
    s_add_u32 s53, s53, 81920
    s_add_u32 m0, s53, 0
    s_add_u32 s54, s52, 0
    buffer_load_dwordx4 v2, s[4:7], s54 offen sc1 lds
    s_add_u32 m0, s53, 1024
    s_add_u32 s54, s52, 1024
    buffer_load_dwordx4 v2, s[4:7], s54 offen sc1 lds
    s_add_u32 m0, s53, 2048
    s_add_u32 s54, s52, 2048
    buffer_load_dwordx4 v2, s[4:7], s54 offen sc1 lds
    s_add_u32 m0, s53, 3072
    s_add_u32 s54, s52, 3072
    buffer_load_dwordx4 v2, s[4:7], s54 offen sc1 lds
    s_add_u32 m0, s53, 4096
    s_add_u32 s54, s52, 4096
    buffer_load_dwordx4 v2, s[4:7], s54 offen sc1 lds
    s_add_u32 m0, s53, 20480
    s_add_u32 s54, s52, 20480
    buffer_load_dwordx4 v2, s[4:7], s54 offen sc1 lds
    s_add_u32 m0, s53, 21504
    s_add_u32 s54, s52, 21504
    buffer_load_dwordx4 v2, s[4:7], s54 offen sc1 lds
    s_add_u32 m0, s53, 22528
    s_add_u32 s54, s52, 22528
    buffer_load_dwordx4 v2, s[4:7], s54 offen sc1 lds
    s_add_u32 m0, s53, 23552
    s_add_u32 s54, s52, 23552
    buffer_load_dwordx4 v2, s[4:7], s54 offen sc1 lds
    s_add_u32 m0, s53, 24576
    s_add_u32 s54, s52, 24576
    buffer_load_dwordx4 v2, s[4:7], s54 offen sc1 lds
    s_waitcnt vmcnt(11)
    ds_read_b64_tr_b16 v[36:37], v29 offset:0
    ds_read_b64_tr_b16 v[38:39], v29 offset:5120
    ds_read_b64_tr_b16 v[44:45], v29 offset:32
    ds_read_b64_tr_b16 v[46:47], v29 offset:5152
    ds_read_b64_tr_b16 v[52:53], v29 offset:64
    ds_read_b64_tr_b16 v[54:55], v29 offset:5184
    ds_read_b64_tr_b16 v[60:61], v29 offset:96
    ds_read_b64_tr_b16 v[62:63], v29 offset:5216
    ds_read_b64_tr_b16 v[68:69], v29 offset:128
    ds_read_b64_tr_b16 v[70:71], v29 offset:5248
    ds_read_b64_tr_b16 v[76:77], v29 offset:160
    ds_read_b64_tr_b16 v[78:79], v29 offset:5280
    ds_read_b64_tr_b16 v[84:85], v29 offset:192
    ds_read_b64_tr_b16 v[86:87], v29 offset:5312
    ds_read_b64_tr_b16 v[92:93], v29 offset:224
    ds_read_b64_tr_b16 v[94:95], v29 offset:5344
    ds_read_b64_tr_b16 v[100:101], v29 offset:256
    ds_read_b64_tr_b16 v[102:103], v29 offset:5376
    ds_read_b64_tr_b16 v[108:109], v29 offset:288
    ds_read_b64_tr_b16 v[110:111], v29 offset:5408
    s_waitcnt lgkmcnt(0)
    ds_write_b128 v30, v[32:35] offset:0
    ds_write_b128 v30, v[36:39] offset:1024
    ds_write_b128 v30, v[40:43] offset:2048
    ds_write_b128 v30, v[44:47] offset:3072
    ds_write_b128 v30, v[48:51] offset:4096
    ds_write_b128 v30, v[52:55] offset:5120
    ds_write_b128 v30, v[56:59] offset:6144
    ds_write_b128 v30, v[60:63] offset:7168
    ds_write_b128 v30, v[64:67] offset:8192
    ds_write_b128 v30, v[68:71] offset:9216
    ds_write_b128 v30, v[72:75] offset:10240
    ds_write_b128 v30, v[76:79] offset:11264
    ds_write_b128 v30, v[80:83] offset:12288
    ds_write_b128 v30, v[84:87] offset:13312
    ds_write_b128 v30, v[88:91] offset:14336
    ds_write_b128 v30, v[92:95] offset:15360
    ds_write_b128 v30, v[96:99] offset:16384
    ds_write_b128 v30, v[100:103] offset:17408
    ds_write_b128 v30, v[104:107] offset:18432
    ds_write_b128 v30, v[108:111] offset:19456
    s_cmp_eq_u64 s[56:57], 0
    s_cbranch_scc1 LD_ok_13
    v_and_b32 v4, 7, v1
    v_lshlrev_b32 v4, 3, v4
    v_add_u32 v4, s63, v4
    s_mov_b32 s35, 0
WI_15:
    global_load_dwordx2 v[6:7], v4, s[48:49] sc1
    s_waitcnt vmcnt(0)
    v_not_b32 v6, v6
    v_xor_b32 v5, 0x2000, v7
    v_or_b32 v6, v6, v5
    v_cmp_ne_u32 vcc, 0, v6
    s_cbranch_vccz WG_16
    v_lshrrev_b32 v7, 8, v7
    s_mov_b32 s30, 0
    v_readlane_b32 s31, v7, 0
    s_add_u32 s30, s30, s31
    v_readlane_b32 s31, v7, 1
    s_add_u32 s30, s30, s31
    v_readlane_b32 s31, v7, 2
    s_add_u32 s30, s30, s31
    v_readlane_b32 s31, v7, 3
    s_add_u32 s30, s30, s31
    v_readlane_b32 s31, v7, 4
    s_add_u32 s30, s30, s31
    v_readlane_b32 s31, v7, 5
    s_add_u32 s30, s30, s31
    v_readlane_b32 s31, v7, 6
    s_add_u32 s30, s30, s31
    v_readlane_b32 s31, v7, 7
    s_add_u32 s30, s30, s31
    s_cmp_ge_u32 s30, 256
    s_cbranch_scc1 M_again
    s_sleep 20
    s_add_u32 s35, s35, 1
    s_cmp_lt_u32 s35, 200000
    s_cbranch_scc1 WI_15
    s_branch M_fail
WG_16:
    v_lshlrev_b32 v4, 2, v1
    s_mov_b32 s34, 54525952
    buffer_load_dword v5, v4, s[4:7], s34 offen sc1
    s_waitcnt vmcnt(0)
    v_and_b32 v4, 2, v5
    v_cmp_eq_u32 vcc, 2, v4
    v_and_b32 v5, 1, v5
    v_cmp_eq_u32 s[20:21], 1, v5
    s_nop 3
    s_and_b32 s20, s20, 0x3ffffff
    s_xor_b32 s21, s20, 0x1555555
    s_bcnt1_i32_b32 s21, s21
    s_cmp_le_u32 s21, 5
    s_cselect_b32 s20, 0x1555555, s20
    s_cmp_ge_u32 s21, 21
    s_cselect_b32 s20, 0x2aaaaaa, s20
    s_and_b32 s21, vcc_lo, 0x1ff
    s_bcnt1_i32_b32 s21, s21
    s_cmp_ge_u32 s21, 5
    s_cselect_b32 s21, 16384, 0
    s_min_u32 s52, s19, 63
    s_mul_i32 s52, s52, 40960
    s_mul_i32 s53, s16, 5120
    s_add_u32 s52, s52, s53
    s_add_u32 s52, s52, 251658240
    s_add_u32 s53, s53, 81920
    s_add_u32 m0, s53, 0
    s_add_u32 s54, s52, 0
    buffer_load_dwordx4 v2, s[4:7], s54 offen sc1 lds
    s_add_u32 m0, s53, 1024
    s_add_u32 s54, s52, 1024
    buffer_load_dwordx4 v2, s[4:7], s54 offen sc1 lds
    s_add_u32 m0, s53, 2048
    s_add_u32 s54, s52, 2048
    buffer_load_dwordx4 v2, s[4:7], s54 offen sc1 lds
    s_add_u32 m0, s53, 3072
    s_add_u32 s54, s52, 3072
    buffer_load_dwordx4 v2, s[4:7], s54 offen sc1 lds
    s_add_u32 m0, s53, 4096
    s_add_u32 s54, s52, 4096
    buffer_load_dwordx4 v2, s[4:7], s54 offen sc1 lds
    s_add_u32 m0, s53, 20480
    s_add_u32 s54, s52, 20480
    buffer_load_dwordx4 v2, s[4:7], s54 offen sc1 lds
    s_add_u32 m0, s53, 21504
    s_add_u32 s54, s52, 21504
    buffer_load_dwordx4 v2, s[4:7], s54 offen sc1 lds
    s_add_u32 m0, s53, 22528
    s_add_u32 s54, s52, 22528
    buffer_load_dwordx4 v2, s[4:7], s54 offen sc1 lds
    s_add_u32 m0, s53, 23552
    s_add_u32 s54, s52, 23552
    buffer_load_dwordx4 v2, s[4:7], s54 offen sc1 lds
    s_add_u32 m0, s53, 24576
    s_add_u32 s54, s52, 24576
    buffer_load_dwordx4 v2, s[4:7], s54 offen sc1 lds
    s_branch LD_dn_14
LD_ok_13:
    s_waitcnt vmcnt(10)
    v_and_b32 v8, 2, v9
    v_cmp_eq_u32 vcc, 2, v8
    v_and_b32 v9, 1, v9
    v_cmp_eq_u32 s[20:21], 1, v9
    s_nop 3
    s_and_b32 s20, s20, 0x3ffffff
    s_xor_b32 s21, s20, 0x1555555
    s_bcnt1_i32_b32 s21, s21
    s_cmp_le_u32 s21, 5
    s_cselect_b32 s20, 0x1555555, s20
    s_cmp_ge_u32 s21, 21
    s_cselect_b32 s20, 0x2aaaaaa, s20
    s_and_b32 s21, vcc_lo, 0x1ff
    s_bcnt1_i32_b32 s21, s21
    s_cmp_ge_u32 s21, 5
    s_cselect_b32 s21, 16384, 0
LD_dn_14:
    s_waitcnt lgkmcnt(0)
    s_mul_i32 s30, s16, 20480
    v_add_u32 v5, s30, v2
    v_mov_b32 v7, 2
    v_add_u32 v4, 81920, v2
    v_add_u32 v9, 122880, v2
    v_and_b32 v8, 0xff, v2
    v_lshrrev_b32 v10, 5, v1
    v_lshlrev_b32 v10, 8, v10
    v_and_b32 v11, 16, v1
    v_lshrrev_b32 v11, 1, v11
    v_add3_u32 v8, v8, v10, v11
    s_mul_i32 s30, s16, 1536
    s_add_u32 s30, s30, 122880
    v_add_u32 v8, s30, v8
    s_mul_i32 s38, s16, 327680
    s_lshl_b32 s30, s17, 10
    s_add_u32 s38, s38, s30
    s_add_u32 s38, s38, 122683392
    s_lshl_b32 s47, s16, 7
    s_lshl_b32 s30, s17, 2
    s_add_u32 s47, s47, s30
    s_add_u32 s47, s47, 54591488
    s_mov_b32 s39, 0x7ffffff0
    s_mov_b32 s36, 0x7ffffff0
    s_waitcnt vmcnt(0)
    s_barrier
    ds_read_b128 v[80:83], v4 offset:0
    ds_read_b128 v[84:87], v4 offset:1024
    ds_read_b128 v[88:91], v4 offset:2048
XV_seg:
    s_waitcnt lgkmcnt(2)
    v_mfma_f32_16x16x32_bf16 v[40:43], a[0:3], v[80:83], 0
    ds_read_b128 v[92:95], v4 offset:3072
    v_mfma_f32_16x16x32_bf16 v[44:47], a[8:11], v[80:83], 0
    v_mfma_f32_16x16x32_bf16 v[48:51], a[16:19], v[80:83], 0
    s_waitcnt lgkmcnt(2)
    v_mfma_f32_16x16x32_bf16 v[40:43], a[4:7], v[84:87], v[40:43]
    ds_read_b128 v[80:83], v4 offset:4096
    v_mfma_f32_16x16x32_bf16 v[44:47], a[12:15], v[84:87], v[44:47]
    v_mfma_f32_16x16x32_bf16 v[48:51], a[20:23], v[84:87], v[48:51]
    s_waitcnt lgkmcnt(2)
    v_cvt_pk_bf16_f32 v72, v72, v73
    v_mfma_f32_16x16x32_bf16 v[40:43], a[24:27], v[88:91], v[40:43]
    ds_read_b128 v[84:87], v4 offset:5120
    v_cvt_pk_bf16_f32 v73, v74, v75
    v_mfma_f32_16x16x32_bf16 v[44:47], a[32:35], v[88:91], v[44:47]
    v_cvt_pk_bf16_f32 v74, v76, v77
    v_mfma_f32_16x16x32_bf16 v[48:51], a[40:43], v[88:91], v[48:51]
    s_waitcnt lgkmcnt(2)
    v_cvt_pk_bf16_f32 v75, v78, v79
    v_mfma_f32_16x16x32_bf16 v[40:43], a[28:31], v[92:95], v[40:43]
    ds_read_b128 v[88:91], v4 offset:6144
    buffer_store_dwordx4 v[72:75], v2, s[4:7], s36 offen sc1
    v_mfma_f32_16x16x32_bf16 v[44:47], a[36:39], v[92:95], v[44:47]
    v_mfma_f32_16x16x32_bf16 v[48:51], a[44:47], v[92:95], v[48:51]
    s_waitcnt lgkmcnt(2)
    v_mfma_f32_16x16x32_bf16 v[40:43], a[48:51], v[80:83], v[40:43]
    ds_read_b128 v[92:95], v4 offset:7168
    v_mfma_f32_16x16x32_bf16 v[44:47], a[56:59], v[80:83], v[44:47]
    s_sub_u32 s34, s19, 0
    v_mfma_f32_16x16x32_bf16 v[48:51], a[64:67], v[80:83], v[48:51]
    s_waitcnt lgkmcnt(2)
    s_cmp_lt_u32 s34, 43
    v_mfma_f32_16x16x32_bf16 v[40:43], a[52:55], v[84:87], v[40:43]
    ds_read_b128 v[80:83], v4 offset:8192
    v_mfma_f32_16x16x32_bf16 v[44:47], a[60:63], v[84:87], v[44:47]
    s_cselect_b32 s34, 2, 1
    v_mfma_f32_16x16x32_bf16 v[48:51], a[68:71], v[84:87], v[48:51]
    s_waitcnt lgkmcnt(2)
    s_add_u32 s34, s34, s19
    v_mfma_f32_16x16x32_bf16 v[40:43], a[72:75], v[88:91], v[40:43]
    ds_read_b128 v[84:87], v4 offset:9216
    v_mfma_f32_16x16x32_bf16 v[44:47], a[80:83], v[88:91], v[44:47]
    s_min_u32 s52, s34, 63
    v_mfma_f32_16x16x32_bf16 v[48:51], a[88:91], v[88:91], v[48:51]
    s_waitcnt lgkmcnt(2)
    s_mul_i32 s52, s52, 40960
    v_mfma_f32_16x16x32_bf16 v[40:43], a[76:79], v[92:95], v[40:43]
    ds_read_b128 v[88:91], v4 offset:10240
    v_mfma_f32_16x16x32_bf16 v[44:47], a[84:87], v[92:95], v[44:47]
    s_mul_i32 s53, s16, 5120
    v_mfma_f32_16x16x32_bf16 v[48:51], a[92:95], v[92:95], v[48:51]
    s_waitcnt lgkmcnt(2)
    s_add_u32 s52, s52, s53
    v_mfma_f32_16x16x32_bf16 v[40:43], a[96:99], v[80:83], v[40:43]
    ds_read_b128 v[92:95], v4 offset:11264
    v_mfma_f32_16x16x32_bf16 v[44:47], a[104:107], v[80:83], v[44:47]
    s_add_u32 s52, s52, 251658240
    v_mfma_f32_16x16x32_bf16 v[48:51], a[112:115], v[80:83], v[48:51]
    s_waitcnt lgkmcnt(2)
    s_add_u32 s53, s53, 81920
    v_mfma_f32_16x16x32_bf16 v[40:43], a[100:103], v[84:87], v[40:43]
    ds_read_b128 v[80:83], v4 offset:12288
    v_mfma_f32_16x16x32_bf16 v[44:47], a[108:111], v[84:87], v[44:47]
    v_mfma_f32_16x16x32_bf16 v[48:51], a[116:119], v[84:87], v[48:51]
    s_waitcnt lgkmcnt(2)
    v_mfma_f32_16x16x32_bf16 v[40:43], a[120:123], v[88:91], v[40:43]
    ds_read_b128 v[84:87], v4 offset:13312
    v_mfma_f32_16x16x32_bf16 v[44:47], a[128:131], v[88:91], v[44:47]
    v_mfma_f32_16x16x32_bf16 v[48:51], a[136:139], v[88:91], v[48:51]
    s_waitcnt lgkmcnt(2)
    v_mfma_f32_16x16x32_bf16 v[40:43], a[124:127], v[92:95], v[40:43]
    ds_read_b128 v[88:91], v4 offset:14336
    v_mfma_f32_16x16x32_bf16 v[44:47], a[132:135], v[92:95], v[44:47]
    v_mfma_f32_16x16x32_bf16 v[48:51], a[140:143], v[92:95], v[48:51]
    s_waitcnt lgkmcnt(2)
    v_mfma_f32_16x16x32_bf16 v[40:43], a[144:147], v[80:83], v[40:43]
    ds_read_b128 v[92:95], v4 offset:15360
    v_mfma_f32_16x16x32_bf16 v[44:47], a[152:155], v[80:83], v[44:47]
    v_mfma_f32_16x16x32_bf16 v[48:51], a[160:163], v[80:83], v[48:51]
    s_waitcnt lgkmcnt(2)
    v_mfma_f32_16x16x32_bf16 v[40:43], a[148:151], v[84:87], v[40:43]
    ds_read_b128 v[80:83], v4 offset:16384
    v_mfma_f32_16x16x32_bf16 v[44:47], a[156:159], v[84:87], v[44:47]
    v_mfma_f32_16x16x32_bf16 v[48:51], a[164:167], v[84:87], v[48:51]
    s_waitcnt lgkmcnt(2)
    v_mfma_f32_16x16x32_bf16 v[40:43], a[168:171], v[88:91], v[40:43]
    ds_read_b128 v[84:87], v4 offset:17408
    v_mfma_f32_16x16x32_bf16 v[44:47], a[176:179], v[88:91], v[44:47]
    v_mfma_f32_16x16x32_bf16 v[48:51], a[184:187], v[88:91], v[48:51]
    s_waitcnt lgkmcnt(2)
    v_mfma_f32_16x16x32_bf16 v[40:43], a[172:175], v[92:95], v[40:43]
    ds_read_b128 v[88:91], v4 offset:18432
    v_mfma_f32_16x16x32_bf16 v[44:47], a[180:183], v[92:95], v[44:47]
    s_waitcnt vmcnt(5)
    v_mfma_f32_16x16x32_bf16 v[48:51], a[188:191], v[92:95], v[48:51]
    s_waitcnt lgkmcnt(2)
    s_barrier
    v_mfma_f32_16x16x32_bf16 v[40:43], a[192:195], v[80:83], v[40:43]
    ds_read_b128 v[92:95], v4 offset:19456
    v_mfma_f32_16x16x32_bf16 v[44:47], a[200:203], v[80:83], v[44:47]
    v_mfma_f32_16x16x32_bf16 v[48:51], a[208:211], v[80:83], v[48:51]
    s_waitcnt lgkmcnt(2)
    v_mfma_f32_16x16x32_bf16 v[40:43], a[196:199], v[84:87], v[40:43]
    ds_read_b128 v[80:83], v4 offset:20480
    v_mfma_f32_16x16x32_bf16 v[44:47], a[204:207], v[84:87], v[44:47]
    v_mfma_f32_16x16x32_bf16 v[48:51], a[212:215], v[84:87], v[48:51]
    s_waitcnt lgkmcnt(2)
    v_mfma_f32_16x16x32_bf16 v[40:43], a[216:219], v[88:91], v[40:43]
    ds_read_b128 v[84:87], v4 offset:21504
    v_mfma_f32_16x16x32_bf16 v[44:47], a[224:227], v[88:91], v[44:47]
    v_mfma_f32_16x16x32_bf16 v[48:51], a[232:235], v[88:91], v[48:51]
    s_waitcnt lgkmcnt(2)
    v_mfma_f32_16x16x32_bf16 v[40:43], a[220:223], v[92:95], v[40:43]
    ds_read_b128 v[88:91], v4 offset:22528
    v_mfma_f32_16x16x32_bf16 v[44:47], a[228:231], v[92:95], v[44:47]
    v_mfma_f32_16x16x32_bf16 v[48:51], a[236:239], v[92:95], v[48:51]
    s_waitcnt lgkmcnt(2)
    v_mfma_f32_16x16x32_bf16 v[52:55], a[0:3], v[80:83], 0
    ds_read_b128 v[92:95], v4 offset:23552
    v_mfma_f32_16x16x32_bf16 v[56:59], a[8:11], v[80:83], 0
    v_mfma_f32_16x16x32_bf16 v[60:63], a[16:19], v[80:83], 0
    s_waitcnt lgkmcnt(2)
    v_mfma_f32_16x16x32_bf16 v[52:55], a[4:7], v[84:87], v[52:55]
    ds_read_b128 v[80:83], v4 offset:24576
    v_mfma_f32_16x16x32_bf16 v[56:59], a[12:15], v[84:87], v[56:59]
    v_mfma_f32_16x16x32_bf16 v[60:63], a[20:23], v[84:87], v[60:63]
    s_waitcnt lgkmcnt(2)
    v_cvt_pk_bf16_f32 v10, v40, v41
    v_mfma_f32_16x16x32_bf16 v[52:55], a[24:27], v[88:91], v[52:55]
    ds_read_b128 v[84:87], v4 offset:25600
    v_cvt_pk_bf16_f32 v11, v42, v43
    v_mfma_f32_16x16x32_bf16 v[56:59], a[32:35], v[88:91], v[56:59]
    ds_write_b64 v8, v[10:11] offset:0
    v_mfma_f32_16x16x32_bf16 v[60:63], a[40:43], v[88:91], v[60:63]
    s_waitcnt lgkmcnt(3)
    v_cvt_pk_bf16_f32 v12, v44, v45
    v_mfma_f32_16x16x32_bf16 v[52:55], a[28:31], v[92:95], v[52:55]
    ds_read_b128 v[88:91], v4 offset:26624
    v_cvt_pk_bf16_f32 v13, v46, v47
    v_mfma_f32_16x16x32_bf16 v[56:59], a[36:39], v[92:95], v[56:59]
    ds_write_b64 v8, v[12:13] offset:512
    v_mfma_f32_16x16x32_bf16 v[60:63], a[44:47], v[92:95], v[60:63]
    s_waitcnt lgkmcnt(4)
    v_cvt_pk_bf16_f32 v14, v48, v49
    v_mfma_f32_16x16x32_bf16 v[52:55], a[48:51], v[80:83], v[52:55]
    ds_read_b128 v[92:95], v4 offset:27648
    v_cvt_pk_bf16_f32 v15, v50, v51
    v_mfma_f32_16x16x32_bf16 v[56:59], a[56:59], v[80:83], v[56:59]
    ds_write_b64 v8, v[14:15] offset:1024
    v_mfma_f32_16x16x32_bf16 v[60:63], a[64:67], v[80:83], v[60:63]
    s_waitcnt lgkmcnt(5)
    v_mfma_f32_16x16x32_bf16 v[52:55], a[52:55], v[84:87], v[52:55]
    ds_read_b128 v[80:83], v4 offset:28672
    v_mfma_f32_16x16x32_bf16 v[56:59], a[60:63], v[84:87], v[56:59]
    s_waitcnt vmcnt(0)
    v_mfma_f32_16x16x32_bf16 v[60:63], a[68:71], v[84:87], v[60:63]
    s_waitcnt lgkmcnt(4)
    buffer_store_dword v7, off, s[4:7], s39 sc1
    v_mfma_f32_16x16x32_bf16 v[52:55], a[72:75], v[88:91], v[52:55]
    ds_read_b128 v[84:87], v4 offset:29696
    v_mfma_f32_16x16x32_bf16 v[56:59], a[80:83], v[88:91], v[56:59]
    v_mfma_f32_16x16x32_bf16 v[60:63], a[88:91], v[88:91], v[60:63]
    s_waitcnt lgkmcnt(3)
    v_mfma_f32_16x16x32_bf16 v[52:55], a[76:79], v[92:95], v[52:55]
    ds_read_b128 v[88:91], v4 offset:30720
    v_mfma_f32_16x16x32_bf16 v[56:59], a[84:87], v[92:95], v[56:59]
    s_waitcnt lgkmcnt(3)
    s_barrier
    v_mfma_f32_16x16x32_bf16 v[60:63], a[92:95], v[92:95], v[60:63]
    s_waitcnt lgkmcnt(2)
    v_mfma_f32_16x16x32_bf16 v[52:55], a[96:99], v[80:83], v[52:55]
    ds_read_b128 v[92:95], v4 offset:31744
    v_mfma_f32_16x16x32_bf16 v[56:59], a[104:107], v[80:83], v[56:59]
    ds_read_b128 v[16:19], v9 offset:0
    v_mfma_f32_16x16x32_bf16 v[60:63], a[112:115], v[80:83], v[60:63]
    s_waitcnt lgkmcnt(3)
    s_add_u32 m0, s53, 0
    s_add_u32 s54, s52, 0
    v_mfma_f32_16x16x32_bf16 v[52:55], a[100:103], v[84:87], v[52:55]
    ds_read_b128 v[80:83], v4 offset:32768
    v_mfma_f32_16x16x32_bf16 v[56:59], a[108:111], v[84:87], v[56:59]
    ds_read_b128 v[20:23], v9 offset:1024
    v_mfma_f32_16x16x32_bf16 v[60:63], a[116:119], v[84:87], v[60:63]
    s_waitcnt lgkmcnt(4)
    buffer_load_dwordx4 v2, s[4:7], s54 offen sc1 lds
    v_mfma_f32_16x16x32_bf16 v[52:55], a[120:123], v[88:91], v[52:55]
    ds_read_b128 v[84:87], v4 offset:33792
    v_mfma_f32_16x16x32_bf16 v[56:59], a[128:131], v[88:91], v[56:59]
    ds_read_b128 v[24:27], v9 offset:2048
    v_mfma_f32_16x16x32_bf16 v[60:63], a[136:139], v[88:91], v[60:63]
    s_waitcnt lgkmcnt(5)
    s_add_u32 m0, s53, 1024
    s_add_u32 s54, s52, 1024
    v_mfma_f32_16x16x32_bf16 v[52:55], a[124:127], v[92:95], v[52:55]
    ds_read_b128 v[88:91], v4 offset:34816
    v_mfma_f32_16x16x32_bf16 v[56:59], a[132:135], v[92:95], v[56:59]
    ds_read_b128 v[28:31], v9 offset:3072
    v_mfma_f32_16x16x32_bf16 v[60:63], a[140:143], v[92:95], v[60:63]
    s_waitcnt lgkmcnt(5)
    buffer_load_dwordx4 v2, s[4:7], s54 offen sc1 lds
    v_mfma_f32_16x16x32_bf16 v[52:55], a[144:147], v[80:83], v[52:55]
    ds_read_b128 v[92:95], v4 offset:35840
    v_mfma_f32_16x16x32_bf16 v[56:59], a[152:155], v[80:83], v[56:59]
    ds_read_b128 v[32:35], v9 offset:4096
    v_mfma_f32_16x16x32_bf16 v[60:63], a[160:163], v[80:83], v[60:63]
    s_waitcnt lgkmcnt(5)
    s_add_u32 m0, s53, 2048
    s_add_u32 s54, s52, 2048
    v_mfma_f32_16x16x32_bf16 v[52:55], a[148:151], v[84:87], v[52:55]
    ds_read_b128 v[80:83], v4 offset:36864
    v_mfma_f32_16x16x32_bf16 v[56:59], a[156:159], v[84:87], v[56:59]
    ds_read_b128 v[36:39], v9 offset:5120
    v_mfma_f32_16x16x32_bf16 v[60:63], a[164:167], v[84:87], v[60:63]
    s_waitcnt lgkmcnt(5)
    buffer_load_dwordx4 v2, s[4:7], s54 offen sc1 lds
    v_mfma_f32_16x16x32_bf16 v[52:55], a[168:171], v[88:91], v[52:55]
    ds_read_b128 v[84:87], v4 offset:37888
    v_mfma_f32_16x16x32_bf16 v[56:59], a[176:179], v[88:91], v[56:59]
    v_mfma_f32_16x16x32_bf16 v[60:63], a[184:187], v[88:91], v[60:63]
    s_waitcnt lgkmcnt(4)
    s_add_u32 m0, s53, 3072
    s_add_u32 s54, s52, 3072
    v_mfma_f32_16x16x32_bf16 v[52:55], a[172:175], v[92:95], v[52:55]
    ds_read_b128 v[88:91], v4 offset:38912
    v_mfma_f32_16x16x32_bf16 v[56:59], a[180:183], v[92:95], v[56:59]
    v_mfma_f32_16x16x32_bf16 v[60:63], a[188:191], v[92:95], v[60:63]
    s_waitcnt lgkmcnt(3)
    buffer_load_dwordx4 v2, s[4:7], s54 offen sc1 lds
    v_mfma_f32_16x16x32_bf16 v[52:55], a[192:195], v[80:83], v[52:55]
    ds_read_b128 v[92:95], v4 offset:39936
    v_mfma_f32_16x16x32_bf16 v[56:59], a[200:203], v[80:83], v[56:59]
    v_mfma_f32_16x16x32_bf16 v[60:63], a[208:211], v[80:83], v[60:63]
    s_waitcnt lgkmcnt(2)
    s_add_u32 m0, s53, 4096
    s_add_u32 s54, s52, 4096
    v_mfma_f32_16x16x32_bf16 v[52:55], a[196:199], v[84:87], v[52:55]
    ds_read_b128 v[96:99], v5 offset:0
    v_mfma_f32_16x16x32_bf16 v[56:59], a[204:207], v[84:87], v[56:59]
    ds_read_b128 v[100:103], v5 offset:1024
    v_mfma_f32_16x16x32_bf16 v[60:63], a[212:215], v[84:87], v[60:63]
    s_waitcnt lgkmcnt(3)
    buffer_load_dwordx4 v2, s[4:7], s54 offen sc1 lds
    ds_read_b128 v[104:107], v5 offset:2048
    v_mfma_f32_16x16x32_bf16 v[52:55], a[216:219], v[88:91], v[52:55]
    ds_read_b128 v[108:111], v5 offset:3072
    v_mfma_f32_16x16x32_bf16 v[56:59], a[224:227], v[88:91], v[56:59]
    s_mul_i32 s36, s19, 1310720
    v_mfma_f32_16x16x32_bf16 v[60:63], a[232:235], v[88:91], v[60:63]
    s_waitcnt lgkmcnt(4)
    s_add_u32 s36, s36, s38
    v_mfma_f32_16x16x32_bf16 v[52:55], a[220:223], v[92:95], v[52:55]
    s_lshl_b32 s39, s19, 9
    v_mfma_f32_16x16x32_bf16 v[56:59], a[228:231], v[92:95], v[56:59]
    s_add_u32 s39, s39, s47
    v_mfma_f32_16x16x32_bf16 v[60:63], a[236:239], v[92:95], v[60:63]
    v_mfma_f32_16x16x32_bf16 v[64:67], v[16:19], a[240:243], 0
    v_mfma_f32_16x16x32_bf16 v[64:67], v[20:23], a[244:247], v[64:67]
    v_mfma_f32_16x16x32_bf16 v[64:67], v[24:27], a[248:251], v[64:67]
    v_mfma_f32_16x16x32_bf16 v[64:67], v[28:31], a[252:255], v[64:67]
    s_waitcnt lgkmcnt(2)
    v_cvt_pk_bf16_f32 v10, v52, v53
    v_cvt_pk_bf16_f32 v11, v54, v55
    v_mfma_f32_16x16x32_bf16 v[64:67], v[32:35], v[96:99], v[64:67]
    ds_write_b64 v8, v[10:11] offset:6144
    v_mfma_f32_16x16x32_bf16 v[64:67], v[36:39], v[100:103], v[64:67]
    ds_read_b128 v[96:99], v5 offset:4096
    v_cvt_pk_bf16_f32 v12, v56, v57
    v_cvt_pk_bf16_f32 v13, v58, v59
    v_mfma_f32_16x16x32_bf16 v[72:75], v[16:19], v[112:115], 0
    ds_read_b128 v[100:103], v5 offset:5120
    ds_write_b64 v8, v[12:13] offset:6656
    v_mfma_f32_16x16x32_bf16 v[72:75], v[20:23], v[116:119], v[72:75]
    v_cvt_pk_bf16_f32 v14, v60, v61
    v_cvt_pk_bf16_f32 v15, v62, v63
    v_mfma_f32_16x16x32_bf16 v[72:75], v[24:27], v[120:123], v[72:75]
    ds_write_b64 v8, v[14:15] offset:7168
    v_mfma_f32_16x16x32_bf16 v[72:75], v[28:31], v[124:127], v[72:75]
    s_waitcnt lgkmcnt(5)
    v_mfma_f32_16x16x32_bf16 v[72:75], v[32:35], v[104:107], v[72:75]
    v_mfma_f32_16x16x32_bf16 v[72:75], v[36:39], v[108:111], v[72:75]
    ds_read_b128 v[104:107], v5 offset:6144
    v_mfma_f32_16x16x32_bf16 v[80:83], v[16:19], v[128:131], 0
    ds_read_b128 v[108:111], v5 offset:7168
    v_mfma_f32_16x16x32_bf16 v[80:83], v[20:23], v[132:135], v[80:83]
    v_mfma_f32_16x16x32_bf16 v[80:83], v[24:27], v[136:139], v[80:83]
    s_waitcnt lgkmcnt(2)
    s_barrier
    ds_read_b128 v[40:43], v9 offset:6144
    v_mfma_f32_16x16x32_bf16 v[80:83], v[28:31], v[140:143], v[80:83]
    ds_read_b128 v[44:47], v9 offset:7168
    v_mfma_f32_16x16x32_bf16 v[80:83], v[32:35], v[96:99], v[80:83]
    ds_read_b128 v[48:51], v9 offset:8192
    v_mfma_f32_16x16x32_bf16 v[80:83], v[36:39], v[100:103], v[80:83]
    ds_read_b128 v[96:99], v5 offset:0
    v_mfma_f32_16x16x32_bf16 v[88:91], v[16:19], v[144:147], 0
    ds_read_b128 v[100:103], v5 offset:1024
    v_mfma_f32_16x16x32_bf16 v[88:91], v[20:23], v[148:151], v[88:91]
    ds_read_b128 v[52:55], v9 offset:9216
    v_mfma_f32_16x16x32_bf16 v[88:91], v[24:27], v[152:155], v[88:91]
    ds_read_b128 v[56:59], v9 offset:10240
    v_mfma_f32_16x16x32_bf16 v[88:91], v[28:31], v[156:159], v[88:91]
    s_waitcnt lgkmcnt(7)
    ds_read_b128 v[60:63], v9 offset:11264
    v_mfma_f32_16x16x32_bf16 v[88:91], v[32:35], v[104:107], v[88:91]
    v_mfma_f32_16x16x32_bf16 v[88:91], v[36:39], v[108:111], v[88:91]
    s_waitcnt lgkmcnt(7)
    ds_read_b128 v[104:107], v5 offset:2048
    v_mfma_f32_16x16x32_bf16 v[68:71], v[40:43], a[240:243], 0
    s_waitcnt lgkmcnt(7)
    ds_read_b128 v[108:111], v5 offset:3072
    v_mfma_f32_16x16x32_bf16 v[68:71], v[44:47], a[244:247], v[68:71]
    s_waitcnt lgkmcnt(7)
    s_add_u32 m0, s53, 20480
    s_add_u32 s54, s52, 20480
    v_mfma_f32_16x16x32_bf16 v[68:71], v[48:51], a[248:251], v[68:71]
    s_waitcnt lgkmcnt(4)
    buffer_load_dwordx4 v2, s[4:7], s54 offen sc1 lds
    v_mfma_f32_16x16x32_bf16 v[68:71], v[52:55], a[252:255], v[68:71]
    s_waitcnt lgkmcnt(3)
    v_mfma_f32_16x16x32_bf16 v[68:71], v[56:59], v[96:99], v[68:71]
    s_waitcnt lgkmcnt(2)
    v_mfma_f32_16x16x32_bf16 v[68:71], v[60:63], v[100:103], v[68:71]
    ds_read_b128 v[96:99], v5 offset:4096
    v_mfma_f32_16x16x32_bf16 v[76:79], v[40:43], v[112:115], 0
    ds_read_b128 v[100:103], v5 offset:5120
    v_mfma_f32_16x16x32_bf16 v[76:79], v[44:47], v[116:119], v[76:79]
    s_add_u32 m0, s53, 21504
    s_add_u32 s54, s52, 21504
    v_mfma_f32_16x16x32_bf16 v[76:79], v[48:51], v[120:123], v[76:79]
    buffer_load_dwordx4 v2, s[4:7], s54 offen sc1 lds
    v_mfma_f32_16x16x32_bf16 v[76:79], v[52:55], v[124:127], v[76:79]
    s_waitcnt lgkmcnt(2)
    v_mfma_f32_16x16x32_bf16 v[76:79], v[56:59], v[104:107], v[76:79]
    v_cvt_pk_bf16_f32 v64, v64, v65
    v_mfma_f32_16x16x32_bf16 v[76:79], v[60:63], v[108:111], v[76:79]
    ds_read_b128 v[104:107], v5 offset:6144
    v_cvt_pk_bf16_f32 v65, v66, v67
    v_mfma_f32_16x16x32_bf16 v[84:87], v[40:43], v[128:131], 0
    ds_read_b128 v[108:111], v5 offset:7168
    v_cvt_pk_bf16_f32 v66, v68, v69
    v_mfma_f32_16x16x32_bf16 v[84:87], v[44:47], v[132:135], v[84:87]
    v_cvt_pk_bf16_f32 v67, v70, v71
    v_mfma_f32_16x16x32_bf16 v[84:87], v[48:51], v[136:139], v[84:87]
    buffer_store_dwordx4 v[64:67], v2, s[4:7], s36 offen sc1
    v_mfma_f32_16x16x32_bf16 v[84:87], v[52:55], v[140:143], v[84:87]
    s_waitcnt lgkmcnt(2)
    s_add_u32 s36, s36, 32768
    v_mfma_f32_16x16x32_bf16 v[84:87], v[56:59], v[96:99], v[84:87]
    v_cvt_pk_bf16_f32 v72, v72, v73
    v_mfma_f32_16x16x32_bf16 v[84:87], v[60:63], v[100:103], v[84:87]
    ds_read_b128 v[96:99], v5 offset:8192
    v_cvt_pk_bf16_f32 v73, v74, v75
    v_mfma_f32_16x16x32_bf16 v[92:95], v[40:43], v[144:147], 0
    ds_read_b128 v[100:103], v5 offset:9216
    v_cvt_pk_bf16_f32 v74, v76, v77
    v_mfma_f32_16x16x32_bf16 v[92:95], v[44:47], v[148:151], v[92:95]
    v_cvt_pk_bf16_f32 v75, v78, v79
    v_mfma_f32_16x16x32_bf16 v[92:95], v[48:51], v[152:155], v[92:95]
    buffer_store_dwordx4 v[72:75], v2, s[4:7], s36 offen sc1
    v_mfma_f32_16x16x32_bf16 v[92:95], v[52:55], v[156:159], v[92:95]
    s_waitcnt lgkmcnt(2)
    s_add_u32 s36, s36, 32768
    v_mfma_f32_16x16x32_bf16 v[92:95], v[56:59], v[104:107], v[92:95]
    v_cvt_pk_bf16_f32 v80, v80, v81
    v_mfma_f32_16x16x32_bf16 v[92:95], v[60:63], v[108:111], v[92:95]
    ds_read_b128 v[104:107], v5 offset:10240
    v_cvt_pk_bf16_f32 v81, v82, v83
    v_mfma_f32_16x16x32_bf16 v[64:67], v[16:19], v[160:163], 0
    ds_read_b128 v[108:111], v5 offset:11264
    v_cvt_pk_bf16_f32 v82, v84, v85
    v_mfma_f32_16x16x32_bf16 v[68:71], v[40:43], v[160:163], 0
    v_cvt_pk_bf16_f32 v83, v86, v87
    v_mfma_f32_16x16x32_bf16 v[64:67], v[20:23], v[164:167], v[64:67]
    buffer_store_dwordx4 v[80:83], v2, s[4:7], s36 offen sc1
    v_mfma_f32_16x16x32_bf16 v[68:71], v[44:47], v[164:167], v[68:71]
    s_add_u32 s36, s36, 32768
    v_mfma_f32_16x16x32_bf16 v[64:67], v[24:27], v[168:171], v[64:67]
    s_add_u32 m0, s53, 22528
    s_add_u32 s54, s52, 22528
    v_cvt_pk_bf16_f32 v88, v88, v89
    v_mfma_f32_16x16x32_bf16 v[68:71], v[48:51], v[168:171], v[68:71]
    buffer_load_dwordx4 v2, s[4:7], s54 offen sc1 lds
    v_cvt_pk_bf16_f32 v89, v90, v91
    v_mfma_f32_16x16x32_bf16 v[64:67], v[28:31], v[172:175], v[64:67]
    v_cvt_pk_bf16_f32 v90, v92, v93
    v_mfma_f32_16x16x32_bf16 v[68:71], v[52:55], v[172:175], v[68:71]
    s_waitcnt lgkmcnt(2)
    v_cvt_pk_bf16_f32 v91, v94, v95
    v_mfma_f32_16x16x32_bf16 v[64:67], v[32:35], v[96:99], v[64:67]
    buffer_store_dwordx4 v[88:91], v2, s[4:7], s36 offen sc1
    v_mfma_f32_16x16x32_bf16 v[68:71], v[56:59], v[96:99], v[68:71]
    s_add_u32 s36, s36, 32768
    v_mfma_f32_16x16x32_bf16 v[64:67], v[36:39], v[100:103], v[64:67]
    v_mfma_f32_16x16x32_bf16 v[68:71], v[60:63], v[100:103], v[68:71]
    ds_read_b128 v[96:99], v5 offset:12288
    v_mfma_f32_16x16x32_bf16 v[72:75], v[16:19], v[176:179], 0
    ds_read_b128 v[100:103], v5 offset:13312
    v_mfma_f32_16x16x32_bf16 v[76:79], v[40:43], v[176:179], 0
    s_add_u32 m0, s53, 23552
    s_add_u32 s54, s52, 23552
    v_mfma_f32_16x16x32_bf16 v[72:75], v[20:23], v[180:183], v[72:75]
    buffer_load_dwordx4 v2, s[4:7], s54 offen sc1 lds
    v_mfma_f32_16x16x32_bf16 v[76:79], v[44:47], v[180:183], v[76:79]
    v_mfma_f32_16x16x32_bf16 v[72:75], v[24:27], v[184:187], v[72:75]
    v_cvt_pk_bf16_f32 v64, v64, v65
    v_mfma_f32_16x16x32_bf16 v[76:79], v[48:51], v[184:187], v[76:79]
    v_cvt_pk_bf16_f32 v65, v66, v67
    v_mfma_f32_16x16x32_bf16 v[72:75], v[28:31], v[188:191], v[72:75]
    v_cvt_pk_bf16_f32 v66, v68, v69
    v_mfma_f32_16x16x32_bf16 v[76:79], v[52:55], v[188:191], v[76:79]
    s_waitcnt lgkmcnt(2)
    v_cvt_pk_bf16_f32 v67, v70, v71
    v_mfma_f32_16x16x32_bf16 v[72:75], v[32:35], v[104:107], v[72:75]
    buffer_store_dwordx4 v[64:67], v2, s[4:7], s36 offen sc1
    v_mfma_f32_16x16x32_bf16 v[76:79], v[56:59], v[104:107], v[76:79]
    s_add_u32 s36, s36, 32768
    v_mfma_f32_16x16x32_bf16 v[72:75], v[36:39], v[108:111], v[72:75]
    v_mfma_f32_16x16x32_bf16 v[76:79], v[60:63], v[108:111], v[76:79]
    ds_read_b128 v[104:107], v5 offset:14336
    v_mfma_f32_16x16x32_bf16 v[80:83], v[16:19], v[192:195], 0
    ds_read_b128 v[108:111], v5 offset:15360
    v_mfma_f32_16x16x32_bf16 v[84:87], v[40:43], v[192:195], 0
    s_add_u32 m0, s53, 24576
    s_add_u32 s54, s52, 24576
    v_mfma_f32_16x16x32_bf16 v[80:83], v[20:23], v[196:199], v[80:83]
    buffer_load_dwordx4 v2, s[4:7], s54 offen sc1 lds
    v_mfma_f32_16x16x32_bf16 v[84:87], v[44:47], v[196:199], v[84:87]
    v_mfma_f32_16x16x32_bf16 v[80:83], v[24:27], v[200:203], v[80:83]
    v_cvt_pk_bf16_f32 v72, v72, v73
    v_mfma_f32_16x16x32_bf16 v[84:87], v[48:51], v[200:203], v[84:87]
    v_cvt_pk_bf16_f32 v73, v74, v75
    v_mfma_f32_16x16x32_bf16 v[80:83], v[28:31], v[204:207], v[80:83]
    v_cvt_pk_bf16_f32 v74, v76, v77
    v_mfma_f32_16x16x32_bf16 v[84:87], v[52:55], v[204:207], v[84:87]
    s_waitcnt lgkmcnt(2)
    v_cvt_pk_bf16_f32 v75, v78, v79
    v_mfma_f32_16x16x32_bf16 v[80:83], v[32:35], v[96:99], v[80:83]
    buffer_store_dwordx4 v[72:75], v2, s[4:7], s36 offen sc1
    v_mfma_f32_16x16x32_bf16 v[84:87], v[56:59], v[96:99], v[84:87]
    s_add_u32 s36, s36, 32768
    v_mfma_f32_16x16x32_bf16 v[80:83], v[36:39], v[100:103], v[80:83]
    v_mfma_f32_16x16x32_bf16 v[84:87], v[60:63], v[100:103], v[84:87]
    ds_read_b128 v[96:99], v5 offset:16384
    v_mfma_f32_16x16x32_bf16 v[88:91], v[16:19], v[208:211], 0
    ds_read_b128 v[100:103], v5 offset:17408
    v_mfma_f32_16x16x32_bf16 v[92:95], v[40:43], v[208:211], 0
    v_mfma_f32_16x16x32_bf16 v[88:91], v[20:23], v[212:215], v[88:91]
    v_mfma_f32_16x16x32_bf16 v[92:95], v[44:47], v[212:215], v[92:95]
    v_mfma_f32_16x16x32_bf16 v[88:91], v[24:27], v[216:219], v[88:91]
    v_cvt_pk_bf16_f32 v80, v80, v81
    v_mfma_f32_16x16x32_bf16 v[92:95], v[48:51], v[216:219], v[92:95]
    v_cvt_pk_bf16_f32 v81, v82, v83
    v_mfma_f32_16x16x32_bf16 v[88:91], v[28:31], v[220:223], v[88:91]
    v_cvt_pk_bf16_f32 v82, v84, v85
    v_mfma_f32_16x16x32_bf16 v[92:95], v[52:55], v[220:223], v[92:95]
    s_waitcnt lgkmcnt(2)
    v_cvt_pk_bf16_f32 v83, v86, v87
    v_mfma_f32_16x16x32_bf16 v[88:91], v[32:35], v[104:107], v[88:91]
    buffer_store_dwordx4 v[80:83], v2, s[4:7], s36 offen sc1
    v_mfma_f32_16x16x32_bf16 v[92:95], v[56:59], v[104:107], v[92:95]
    s_add_u32 s36, s36, 32768
    v_mfma_f32_16x16x32_bf16 v[88:91], v[36:39], v[108:111], v[88:91]
    v_mfma_f32_16x16x32_bf16 v[92:95], v[60:63], v[108:111], v[92:95]
    ds_read_b128 v[104:107], v5 offset:18432
    v_mfma_f32_16x16x32_bf16 v[64:67], v[16:19], v[224:227], 0
    ds_read_b128 v[108:111], v5 offset:19456
    v_mfma_f32_16x16x32_bf16 v[68:71], v[40:43], v[224:227], 0
    v_mfma_f32_16x16x32_bf16 v[64:67], v[20:23], v[228:231], v[64:67]
    v_mfma_f32_16x16x32_bf16 v[68:71], v[44:47], v[228:231], v[68:71]
    v_mfma_f32_16x16x32_bf16 v[64:67], v[24:27], v[232:235], v[64:67]
    v_cvt_pk_bf16_f32 v88, v88, v89
    v_mfma_f32_16x16x32_bf16 v[68:71], v[48:51], v[232:235], v[68:71]
    v_cvt_pk_bf16_f32 v89, v90, v91
    v_mfma_f32_16x16x32_bf16 v[64:67], v[28:31], v[236:239], v[64:67]
    v_cvt_pk_bf16_f32 v90, v92, v93
    v_mfma_f32_16x16x32_bf16 v[68:71], v[52:55], v[236:239], v[68:71]
    s_waitcnt lgkmcnt(2)
    v_cvt_pk_bf16_f32 v91, v94, v95
    v_mfma_f32_16x16x32_bf16 v[64:67], v[32:35], v[96:99], v[64:67]
    buffer_store_dwordx4 v[88:91], v2, s[4:7], s36 offen sc1
    v_mfma_f32_16x16x32_bf16 v[68:71], v[56:59], v[96:99], v[68:71]
    s_add_u32 s36, s36, 32768
    v_mfma_f32_16x16x32_bf16 v[64:67], v[36:39], v[100:103], v[64:67]
    v_mfma_f32_16x16x32_bf16 v[68:71], v[60:63], v[100:103], v[68:71]
    v_mfma_f32_16x16x32_bf16 v[72:75], v[16:19], v[240:243], 0
    s_waitcnt vmcnt(13)
    v_mfma_f32_16x16x32_bf16 v[76:79], v[40:43], v[240:243], 0
    s_barrier
    v_mfma_f32_16x16x32_bf16 v[72:75], v[20:23], v[244:247], v[72:75]
    v_mfma_f32_16x16x32_bf16 v[76:79], v[44:47], v[244:247], v[76:79]
    ds_read_b128 v[80:83], v4 offset:0
    v_mfma_f32_16x16x32_bf16 v[72:75], v[24:27], v[248:251], v[72:75]
    ds_read_b128 v[84:87], v4 offset:1024
    v_cvt_pk_bf16_f32 v64, v64, v65
    v_mfma_f32_16x16x32_bf16 v[76:79], v[48:51], v[248:251], v[76:79]
    ds_read_b128 v[88:91], v4 offset:2048
    v_cvt_pk_bf16_f32 v65, v66, v67
    v_mfma_f32_16x16x32_bf16 v[72:75], v[28:31], v[252:255], v[72:75]
    v_cvt_pk_bf16_f32 v66, v68, v69
    v_mfma_f32_16x16x32_bf16 v[76:79], v[52:55], v[252:255], v[76:79]
    s_waitcnt lgkmcnt(3)
    v_cvt_pk_bf16_f32 v67, v70, v71
    v_mfma_f32_16x16x32_bf16 v[72:75], v[32:35], v[104:107], v[72:75]
    buffer_store_dwordx4 v[64:67], v2, s[4:7], s36 offen sc1
    v_mfma_f32_16x16x32_bf16 v[76:79], v[56:59], v[104:107], v[76:79]
    s_add_u32 s36, s36, 32768
    v_mfma_f32_16x16x32_bf16 v[72:75], v[36:39], v[108:111], v[72:75]
    s_cmp_lt_u32 s19, 2
    s_cselect_b32 s30, 0, s55
    v_mfma_f32_16x16x32_bf16 v[76:79], v[60:63], v[108:111], v[76:79]
    s_mov_b32 s19, s34
    s_cmp_lt_u32 s19, s30
    s_cbranch_scc1 XV_seg
    s_nop 1
    v_cvt_pk_bf16_f32 v72, v72, v73
    v_cvt_pk_bf16_f32 v73, v74, v75
    s_nop 0
    v_cvt_pk_bf16_f32 v74, v76, v77
    v_cvt_pk_bf16_f32 v75, v78, v79
    buffer_store_dwordx4 v[72:75], v2, s[4:7], s36 offen sc1
    v_mov_b32 v7, 2
    s_waitcnt vmcnt(0)
    s_mov_b64 exec, 1
    buffer_store_dword v7, v2, s[4:7], s39 offen sc1
    s_mov_b64 exec, -1
    s_mov_b32 s36, 0x7ffffff0
    s_mov_b32 s39, 0x7ffffff0
    s_cmp_lt_u32 s19, s55
    s_cbranch_scc1 XV_seg
    s_branch M_second
I_start:
    v_lshlrev_b32 v3, 4, v0
    v_mov_b32 v16, -1
    v_mov_b32 v80, 0
    v_mov_b32 v17, -1
    v_mov_b32 v81, 0
    v_mov_b32 v18, -1
    v_mov_b32 v82, 0
    v_mov_b32 v19, -1
    v_mov_b32 v83, 0
    s_mov_b32 s8, s64
    s_and_b32 s9, s65, 0xffff
    s_mov_b32 s10, 2621440
    s_mov_b32 s11, 0x20000
    s_mov_b32 s12, s66
    s_and_b32 s13, s67, 0xffff
    s_mov_b32 s14, 10240
    s_mov_b32 s15, 0x20000
    s_lshl_b32 s62, s60, 7
    s_add_u32 s62, s62, 236978176
    s_sub_u32 s61, s60, 64
    s_lshl_b32 s61, s61, 1
    s_add_u32 s61, s61, s16
    s_cmp_ge_u32 s60, 64
    s_cbranch_scc1 I_ln1
    s_mov_b32 s59, s60
    s_cmp_lg_u32 s16, 1
    s_cbranch_scc1 I_ln
    s_cmp_ge_u32 s60, 26
    s_cbranch_scc1 I_ln
    s_lshl_b32 s24, s59, 21
    s_add_u32 s24, s24, 2070528
    s_add_u32 s25, s24, 8192
    s_add_u32 s26, s24, 16384
    s_add_u32 s27, s24, 24576
    s_mov_b64 exec, 0xff
    s_mov_b64 s[30:31], -1
    s_mov_b64 s[32:33], -1
    s_mov_b32 s34, 0
I_probe:
    s_memtime s[72:73]
    s_waitcnt lgkmcnt(0)
    buffer_store_dwordx4 v[16:19], v2, s[4:7], s24 offen sc1
    s_waitcnt vmcnt(0)
    s_memtime s[74:75]
    s_waitcnt lgkmcnt(0)
    s_sub_u32 s74, s74, s72
    s_min_u32 s30, s30, s74
    s_memtime s[72:73]
    s_waitcnt lgkmcnt(0)
    buffer_store_dwordx4 v[16:19], v2, s[4:7], s25 offen sc1
    s_waitcnt vmcnt(0)
    s_memtime s[74:75]
    s_waitcnt lgkmcnt(0)
    s_sub_u32 s74, s74, s72
    s_min_u32 s31, s31, s74
    s_memtime s[72:73]
    s_waitcnt lgkmcnt(0)
    buffer_store_dwordx4 v[16:19], v2, s[4:7], s26 offen sc1
    s_waitcnt vmcnt(0)
    s_memtime s[74:75]
    s_waitcnt lgkmcnt(0)
    s_sub_u32 s74, s74, s72
    s_min_u32 s32, s32, s74
    s_memtime s[72:73]
    s_waitcnt lgkmcnt(0)
    buffer_store_dwordx4 v[16:19], v2, s[4:7], s27 offen sc1
    s_waitcnt vmcnt(0)
    s_memtime s[74:75]
    s_waitcnt lgkmcnt(0)
    s_sub_u32 s74, s74, s72
    s_min_u32 s33, s33, s74
    s_add_u32 s34, s34, 1
    s_cmp_lt_u32 s34, 3
    s_cbranch_scc1 I_probe
    s_min_u32 s30, s30, s32
    s_cselect_b32 s35, 0, 2
    s_min_u32 s31, s31, s33
    s_cselect_b32 s36, 1, 3
    s_cmp_lt_u32 s30, s31
    s_cselect_b32 s34, s35, s36
    v_mov_b32 v20, s34
    s_lshl_b32 s30, s59, 2
    s_add_u32 s30, s30, 54525952
    s_mov_b64 exec, 1
    buffer_store_dword v20, v2, s[4:7], s30 offen sc1
    s_mov_b64 exec, -1
I_ln:
    s_waitcnt vmcnt(0)
    s_barrier
    s_branch I_pf
I_ln1:
    s_cmp_ge_u32 s16, 2
    s_cbranch_scc1 I_lnd
    v_and_b32 v4, 15, v1
    s_lshl_b32 s30, s61, 4
    v_add_u32 v5, s30, v4
    v_mul_u32_u24 v5, 1280, v5
    v_and_b32 v6, 48, v1
    v_add_u32 v5, v5, v6
    buffer_load_dwordx4 v[176:179], v5, s[8:11], 0 offen offset:0
    buffer_load_dwordx4 v[180:183], v5, s[8:11], 0 offen offset:64
    buffer_load_dwordx4 v[184:187], v5, s[8:11], 0 offen offset:128
    buffer_load_dwordx4 v[188:191], v5, s[8:11], 0 offen offset:192
    buffer_load_dwordx4 v[192:195], v5, s[8:11], 0 offen offset:256
    buffer_load_dwordx4 v[196:199], v5, s[8:11], 0 offen offset:320
    buffer_load_dwordx4 v[200:203], v5, s[8:11], 0 offen offset:384
    buffer_load_dwordx4 v[204:207], v5, s[8:11], 0 offen offset:448
    buffer_load_dwordx4 v[208:211], v5, s[8:11], 0 offen offset:512
    buffer_load_dwordx4 v[212:215], v5, s[8:11], 0 offen offset:576
    buffer_load_dwordx4 v[216:219], v5, s[8:11], 0 offen offset:640
    buffer_load_dwordx4 v[220:223], v5, s[8:11], 0 offen offset:704
    buffer_load_dwordx4 v[224:227], v5, s[8:11], 0 offen offset:768
    buffer_load_dwordx4 v[228:231], v5, s[8:11], 0 offen offset:832
    buffer_load_dwordx4 v[232:235], v5, s[8:11], 0 offen offset:896
    buffer_load_dwordx4 v[236:239], v5, s[8:11], 0 offen offset:960
    buffer_load_dwordx4 v[240:243], v5, s[8:11], 0 offen offset:1024
    buffer_load_dwordx4 v[244:247], v5, s[8:11], 0 offen offset:1088
    buffer_load_dwordx4 v[248:251], v5, s[8:11], 0 offen offset:1152
    buffer_load_dwordx4 v[252:255], v5, s[8:11], 0 offen offset:1216
    s_mul_i32 s30, s61, 5120
    s_add_u32 s30, s30, 8388608
    buffer_store_dwordx4 v[16:19], v2, s[4:7], s30 offen sc1
    s_add_u32 s30, s30, 1024
    buffer_store_dwordx4 v[16:19], v2, s[4:7], s30 offen sc1
    s_add_u32 s30, s30, 1024
    buffer_store_dwordx4 v[16:19], v2, s[4:7], s30 offen sc1
    s_add_u32 s30, s30, 1024
    buffer_store_dwordx4 v[16:19], v2, s[4:7], s30 offen sc1
    s_add_u32 s30, s30, 1024
    buffer_store_dwordx4 v[16:19], v2, s[4:7], s30 offen sc1
    s_add_u32 s30, s30, 1024
    s_lshl_b32 s30, s61, 11
    buffer_store_dwordx4 v[16:19], v2, s[4:7], s30 offen sc1
    buffer_store_dwordx4 v[16:19], v2, s[4:7], s30 offen offset:1024 sc1
    s_lshl_b32 s31, s61, 10
    s_add_u32 s30, s31, 67371008
    buffer_store_dwordx4 v[16:19], v2, s[4:7], s30 offen sc1
    s_add_u32 s30, s31, 67502080
    buffer_store_dwordx4 v[16:19], v2, s[4:7], s30 offen sc1
    s_add_u32 s30, s31, 67633152
    buffer_store_dwordx4 v[16:19], v2, s[4:7], s30 offen sc1
    s_add_u32 s30, s31, 67764224
    buffer_store_dwordx4 v[16:19], v2, s[4:7], s30 offen sc1
    s_add_u32 s30, s31, 67895296
    buffer_store_dwordx4 v[16:19], v2, s[4:7], s30 offen sc1
    s_add_u32 s30, s31, 68026368
    buffer_store_dwordx4 v[16:19], v2, s[4:7], s30 offen sc1
    s_add_u32 s30, s31, 215678976
    buffer_store_dwordx4 v[16:19], v2, s[4:7], s30 offen sc1
    s_add_u32 s30, s31, 215810048
    buffer_store_dwordx4 v[16:19], v2, s[4:7], s30 offen sc1
    s_add_u32 s30, s31, 215941120
    s_cmp_lt_u32 s61, 64
    s_cselect_b32 s30, s30, 0x7ffffff0
    buffer_store_dwordx4 v[16:19], v2, s[4:7], s30 offen sc1
    s_add_u32 s30, s31, 219512832
    buffer_store_dwordx4 v[16:19], v2, s[4:7], s30 offen sc1
    s_add_u32 s30, s31, 219643904
    s_cmp_lt_u32 s61, 32
    s_cselect_b32 s30, s30, 0x7ffffff0
    buffer_store_dwordx4 v[16:19], v2, s[4:7], s30 offen sc1
    s_add_u32 s30, s31, 229244928
    buffer_store_dwordx4 v[16:19], v2, s[4:7], s30 offen sc1
    s_add_u32 s30, s31, 229376000
    buffer_store_dwordx4 v[16:19], v2, s[4:7], s30 offen sc1
    s_add_u32 s30, s31, 229507072
    buffer_store_dwordx4 v[16:19], v2, s[4:7], s30 offen sc1
    v_lshlrev_b32 v14, 7, v1
    s_mul_i32 s31, s61, 171
    s_lshr_b32 s31, s31, 10
    s_mul_i32 s30, s31, 6
    s_sub_u32 s30, s61, s30
    s_lshl_b32 s30, s30, 14
    s_lshl_b32 s31, s31, 21
    s_add_u32 s30, s30, s31
    s_add_u32 s30, s30, 10354688
    buffer_store_dword v80, v14, s[4:7], s30 offen sc1
    s_add_u32 s30, s30, 8192
    buffer_store_dword v80, v14, s[4:7], s30 offen sc1
    s_mul_i32 s30, s61, 736
    s_add_u32 s30, s30, 54530048
    s_mov_b32 exec_hi, 0x3fff
    buffer_store_dwordx4 v[80:83], v2, s[4:7], s30 offen sc1
    s_lshl_b32 s30, s61, 8
    s_add_u32 s30, s30, 622592
    s_mov_b64 exec, 3
    buffer_store_dword v80, v14, s[4:7], s30 offen sc1
    s_lshr_b32 s30, s61, 1
    s_lshl_b32 s30, s30, 7
    s_add_u32 s30, s30, 236978176
    s_mov_b64 exec, 1
    buffer_store_dword v80, v14, s[4:7], s30 offen sc1
    s_mov_b64 exec, -1
    s_sub_u32 s30, s61, 64
    s_cmp_ge_u32 s30, 10
    s_cbranch_scc1 I_nomem
    v_and_b32 v4, 12, v1
    v_lshrrev_b32 v4, 1, v4
    v_and_b32 v5, 1, v1
    v_add_u32 v4, v4, v5
    v_mul_u32_u24 v4, 1280, v4
    v_and_b32 v5, 48, v1
    v_lshlrev_b32 v5, 1, v5
    v_add_u32 v4, v4, v5
    v_and_b32 v5, 2, v1
    v_lshlrev_b32 v5, 1, v5
    v_add_u32 v4, v4, v5
    s_lshl_b32 s31, s30, 7
    buffer_load_dword v84, v4, s[12:15], s31 offen offset:0
    buffer_load_dword v85, v4, s[12:15], s31 offen offset:8
    buffer_load_dword v86, v4, s[12:15], s31 offen offset:16
    buffer_load_dword v87, v4, s[12:15], s31 offen offset:24
    s_lshr_b32 s31, s30, 3
    s_lshl_b32 s31, s31, 15
    s_and_b32 s30, s30, 7
    s_lshl_b32 s30, s30, 10
    s_add_u32 s30, s30, s31
    s_add_u32 s30, s30, 54738944
    s_waitcnt vmcnt(0)
    v_min_u32 v84, -2, v84
    v_min_u32 v85, -2, v85
    v_min_u32 v86, -2, v86
    v_min_u32 v87, -2, v87
    buffer_store_dwordx4 v[84:87], v2, s[4:7], s30 offen sc1
I_nomem:
    s_waitcnt vmcnt(26)
    v_lshlrev_b32 v16, 16, v176
    v_and_b32 v17, 0xffff0000, v176
    v_lshlrev_b32 v18, 16, v177
    v_and_b32 v19, 0xffff0000, v177
    v_lshlrev_b32 v20, 16, v178
    v_and_b32 v21, 0xffff0000, v178
    v_lshlrev_b32 v22, 16, v179
    v_and_b32 v23, 0xffff0000, v179
    v_lshlrev_b32 v24, 16, v180
    v_and_b32 v25, 0xffff0000, v180
    v_lshlrev_b32 v26, 16, v181
    v_and_b32 v27, 0xffff0000, v181
    v_lshlrev_b32 v28, 16, v182
    v_and_b32 v29, 0xffff0000, v182
    v_lshlrev_b32 v30, 16, v183
    v_and_b32 v31, 0xffff0000, v183
    v_lshlrev_b32 v32, 16, v184
    v_and_b32 v33, 0xffff0000, v184
    v_lshlrev_b32 v34, 16, v185
    v_and_b32 v35, 0xffff0000, v185
    v_lshlrev_b32 v36, 16, v186
    v_and_b32 v37, 0xffff0000, v186
    v_lshlrev_b32 v38, 16, v187
    v_and_b32 v39, 0xffff0000, v187
    v_lshlrev_b32 v40, 16, v188
    v_and_b32 v41, 0xffff0000, v188
    v_lshlrev_b32 v42, 16, v189
    v_and_b32 v43, 0xffff0000, v189
    v_lshlrev_b32 v44, 16, v190
    v_and_b32 v45, 0xffff0000, v190
    v_lshlrev_b32 v46, 16, v191
    v_and_b32 v47, 0xffff0000, v191
    v_lshlrev_b32 v48, 16, v192
    v_and_b32 v49, 0xffff0000, v192
    v_lshlrev_b32 v50, 16, v193
    v_and_b32 v51, 0xffff0000, v193
    v_lshlrev_b32 v52, 16, v194
    v_and_b32 v53, 0xffff0000, v194
    v_lshlrev_b32 v54, 16, v195
    v_and_b32 v55, 0xffff0000, v195
    v_lshlrev_b32 v56, 16, v196
    v_and_b32 v57, 0xffff0000, v196
    v_lshlrev_b32 v58, 16, v197
    v_and_b32 v59, 0xffff0000, v197
    v_lshlrev_b32 v60, 16, v198
    v_and_b32 v61, 0xffff0000, v198
    v_lshlrev_b32 v62, 16, v199
    v_and_b32 v63, 0xffff0000, v199
    v_lshlrev_b32 v64, 16, v200
    v_and_b32 v65, 0xffff0000, v200
    v_lshlrev_b32 v66, 16, v201
    v_and_b32 v67, 0xffff0000, v201
    v_lshlrev_b32 v68, 16, v202
    v_and_b32 v69, 0xffff0000, v202
    v_lshlrev_b32 v70, 16, v203
    v_and_b32 v71, 0xffff0000, v203
    v_lshlrev_b32 v72, 16, v204
    v_and_b32 v73, 0xffff0000, v204
    v_lshlrev_b32 v74, 16, v205
    v_and_b32 v75, 0xffff0000, v205
    v_lshlrev_b32 v76, 16, v206
    v_and_b32 v77, 0xffff0000, v206
    v_lshlrev_b32 v78, 16, v207
    v_and_b32 v79, 0xffff0000, v207
    v_lshlrev_b32 v80, 16, v208
    v_and_b32 v81, 0xffff0000, v208
    v_lshlrev_b32 v82, 16, v209
    v_and_b32 v83, 0xffff0000, v209
    v_lshlrev_b32 v84, 16, v210
    v_and_b32 v85, 0xffff0000, v210
    v_lshlrev_b32 v86, 16, v211
    v_and_b32 v87, 0xffff0000, v211
    v_lshlrev_b32 v88, 16, v212
    v_and_b32 v89, 0xffff0000, v212
    v_lshlrev_b32 v90, 16, v213
    v_and_b32 v91, 0xffff0000, v213
    v_lshlrev_b32 v92, 16, v214
    v_and_b32 v93, 0xffff0000, v214
    v_lshlrev_b32 v94, 16, v215
    v_and_b32 v95, 0xffff0000, v215
    v_lshlrev_b32 v96, 16, v216
    v_and_b32 v97, 0xffff0000, v216
    v_lshlrev_b32 v98, 16, v217
    v_and_b32 v99, 0xffff0000, v217
    v_lshlrev_b32 v100, 16, v218
    v_and_b32 v101, 0xffff0000, v218
    v_lshlrev_b32 v102, 16, v219
    v_and_b32 v103, 0xffff0000, v219
    v_lshlrev_b32 v104, 16, v220
    v_and_b32 v105, 0xffff0000, v220
    v_lshlrev_b32 v106, 16, v221
    v_and_b32 v107, 0xffff0000, v221
    v_lshlrev_b32 v108, 16, v222
    v_and_b32 v109, 0xffff0000, v222
    v_lshlrev_b32 v110, 16, v223
    v_and_b32 v111, 0xffff0000, v223
    v_lshlrev_b32 v112, 16, v224
    v_and_b32 v113, 0xffff0000, v224
    v_lshlrev_b32 v114, 16, v225
    v_and_b32 v115, 0xffff0000, v225
    v_lshlrev_b32 v116, 16, v226
    v_and_b32 v117, 0xffff0000, v226
    v_lshlrev_b32 v118, 16, v227
    v_and_b32 v119, 0xffff0000, v227
    v_lshlrev_b32 v120, 16, v228
    v_and_b32 v121, 0xffff0000, v228
    v_lshlrev_b32 v122, 16, v229
    v_and_b32 v123, 0xffff0000, v229
    v_lshlrev_b32 v124, 16, v230
    v_and_b32 v125, 0xffff0000, v230
    v_lshlrev_b32 v126, 16, v231
    v_and_b32 v127, 0xffff0000, v231
    v_lshlrev_b32 v128, 16, v232
    v_and_b32 v129, 0xffff0000, v232
    v_lshlrev_b32 v130, 16, v233
    v_and_b32 v131, 0xffff0000, v233
    v_lshlrev_b32 v132, 16, v234
    v_and_b32 v133, 0xffff0000, v234
    v_lshlrev_b32 v134, 16, v235
    v_and_b32 v135, 0xffff0000, v235
    v_lshlrev_b32 v136, 16, v236
    v_and_b32 v137, 0xffff0000, v236
    v_lshlrev_b32 v138, 16, v237
    v_and_b32 v139, 0xffff0000, v237
    v_lshlrev_b32 v140, 16, v238
    v_and_b32 v141, 0xffff0000, v238
    v_lshlrev_b32 v142, 16, v239
    v_and_b32 v143, 0xffff0000, v239
    v_lshlrev_b32 v144, 16, v240
    v_and_b32 v145, 0xffff0000, v240
    v_lshlrev_b32 v146, 16, v241
    v_and_b32 v147, 0xffff0000, v241
    v_lshlrev_b32 v148, 16, v242
    v_and_b32 v149, 0xffff0000, v242
    v_lshlrev_b32 v150, 16, v243
    v_and_b32 v151, 0xffff0000, v243
    v_lshlrev_b32 v152, 16, v244
    v_and_b32 v153, 0xffff0000, v244
    v_lshlrev_b32 v154, 16, v245
    v_and_b32 v155, 0xffff0000, v245
    v_lshlrev_b32 v156, 16, v246
    v_and_b32 v157, 0xffff0000, v246
    v_lshlrev_b32 v158, 16, v247
    v_and_b32 v159, 0xffff0000, v247
    v_lshlrev_b32 v160, 16, v248
    v_and_b32 v161, 0xffff0000, v248
    v_lshlrev_b32 v162, 16, v249
    v_and_b32 v163, 0xffff0000, v249
    v_lshlrev_b32 v164, 16, v250
    v_and_b32 v165, 0xffff0000, v250
    v_lshlrev_b32 v166, 16, v251
    v_and_b32 v167, 0xffff0000, v251
    v_lshlrev_b32 v168, 16, v252
    v_and_b32 v169, 0xffff0000, v252
    v_lshlrev_b32 v170, 16, v253
    v_and_b32 v171, 0xffff0000, v253
    v_lshlrev_b32 v172, 16, v254
    v_and_b32 v173, 0xffff0000, v254
    v_lshlrev_b32 v174, 16, v255
    v_and_b32 v175, 0xffff0000, v255
    v_add_f32 v8, v16, v17
    v_add_f32 v9, v18, v19
    v_add_f32 v8, v8, v20
    v_add_f32 v9, v9, v21
    v_add_f32 v8, v8, v22
    v_add_f32 v9, v9, v23
    v_add_f32 v8, v8, v24
    v_add_f32 v9, v9, v25
    v_add_f32 v8, v8, v26
    v_add_f32 v9, v9, v27
    v_add_f32 v8, v8, v28
    v_add_f32 v9, v9, v29
    v_add_f32 v8, v8, v30
    v_add_f32 v9, v9, v31
    v_add_f32 v8, v8, v32
    v_add_f32 v9, v9, v33
    v_add_f32 v8, v8, v34
    v_add_f32 v9, v9, v35
    v_add_f32 v8, v8, v36
    v_add_f32 v9, v9, v37
    v_add_f32 v8, v8, v38
    v_add_f32 v9, v9, v39
    v_add_f32 v8, v8, v40
    v_add_f32 v9, v9, v41
    v_add_f32 v8, v8, v42
    v_add_f32 v9, v9, v43
    v_add_f32 v8, v8, v44
    v_add_f32 v9, v9, v45
    v_add_f32 v8, v8, v46
    v_add_f32 v9, v9, v47
    v_add_f32 v8, v8, v48
    v_add_f32 v9, v9, v49
    v_add_f32 v8, v8, v50
    v_add_f32 v9, v9, v51
    v_add_f32 v8, v8, v52
    v_add_f32 v9, v9, v53
    v_add_f32 v8, v8, v54
    v_add_f32 v9, v9, v55
    v_add_f32 v8, v8, v56
    v_add_f32 v9, v9, v57
    v_add_f32 v8, v8, v58
    v_add_f32 v9, v9, v59
    v_add_f32 v8, v8, v60
    v_add_f32 v9, v9, v61
    v_add_f32 v8, v8, v62
    v_add_f32 v9, v9, v63
    v_add_f32 v8, v8, v64
    v_add_f32 v9, v9, v65
    v_add_f32 v8, v8, v66
    v_add_f32 v9, v9, v67
    v_add_f32 v8, v8, v68
    v_add_f32 v9, v9, v69
    v_add_f32 v8, v8, v70
    v_add_f32 v9, v9, v71
    v_add_f32 v8, v8, v72
    v_add_f32 v9, v9, v73
    v_add_f32 v8, v8, v74
    v_add_f32 v9, v9, v75
    v_add_f32 v8, v8, v76
    v_add_f32 v9, v9, v77
    v_add_f32 v8, v8, v78
    v_add_f32 v9, v9, v79
    v_add_f32 v8, v8, v80
    v_add_f32 v9, v9, v81
    v_add_f32 v8, v8, v82
    v_add_f32 v9, v9, v83
    v_add_f32 v8, v8, v84
    v_add_f32 v9, v9, v85
    v_add_f32 v8, v8, v86
    v_add_f32 v9, v9, v87
    v_add_f32 v8, v8, v88
    v_add_f32 v9, v9, v89
    v_add_f32 v8, v8, v90
    v_add_f32 v9, v9, v91
    v_add_f32 v8, v8, v92
    v_add_f32 v9, v9, v93
    v_add_f32 v8, v8, v94
    v_add_f32 v9, v9, v95
    v_add_f32 v8, v8, v96
    v_add_f32 v9, v9, v97
    v_add_f32 v8, v8, v98
    v_add_f32 v9, v9, v99
    v_add_f32 v8, v8, v100
    v_add_f32 v9, v9, v101
    v_add_f32 v8, v8, v102
    v_add_f32 v9, v9, v103
    v_add_f32 v8, v8, v104
    v_add_f32 v9, v9, v105
    v_add_f32 v8, v8, v106
    v_add_f32 v9, v9, v107
    v_add_f32 v8, v8, v108
    v_add_f32 v9, v9, v109
    v_add_f32 v8, v8, v110
    v_add_f32 v9, v9, v111
    v_add_f32 v8, v8, v112
    v_add_f32 v9, v9, v113
    v_add_f32 v8, v8, v114
    v_add_f32 v9, v9, v115
    v_add_f32 v8, v8, v116
    v_add_f32 v9, v9, v117
    v_add_f32 v8, v8, v118
    v_add_f32 v9, v9, v119
    v_add_f32 v8, v8, v120
    v_add_f32 v9, v9, v121
    v_add_f32 v8, v8, v122
    v_add_f32 v9, v9, v123
    v_add_f32 v8, v8, v124
    v_add_f32 v9, v9, v125
    v_add_f32 v8, v8, v126
    v_add_f32 v9, v9, v127
    v_add_f32 v8, v8, v128
    v_add_f32 v9, v9, v129
    v_add_f32 v8, v8, v130
    v_add_f32 v9, v9, v131
    v_add_f32 v8, v8, v132
    v_add_f32 v9, v9, v133
    v_add_f32 v8, v8, v134
    v_add_f32 v9, v9, v135
    v_add_f32 v8, v8, v136
    v_add_f32 v9, v9, v137
    v_add_f32 v8, v8, v138
    v_add_f32 v9, v9, v139
    v_add_f32 v8, v8, v140
    v_add_f32 v9, v9, v141
    v_add_f32 v8, v8, v142
    v_add_f32 v9, v9, v143
    v_add_f32 v8, v8, v144
    v_add_f32 v9, v9, v145
    v_add_f32 v8, v8, v146
    v_add_f32 v9, v9, v147
    v_add_f32 v8, v8, v148
    v_add_f32 v9, v9, v149
    v_add_f32 v8, v8, v150
    v_add_f32 v9, v9, v151
    v_add_f32 v8, v8, v152
    v_add_f32 v9, v9, v153
    v_add_f32 v8, v8, v154
    v_add_f32 v9, v9, v155
    v_add_f32 v8, v8, v156
    v_add_f32 v9, v9, v157
    v_add_f32 v8, v8, v158
    v_add_f32 v9, v9, v159
    v_add_f32 v8, v8, v160
    v_add_f32 v9, v9, v161
    v_add_f32 v8, v8, v162
    v_add_f32 v9, v9, v163
    v_add_f32 v8, v8, v164
    v_add_f32 v9, v9, v165
    v_add_f32 v8, v8, v166
    v_add_f32 v9, v9, v167
    v_add_f32 v8, v8, v168
    v_add_f32 v9, v9, v169
    v_add_f32 v8, v8, v170
    v_add_f32 v9, v9, v171
    v_add_f32 v8, v8, v172
    v_add_f32 v9, v9, v173
    v_add_f32 v8, v8, v174
    v_add_f32 v9, v9, v175
    v_add_f32 v8, v8, v9
    v_mov_b32 v9, v8
    s_nop 1
    v_permlane16_swap_b32 v8, v9
    v_add_f32 v8, v8, v9
    v_mov_b32 v9, v8
    s_nop 1
    v_permlane32_swap_b32 v8, v9
    v_add_f32 v8, v8, v9
    v_mul_f32 v8, 0x3acccccd, v8
    v_mov_b32 v14, 0
    v_mov_b32 v15, 0
    v_sub_f32 v10, v16, v8
    v_sub_f32 v11, v17, v8
    v_fmac_f32 v14, v10, v10
    v_fmac_f32 v15, v11, v11
    v_sub_f32 v10, v18, v8
    v_sub_f32 v11, v19, v8
    v_fmac_f32 v14, v10, v10
    v_fmac_f32 v15, v11, v11
    v_sub_f32 v10, v20, v8
    v_sub_f32 v11, v21, v8
    v_fmac_f32 v14, v10, v10
    v_fmac_f32 v15, v11, v11
    v_sub_f32 v10, v22, v8
    v_sub_f32 v11, v23, v8
    v_fmac_f32 v14, v10, v10
    v_fmac_f32 v15, v11, v11
    v_sub_f32 v10, v24, v8
    v_sub_f32 v11, v25, v8
    v_fmac_f32 v14, v10, v10
    v_fmac_f32 v15, v11, v11
    v_sub_f32 v10, v26, v8
    v_sub_f32 v11, v27, v8
    v_fmac_f32 v14, v10, v10
    v_fmac_f32 v15, v11, v11
    v_sub_f32 v10, v28, v8
    v_sub_f32 v11, v29, v8
    v_fmac_f32 v14, v10, v10
    v_fmac_f32 v15, v11, v11
    v_sub_f32 v10, v30, v8
    v_sub_f32 v11, v31, v8
    v_fmac_f32 v14, v10, v10
    v_fmac_f32 v15, v11, v11
    v_sub_f32 v10, v32, v8
    v_sub_f32 v11, v33, v8
    v_fmac_f32 v14, v10, v10
    v_fmac_f32 v15, v11, v11
    v_sub_f32 v10, v34, v8
    v_sub_f32 v11, v35, v8
    v_fmac_f32 v14, v10, v10
    v_fmac_f32 v15, v11, v11
    v_sub_f32 v10, v36, v8
    v_sub_f32 v11, v37, v8
    v_fmac_f32 v14, v10, v10
    v_fmac_f32 v15, v11, v11
    v_sub_f32 v10, v38, v8
    v_sub_f32 v11, v39, v8
    v_fmac_f32 v14, v10, v10
    v_fmac_f32 v15, v11, v11
    v_sub_f32 v10, v40, v8
    v_sub_f32 v11, v41, v8
    v_fmac_f32 v14, v10, v10
    v_fmac_f32 v15, v11, v11
    v_sub_f32 v10, v42, v8
    v_sub_f32 v11, v43, v8
    v_fmac_f32 v14, v10, v10
    v_fmac_f32 v15, v11, v11
    v_sub_f32 v10, v44, v8
    v_sub_f32 v11, v45, v8
    v_fmac_f32 v14, v10, v10
    v_fmac_f32 v15, v11, v11
    v_sub_f32 v10, v46, v8
    v_sub_f32 v11, v47, v8
    v_fmac_f32 v14, v10, v10
    v_fmac_f32 v15, v11, v11
    v_sub_f32 v10, v48, v8
    v_sub_f32 v11, v49, v8
    v_fmac_f32 v14, v10, v10
    v_fmac_f32 v15, v11, v11
    v_sub_f32 v10, v50, v8
    v_sub_f32 v11, v51, v8
    v_fmac_f32 v14, v10, v10
    v_fmac_f32 v15, v11, v11
    v_sub_f32 v10, v52, v8
    v_sub_f32 v11, v53, v8
    v_fmac_f32 v14, v10, v10
    v_fmac_f32 v15, v11, v11
    v_sub_f32 v10, v54, v8
    v_sub_f32 v11, v55, v8
    v_fmac_f32 v14, v10, v10
    v_fmac_f32 v15, v11, v11
    v_sub_f32 v10, v56, v8
    v_sub_f32 v11, v57, v8
    v_fmac_f32 v14, v10, v10
    v_fmac_f32 v15, v11, v11
    v_sub_f32 v10, v58, v8
    v_sub_f32 v11, v59, v8
    v_fmac_f32 v14, v10, v10
    v_fmac_f32 v15, v11, v11
    v_sub_f32 v10, v60, v8
    v_sub_f32 v11, v61, v8
    v_fmac_f32 v14, v10, v10
    v_fmac_f32 v15, v11, v11
    v_sub_f32 v10, v62, v8
    v_sub_f32 v11, v63, v8
    v_fmac_f32 v14, v10, v10
    v_fmac_f32 v15, v11, v11
    v_sub_f32 v10, v64, v8
    v_sub_f32 v11, v65, v8
    v_fmac_f32 v14, v10, v10
    v_fmac_f32 v15, v11, v11
    v_sub_f32 v10, v66, v8
    v_sub_f32 v11, v67, v8
    v_fmac_f32 v14, v10, v10
    v_fmac_f32 v15, v11, v11
    v_sub_f32 v10, v68, v8
    v_sub_f32 v11, v69, v8
    v_fmac_f32 v14, v10, v10
    v_fmac_f32 v15, v11, v11
    v_sub_f32 v10, v70, v8
    v_sub_f32 v11, v71, v8
    v_fmac_f32 v14, v10, v10
    v_fmac_f32 v15, v11, v11
    v_sub_f32 v10, v72, v8
    v_sub_f32 v11, v73, v8
    v_fmac_f32 v14, v10, v10
    v_fmac_f32 v15, v11, v11
    v_sub_f32 v10, v74, v8
    v_sub_f32 v11, v75, v8
    v_fmac_f32 v14, v10, v10
    v_fmac_f32 v15, v11, v11
    v_sub_f32 v10, v76, v8
    v_sub_f32 v11, v77, v8
    v_fmac_f32 v14, v10, v10
    v_fmac_f32 v15, v11, v11
    v_sub_f32 v10, v78, v8
    v_sub_f32 v11, v79, v8
    v_fmac_f32 v14, v10, v10
    v_fmac_f32 v15, v11, v11
    v_sub_f32 v10, v80, v8
    v_sub_f32 v11, v81, v8
    v_fmac_f32 v14, v10, v10
    v_fmac_f32 v15, v11, v11
    v_sub_f32 v10, v82, v8
    v_sub_f32 v11, v83, v8
    v_fmac_f32 v14, v10, v10
    v_fmac_f32 v15, v11, v11
    v_sub_f32 v10, v84, v8
    v_sub_f32 v11, v85, v8
    v_fmac_f32 v14, v10, v10
    v_fmac_f32 v15, v11, v11
    v_sub_f32 v10, v86, v8
    v_sub_f32 v11, v87, v8
    v_fmac_f32 v14, v10, v10
    v_fmac_f32 v15, v11, v11
    v_sub_f32 v10, v88, v8
    v_sub_f32 v11, v89, v8
    v_fmac_f32 v14, v10, v10
    v_fmac_f32 v15, v11, v11
    v_sub_f32 v10, v90, v8
    v_sub_f32 v11, v91, v8
    v_fmac_f32 v14, v10, v10
    v_fmac_f32 v15, v11, v11
    v_sub_f32 v10, v92, v8
    v_sub_f32 v11, v93, v8
    v_fmac_f32 v14, v10, v10
    v_fmac_f32 v15, v11, v11
    v_sub_f32 v10, v94, v8
    v_sub_f32 v11, v95, v8
    v_fmac_f32 v14, v10, v10
    v_fmac_f32 v15, v11, v11
    v_sub_f32 v10, v96, v8
    v_sub_f32 v11, v97, v8
    v_fmac_f32 v14, v10, v10
    v_fmac_f32 v15, v11, v11
    v_sub_f32 v10, v98, v8
    v_sub_f32 v11, v99, v8
    v_fmac_f32 v14, v10, v10
    v_fmac_f32 v15, v11, v11
    v_sub_f32 v10, v100, v8
    v_sub_f32 v11, v101, v8
    v_fmac_f32 v14, v10, v10
    v_fmac_f32 v15, v11, v11
    v_sub_f32 v10, v102, v8
    v_sub_f32 v11, v103, v8
    v_fmac_f32 v14, v10, v10
    v_fmac_f32 v15, v11, v11
    v_sub_f32 v10, v104, v8
    v_sub_f32 v11, v105, v8
    v_fmac_f32 v14, v10, v10
    v_fmac_f32 v15, v11, v11
    v_sub_f32 v10, v106, v8
    v_sub_f32 v11, v107, v8
    v_fmac_f32 v14, v10, v10
    v_fmac_f32 v15, v11, v11
    v_sub_f32 v10, v108, v8
    v_sub_f32 v11, v109, v8
    v_fmac_f32 v14, v10, v10
    v_fmac_f32 v15, v11, v11
    v_sub_f32 v10, v110, v8
    v_sub_f32 v11, v111, v8
    v_fmac_f32 v14, v10, v10
    v_fmac_f32 v15, v11, v11
    v_sub_f32 v10, v112, v8
    v_sub_f32 v11, v113, v8
    v_fmac_f32 v14, v10, v10
    v_fmac_f32 v15, v11, v11
    v_sub_f32 v10, v114, v8
    v_sub_f32 v11, v115, v8
    v_fmac_f32 v14, v10, v10
    v_fmac_f32 v15, v11, v11
    v_sub_f32 v10, v116, v8
    v_sub_f32 v11, v117, v8
    v_fmac_f32 v14, v10, v10
    v_fmac_f32 v15, v11, v11
    v_sub_f32 v10, v118, v8
    v_sub_f32 v11, v119, v8
    v_fmac_f32 v14, v10, v10
    v_fmac_f32 v15, v11, v11
    v_sub_f32 v10, v120, v8
    v_sub_f32 v11, v121, v8
    v_fmac_f32 v14, v10, v10
    v_fmac_f32 v15, v11, v11
    v_sub_f32 v10, v122, v8
    v_sub_f32 v11, v123, v8
    v_fmac_f32 v14, v10, v10
    v_fmac_f32 v15, v11, v11
    v_sub_f32 v10, v124, v8
    v_sub_f32 v11, v125, v8
    v_fmac_f32 v14, v10, v10
    v_fmac_f32 v15, v11, v11
    v_sub_f32 v10, v126, v8
    v_sub_f32 v11, v127, v8
    v_fmac_f32 v14, v10, v10
    v_fmac_f32 v15, v11, v11
    v_sub_f32 v10, v128, v8
    v_sub_f32 v11, v129, v8
    v_fmac_f32 v14, v10, v10
    v_fmac_f32 v15, v11, v11
    v_sub_f32 v10, v130, v8
    v_sub_f32 v11, v131, v8
    v_fmac_f32 v14, v10, v10
    v_fmac_f32 v15, v11, v11
    v_sub_f32 v10, v132, v8
    v_sub_f32 v11, v133, v8
    v_fmac_f32 v14, v10, v10
    v_fmac_f32 v15, v11, v11
    v_sub_f32 v10, v134, v8
    v_sub_f32 v11, v135, v8
    v_fmac_f32 v14, v10, v10
    v_fmac_f32 v15, v11, v11
    v_sub_f32 v10, v136, v8
    v_sub_f32 v11, v137, v8
    v_fmac_f32 v14, v10, v10
    v_fmac_f32 v15, v11, v11
    v_sub_f32 v10, v138, v8
    v_sub_f32 v11, v139, v8
    v_fmac_f32 v14, v10, v10
    v_fmac_f32 v15, v11, v11
    v_sub_f32 v10, v140, v8
    v_sub_f32 v11, v141, v8
    v_fmac_f32 v14, v10, v10
    v_fmac_f32 v15, v11, v11
    v_sub_f32 v10, v142, v8
    v_sub_f32 v11, v143, v8
    v_fmac_f32 v14, v10, v10
    v_fmac_f32 v15, v11, v11
    v_sub_f32 v10, v144, v8
    v_sub_f32 v11, v145, v8
    v_fmac_f32 v14, v10, v10
    v_fmac_f32 v15, v11, v11
    v_sub_f32 v10, v146, v8
    v_sub_f32 v11, v147, v8
    v_fmac_f32 v14, v10, v10
    v_fmac_f32 v15, v11, v11
    v_sub_f32 v10, v148, v8
    v_sub_f32 v11, v149, v8
    v_fmac_f32 v14, v10, v10
    v_fmac_f32 v15, v11, v11
    v_sub_f32 v10, v150, v8
    v_sub_f32 v11, v151, v8
    v_fmac_f32 v14, v10, v10
    v_fmac_f32 v15, v11, v11
    v_sub_f32 v10, v152, v8
    v_sub_f32 v11, v153, v8
    v_fmac_f32 v14, v10, v10
    v_fmac_f32 v15, v11, v11
    v_sub_f32 v10, v154, v8
    v_sub_f32 v11, v155, v8
    v_fmac_f32 v14, v10, v10
    v_fmac_f32 v15, v11, v11
    v_sub_f32 v10, v156, v8
    v_sub_f32 v11, v157, v8
    v_fmac_f32 v14, v10, v10
    v_fmac_f32 v15, v11, v11
    v_sub_f32 v10, v158, v8
    v_sub_f32 v11, v159, v8
    v_fmac_f32 v14, v10, v10
    v_fmac_f32 v15, v11, v11
    v_sub_f32 v10, v160, v8
    v_sub_f32 v11, v161, v8
    v_fmac_f32 v14, v10, v10
    v_fmac_f32 v15, v11, v11
    v_sub_f32 v10, v162, v8
    v_sub_f32 v11, v163, v8
    v_fmac_f32 v14, v10, v10
    v_fmac_f32 v15, v11, v11
    v_sub_f32 v10, v164, v8
    v_sub_f32 v11, v165, v8
    v_fmac_f32 v14, v10, v10
    v_fmac_f32 v15, v11, v11
    v_sub_f32 v10, v166, v8
    v_sub_f32 v11, v167, v8
    v_fmac_f32 v14, v10, v10
    v_fmac_f32 v15, v11, v11
    v_sub_f32 v10, v168, v8
    v_sub_f32 v11, v169, v8
    v_fmac_f32 v14, v10, v10
    v_fmac_f32 v15, v11, v11
    v_sub_f32 v10, v170, v8
    v_sub_f32 v11, v171, v8
    v_fmac_f32 v14, v10, v10
    v_fmac_f32 v15, v11, v11
    v_sub_f32 v10, v172, v8
    v_sub_f32 v11, v173, v8
    v_fmac_f32 v14, v10, v10
    v_fmac_f32 v15, v11, v11
    v_sub_f32 v10, v174, v8
    v_sub_f32 v11, v175, v8
    v_fmac_f32 v14, v10, v10
    v_fmac_f32 v15, v11, v11
    v_add_f32 v14, v14, v15
    v_mov_b32 v9, v14
    s_nop 1
    v_permlane16_swap_b32 v14, v9
    v_add_f32 v14, v14, v9
    v_mov_b32 v9, v14
    s_nop 1
    v_permlane32_swap_b32 v14, v9
    v_add_f32 v14, v14, v9
    v_mul_f32 v14, 0x3acccccd, v14
    v_cvt_pk_bf16_f32 v8, v8, v8
    v_and_b32 v8, 0xffff0000, v8
    v_cvt_pk_bf16_f32 v14, v14, v14
    v_and_b32 v14, 0xffff0000, v14
    v_add_f32 v14, 0x3727c5ac, v14
    v_cvt_pk_bf16_f32 v14, v14, v14
    v_and_b32 v14, 0xffff0000, v14
    v_sqrt_f32 v14, v14
    s_nop 0
    v_cvt_pk_bf16_f32 v14, v14, v14
    v_and_b32 v14, 0xffff0000, v14
    v_rcp_f32 v14, v14
    v_sub_f32 v16, v16, v8
    v_sub_f32 v17, v17, v8
    v_cvt_pk_bf16_f32 v176, v16, v17
    v_lshlrev_b32 v16, 16, v176
    v_and_b32 v17, 0xffff0000, v176
    v_mul_f32 v16, v16, v14
    v_mul_f32 v17, v17, v14
    v_cvt_pk_bf16_f32 v176, v16, v17
    v_sub_f32 v18, v18, v8
    v_sub_f32 v19, v19, v8
    v_cvt_pk_bf16_f32 v177, v18, v19
    v_lshlrev_b32 v18, 16, v177
    v_and_b32 v19, 0xffff0000, v177
    v_mul_f32 v18, v18, v14
    v_mul_f32 v19, v19, v14
    v_cvt_pk_bf16_f32 v177, v18, v19
    v_sub_f32 v20, v20, v8
    v_sub_f32 v21, v21, v8
    v_cvt_pk_bf16_f32 v178, v20, v21
    v_lshlrev_b32 v20, 16, v178
    v_and_b32 v21, 0xffff0000, v178
    v_mul_f32 v20, v20, v14
    v_mul_f32 v21, v21, v14
    v_cvt_pk_bf16_f32 v178, v20, v21
    v_sub_f32 v22, v22, v8
    v_sub_f32 v23, v23, v8
    v_cvt_pk_bf16_f32 v179, v22, v23
    v_lshlrev_b32 v22, 16, v179
    v_and_b32 v23, 0xffff0000, v179
    v_mul_f32 v22, v22, v14
    v_mul_f32 v23, v23, v14
    v_cvt_pk_bf16_f32 v179, v22, v23
    v_sub_f32 v24, v24, v8
    v_sub_f32 v25, v25, v8
    v_cvt_pk_bf16_f32 v180, v24, v25
    v_lshlrev_b32 v24, 16, v180
    v_and_b32 v25, 0xffff0000, v180
    v_mul_f32 v24, v24, v14
    v_mul_f32 v25, v25, v14
    v_cvt_pk_bf16_f32 v180, v24, v25
    v_sub_f32 v26, v26, v8
    v_sub_f32 v27, v27, v8
    v_cvt_pk_bf16_f32 v181, v26, v27
    v_lshlrev_b32 v26, 16, v181
    v_and_b32 v27, 0xffff0000, v181
    v_mul_f32 v26, v26, v14
    v_mul_f32 v27, v27, v14
    v_cvt_pk_bf16_f32 v181, v26, v27
    v_sub_f32 v28, v28, v8
    v_sub_f32 v29, v29, v8
    v_cvt_pk_bf16_f32 v182, v28, v29
    v_lshlrev_b32 v28, 16, v182
    v_and_b32 v29, 0xffff0000, v182
    v_mul_f32 v28, v28, v14
    v_mul_f32 v29, v29, v14
    v_cvt_pk_bf16_f32 v182, v28, v29
    v_sub_f32 v30, v30, v8
    v_sub_f32 v31, v31, v8
    v_cvt_pk_bf16_f32 v183, v30, v31
    v_lshlrev_b32 v30, 16, v183
    v_and_b32 v31, 0xffff0000, v183
    v_mul_f32 v30, v30, v14
    v_mul_f32 v31, v31, v14
    v_cvt_pk_bf16_f32 v183, v30, v31
    v_sub_f32 v32, v32, v8
    v_sub_f32 v33, v33, v8
    v_cvt_pk_bf16_f32 v184, v32, v33
    v_lshlrev_b32 v32, 16, v184
    v_and_b32 v33, 0xffff0000, v184
    v_mul_f32 v32, v32, v14
    v_mul_f32 v33, v33, v14
    v_cvt_pk_bf16_f32 v184, v32, v33
    v_sub_f32 v34, v34, v8
    v_sub_f32 v35, v35, v8
    v_cvt_pk_bf16_f32 v185, v34, v35
    v_lshlrev_b32 v34, 16, v185
    v_and_b32 v35, 0xffff0000, v185
    v_mul_f32 v34, v34, v14
    v_mul_f32 v35, v35, v14
    v_cvt_pk_bf16_f32 v185, v34, v35
    v_sub_f32 v36, v36, v8
    v_sub_f32 v37, v37, v8
    v_cvt_pk_bf16_f32 v186, v36, v37
    v_lshlrev_b32 v36, 16, v186
    v_and_b32 v37, 0xffff0000, v186
    v_mul_f32 v36, v36, v14
    v_mul_f32 v37, v37, v14
    v_cvt_pk_bf16_f32 v186, v36, v37
    v_sub_f32 v38, v38, v8
    v_sub_f32 v39, v39, v8
    v_cvt_pk_bf16_f32 v187, v38, v39
    v_lshlrev_b32 v38, 16, v187
    v_and_b32 v39, 0xffff0000, v187
    v_mul_f32 v38, v38, v14
    v_mul_f32 v39, v39, v14
    v_cvt_pk_bf16_f32 v187, v38, v39
    v_sub_f32 v40, v40, v8
    v_sub_f32 v41, v41, v8
    v_cvt_pk_bf16_f32 v188, v40, v41
    v_lshlrev_b32 v40, 16, v188
    v_and_b32 v41, 0xffff0000, v188
    v_mul_f32 v40, v40, v14
    v_mul_f32 v41, v41, v14
    v_cvt_pk_bf16_f32 v188, v40, v41
    v_sub_f32 v42, v42, v8
    v_sub_f32 v43, v43, v8
    v_cvt_pk_bf16_f32 v189, v42, v43
    v_lshlrev_b32 v42, 16, v189
    v_and_b32 v43, 0xffff0000, v189
    v_mul_f32 v42, v42, v14
    v_mul_f32 v43, v43, v14
    v_cvt_pk_bf16_f32 v189, v42, v43
    v_sub_f32 v44, v44, v8
    v_sub_f32 v45, v45, v8
    v_cvt_pk_bf16_f32 v190, v44, v45
    v_lshlrev_b32 v44, 16, v190
    v_and_b32 v45, 0xffff0000, v190
    v_mul_f32 v44, v44, v14
    v_mul_f32 v45, v45, v14
    v_cvt_pk_bf16_f32 v190, v44, v45
    v_sub_f32 v46, v46, v8
    v_sub_f32 v47, v47, v8
    v_cvt_pk_bf16_f32 v191, v46, v47
    v_lshlrev_b32 v46, 16, v191
    v_and_b32 v47, 0xffff0000, v191
    v_mul_f32 v46, v46, v14
    v_mul_f32 v47, v47, v14
    v_cvt_pk_bf16_f32 v191, v46, v47
    v_sub_f32 v48, v48, v8
    v_sub_f32 v49, v49, v8
    v_cvt_pk_bf16_f32 v192, v48, v49
    v_lshlrev_b32 v48, 16, v192
    v_and_b32 v49, 0xffff0000, v192
    v_mul_f32 v48, v48, v14
    v_mul_f32 v49, v49, v14
    v_cvt_pk_bf16_f32 v192, v48, v49
    v_sub_f32 v50, v50, v8
    v_sub_f32 v51, v51, v8
    v_cvt_pk_bf16_f32 v193, v50, v51
    v_lshlrev_b32 v50, 16, v193
    v_and_b32 v51, 0xffff0000, v193
    v_mul_f32 v50, v50, v14
    v_mul_f32 v51, v51, v14
    v_cvt_pk_bf16_f32 v193, v50, v51
    v_sub_f32 v52, v52, v8
    v_sub_f32 v53, v53, v8
    v_cvt_pk_bf16_f32 v194, v52, v53
    v_lshlrev_b32 v52, 16, v194
    v_and_b32 v53, 0xffff0000, v194
    v_mul_f32 v52, v52, v14
    v_mul_f32 v53, v53, v14
    v_cvt_pk_bf16_f32 v194, v52, v53
    v_sub_f32 v54, v54, v8
    v_sub_f32 v55, v55, v8
    v_cvt_pk_bf16_f32 v195, v54, v55
    v_lshlrev_b32 v54, 16, v195
    v_and_b32 v55, 0xffff0000, v195
    v_mul_f32 v54, v54, v14
    v_mul_f32 v55, v55, v14
    v_cvt_pk_bf16_f32 v195, v54, v55
    v_sub_f32 v56, v56, v8
    v_sub_f32 v57, v57, v8
    v_cvt_pk_bf16_f32 v196, v56, v57
    v_lshlrev_b32 v56, 16, v196
    v_and_b32 v57, 0xffff0000, v196
    v_mul_f32 v56, v56, v14
    v_mul_f32 v57, v57, v14
    v_cvt_pk_bf16_f32 v196, v56, v57
    v_sub_f32 v58, v58, v8
    v_sub_f32 v59, v59, v8
    v_cvt_pk_bf16_f32 v197, v58, v59
    v_lshlrev_b32 v58, 16, v197
    v_and_b32 v59, 0xffff0000, v197
    v_mul_f32 v58, v58, v14
    v_mul_f32 v59, v59, v14
    v_cvt_pk_bf16_f32 v197, v58, v59
    v_sub_f32 v60, v60, v8
    v_sub_f32 v61, v61, v8
    v_cvt_pk_bf16_f32 v198, v60, v61
    v_lshlrev_b32 v60, 16, v198
    v_and_b32 v61, 0xffff0000, v198
    v_mul_f32 v60, v60, v14
    v_mul_f32 v61, v61, v14
    v_cvt_pk_bf16_f32 v198, v60, v61
    v_sub_f32 v62, v62, v8
    v_sub_f32 v63, v63, v8
    v_cvt_pk_bf16_f32 v199, v62, v63
    v_lshlrev_b32 v62, 16, v199
    v_and_b32 v63, 0xffff0000, v199
    v_mul_f32 v62, v62, v14
    v_mul_f32 v63, v63, v14
    v_cvt_pk_bf16_f32 v199, v62, v63
    v_sub_f32 v64, v64, v8
    v_sub_f32 v65, v65, v8
    v_cvt_pk_bf16_f32 v200, v64, v65
    v_lshlrev_b32 v64, 16, v200
    v_and_b32 v65, 0xffff0000, v200
    v_mul_f32 v64, v64, v14
    v_mul_f32 v65, v65, v14
    v_cvt_pk_bf16_f32 v200, v64, v65
    v_sub_f32 v66, v66, v8
    v_sub_f32 v67, v67, v8
    v_cvt_pk_bf16_f32 v201, v66, v67
    v_lshlrev_b32 v66, 16, v201
    v_and_b32 v67, 0xffff0000, v201
    v_mul_f32 v66, v66, v14
    v_mul_f32 v67, v67, v14
    v_cvt_pk_bf16_f32 v201, v66, v67
    v_sub_f32 v68, v68, v8
    v_sub_f32 v69, v69, v8
    v_cvt_pk_bf16_f32 v202, v68, v69
    v_lshlrev_b32 v68, 16, v202
    v_and_b32 v69, 0xffff0000, v202
    v_mul_f32 v68, v68, v14
    v_mul_f32 v69, v69, v14
    v_cvt_pk_bf16_f32 v202, v68, v69
    v_sub_f32 v70, v70, v8
    v_sub_f32 v71, v71, v8
    v_cvt_pk_bf16_f32 v203, v70, v71
    v_lshlrev_b32 v70, 16, v203
    v_and_b32 v71, 0xffff0000, v203
    v_mul_f32 v70, v70, v14
    v_mul_f32 v71, v71, v14
    v_cvt_pk_bf16_f32 v203, v70, v71
    v_sub_f32 v72, v72, v8
    v_sub_f32 v73, v73, v8
    v_cvt_pk_bf16_f32 v204, v72, v73
    v_lshlrev_b32 v72, 16, v204
    v_and_b32 v73, 0xffff0000, v204
    v_mul_f32 v72, v72, v14
    v_mul_f32 v73, v73, v14
    v_cvt_pk_bf16_f32 v204, v72, v73
    v_sub_f32 v74, v74, v8
    v_sub_f32 v75, v75, v8
    v_cvt_pk_bf16_f32 v205, v74, v75
    v_lshlrev_b32 v74, 16, v205
    v_and_b32 v75, 0xffff0000, v205
    v_mul_f32 v74, v74, v14
    v_mul_f32 v75, v75, v14
    v_cvt_pk_bf16_f32 v205, v74, v75
    v_sub_f32 v76, v76, v8
    v_sub_f32 v77, v77, v8
    v_cvt_pk_bf16_f32 v206, v76, v77
    v_lshlrev_b32 v76, 16, v206
    v_and_b32 v77, 0xffff0000, v206
    v_mul_f32 v76, v76, v14
    v_mul_f32 v77, v77, v14
    v_cvt_pk_bf16_f32 v206, v76, v77
    v_sub_f32 v78, v78, v8
    v_sub_f32 v79, v79, v8
    v_cvt_pk_bf16_f32 v207, v78, v79
    v_lshlrev_b32 v78, 16, v207
    v_and_b32 v79, 0xffff0000, v207
    v_mul_f32 v78, v78, v14
    v_mul_f32 v79, v79, v14
    v_cvt_pk_bf16_f32 v207, v78, v79
    v_sub_f32 v80, v80, v8
    v_sub_f32 v81, v81, v8
    v_cvt_pk_bf16_f32 v208, v80, v81
    v_lshlrev_b32 v80, 16, v208
    v_and_b32 v81, 0xffff0000, v208
    v_mul_f32 v80, v80, v14
    v_mul_f32 v81, v81, v14
    v_cvt_pk_bf16_f32 v208, v80, v81
    v_sub_f32 v82, v82, v8
    v_sub_f32 v83, v83, v8
    v_cvt_pk_bf16_f32 v209, v82, v83
    v_lshlrev_b32 v82, 16, v209
    v_and_b32 v83, 0xffff0000, v209
    v_mul_f32 v82, v82, v14
    v_mul_f32 v83, v83, v14
    v_cvt_pk_bf16_f32 v209, v82, v83
    v_sub_f32 v84, v84, v8
    v_sub_f32 v85, v85, v8
    v_cvt_pk_bf16_f32 v210, v84, v85
    v_lshlrev_b32 v84, 16, v210
    v_and_b32 v85, 0xffff0000, v210
    v_mul_f32 v84, v84, v14
    v_mul_f32 v85, v85, v14
    v_cvt_pk_bf16_f32 v210, v84, v85
    v_sub_f32 v86, v86, v8
    v_sub_f32 v87, v87, v8
    v_cvt_pk_bf16_f32 v211, v86, v87
    v_lshlrev_b32 v86, 16, v211
    v_and_b32 v87, 0xffff0000, v211
    v_mul_f32 v86, v86, v14
    v_mul_f32 v87, v87, v14
    v_cvt_pk_bf16_f32 v211, v86, v87
    v_sub_f32 v88, v88, v8
    v_sub_f32 v89, v89, v8
    v_cvt_pk_bf16_f32 v212, v88, v89
    v_lshlrev_b32 v88, 16, v212
    v_and_b32 v89, 0xffff0000, v212
    v_mul_f32 v88, v88, v14
    v_mul_f32 v89, v89, v14
    v_cvt_pk_bf16_f32 v212, v88, v89
    v_sub_f32 v90, v90, v8
    v_sub_f32 v91, v91, v8
    v_cvt_pk_bf16_f32 v213, v90, v91
    v_lshlrev_b32 v90, 16, v213
    v_and_b32 v91, 0xffff0000, v213
    v_mul_f32 v90, v90, v14
    v_mul_f32 v91, v91, v14
    v_cvt_pk_bf16_f32 v213, v90, v91
    v_sub_f32 v92, v92, v8
    v_sub_f32 v93, v93, v8
    v_cvt_pk_bf16_f32 v214, v92, v93
    v_lshlrev_b32 v92, 16, v214
    v_and_b32 v93, 0xffff0000, v214
    v_mul_f32 v92, v92, v14
    v_mul_f32 v93, v93, v14
    v_cvt_pk_bf16_f32 v214, v92, v93
    v_sub_f32 v94, v94, v8
    v_sub_f32 v95, v95, v8
    v_cvt_pk_bf16_f32 v215, v94, v95
    v_lshlrev_b32 v94, 16, v215
    v_and_b32 v95, 0xffff0000, v215
    v_mul_f32 v94, v94, v14
    v_mul_f32 v95, v95, v14
    v_cvt_pk_bf16_f32 v215, v94, v95
    v_sub_f32 v96, v96, v8
    v_sub_f32 v97, v97, v8
    v_cvt_pk_bf16_f32 v216, v96, v97
    v_lshlrev_b32 v96, 16, v216
    v_and_b32 v97, 0xffff0000, v216
    v_mul_f32 v96, v96, v14
    v_mul_f32 v97, v97, v14
    v_cvt_pk_bf16_f32 v216, v96, v97
    v_sub_f32 v98, v98, v8
    v_sub_f32 v99, v99, v8
    v_cvt_pk_bf16_f32 v217, v98, v99
    v_lshlrev_b32 v98, 16, v217
    v_and_b32 v99, 0xffff0000, v217
    v_mul_f32 v98, v98, v14
    v_mul_f32 v99, v99, v14
    v_cvt_pk_bf16_f32 v217, v98, v99
    v_sub_f32 v100, v100, v8
    v_sub_f32 v101, v101, v8
    v_cvt_pk_bf16_f32 v218, v100, v101
    v_lshlrev_b32 v100, 16, v218
    v_and_b32 v101, 0xffff0000, v218
    v_mul_f32 v100, v100, v14
    v_mul_f32 v101, v101, v14
    v_cvt_pk_bf16_f32 v218, v100, v101
    v_sub_f32 v102, v102, v8
    v_sub_f32 v103, v103, v8
    v_cvt_pk_bf16_f32 v219, v102, v103
    v_lshlrev_b32 v102, 16, v219
    v_and_b32 v103, 0xffff0000, v219
    v_mul_f32 v102, v102, v14
    v_mul_f32 v103, v103, v14
    v_cvt_pk_bf16_f32 v219, v102, v103
    v_sub_f32 v104, v104, v8
    v_sub_f32 v105, v105, v8
    v_cvt_pk_bf16_f32 v220, v104, v105
    v_lshlrev_b32 v104, 16, v220
    v_and_b32 v105, 0xffff0000, v220
    v_mul_f32 v104, v104, v14
    v_mul_f32 v105, v105, v14
    v_cvt_pk_bf16_f32 v220, v104, v105
    v_sub_f32 v106, v106, v8
    v_sub_f32 v107, v107, v8
    v_cvt_pk_bf16_f32 v221, v106, v107
    v_lshlrev_b32 v106, 16, v221
    v_and_b32 v107, 0xffff0000, v221
    v_mul_f32 v106, v106, v14
    v_mul_f32 v107, v107, v14
    v_cvt_pk_bf16_f32 v221, v106, v107
    v_sub_f32 v108, v108, v8
    v_sub_f32 v109, v109, v8
    v_cvt_pk_bf16_f32 v222, v108, v109
    v_lshlrev_b32 v108, 16, v222
    v_and_b32 v109, 0xffff0000, v222
    v_mul_f32 v108, v108, v14
    v_mul_f32 v109, v109, v14
    v_cvt_pk_bf16_f32 v222, v108, v109
    v_sub_f32 v110, v110, v8
    v_sub_f32 v111, v111, v8
    v_cvt_pk_bf16_f32 v223, v110, v111
    v_lshlrev_b32 v110, 16, v223
    v_and_b32 v111, 0xffff0000, v223
    v_mul_f32 v110, v110, v14
    v_mul_f32 v111, v111, v14
    v_cvt_pk_bf16_f32 v223, v110, v111
    v_sub_f32 v112, v112, v8
    v_sub_f32 v113, v113, v8
    v_cvt_pk_bf16_f32 v224, v112, v113
    v_lshlrev_b32 v112, 16, v224
    v_and_b32 v113, 0xffff0000, v224
    v_mul_f32 v112, v112, v14
    v_mul_f32 v113, v113, v14
    v_cvt_pk_bf16_f32 v224, v112, v113
    v_sub_f32 v114, v114, v8
    v_sub_f32 v115, v115, v8
    v_cvt_pk_bf16_f32 v225, v114, v115
    v_lshlrev_b32 v114, 16, v225
    v_and_b32 v115, 0xffff0000, v225
    v_mul_f32 v114, v114, v14
    v_mul_f32 v115, v115, v14
    v_cvt_pk_bf16_f32 v225, v114, v115
    v_sub_f32 v116, v116, v8
    v_sub_f32 v117, v117, v8
    v_cvt_pk_bf16_f32 v226, v116, v117
    v_lshlrev_b32 v116, 16, v226
    v_and_b32 v117, 0xffff0000, v226
    v_mul_f32 v116, v116, v14
    v_mul_f32 v117, v117, v14
    v_cvt_pk_bf16_f32 v226, v116, v117
    v_sub_f32 v118, v118, v8
    v_sub_f32 v119, v119, v8
    v_cvt_pk_bf16_f32 v227, v118, v119
    v_lshlrev_b32 v118, 16, v227
    v_and_b32 v119, 0xffff0000, v227
    v_mul_f32 v118, v118, v14
    v_mul_f32 v119, v119, v14
    v_cvt_pk_bf16_f32 v227, v118, v119
    v_sub_f32 v120, v120, v8
    v_sub_f32 v121, v121, v8
    v_cvt_pk_bf16_f32 v228, v120, v121
    v_lshlrev_b32 v120, 16, v228
    v_and_b32 v121, 0xffff0000, v228
    v_mul_f32 v120, v120, v14
    v_mul_f32 v121, v121, v14
    v_cvt_pk_bf16_f32 v228, v120, v121
    v_sub_f32 v122, v122, v8
    v_sub_f32 v123, v123, v8
    v_cvt_pk_bf16_f32 v229, v122, v123
    v_lshlrev_b32 v122, 16, v229
    v_and_b32 v123, 0xffff0000, v229
    v_mul_f32 v122, v122, v14
    v_mul_f32 v123, v123, v14
    v_cvt_pk_bf16_f32 v229, v122, v123
    v_sub_f32 v124, v124, v8
    v_sub_f32 v125, v125, v8
    v_cvt_pk_bf16_f32 v230, v124, v125
    v_lshlrev_b32 v124, 16, v230
    v_and_b32 v125, 0xffff0000, v230
    v_mul_f32 v124, v124, v14
    v_mul_f32 v125, v125, v14
    v_cvt_pk_bf16_f32 v230, v124, v125
    v_sub_f32 v126, v126, v8
    v_sub_f32 v127, v127, v8
    v_cvt_pk_bf16_f32 v231, v126, v127
    v_lshlrev_b32 v126, 16, v231
    v_and_b32 v127, 0xffff0000, v231
    v_mul_f32 v126, v126, v14
    v_mul_f32 v127, v127, v14
    v_cvt_pk_bf16_f32 v231, v126, v127
    v_sub_f32 v128, v128, v8
    v_sub_f32 v129, v129, v8
    v_cvt_pk_bf16_f32 v232, v128, v129
    v_lshlrev_b32 v128, 16, v232
    v_and_b32 v129, 0xffff0000, v232
    v_mul_f32 v128, v128, v14
    v_mul_f32 v129, v129, v14
    v_cvt_pk_bf16_f32 v232, v128, v129
    v_sub_f32 v130, v130, v8
    v_sub_f32 v131, v131, v8
    v_cvt_pk_bf16_f32 v233, v130, v131
    v_lshlrev_b32 v130, 16, v233
    v_and_b32 v131, 0xffff0000, v233
    v_mul_f32 v130, v130, v14
    v_mul_f32 v131, v131, v14
    v_cvt_pk_bf16_f32 v233, v130, v131
    v_sub_f32 v132, v132, v8
    v_sub_f32 v133, v133, v8
    v_cvt_pk_bf16_f32 v234, v132, v133
    v_lshlrev_b32 v132, 16, v234
    v_and_b32 v133, 0xffff0000, v234
    v_mul_f32 v132, v132, v14
    v_mul_f32 v133, v133, v14
    v_cvt_pk_bf16_f32 v234, v132, v133
    v_sub_f32 v134, v134, v8
    v_sub_f32 v135, v135, v8
    v_cvt_pk_bf16_f32 v235, v134, v135
    v_lshlrev_b32 v134, 16, v235
    v_and_b32 v135, 0xffff0000, v235
    v_mul_f32 v134, v134, v14
    v_mul_f32 v135, v135, v14
    v_cvt_pk_bf16_f32 v235, v134, v135
    v_sub_f32 v136, v136, v8
    v_sub_f32 v137, v137, v8
    v_cvt_pk_bf16_f32 v236, v136, v137
    v_lshlrev_b32 v136, 16, v236
    v_and_b32 v137, 0xffff0000, v236
    v_mul_f32 v136, v136, v14
    v_mul_f32 v137, v137, v14
    v_cvt_pk_bf16_f32 v236, v136, v137
    v_sub_f32 v138, v138, v8
    v_sub_f32 v139, v139, v8
    v_cvt_pk_bf16_f32 v237, v138, v139
    v_lshlrev_b32 v138, 16, v237
    v_and_b32 v139, 0xffff0000, v237
    v_mul_f32 v138, v138, v14
    v_mul_f32 v139, v139, v14
    v_cvt_pk_bf16_f32 v237, v138, v139
    v_sub_f32 v140, v140, v8
    v_sub_f32 v141, v141, v8
    v_cvt_pk_bf16_f32 v238, v140, v141
    v_lshlrev_b32 v140, 16, v238
    v_and_b32 v141, 0xffff0000, v238
    v_mul_f32 v140, v140, v14
    v_mul_f32 v141, v141, v14
    v_cvt_pk_bf16_f32 v238, v140, v141
    v_sub_f32 v142, v142, v8
    v_sub_f32 v143, v143, v8
    v_cvt_pk_bf16_f32 v239, v142, v143
    v_lshlrev_b32 v142, 16, v239
    v_and_b32 v143, 0xffff0000, v239
    v_mul_f32 v142, v142, v14
    v_mul_f32 v143, v143, v14
    v_cvt_pk_bf16_f32 v239, v142, v143
    v_sub_f32 v144, v144, v8
    v_sub_f32 v145, v145, v8
    v_cvt_pk_bf16_f32 v240, v144, v145
    v_lshlrev_b32 v144, 16, v240
    v_and_b32 v145, 0xffff0000, v240
    v_mul_f32 v144, v144, v14
    v_mul_f32 v145, v145, v14
    v_cvt_pk_bf16_f32 v240, v144, v145
    v_sub_f32 v146, v146, v8
    v_sub_f32 v147, v147, v8
    v_cvt_pk_bf16_f32 v241, v146, v147
    v_lshlrev_b32 v146, 16, v241
    v_and_b32 v147, 0xffff0000, v241
    v_mul_f32 v146, v146, v14
    v_mul_f32 v147, v147, v14
    v_cvt_pk_bf16_f32 v241, v146, v147
    v_sub_f32 v148, v148, v8
    v_sub_f32 v149, v149, v8
    v_cvt_pk_bf16_f32 v242, v148, v149
    v_lshlrev_b32 v148, 16, v242
    v_and_b32 v149, 0xffff0000, v242
    v_mul_f32 v148, v148, v14
    v_mul_f32 v149, v149, v14
    v_cvt_pk_bf16_f32 v242, v148, v149
    v_sub_f32 v150, v150, v8
    v_sub_f32 v151, v151, v8
    v_cvt_pk_bf16_f32 v243, v150, v151
    v_lshlrev_b32 v150, 16, v243
    v_and_b32 v151, 0xffff0000, v243
    v_mul_f32 v150, v150, v14
    v_mul_f32 v151, v151, v14
    v_cvt_pk_bf16_f32 v243, v150, v151
    v_sub_f32 v152, v152, v8
    v_sub_f32 v153, v153, v8
    v_cvt_pk_bf16_f32 v244, v152, v153
    v_lshlrev_b32 v152, 16, v244
    v_and_b32 v153, 0xffff0000, v244
    v_mul_f32 v152, v152, v14
    v_mul_f32 v153, v153, v14
    v_cvt_pk_bf16_f32 v244, v152, v153
    v_sub_f32 v154, v154, v8
    v_sub_f32 v155, v155, v8
    v_cvt_pk_bf16_f32 v245, v154, v155
    v_lshlrev_b32 v154, 16, v245
    v_and_b32 v155, 0xffff0000, v245
    v_mul_f32 v154, v154, v14
    v_mul_f32 v155, v155, v14
    v_cvt_pk_bf16_f32 v245, v154, v155
    v_sub_f32 v156, v156, v8
    v_sub_f32 v157, v157, v8
    v_cvt_pk_bf16_f32 v246, v156, v157
    v_lshlrev_b32 v156, 16, v246
    v_and_b32 v157, 0xffff0000, v246
    v_mul_f32 v156, v156, v14
    v_mul_f32 v157, v157, v14
    v_cvt_pk_bf16_f32 v246, v156, v157
    v_sub_f32 v158, v158, v8
    v_sub_f32 v159, v159, v8
    v_cvt_pk_bf16_f32 v247, v158, v159
    v_lshlrev_b32 v158, 16, v247
    v_and_b32 v159, 0xffff0000, v247
    v_mul_f32 v158, v158, v14
    v_mul_f32 v159, v159, v14
    v_cvt_pk_bf16_f32 v247, v158, v159
    v_sub_f32 v160, v160, v8
    v_sub_f32 v161, v161, v8
    v_cvt_pk_bf16_f32 v248, v160, v161
    v_lshlrev_b32 v160, 16, v248
    v_and_b32 v161, 0xffff0000, v248
    v_mul_f32 v160, v160, v14
    v_mul_f32 v161, v161, v14
    v_cvt_pk_bf16_f32 v248, v160, v161
    v_sub_f32 v162, v162, v8
    v_sub_f32 v163, v163, v8
    v_cvt_pk_bf16_f32 v249, v162, v163
    v_lshlrev_b32 v162, 16, v249
    v_and_b32 v163, 0xffff0000, v249
    v_mul_f32 v162, v162, v14
    v_mul_f32 v163, v163, v14
    v_cvt_pk_bf16_f32 v249, v162, v163
    v_sub_f32 v164, v164, v8
    v_sub_f32 v165, v165, v8
    v_cvt_pk_bf16_f32 v250, v164, v165
    v_lshlrev_b32 v164, 16, v250
    v_and_b32 v165, 0xffff0000, v250
    v_mul_f32 v164, v164, v14
    v_mul_f32 v165, v165, v14
    v_cvt_pk_bf16_f32 v250, v164, v165
    v_sub_f32 v166, v166, v8
    v_sub_f32 v167, v167, v8
    v_cvt_pk_bf16_f32 v251, v166, v167
    v_lshlrev_b32 v166, 16, v251
    v_and_b32 v167, 0xffff0000, v251
    v_mul_f32 v166, v166, v14
    v_mul_f32 v167, v167, v14
    v_cvt_pk_bf16_f32 v251, v166, v167
    v_sub_f32 v168, v168, v8
    v_sub_f32 v169, v169, v8
    v_cvt_pk_bf16_f32 v252, v168, v169
    v_lshlrev_b32 v168, 16, v252
    v_and_b32 v169, 0xffff0000, v252
    v_mul_f32 v168, v168, v14
    v_mul_f32 v169, v169, v14
    v_cvt_pk_bf16_f32 v252, v168, v169
    v_sub_f32 v170, v170, v8
    v_sub_f32 v171, v171, v8
    v_cvt_pk_bf16_f32 v253, v170, v171
    v_lshlrev_b32 v170, 16, v253
    v_and_b32 v171, 0xffff0000, v253
    v_mul_f32 v170, v170, v14
    v_mul_f32 v171, v171, v14
    v_cvt_pk_bf16_f32 v253, v170, v171
    v_sub_f32 v172, v172, v8
    v_sub_f32 v173, v173, v8
    v_cvt_pk_bf16_f32 v254, v172, v173
    v_lshlrev_b32 v172, 16, v254
    v_and_b32 v173, 0xffff0000, v254
    v_mul_f32 v172, v172, v14
    v_mul_f32 v173, v173, v14
    v_cvt_pk_bf16_f32 v254, v172, v173
    v_sub_f32 v174, v174, v8
    v_sub_f32 v175, v175, v8
    v_cvt_pk_bf16_f32 v255, v174, v175
    v_lshlrev_b32 v174, 16, v255
    v_and_b32 v175, 0xffff0000, v255
    v_mul_f32 v174, v174, v14
    v_mul_f32 v175, v175, v14
    v_cvt_pk_bf16_f32 v255, v174, v175
    s_mul_i32 s30, s61, 20480
    s_add_u32 s30, s30, 251658240
    buffer_store_dwordx4 v[176:179], v2, s[4:7], s30 offen offset:0 sc1
    buffer_store_dwordx4 v[180:183], v2, s[4:7], s30 offen offset:1024 sc1
    buffer_store_dwordx4 v[184:187], v2, s[4:7], s30 offen offset:2048 sc1
    buffer_store_dwordx4 v[188:191], v2, s[4:7], s30 offen offset:3072 sc1
    s_add_u32 s30, s30, 4096
    buffer_store_dwordx4 v[192:195], v2, s[4:7], s30 offen offset:0 sc1
    buffer_store_dwordx4 v[196:199], v2, s[4:7], s30 offen offset:1024 sc1
    buffer_store_dwordx4 v[200:203], v2, s[4:7], s30 offen offset:2048 sc1
    buffer_store_dwordx4 v[204:207], v2, s[4:7], s30 offen offset:3072 sc1
    s_add_u32 s30, s30, 4096
    buffer_store_dwordx4 v[208:211], v2, s[4:7], s30 offen offset:0 sc1
    buffer_store_dwordx4 v[212:215], v2, s[4:7], s30 offen offset:1024 sc1
    buffer_store_dwordx4 v[216:219], v2, s[4:7], s30 offen offset:2048 sc1
    buffer_store_dwordx4 v[220:223], v2, s[4:7], s30 offen offset:3072 sc1
    s_add_u32 s30, s30, 4096
    buffer_store_dwordx4 v[224:227], v2, s[4:7], s30 offen offset:0 sc1
    buffer_store_dwordx4 v[228:231], v2, s[4:7], s30 offen offset:1024 sc1
    buffer_store_dwordx4 v[232:235], v2, s[4:7], s30 offen offset:2048 sc1
    buffer_store_dwordx4 v[236:239], v2, s[4:7], s30 offen offset:3072 sc1
    s_add_u32 s30, s30, 4096
    buffer_store_dwordx4 v[240:243], v2, s[4:7], s30 offen offset:0 sc1
    buffer_store_dwordx4 v[244:247], v2, s[4:7], s30 offen offset:1024 sc1
    buffer_store_dwordx4 v[248:251], v2, s[4:7], s30 offen offset:2048 sc1
    buffer_store_dwordx4 v[252:255], v2, s[4:7], s30 offen offset:3072 sc1
    s_add_u32 s30, s30, 4096
I_lnd:
    s_waitcnt vmcnt(0)
    s_barrier
    s_branch M_claim
I_pf:
    s_cmp_lg_u32 s16, 0
    s_cbranch_scc1 I_pf1
    s_lshr_b32 s30, s3, 5
    s_lshl_b32 s30, s30, 3
    s_add_u32 s30, s30, s63
    s_lshl_b32 s31, 1, s3
    v_mov_b32 v3, s30
    v_mov_b32 v4, s31
    v_mov_b32 v5, 0x100
    s_mov_b64 exec, 1
    global_atomic_add_x2 v3, v[4:5], s[48:49] sc1
    s_mov_b64 exec, -1
I_pf1:
    s_cmp_lt_u32 s60, 32
    s_cbranch_scc1 I_pfo
    s_and_b32 s30, s60, 31
    s_lshl_b32 s30, s30, 1
    s_lshr_b32 s31, s16, 1
    s_add_u32 s30, s30, s31
    s_mov_b32 exec_hi, 0xffff
    s_mul_i32 s30, s30, 48
    v_add_u32 v90, s30, v1
    v_lshlrev_b32 v91, 7, v90
    s_bitcmp1_b32 s16, 0
    s_cbranch_scc1 J_pf3
    s_mov_b32 s72, s40
    s_and_b32 s73, s41, 0xffff
    s_mov_b32 s74, 7864320
    s_mov_b32 s75, 0x20000
    s_mov_b32 s76, s42
    s_and_b32 s77, s43, 0xffff
    s_mov_b32 s78, 7864320
    s_mov_b32 s79, 0x20000
    s_waitcnt vmcnt(0)
    s_mov_b32 s30, 786432
    buffer_load_dword v95, v91, s[72:75], s30 offen
    s_mov_b32 s30, 786432
    buffer_load_dword v95, v91, s[76:79], s30 offen
    s_mov_b32 s30, 2359296
    buffer_load_dword v95, v91, s[72:75], s30 offen
    s_mov_b32 s30, 2359296
    buffer_load_dword v95, v91, s[76:79], s30 offen
    s_waitcnt vmcnt(0)
    s_mov_b32 s30, 1179648
    buffer_load_dword v95, v91, s[72:75], s30 offen
    s_mov_b32 s30, 1179648
    buffer_load_dword v95, v91, s[76:79], s30 offen
    s_mov_b32 s30, 2752512
    buffer_load_dword v95, v91, s[72:75], s30 offen
    s_mov_b32 s30, 2752512
    buffer_load_dword v95, v91, s[76:79], s30 offen
    s_waitcnt vmcnt(0)
    s_mov_b32 s30, 6291456
    buffer_load_dword v95, v91, s[72:75], s30 offen
    s_mov_b32 s30, 6291456
    buffer_load_dword v95, v91, s[76:79], s30 offen
    s_mov_b32 s30, 7077888
    buffer_load_dword v95, v91, s[72:75], s30 offen
    s_mov_b32 s30, 7077888
    buffer_load_dword v95, v91, s[76:79], s30 offen
    s_branch J_pf9
J_pf3:
    s_mov_b32 s72, s44
    s_and_b32 s73, s45, 0xffff
    s_mov_b32 s74, 7864320
    s_mov_b32 s75, 0x20000
    s_mov_b32 s76, s46
    s_and_b32 s77, s47, 0xffff
    s_mov_b32 s78, 7864320
    s_mov_b32 s79, 0x20000
    s_mov_b32 s31, 52429
    s_waitcnt vmcnt(0)
    s_mov_b32 s30, 6291456
    buffer_load_dword v95, v91, s[72:75], s30 offen
    s_mov_b32 s30, 7077888
    buffer_load_dword v95, v91, s[72:75], s30 offen
    s_mov_b32 s30, 6684672
    buffer_load_dword v95, v91, s[72:75], s30 offen
    s_mov_b32 s30, 7471104
    buffer_load_dword v95, v91, s[72:75], s30 offen
    s_waitcnt vmcnt(0)
    v_add_u32 v94, 12288, v90
    v_lshrrev_b32 v92, 6, v94
    v_mul_u32_u24 v92, s31, v92
    v_lshrrev_b32 v92, 18, v92
    v_mul_u32_u24 v93, 320, v92
    v_sub_u32 v94, v94, v93
    v_lshlrev_b32 v94, 7, v94
    v_and_b32 v93, 31, v92
    v_mul_u32_u24 v93, 245760, v93
    v_lshrrev_b32 v92, 5, v92
    v_mul_u32_u24 v92, 40960, v92
    v_add3_u32 v94, v94, v92, v93
    buffer_load_dword v95, v94, s[76:79], 0 offen
    v_add_u32 v94, 15360, v90
    v_lshrrev_b32 v92, 6, v94
    v_mul_u32_u24 v92, s31, v92
    v_lshrrev_b32 v92, 18, v92
    v_mul_u32_u24 v93, 320, v92
    v_sub_u32 v94, v94, v93
    v_lshlrev_b32 v94, 7, v94
    v_and_b32 v93, 31, v92
    v_mul_u32_u24 v93, 245760, v93
    v_lshrrev_b32 v92, 5, v92
    v_mul_u32_u24 v92, 40960, v92
    v_add3_u32 v94, v94, v92, v93
    buffer_load_dword v95, v94, s[76:79], 0 offen
    v_add_u32 v94, 18432, v90
    v_lshrrev_b32 v92, 6, v94
    v_mul_u32_u24 v92, s31, v92
    v_lshrrev_b32 v92, 18, v92
    v_mul_u32_u24 v93, 320, v92
    v_sub_u32 v94, v94, v93
    v_lshlrev_b32 v94, 7, v94
    v_and_b32 v93, 31, v92
    v_mul_u32_u24 v93, 245760, v93
    v_lshrrev_b32 v92, 5, v92
    v_mul_u32_u24 v92, 40960, v92
    v_add3_u32 v94, v94, v92, v93
    buffer_load_dword v95, v94, s[76:79], 0 offen
    v_add_u32 v94, 21504, v90
    v_lshrrev_b32 v92, 6, v94
    v_mul_u32_u24 v92, s31, v92
    v_lshrrev_b32 v92, 18, v92
    v_mul_u32_u24 v93, 320, v92
    v_sub_u32 v94, v94, v93
    v_lshlrev_b32 v94, 7, v94
    v_and_b32 v93, 31, v92
    v_mul_u32_u24 v93, 245760, v93
    v_lshrrev_b32 v92, 5, v92
    v_mul_u32_u24 v92, 40960, v92
    v_add3_u32 v94, v94, v92, v93
    buffer_load_dword v95, v94, s[76:79], 0 offen
    s_waitcnt vmcnt(0)
    v_add_u32 v94, 36864, v90
    v_lshrrev_b32 v92, 6, v94
    v_mul_u32_u24 v92, s31, v92
    v_lshrrev_b32 v92, 18, v92
    v_mul_u32_u24 v93, 320, v92
    v_sub_u32 v94, v94, v93
    v_lshlrev_b32 v94, 7, v94
    v_and_b32 v93, 31, v92
    v_mul_u32_u24 v93, 245760, v93
    v_lshrrev_b32 v92, 5, v92
    v_mul_u32_u24 v92, 40960, v92
    v_add3_u32 v94, v94, v92, v93
    buffer_load_dword v95, v94, s[76:79], 0 offen
    v_add_u32 v94, 39936, v90
    v_lshrrev_b32 v92, 6, v94
    v_mul_u32_u24 v92, s31, v92
    v_lshrrev_b32 v92, 18, v92
    v_mul_u32_u24 v93, 320, v92
    v_sub_u32 v94, v94, v93
    v_lshlrev_b32 v94, 7, v94
    v_and_b32 v93, 31, v92
    v_mul_u32_u24 v93, 245760, v93
    v_lshrrev_b32 v92, 5, v92
    v_mul_u32_u24 v92, 40960, v92
    v_add3_u32 v94, v94, v92, v93
    buffer_load_dword v95, v94, s[76:79], 0 offen
    v_add_u32 v94, 43008, v90
    v_lshrrev_b32 v92, 6, v94
    v_mul_u32_u24 v92, s31, v92
    v_lshrrev_b32 v92, 18, v92
    v_mul_u32_u24 v93, 320, v92
    v_sub_u32 v94, v94, v93
    v_lshlrev_b32 v94, 7, v94
    v_and_b32 v93, 31, v92
    v_mul_u32_u24 v93, 245760, v93
    v_lshrrev_b32 v92, 5, v92
    v_mul_u32_u24 v92, 40960, v92
    v_add3_u32 v94, v94, v92, v93
    buffer_load_dword v95, v94, s[76:79], 0 offen
    v_add_u32 v94, 46080, v90
    v_lshrrev_b32 v92, 6, v94
    v_mul_u32_u24 v92, s31, v92
    v_lshrrev_b32 v92, 18, v92
    v_mul_u32_u24 v93, 320, v92
    v_sub_u32 v94, v94, v93
    v_lshlrev_b32 v94, 7, v94
    v_and_b32 v93, 31, v92
    v_mul_u32_u24 v93, 245760, v93
    v_lshrrev_b32 v92, 5, v92
    v_mul_u32_u24 v92, 40960, v92
    v_add3_u32 v94, v94, v92, v93
    buffer_load_dword v95, v94, s[76:79], 0 offen
J_pf9:
    s_mov_b32 exec_hi, -1
    s_branch I_claimed
I_pfo:
    s_and_b32 s30, s60, 31
    s_lshl_b32 s30, s30, 1
    s_lshr_b32 s31, s16, 1
    s_add_u32 s30, s30, s31
    s_mov_b32 exec_hi, 0xffff
    s_mul_i32 s30, s30, 48
    v_add_u32 v90, s30, v1
    v_lshlrev_b32 v91, 7, v90
    s_bitcmp1_b32 s16, 0
    s_cbranch_scc1 I_pf3
    s_mov_b32 s72, s40
    s_and_b32 s73, s41, 0xffff
    s_mov_b32 s74, 7864320
    s_mov_b32 s75, 0x20000
    s_mov_b32 s76, s42
    s_and_b32 s77, s43, 0xffff
    s_mov_b32 s78, 7864320
    s_mov_b32 s79, 0x20000
    s_waitcnt vmcnt(0)
    s_mov_b32 s30, 3932160
    buffer_load_dword v95, v91, s[72:75], s30 offen
    s_mov_b32 s30, 3932160
    buffer_load_dword v95, v91, s[76:79], s30 offen
    s_mov_b32 s30, 5505024
    buffer_load_dword v95, v91, s[72:75], s30 offen
    s_mov_b32 s30, 5505024
    buffer_load_dword v95, v91, s[76:79], s30 offen
    s_waitcnt vmcnt(0)
    s_mov_b32 s30, 4325376
    buffer_load_dword v95, v91, s[72:75], s30 offen
    s_mov_b32 s30, 4325376
    buffer_load_dword v95, v91, s[76:79], s30 offen
    s_mov_b32 s30, 5898240
    buffer_load_dword v95, v91, s[72:75], s30 offen
    s_mov_b32 s30, 5898240
    buffer_load_dword v95, v91, s[76:79], s30 offen
    s_waitcnt vmcnt(0)
    s_mov_b32 s30, 6684672
    buffer_load_dword v95, v91, s[72:75], s30 offen
    s_mov_b32 s30, 6684672
    buffer_load_dword v95, v91, s[76:79], s30 offen
    s_mov_b32 s30, 7471104
    buffer_load_dword v95, v91, s[72:75], s30 offen
    s_mov_b32 s30, 7471104
    buffer_load_dword v95, v91, s[76:79], s30 offen
    s_branch I_pf9
I_pf3:
    s_mov_b32 s72, s44
    s_and_b32 s73, s45, 0xffff
    s_mov_b32 s74, 7864320
    s_mov_b32 s75, 0x20000
    s_mov_b32 s76, s46
    s_and_b32 s77, s47, 0xffff
    s_mov_b32 s78, 7864320
    s_mov_b32 s79, 0x20000
    s_mov_b32 s31, 52429
    s_waitcnt vmcnt(0)
    v_add_u32 v94, 0, v90
    v_lshrrev_b32 v92, 6, v94
    v_mul_u32_u24 v92, s31, v92
    v_lshrrev_b32 v92, 18, v92
    v_mul_u32_u24 v93, 320, v92
    v_sub_u32 v94, v94, v93
    v_lshlrev_b32 v94, 7, v94
    v_and_b32 v93, 31, v92
    v_mul_u32_u24 v93, 245760, v93
    v_lshrrev_b32 v92, 5, v92
    v_mul_u32_u24 v92, 40960, v92
    v_add3_u32 v94, v94, v92, v93
    buffer_load_dword v95, v94, s[76:79], 0 offen
    v_add_u32 v94, 3072, v90
    v_lshrrev_b32 v92, 6, v94
    v_mul_u32_u24 v92, s31, v92
    v_lshrrev_b32 v92, 18, v92
    v_mul_u32_u24 v93, 320, v92
    v_sub_u32 v94, v94, v93
    v_lshlrev_b32 v94, 7, v94
    v_and_b32 v93, 31, v92
    v_mul_u32_u24 v93, 245760, v93
    v_lshrrev_b32 v92, 5, v92
    v_mul_u32_u24 v92, 40960, v92
    v_add3_u32 v94, v94, v92, v93
    buffer_load_dword v95, v94, s[76:79], 0 offen
    v_add_u32 v94, 6144, v90
    v_lshrrev_b32 v92, 6, v94
    v_mul_u32_u24 v92, s31, v92
    v_lshrrev_b32 v92, 18, v92
    v_mul_u32_u24 v93, 320, v92
    v_sub_u32 v94, v94, v93
    v_lshlrev_b32 v94, 7, v94
    v_and_b32 v93, 31, v92
    v_mul_u32_u24 v93, 245760, v93
    v_lshrrev_b32 v92, 5, v92
    v_mul_u32_u24 v92, 40960, v92
    v_add3_u32 v94, v94, v92, v93
    buffer_load_dword v95, v94, s[76:79], 0 offen
    v_add_u32 v94, 9216, v90
    v_lshrrev_b32 v92, 6, v94
    v_mul_u32_u24 v92, s31, v92
    v_lshrrev_b32 v92, 18, v92
    v_mul_u32_u24 v93, 320, v92
    v_sub_u32 v94, v94, v93
    v_lshlrev_b32 v94, 7, v94
    v_and_b32 v93, 31, v92
    v_mul_u32_u24 v93, 245760, v93
    v_lshrrev_b32 v92, 5, v92
    v_mul_u32_u24 v92, 40960, v92
    v_add3_u32 v94, v94, v92, v93
    buffer_load_dword v95, v94, s[76:79], 0 offen
    s_waitcnt vmcnt(0)
    v_add_u32 v94, 24576, v90
    v_lshrrev_b32 v92, 6, v94
    v_mul_u32_u24 v92, s31, v92
    v_lshrrev_b32 v92, 18, v92
    v_mul_u32_u24 v93, 320, v92
    v_sub_u32 v94, v94, v93
    v_lshlrev_b32 v94, 7, v94
    v_and_b32 v93, 31, v92
    v_mul_u32_u24 v93, 245760, v93
    v_lshrrev_b32 v92, 5, v92
    v_mul_u32_u24 v92, 40960, v92
    v_add3_u32 v94, v94, v92, v93
    buffer_load_dword v95, v94, s[76:79], 0 offen
    v_add_u32 v94, 27648, v90
    v_lshrrev_b32 v92, 6, v94
    v_mul_u32_u24 v92, s31, v92
    v_lshrrev_b32 v92, 18, v92
    v_mul_u32_u24 v93, 320, v92
    v_sub_u32 v94, v94, v93
    v_lshlrev_b32 v94, 7, v94
    v_and_b32 v93, 31, v92
    v_mul_u32_u24 v93, 245760, v93
    v_lshrrev_b32 v92, 5, v92
    v_mul_u32_u24 v92, 40960, v92
    v_add3_u32 v94, v94, v92, v93
    buffer_load_dword v95, v94, s[76:79], 0 offen
    v_add_u32 v94, 30720, v90
    v_lshrrev_b32 v92, 6, v94
    v_mul_u32_u24 v92, s31, v92
    v_lshrrev_b32 v92, 18, v92
    v_mul_u32_u24 v93, 320, v92
    v_sub_u32 v94, v94, v93
    v_lshlrev_b32 v94, 7, v94
    v_and_b32 v93, 31, v92
    v_mul_u32_u24 v93, 245760, v93
    v_lshrrev_b32 v92, 5, v92
    v_mul_u32_u24 v92, 40960, v92
    v_add3_u32 v94, v94, v92, v93
    buffer_load_dword v95, v94, s[76:79], 0 offen
    v_add_u32 v94, 33792, v90
    v_lshrrev_b32 v92, 6, v94
    v_mul_u32_u24 v92, s31, v92
    v_lshrrev_b32 v92, 18, v92
    v_mul_u32_u24 v93, 320, v92
    v_sub_u32 v94, v94, v93
    v_lshlrev_b32 v94, 7, v94
    v_and_b32 v93, 31, v92
    v_mul_u32_u24 v93, 245760, v93
    v_lshrrev_b32 v92, 5, v92
    v_mul_u32_u24 v92, 40960, v92
    v_add3_u32 v94, v94, v92, v93
    buffer_load_dword v95, v94, s[76:79], 0 offen
    s_waitcnt vmcnt(0)
    v_add_u32 v94, 49152, v90
    v_lshrrev_b32 v92, 6, v94
    v_mul_u32_u24 v92, s31, v92
    v_lshrrev_b32 v92, 18, v92
    v_mul_u32_u24 v93, 320, v92
    v_sub_u32 v94, v94, v93
    v_lshlrev_b32 v94, 7, v94
    v_and_b32 v93, 31, v92
    v_mul_u32_u24 v93, 245760, v93
    v_lshrrev_b32 v92, 5, v92
    v_mul_u32_u24 v92, 40960, v92
    v_add3_u32 v94, v94, v92, v93
    buffer_load_dword v95, v94, s[76:79], 0 offen
    v_add_u32 v94, 52224, v90
    v_lshrrev_b32 v92, 6, v94
    v_mul_u32_u24 v92, s31, v92
    v_lshrrev_b32 v92, 18, v92
    v_mul_u32_u24 v93, 320, v92
    v_sub_u32 v94, v94, v93
    v_lshlrev_b32 v94, 7, v94
    v_and_b32 v93, 31, v92
    v_mul_u32_u24 v93, 245760, v93
    v_lshrrev_b32 v92, 5, v92
    v_mul_u32_u24 v92, 40960, v92
    v_add3_u32 v94, v94, v92, v93
    buffer_load_dword v95, v94, s[76:79], 0 offen
    v_add_u32 v94, 55296, v90
    v_lshrrev_b32 v92, 6, v94
    v_mul_u32_u24 v92, s31, v92
    v_lshrrev_b32 v92, 18, v92
    v_mul_u32_u24 v93, 320, v92
    v_sub_u32 v94, v94, v93
    v_lshlrev_b32 v94, 7, v94
    v_and_b32 v93, 31, v92
    v_mul_u32_u24 v93, 245760, v93
    v_lshrrev_b32 v92, 5, v92
    v_mul_u32_u24 v92, 40960, v92
    v_add3_u32 v94, v94, v92, v93
    buffer_load_dword v95, v94, s[76:79], 0 offen
    v_add_u32 v94, 58368, v90
    v_lshrrev_b32 v92, 6, v94
    v_mul_u32_u24 v92, s31, v92
    v_lshrrev_b32 v92, 18, v92
    v_mul_u32_u24 v93, 320, v92
    v_sub_u32 v94, v94, v93
    v_lshlrev_b32 v94, 7, v94
    v_and_b32 v93, 31, v92
    v_mul_u32_u24 v93, 245760, v93
    v_lshrrev_b32 v92, 5, v92
    v_mul_u32_u24 v92, 40960, v92
    v_add3_u32 v94, v94, v92, v93
    buffer_load_dword v95, v94, s[76:79], 0 offen
I_pf9:
    s_mov_b32 exec_hi, -1
I_claimed:
    s_mov_b32 s72, s68
    s_and_b32 s73, s69, 0xffff
    s_mov_b32 s74, 1966080
    s_mov_b32 s75, 0x20000
    s_mov_b32 s76, s70
    s_and_b32 s77, s71, 0xffff
    s_mov_b32 s78, 1966080
    s_mov_b32 s79, 0x20000
    s_lshl_b32 s30, s60, 2
    s_add_u32 s30, s30, s16
    s_lshl_b32 s30, s30, 13
    v_lshlrev_b32 v14, 7, v1
    s_waitcnt vmcnt(0)
    buffer_load_dword v15, v14, s[72:75], s30 offen
    buffer_load_dword v15, v14, s[76:79], s30 offen
    v_and_b32 v4, 7, v1
    v_lshlrev_b32 v4, 3, v4
    v_add_u32 v4, s63, v4
    s_mov_b32 s35, 0
WI_17:
    global_load_dwordx2 v[6:7], v4, s[48:49] sc1
    s_waitcnt vmcnt(0)
    v_not_b32 v6, v6
    v_xor_b32 v5, 0x2000, v7
    v_or_b32 v6, v6, v5
    v_cmp_ne_u32 vcc, 0, v6
    s_cbranch_vccz WG_18
    v_lshrrev_b32 v7, 8, v7
    s_mov_b32 s30, 0
    v_readlane_b32 s31, v7, 0
    s_add_u32 s30, s30, s31
    v_readlane_b32 s31, v7, 1
    s_add_u32 s30, s30, s31
    v_readlane_b32 s31, v7, 2
    s_add_u32 s30, s30, s31
    v_readlane_b32 s31, v7, 3
    s_add_u32 s30, s30, s31
    v_readlane_b32 s31, v7, 4
    s_add_u32 s30, s30, s31
    v_readlane_b32 s31, v7, 5
    s_add_u32 s30, s30, s31
    v_readlane_b32 s31, v7, 6
    s_add_u32 s30, s30, s31
    v_readlane_b32 s31, v7, 7
    s_add_u32 s30, s30, s31
    s_cmp_ge_u32 s30, 256
    s_cbranch_scc1 M_again
    s_sleep 20
    s_add_u32 s35, s35, 1
    s_cmp_lt_u32 s35, 200000
    s_cbranch_scc1 WI_17
    s_branch M_fail
WG_18:
    v_lshlrev_b32 v4, 2, v1
    s_mov_b32 s34, 54525952
    buffer_load_dword v5, v4, s[4:7], s34 offen sc1
    s_waitcnt vmcnt(0)
    v_and_b32 v4, 2, v5
    v_cmp_eq_u32 vcc, 2, v4
    v_and_b32 v5, 1, v5
    v_cmp_eq_u32 s[20:21], 1, v5
    s_nop 3
    s_and_b32 s20, s20, 0x3ffffff
    s_xor_b32 s21, s20, 0x1555555
    s_bcnt1_i32_b32 s21, s21
    s_cmp_le_u32 s21, 5
    s_cselect_b32 s20, 0x1555555, s20
    s_cmp_ge_u32 s21, 21
    s_cselect_b32 s20, 0x2aaaaaa, s20
    s_and_b32 s21, vcc_lo, 0x1ff
    s_bcnt1_i32_b32 s21, s21
    s_cmp_ge_u32 s21, 5
    s_cselect_b32 s21, 16384, 0
    s_branch M_roles
P_a:
    s_lshl_b32 s17, s17, 2
    s_add_u32 s17, s17, s16
    v_and_b32 v3, 15, v1
    v_lshrrev_b32 v4, 4, v1
    v_lshlrev_b32 v4, 2, v4
    v_sub_u32 v3, v3, v4
    v_cmp_le_i32 s[60:61], 0, v3
    v_cmp_le_i32 s[62:63], 1, v3
    v_cmp_le_i32 s[64:65], 2, v3
    v_cmp_le_i32 s[66:67], 3, v3
    s_mov_b32 s38, 0x3d93cd3a
    s_mov_b32 s39, 0x3fb8aa3b
    v_mov_b32 v5, 0xce6e6b28
    v_and_b32 v6, 0xff, v2
    v_and_b32 v7, 16, v1
    v_lshrrev_b32 v7, 1, v7
    v_add_u32 v6, v6, v7
    v_and_b32 v9, 3, v1
    v_lshlrev_b32 v9, 2, v9
    v_mov_b32 v14, 0
PA_seg:
    s_lshl_b32 s40, s19, 5
    s_add_u32 s40, s40, s17
    s_lshl_b32 s30, s40, 4
    s_add_u32 s30, s30, 54530048
    s_mov_b32 s35, 0
W_19:
    buffer_load_dword v8, v9, s[4:7], s30 offen sc1
    s_waitcnt vmcnt(0)
    v_cmp_gt_u32 vcc, 1, v8
    s_cbranch_vccz G_20
    s_sleep 2
    s_add_u32 s35, s35, 1
    s_cmp_lt_u32 s35, 200000
    s_cbranch_scc1 W_19
    s_branch M_fail
G_20:
    s_mul_i32 s41, s40, 12288
    s_add_u32 s42, s41, 95420416
    s_add_u32 s41, s41, 68157440
    s_mul_i32 s43, s40, 6144
    s_add_u32 s43, s43, 55574528
    buffer_load_dwordx4 v[16:19], v2, s[4:7], s41 offen offset:0 sc1
    buffer_load_dwordx4 v[20:23], v2, s[4:7], s41 offen offset:1024 sc1
    buffer_load_dwordx4 v[24:27], v2, s[4:7], s41 offen offset:2048 sc1
    buffer_load_dwordx4 v[28:31], v2, s[4:7], s41 offen offset:3072 sc1
    s_add_u32 s41, s41, 4096
    buffer_load_dwordx4 v[32:35], v2, s[4:7], s41 offen offset:0 sc1
    buffer_load_dwordx4 v[36:39], v2, s[4:7], s41 offen offset:1024 sc1
    buffer_load_dwordx4 v[40:43], v2, s[4:7], s41 offen offset:2048 sc1
    buffer_load_dwordx4 v[44:47], v2, s[4:7], s41 offen offset:3072 sc1
    s_add_u32 s41, s41, 4096
    buffer_load_dwordx4 v[48:51], v2, s[4:7], s41 offen offset:0 sc1
    buffer_load_dwordx4 v[52:55], v2, s[4:7], s41 offen offset:1024 sc1
    buffer_load_dwordx4 v[56:59], v2, s[4:7], s41 offen offset:2048 sc1
    buffer_load_dwordx4 v[60:63], v2, s[4:7], s41 offen offset:3072 sc1
    s_add_u32 s41, s41, 4096
    buffer_load_dwordx4 v[64:67], v2, s[4:7], s42 offen offset:0 sc1
    buffer_load_dwordx4 v[68:71], v2, s[4:7], s42 offen offset:1024 sc1
    buffer_load_dwordx4 v[72:75], v2, s[4:7], s42 offen offset:2048 sc1
    buffer_load_dwordx4 v[76:79], v2, s[4:7], s42 offen offset:3072 sc1
    s_add_u32 s42, s42, 4096
    buffer_load_dwordx4 v[80:83], v2, s[4:7], s42 offen offset:0 sc1
    buffer_load_dwordx4 v[84:87], v2, s[4:7], s42 offen offset:1024 sc1
    buffer_load_dwordx4 v[88:91], v2, s[4:7], s42 offen offset:2048 sc1
    buffer_load_dwordx4 v[92:95], v2, s[4:7], s42 offen offset:3072 sc1
    s_add_u32 s42, s42, 4096
    buffer_load_dwordx4 v[96:99], v2, s[4:7], s42 offen offset:0 sc1
    buffer_load_dwordx4 v[100:103], v2, s[4:7], s42 offen offset:1024 sc1
    buffer_load_dwordx4 v[104:107], v2, s[4:7], s42 offen offset:2048 sc1
    buffer_load_dwordx4 v[108:111], v2, s[4:7], s42 offen offset:3072 sc1
    s_add_u32 s42, s42, 4096
    s_mul_i32 s44, s19, 81920
    s_add_u32 s44, s44, 210763776
    s_lshl_b32 s45, s17, 10
    s_add_u32 s45, s45, s44
    s_lshl_b32 s46, s17, 8
    s_add_u32 s46, s46, s44
    s_add_u32 s46, s46, 32768
    s_mul_i32 s28, s19, 171
    s_lshr_b32 s28, s28, 9
    s_mul_i32 s76, s28, 3
    s_sub_u32 s76, s19, s76
    s_lshl_b32 s76, s76, 15
    s_add_u32 s28, s28, 4
    s_lshl_b32 s30, s28, 21
    s_add_u32 s30, s30, s76
    s_add_u32 s30, s30, 1966080
    s_lshr_b32 s29, s20, s28
    s_and_b32 s29, s29, 1
    s_lshl_b32 s29, s29, 13
    s_add_u32 s30, s30, s29
    s_mul_i32 s28, s19, 171
    s_lshr_b32 s28, s28, 9
    s_mul_i32 s76, s28, 3
    s_sub_u32 s76, s19, s76
    s_lshl_b32 s76, s76, 15
    s_add_u32 s28, s28, 4
    s_lshl_b32 s47, s28, 21
    s_add_u32 s47, s47, s76
    s_add_u32 s47, s47, 1972224
    s_lshr_b32 s29, s20, s28
    s_and_b32 s29, s29, 1
    s_lshl_b32 s29, s29, 13
    s_add_u32 s47, s47, s29
    s_xor_b32 s47, s47, 8192
    s_lshl_b32 s31, s17, 7
    s_add_u32 s30, s30, s31
    s_add_u32 s47, s47, s31
    s_lshr_b32 s31, s17, 4
    s_mul_i32 s31, s31, 14336
    s_add_u32 s47, s47, s31
    s_waitcnt vmcnt(0)
    v_mfma_f32_16x16x32_bf16 v[136:139], v[64:67], v[16:19], 0
    v_mfma_f32_16x16x32_bf16 v[140:143], v[64:67], v[40:43], 0
    v_mfma_f32_16x16x32_bf16 v[144:147], v[88:91], v[40:43], 0
    v_mfma_f32_16x16x32_bf16 v[136:139], v[68:71], v[20:23], v[136:139]
    v_mfma_f32_16x16x32_bf16 v[140:143], v[68:71], v[44:47], v[140:143]
    v_mfma_f32_16x16x32_bf16 v[144:147], v[92:95], v[44:47], v[144:147]
    v_mfma_f32_16x16x32_bf16 v[136:139], v[72:75], v[24:27], v[136:139]
    v_mfma_f32_16x16x32_bf16 v[140:143], v[72:75], v[48:51], v[140:143]
    v_mfma_f32_16x16x32_bf16 v[144:147], v[96:99], v[48:51], v[144:147]
    v_mfma_f32_16x16x32_bf16 v[136:139], v[76:79], v[28:31], v[136:139]
    v_mfma_f32_16x16x32_bf16 v[140:143], v[76:79], v[52:55], v[140:143]
    v_mfma_f32_16x16x32_bf16 v[144:147], v[100:103], v[52:55], v[144:147]
    v_mfma_f32_16x16x32_bf16 v[136:139], v[80:83], v[32:35], v[136:139]
    v_mfma_f32_16x16x32_bf16 v[140:143], v[80:83], v[56:59], v[140:143]
    v_mfma_f32_16x16x32_bf16 v[144:147], v[104:107], v[56:59], v[144:147]
    v_mfma_f32_16x16x32_bf16 v[136:139], v[84:87], v[36:39], v[136:139]
    v_mfma_f32_16x16x32_bf16 v[140:143], v[84:87], v[60:63], v[140:143]
    v_mfma_f32_16x16x32_bf16 v[144:147], v[108:111], v[60:63], v[144:147]
    s_nop 5
    v_cvt_pk_bf16_f32 v8, v136, v137
    v_lshlrev_b32 v136, 16, v8
    v_and_b32 v137, 0xffff0000, v8
    v_mul_f32 v136, s38, v136
    v_mul_f32 v137, s38, v137
    v_cvt_pk_bf16_f32 v8, v136, v137
    v_lshlrev_b32 v136, 16, v8
    v_and_b32 v137, 0xffff0000, v8
    v_cvt_pk_bf16_f32 v8, v138, v139
    v_lshlrev_b32 v138, 16, v8
    v_and_b32 v139, 0xffff0000, v8
    v_mul_f32 v138, s38, v138
    v_mul_f32 v139, s38, v139
    v_cvt_pk_bf16_f32 v8, v138, v139
    v_lshlrev_b32 v138, 16, v8
    v_and_b32 v139, 0xffff0000, v8
    v_cvt_pk_bf16_f32 v8, v140, v141
    v_lshlrev_b32 v140, 16, v8
    v_and_b32 v141, 0xffff0000, v8
    v_mul_f32 v140, s38, v140
    v_mul_f32 v141, s38, v141
    v_cvt_pk_bf16_f32 v8, v140, v141
    v_lshlrev_b32 v140, 16, v8
    v_and_b32 v141, 0xffff0000, v8
    v_cvt_pk_bf16_f32 v8, v142, v143
    v_lshlrev_b32 v142, 16, v8
    v_and_b32 v143, 0xffff0000, v8
    v_mul_f32 v142, s38, v142
    v_mul_f32 v143, s38, v143
    v_cvt_pk_bf16_f32 v8, v142, v143
    v_lshlrev_b32 v142, 16, v8
    v_and_b32 v143, 0xffff0000, v8
    v_cvt_pk_bf16_f32 v8, v144, v145
    v_lshlrev_b32 v144, 16, v8
    v_and_b32 v145, 0xffff0000, v8
    v_mul_f32 v144, s38, v144
    v_mul_f32 v145, s38, v145
    v_cvt_pk_bf16_f32 v8, v144, v145
    v_lshlrev_b32 v144, 16, v8
    v_and_b32 v145, 0xffff0000, v8
    v_cvt_pk_bf16_f32 v8, v146, v147
    v_lshlrev_b32 v146, 16, v8
    v_and_b32 v147, 0xffff0000, v8
    v_mul_f32 v146, s38, v146
    v_mul_f32 v147, s38, v147
    v_cvt_pk_bf16_f32 v8, v146, v147
    v_lshlrev_b32 v146, 16, v8
    v_and_b32 v147, 0xffff0000, v8
    v_cndmask_b32 v136, v5, v136, s[60:61]
    v_cndmask_b32 v137, v5, v137, s[62:63]
    v_cndmask_b32 v138, v5, v138, s[64:65]
    v_cndmask_b32 v139, v5, v139, s[66:67]
    v_cndmask_b32 v144, v5, v144, s[60:61]
    v_cndmask_b32 v145, v5, v145, s[62:63]
    v_cndmask_b32 v146, v5, v146, s[64:65]
    v_cndmask_b32 v147, v5, v147, s[66:67]
    s_cmp_ge_u32 s19, 60
    s_cselect_b32 s58, 1, 2
PA_km:
    s_mov_b32 s35, 0
W_21:
    buffer_load_dword v8, v14, s[4:7], s30 offen sc1
    s_waitcnt vmcnt(0)
    v_cmp_gt_u32 vcc, s58, v8
    s_cbranch_vccz G_22
    s_sleep 2
    s_add_u32 s35, s35, 1
    s_cmp_lt_u32 s35, 200000
    s_cbranch_scc1 W_21
    s_branch M_fail
G_22:
    s_mov_b32 s41, s43
    buffer_load_dwordx4 v[112:115], v2, s[4:7], s41 offen offset:0 sc1
    buffer_load_dwordx4 v[116:119], v2, s[4:7], s41 offen offset:1024 sc1
    buffer_load_dwordx4 v[120:123], v2, s[4:7], s41 offen offset:2048 sc1
    buffer_load_dwordx4 v[124:127], v2, s[4:7], s41 offen offset:3072 sc1
    s_add_u32 s41, s41, 4096
    buffer_load_dwordx4 v[128:131], v2, s[4:7], s41 offen offset:0 sc1
    buffer_load_dwordx4 v[132:135], v2, s[4:7], s41 offen offset:1024 sc1
    s_waitcnt vmcnt(5)
    v_mfma_f32_16x16x32_bf16 v[148:151], v[112:115], v[16:19], 0
    v_mfma_f32_16x16x32_bf16 v[152:155], v[112:115], v[40:43], 0
    s_waitcnt vmcnt(4)
    v_mfma_f32_16x16x32_bf16 v[148:151], v[116:119], v[20:23], v[148:151]
    v_mfma_f32_16x16x32_bf16 v[152:155], v[116:119], v[44:47], v[152:155]
    s_waitcnt vmcnt(3)
    v_mfma_f32_16x16x32_bf16 v[148:151], v[120:123], v[24:27], v[148:151]
    v_mfma_f32_16x16x32_bf16 v[152:155], v[120:123], v[48:51], v[152:155]
    s_waitcnt vmcnt(2)
    v_mfma_f32_16x16x32_bf16 v[148:151], v[124:127], v[28:31], v[148:151]
    v_mfma_f32_16x16x32_bf16 v[152:155], v[124:127], v[52:55], v[152:155]
    s_waitcnt vmcnt(1)
    v_mfma_f32_16x16x32_bf16 v[148:151], v[128:131], v[32:35], v[148:151]
    v_mfma_f32_16x16x32_bf16 v[152:155], v[128:131], v[56:59], v[152:155]
    s_waitcnt vmcnt(0)
    v_mfma_f32_16x16x32_bf16 v[148:151], v[132:135], v[36:39], v[148:151]
    v_mfma_f32_16x16x32_bf16 v[152:155], v[132:135], v[60:63], v[152:155]
    s_nop 6
    v_add_f32 v8, v148, v149
    v_add_f32 v15, v150, v151
    v_cmp_u_f32 vcc, v8, v15
    s_cbranch_vccz PA_ok
    s_cmp_eq_u32 s58, 2
    s_mov_b32 s58, 2
    s_cbranch_scc0 PA_km
PA_ok:
    v_cvt_pk_bf16_f32 v8, v148, v149
    v_lshlrev_b32 v148, 16, v8
    v_and_b32 v149, 0xffff0000, v8
    v_mul_f32 v148, s38, v148
    v_mul_f32 v149, s38, v149
    v_cvt_pk_bf16_f32 v8, v148, v149
    v_lshlrev_b32 v148, 16, v8
    v_and_b32 v149, 0xffff0000, v8
    v_cvt_pk_bf16_f32 v8, v150, v151
    v_lshlrev_b32 v150, 16, v8
    v_and_b32 v151, 0xffff0000, v8
    v_mul_f32 v150, s38, v150
    v_mul_f32 v151, s38, v151
    v_cvt_pk_bf16_f32 v8, v150, v151
    v_lshlrev_b32 v150, 16, v8
    v_and_b32 v151, 0xffff0000, v8
    v_cvt_pk_bf16_f32 v8, v152, v153
    v_lshlrev_b32 v152, 16, v8
    v_and_b32 v153, 0xffff0000, v8
    v_mul_f32 v152, s38, v152
    v_mul_f32 v153, s38, v153
    v_cvt_pk_bf16_f32 v8, v152, v153
    v_lshlrev_b32 v152, 16, v8
    v_and_b32 v153, 0xffff0000, v8
    v_cvt_pk_bf16_f32 v8, v154, v155
    v_lshlrev_b32 v154, 16, v8
    v_and_b32 v155, 0xffff0000, v8
    v_mul_f32 v154, s38, v154
    v_mul_f32 v155, s38, v155
    v_cvt_pk_bf16_f32 v8, v154, v155
    v_lshlrev_b32 v154, 16, v8
    v_and_b32 v155, 0xffff0000, v8
    v_max3_f32 v10, v136, v137, v138
    v_max3_f32 v10, v10, v139, v148
    v_max3_f32 v10, v10, v149, v150
    v_max_f32 v10, v10, v151
    v_max3_f32 v11, v140, v141, v142
    v_max3_f32 v11, v11, v143, v144
    v_max3_f32 v11, v11, v145, v146
    v_max3_f32 v11, v11, v147, v152
    v_max3_f32 v11, v11, v153, v154
    v_max_f32 v11, v11, v155
    v_mov_b32 v176, v10
    v_mov_b32 v177, v11
    s_nop 0
    v_permlane16_swap_b32 v10, v176
    v_permlane16_swap_b32 v11, v177
    v_max_f32 v10, v10, v176
    v_max_f32 v11, v11, v177
    v_mov_b32 v176, v10
    v_mov_b32 v177, v11
    s_nop 0
    v_permlane32_swap_b32 v10, v176
    v_permlane32_swap_b32 v11, v177
    v_max_f32 v10, v10, v176
    v_max_f32 v11, v11, v177
    v_mul_f32 v10, s39, v10
    v_fma_f32 v136, v136, s39, -v10
    v_fma_f32 v137, v137, s39, -v10
    v_fma_f32 v138, v138, s39, -v10
    v_fma_f32 v139, v139, s39, -v10
    v_fma_f32 v148, v148, s39, -v10
    v_fma_f32 v149, v149, s39, -v10
    v_fma_f32 v150, v150, s39, -v10
    v_fma_f32 v151, v151, s39, -v10
    v_exp_f32 v136, v136
    v_exp_f32 v137, v137
    v_exp_f32 v138, v138
    v_exp_f32 v139, v139
    v_exp_f32 v148, v148
    v_exp_f32 v149, v149
    v_exp_f32 v150, v150
    v_exp_f32 v151, v151
    v_add_f32 v12, v148, v149
    v_add_f32 v176, v150, v151
    v_add_f32 v12, v12, v176
    v_mul_f32 v12, 0.5, v12
    v_add_f32 v12, v12, v136
    v_add_f32 v12, v12, v137
    v_add_f32 v12, v12, v138
    v_add_f32 v12, v12, v139
    v_mul_f32 v11, s39, v11
    v_fma_f32 v140, v140, s39, -v11
    v_fma_f32 v141, v141, s39, -v11
    v_fma_f32 v142, v142, s39, -v11
    v_fma_f32 v143, v143, s39, -v11
    v_fma_f32 v144, v144, s39, -v11
    v_fma_f32 v145, v145, s39, -v11
    v_fma_f32 v146, v146, s39, -v11
    v_fma_f32 v147, v147, s39, -v11
    v_fma_f32 v152, v152, s39, -v11
    v_fma_f32 v153, v153, s39, -v11
    v_fma_f32 v154, v154, s39, -v11
    v_fma_f32 v155, v155, s39, -v11
    v_exp_f32 v140, v140
    v_exp_f32 v141, v141
    v_exp_f32 v142, v142
    v_exp_f32 v143, v143
    v_exp_f32 v144, v144
    v_exp_f32 v145, v145
    v_exp_f32 v146, v146
    v_exp_f32 v147, v147
    v_exp_f32 v152, v152
    v_exp_f32 v153, v153
    v_exp_f32 v154, v154
    v_exp_f32 v155, v155
    v_add_f32 v13, v152, v153
    v_add_f32 v177, v154, v155
    v_add_f32 v13, v13, v177
    v_mul_f32 v13, 0.5, v13
    v_add_f32 v13, v13, v140
    v_add_f32 v13, v13, v141
    v_add_f32 v13, v13, v142
    v_add_f32 v13, v13, v143
    v_add_f32 v13, v13, v144
    v_add_f32 v13, v13, v145
    v_add_f32 v13, v13, v146
    v_add_f32 v13, v13, v147
    v_mov_b32 v176, v12
    v_mov_b32 v177, v13
    s_nop 0
    v_permlane16_swap_b32 v12, v176
    v_permlane16_swap_b32 v13, v177
    v_add_f32 v12, v12, v176
    v_add_f32 v13, v13, v177
    v_mov_b32 v176, v12
    v_mov_b32 v177, v13
    s_nop 0
    v_permlane32_swap_b32 v12, v176
    v_permlane32_swap_b32 v13, v177
    v_add_f32 v12, v12, v176
    v_add_f32 v13, v13, v177
    v_rcp_f32 v12, v12
    s_nop 0
    v_mul_f32 v136, v136, v12
    v_mul_f32 v137, v137, v12
    v_mul_f32 v138, v138, v12
    v_mul_f32 v139, v139, v12
    v_mul_f32 v148, v148, v12
    v_mul_f32 v149, v149, v12
    v_mul_f32 v150, v150, v12
    v_mul_f32 v151, v151, v12
    v_cvt_pk_bf16_f32 v160, v136, v137
    v_cvt_pk_bf16_f32 v161, v138, v139
    v_mov_b32 v162, 0
    v_mov_b32 v163, 0
    v_cvt_pk_bf16_f32 v164, v148, v149
    v_cvt_pk_bf16_f32 v165, v150, v151
    buffer_store_dwordx4 v[160:163], v2, s[4:7], s45 offen sc1
    s_mov_b32 exec_hi, 0
    buffer_store_dwordx2 v[164:165], v6, s[4:7], s46 offen sc1
    s_mov_b32 exec_hi, -1
    s_add_u32 s45, s45, 40960
    s_add_u32 s46, s46, 40960
    v_rcp_f32 v13, v13
    s_nop 0
    v_mul_f32 v140, v140, v13
    v_mul_f32 v141, v141, v13
    v_mul_f32 v142, v142, v13
    v_mul_f32 v143, v143, v13
    v_mul_f32 v144, v144, v13
    v_mul_f32 v145, v145, v13
    v_mul_f32 v146, v146, v13
    v_mul_f32 v147, v147, v13
    v_mul_f32 v152, v152, v13
    v_mul_f32 v153, v153, v13
    v_mul_f32 v154, v154, v13
    v_mul_f32 v155, v155, v13
    v_cvt_pk_bf16_f32 v168, v140, v141
    v_cvt_pk_bf16_f32 v169, v142, v143
    v_cvt_pk_bf16_f32 v170, v144, v145
    v_cvt_pk_bf16_f32 v171, v146, v147
    v_cvt_pk_bf16_f32 v172, v152, v153
    v_cvt_pk_bf16_f32 v173, v154, v155
    buffer_store_dwordx4 v[168:171], v2, s[4:7], s45 offen sc1
    s_mov_b32 exec_hi, 0
    buffer_store_dwordx2 v[172:173], v6, s[4:7], s46 offen sc1
    s_mov_b32 exec_hi, -1
    s_cmp_ge_u32 s19, 60
    s_cselect_b32 s33, s47, 0x7ffffff0
    v_mov_b32 v8, 1
    s_mov_b64 exec, 1
    buffer_store_dword v8, v2, s[4:7], s33 offen sc1
    s_mov_b64 exec, -1
    v_mov_b32 v8, 2
    s_waitcnt vmcnt(0)
    s_mov_b64 exec, 1
    buffer_store_dword v8, v2, s[4:7], s47 offen sc1
    s_mov_b64 exec, -1
    s_add_u32 s19, s19, s18
    s_cmp_lt_u32 s19, s59
    s_cbranch_scc1 PA_seg
    s_endpgm
P_b:
    s_load_dwordx2 s[40:41], s[0:1], 0
    s_load_dwordx2 s[42:43], s[0:1], 64
    s_load_dwordx2 s[44:45], s[0:1], 80
    s_waitcnt lgkmcnt(0)
    s_mov_b32 s8, s40
    s_and_b32 s9, s41, 0xffff
    s_mov_b32 s10, 2621440
    s_mov_b32 s11, 0x20000
    s_lshl_b32 s30, s16, 10
    v_add_u32 v10, s30, v2
    s_lshl_b32 s30, s16, 13
    v_add_u32 v11, s30, v2
    v_and_b32 v5, 48, v1
    v_lshlrev_b32 v5, 4, v5
    v_and_b32 v6, 15, v1
    v_lshlrev_b32 v6, 2, v6
    v_add_u32 v5, v5, v6
    v_and_b32 v6, 15, v1
    v_mul_u32_u24 v6, 1280, v6
    v_lshrrev_b32 v7, 4, v1
    v_lshlrev_b32 v7, 3, v7
    v_add_u32 v6, v6, v7
    v_and_b32 v7, 0xff, v2
    v_lshrrev_b32 v8, 5, v1
    v_lshlrev_b32 v8, 8, v8
    v_add_u32 v7, v7, v8
    v_and_b32 v8, 16, v1
    v_lshrrev_b32 v8, 1, v8
    v_add_u32 v7, v7, v8
    s_lshl_b32 s42, s17, 2
    s_mul_i32 s30, s42, 205
    s_lshr_b32 s30, s30, 11
    s_add_u32 s31, s42, 3
    s_mul_i32 s31, s31, 205
    s_lshr_b32 s31, s31, 11
    s_sub_u32 s31, s31, s30
    s_lshl_b32 s31, s31, 4
    s_lshl_b32 s43, s30, 7
    s_lshl_b32 s30, s16, 5
    s_add_u32 s43, s43, s30
    s_add_u32 s43, s43, 54591488
    v_and_b32 v9, 7, v1
    v_lshlrev_b32 v9, 2, v9
    v_and_b32 v12, 8, v1
    v_mul_u32_u24 v12, s31, v12
    v_add_u32 v12, v12, v9
    v_lshlrev_b32 v9, 5, v9
    s_lshl_b32 s44, s16, 10
    s_lshr_b32 s30, s16, 1
    s_mul_i32 s30, s30, 14336
    s_add_u32 s44, s44, s30
    s_lshl_b32 s45, s42, 15
    s_lshl_b32 s30, s16, 13
    s_add_u32 s45, s45, s30
    s_add_u32 s45, s45, 122683392
    s_lshl_b32 s46, s42, 14
    s_lshl_b32 s30, s16, 11
    s_add_u32 s46, s46, s30
    s_add_u32 s42, s42, s16
    s_mov_b32 s66, 0
    s_lshl_b32 s66, s66, 12
    s_lshl_b32 s67, s66, 1
    s_sub_u32 s67, 4096, s67
    s_sub_u32 s68, 32768, s67
    s_lshl_b32 s47, s16, 13
    s_add_u32 s47, s47, 65536
    v_add_u32 v5, s47, v5
    s_mov_b32 s56, 0x7ffffff0
    s_lshl_b32 s30, s19, 9
    s_add_u32 s30, s30, s43
    s_mov_b32 s35, 0
W_23:
    buffer_load_dword v8, v12, s[4:7], s30 offen sc1
    s_waitcnt vmcnt(0)
    v_cmp_gt_u32 vcc, 1, v8
    s_cbranch_vccz G_24
    s_sleep 2
    s_add_u32 s35, s35, 1
    s_cmp_lt_u32 s35, 200000
    s_cbranch_scc1 W_23
    s_branch M_fail
G_24:
    s_mul_i32 s30, s19, 1310720
    s_add_u32 s30, s30, s45
    s_add_u32 s30, s30, s66
    buffer_load_dwordx4 a[0:3], v2, s[4:7], s30 offen offset:0 sc1
    buffer_load_dwordx4 a[4:7], v2, s[4:7], s30 offen offset:1024 sc1
    buffer_load_dwordx4 a[8:11], v2, s[4:7], s30 offen offset:2048 sc1
    buffer_load_dwordx4 a[12:15], v2, s[4:7], s30 offen offset:3072 sc1
    s_add_u32 s30, s30, s67
    buffer_load_dwordx4 a[16:19], v2, s[4:7], s30 offen offset:0 sc1
    buffer_load_dwordx4 a[20:23], v2, s[4:7], s30 offen offset:1024 sc1
    buffer_load_dwordx4 a[24:27], v2, s[4:7], s30 offen offset:2048 sc1
    buffer_load_dwordx4 a[28:31], v2, s[4:7], s30 offen offset:3072 sc1
    s_add_u32 s30, s30, s68
    buffer_load_dwordx4 a[32:35], v2, s[4:7], s30 offen offset:0 sc1
    buffer_load_dwordx4 a[36:39], v2, s[4:7], s30 offen offset:1024 sc1
    buffer_load_dwordx4 a[40:43], v2, s[4:7], s30 offen offset:2048 sc1
    buffer_load_dwordx4 a[44:47], v2, s[4:7], s30 offen offset:3072 sc1
    s_add_u32 s30, s30, s67
    buffer_load_dwordx4 a[48:51], v2, s[4:7], s30 offen offset:0 sc1
    buffer_load_dwordx4 a[52:55], v2, s[4:7], s30 offen offset:1024 sc1
    buffer_load_dwordx4 a[56:59], v2, s[4:7], s30 offen offset:2048 sc1
    buffer_load_dwordx4 a[60:63], v2, s[4:7], s30 offen offset:3072 sc1
    s_add_u32 s30, s30, s68
    buffer_load_dwordx4 a[64:67], v2, s[4:7], s30 offen offset:0 sc1
    buffer_load_dwordx4 a[68:71], v2, s[4:7], s30 offen offset:1024 sc1
    buffer_load_dwordx4 a[72:75], v2, s[4:7], s30 offen offset:2048 sc1
    buffer_load_dwordx4 a[76:79], v2, s[4:7], s30 offen offset:3072 sc1
    s_add_u32 s30, s30, s67
    buffer_load_dwordx4 a[80:83], v2, s[4:7], s30 offen offset:0 sc1
    buffer_load_dwordx4 a[84:87], v2, s[4:7], s30 offen offset:1024 sc1
    buffer_load_dwordx4 a[88:91], v2, s[4:7], s30 offen offset:2048 sc1
    buffer_load_dwordx4 a[92:95], v2, s[4:7], s30 offen offset:3072 sc1
    s_add_u32 s30, s30, s68
    buffer_load_dwordx4 a[96:99], v2, s[4:7], s30 offen offset:0 sc1
    buffer_load_dwordx4 a[100:103], v2, s[4:7], s30 offen offset:1024 sc1
    buffer_load_dwordx4 a[104:107], v2, s[4:7], s30 offen offset:2048 sc1
    buffer_load_dwordx4 a[108:111], v2, s[4:7], s30 offen offset:3072 sc1
    s_add_u32 s30, s30, s67
    buffer_load_dwordx4 a[112:115], v2, s[4:7], s30 offen offset:0 sc1
    buffer_load_dwordx4 a[116:119], v2, s[4:7], s30 offen offset:1024 sc1
    buffer_load_dwordx4 a[120:123], v2, s[4:7], s30 offen offset:2048 sc1
    buffer_load_dwordx4 a[124:127], v2, s[4:7], s30 offen offset:3072 sc1
    s_add_u32 s30, s30, s68
PB_seg:
    s_cmp_ge_u32 s19, 60
    s_cselect_b32 s58, 1, 2
    s_cmp_eq_u32 s58, 2
    s_cbranch_scc1 PB_n
    s_mov_b32 s30, 236978176
    s_add_u32 s34, s19, 1
    v_mov_b32 v15, 0
    s_mov_b32 s35, 0
W_25:
    buffer_load_dword v8, v15, s[4:7], s30 offen sc1
    s_waitcnt vmcnt(0)
    v_cmp_gt_u32 vcc, s34, v8
    s_cbranch_vccz G_26
    s_sleep 2
    s_add_u32 s35, s35, 1
    s_cmp_lt_u32 s35, 200000
    s_cbranch_scc1 W_25
    s_branch M_fail
G_26:
    s_mul_i32 s30, s19, 40960
    s_lshl_b32 s31, s42, 5
    s_add_u32 s30, s30, s31
    s_add_u32 s31, s30, 20480
    buffer_load_dwordx2 v[24:25], v6, s[8:11], s30 offen
    buffer_load_dwordx2 v[26:27], v6, s[8:11], s31 offen
    s_mul_i32 s28, s19, 171
    s_lshr_b32 s28, s28, 9
    s_mul_i32 s27, s28, 3
    s_sub_u32 s27, s19, s27
    s_mul_i32 s27, s27, 655360
    s_add_u32 s28, s28, 4
    s_lshl_b32 s26, s28, 21
    s_add_u32 s26, s26, s27
    s_lshr_b32 s29, s20, s28
    s_and_b32 s29, s29, 1
    s_lshl_b32 s29, s29, 13
    s_add_u32 s26, s26, s29
    s_add_u32 s26, s26, s46
    s_add_u32 m0, s47, 0
    s_mov_b32 s27, s26
    s_lshr_b32 s29, s27, 5
    s_xor_b32 s29, s29, s21
    s_not_b32 s29, s29
    s_and_b32 s29, s29, 16384
    s_xor_b32 s27, s27, s29
    buffer_load_dwordx4 v2, s[4:7], s27 offen offset:0 sc1 lds
    buffer_load_dwordx4 v2, s[4:7], s27 offen offset:1024 sc1 lds
    s_add_u32 s26, s26, 16384
    s_add_u32 m0, s47, 2048
    s_mov_b32 s27, s26
    s_lshr_b32 s29, s27, 5
    s_xor_b32 s29, s29, s21
    s_not_b32 s29, s29
    s_and_b32 s29, s29, 16384
    s_xor_b32 s27, s27, s29
    buffer_load_dwordx4 v2, s[4:7], s27 offen offset:0 sc1 lds
    buffer_load_dwordx4 v2, s[4:7], s27 offen offset:1024 sc1 lds
    s_add_u32 s26, s26, 16384
    s_add_u32 m0, s47, 4096
    s_mov_b32 s27, s26
    s_lshr_b32 s29, s27, 5
    s_xor_b32 s29, s29, s21
    s_not_b32 s29, s29
    s_and_b32 s29, s29, 16384
    s_xor_b32 s27, s27, s29
    buffer_load_dwordx4 v2, s[4:7], s27 offen offset:0 sc1 lds
    buffer_load_dwordx4 v2, s[4:7], s27 offen offset:1024 sc1 lds
    s_add_u32 s26, s26, 16384
    s_add_u32 m0, s47, 6144
    s_mov_b32 s27, s26
    s_lshr_b32 s29, s27, 5
    s_xor_b32 s29, s29, s21
    s_not_b32 s29, s29
    s_and_b32 s29, s29, 16384
    s_xor_b32 s27, s27, s29
    buffer_load_dwordx4 v2, s[4:7], s27 offen offset:0 sc1 lds
    buffer_load_dwordx4 v2, s[4:7], s27 offen offset:1024 sc1 lds
    s_add_u32 s26, s26, 16384
    s_mov_b32 s35, 0
    s_waitcnt vmcnt(0)
PB_ze:
    v_add_u32 v15, 0, v5
    ds_read2_b32 v[144:145], v15 offset0:0 offset1:16
    ds_read2_b32 v[146:147], v15 offset0:32 offset1:48
    v_add_u32 v15, 1024, v5
    ds_read2_b32 v[148:149], v15 offset0:0 offset1:16
    ds_read2_b32 v[150:151], v15 offset0:32 offset1:48
    v_add_u32 v15, 2048, v5
    ds_read2_b32 v[152:153], v15 offset0:0 offset1:16
    ds_read2_b32 v[154:155], v15 offset0:32 offset1:48
    v_add_u32 v15, 3072, v5
    ds_read2_b32 v[156:157], v15 offset0:0 offset1:16
    ds_read2_b32 v[158:159], v15 offset0:32 offset1:48
    v_add_u32 v15, 4096, v5
    ds_read2_b32 v[160:161], v15 offset0:0 offset1:16
    ds_read2_b32 v[162:163], v15 offset0:32 offset1:48
    v_add_u32 v15, 5120, v5
    ds_read2_b32 v[164:165], v15 offset0:0 offset1:16
    ds_read2_b32 v[166:167], v15 offset0:32 offset1:48
    v_add_u32 v15, 6144, v5
    ds_read2_b32 v[168:169], v15 offset0:0 offset1:16
    ds_read2_b32 v[170:171], v15 offset0:32 offset1:48
    v_add_u32 v15, 7168, v5
    ds_read2_b32 v[172:173], v15 offset0:0 offset1:16
    ds_read2_b32 v[174:175], v15 offset0:32 offset1:48
    s_waitcnt lgkmcnt(0)
    v_max3_u32 v176, v144, v145, v146
    v_max3_u32 v177, v147, v148, v149
    v_max3_u32 v178, v150, v151, v152
    v_max3_u32 v179, v153, v154, v155
    v_max3_u32 v180, v156, v157, v158
    v_max3_u32 v181, v159, v160, v161
    v_max3_u32 v182, v162, v163, v164
    v_max3_u32 v183, v165, v166, v167
    v_max3_u32 v184, v168, v169, v170
    v_max3_u32 v185, v171, v172, v173
    v_max_u32 v186, v174, v175
    v_max3_u32 v187, v176, v177, v178
    v_max3_u32 v188, v179, v180, v181
    v_max3_u32 v189, v182, v183, v184
    v_max_u32 v190, v185, v186
    v_max3_u32 v191, v187, v188, v189
    v_max_u32 v192, v191, v190
    v_cmp_eq_u32 vcc, -1, v192
    s_cbranch_vccz PB_zoke
    s_mul_i32 s28, s19, 171
    s_lshr_b32 s28, s28, 9
    s_mul_i32 s27, s28, 3
    s_sub_u32 s27, s19, s27
    s_mul_i32 s27, s27, 655360
    s_add_u32 s28, s28, 4
    s_lshl_b32 s26, s28, 21
    s_add_u32 s26, s26, s27
    s_lshr_b32 s29, s20, s28
    s_and_b32 s29, s29, 1
    s_lshl_b32 s29, s29, 13
    s_add_u32 s26, s26, s29
    s_add_u32 s26, s26, s46
    s_add_u32 m0, s47, 0
    s_mov_b32 s27, s26
    s_lshr_b32 s29, s27, 5
    s_xor_b32 s29, s29, s21
    s_not_b32 s29, s29
    s_and_b32 s29, s29, 16384
    s_xor_b32 s27, s27, s29
    buffer_load_dwordx4 v2, s[4:7], s27 offen offset:0 sc1 lds
    buffer_load_dwordx4 v2, s[4:7], s27 offen offset:1024 sc1 lds
    s_add_u32 s26, s26, 16384
    s_add_u32 m0, s47, 2048
    s_mov_b32 s27, s26
    s_lshr_b32 s29, s27, 5
    s_xor_b32 s29, s29, s21
    s_not_b32 s29, s29
    s_and_b32 s29, s29, 16384
    s_xor_b32 s27, s27, s29
    buffer_load_dwordx4 v2, s[4:7], s27 offen offset:0 sc1 lds
    buffer_load_dwordx4 v2, s[4:7], s27 offen offset:1024 sc1 lds
    s_add_u32 s26, s26, 16384
    s_add_u32 m0, s47, 4096
    s_mov_b32 s27, s26
    s_lshr_b32 s29, s27, 5
    s_xor_b32 s29, s29, s21
    s_not_b32 s29, s29
    s_and_b32 s29, s29, 16384
    s_xor_b32 s27, s27, s29
    buffer_load_dwordx4 v2, s[4:7], s27 offen offset:0 sc1 lds
    buffer_load_dwordx4 v2, s[4:7], s27 offen offset:1024 sc1 lds
    s_add_u32 s26, s26, 16384
    s_add_u32 m0, s47, 6144
    s_mov_b32 s27, s26
    s_lshr_b32 s29, s27, 5
    s_xor_b32 s29, s29, s21
    s_not_b32 s29, s29
    s_and_b32 s29, s29, 16384
    s_xor_b32 s27, s27, s29
    buffer_load_dwordx4 v2, s[4:7], s27 offen offset:0 sc1 lds
    buffer_load_dwordx4 v2, s[4:7], s27 offen offset:1024 sc1 lds
    s_add_u32 s26, s26, 16384
    s_waitcnt vmcnt(0)
    s_add_u32 s35, s35, 1
    s_cmp_lt_u32 s35, 200000
    s_cbranch_scc1 PB_ze
    s_branch M_fail
PB_zoke:
    s_mul_i32 s28, s19, 171
    s_lshr_b32 s28, s28, 9
    s_mul_i32 s76, s28, 3
    s_sub_u32 s76, s19, s76
    s_lshl_b32 s76, s76, 15
    s_add_u32 s28, s28, 4
    s_lshl_b32 s30, s28, 21
    s_add_u32 s30, s30, s76
    s_add_u32 s30, s30, 1972224
    s_lshr_b32 s29, s20, s28
    s_and_b32 s29, s29, 1
    s_lshl_b32 s29, s29, 13
    s_add_u32 s30, s30, s29
    s_xor_b32 s30, s30, 8192
    s_add_u32 s30, s30, s44
    s_mov_b32 s35, 0
W_27:
    buffer_load_dword v8, v9, s[4:7], s30 offen sc1
    s_waitcnt vmcnt(0)
    v_cmp_gt_u32 vcc, s58, v8
    s_cbranch_vccz G_28
    s_sleep 2
    s_add_u32 s35, s35, 1
    s_cmp_lt_u32 s35, 200000
    s_cbranch_scc1 W_27
    s_branch M_fail
G_28:
    s_mul_i32 s30, s19, 81920
    s_add_u32 s30, s30, 210763776
    s_lshl_b32 s31, s16, 11
    s_add_u32 s32, s30, s31
    s_add_u32 s32, s32, 32768
    s_lshl_b32 s31, s16, 13
    s_add_u32 s30, s30, s31
    s_add_u32 s30, s30, s66
    s_add_u32 s31, s30, 40960
    s_add_u32 s33, s32, 40960
    buffer_load_dwordx4 v[64:67], v2, s[4:7], s30 offen offset:0 sc1
    buffer_load_dwordx4 v[68:71], v2, s[4:7], s31 offen offset:0 sc1
    buffer_load_dwordx4 v[72:75], v2, s[4:7], s30 offen offset:1024 sc1
    buffer_load_dwordx4 v[76:79], v2, s[4:7], s31 offen offset:1024 sc1
    buffer_load_dwordx4 v[80:83], v2, s[4:7], s30 offen offset:2048 sc1
    buffer_load_dwordx4 v[84:87], v2, s[4:7], s31 offen offset:2048 sc1
    buffer_load_dwordx4 v[88:91], v2, s[4:7], s30 offen offset:3072 sc1
    buffer_load_dwordx4 v[92:95], v2, s[4:7], s31 offen offset:3072 sc1
    s_add_u32 s30, s30, s67
    s_add_u32 s31, s31, s67
    buffer_load_dwordx4 v[96:99], v2, s[4:7], s30 offen offset:0 sc1
    buffer_load_dwordx4 v[100:103], v2, s[4:7], s31 offen offset:0 sc1
    buffer_load_dwordx4 v[104:107], v2, s[4:7], s30 offen offset:1024 sc1
    buffer_load_dwordx4 v[108:111], v2, s[4:7], s31 offen offset:1024 sc1
    buffer_load_dwordx4 v[112:115], v2, s[4:7], s30 offen offset:2048 sc1
    buffer_load_dwordx4 v[116:119], v2, s[4:7], s31 offen offset:2048 sc1
    buffer_load_dwordx4 v[120:123], v2, s[4:7], s30 offen offset:3072 sc1
    buffer_load_dwordx4 v[124:127], v2, s[4:7], s31 offen offset:3072 sc1
    buffer_load_dwordx4 v[128:131], v2, s[4:7], s32 offen offset:0 sc1
    buffer_load_dwordx4 v[132:135], v2, s[4:7], s33 offen offset:0 sc1
    buffer_load_dwordx4 v[136:139], v2, s[4:7], s32 offen offset:1024 sc1
    buffer_load_dwordx4 v[140:143], v2, s[4:7], s33 offen offset:1024 sc1
    s_waitcnt vmcnt(18)
    v_mfma_f32_16x16x32_bf16 v[32:35], a[0:3], v[64:67], 0
    v_mfma_f32_16x16x32_bf16 v[36:39], a[0:3], v[68:71], 0
    v_mfma_f32_16x16x32_bf16 v[40:43], a[32:35], v[64:67], 0
    v_mfma_f32_16x16x32_bf16 v[44:47], a[32:35], v[68:71], 0
    v_mfma_f32_16x16x32_bf16 v[48:51], a[64:67], v[64:67], 0
    v_mfma_f32_16x16x32_bf16 v[52:55], a[64:67], v[68:71], 0
    v_mfma_f32_16x16x32_bf16 v[56:59], a[96:99], v[64:67], 0
    v_mfma_f32_16x16x32_bf16 v[60:63], a[96:99], v[68:71], 0
    s_waitcnt vmcnt(16)
    v_mfma_f32_16x16x32_bf16 v[32:35], a[4:7], v[72:75], v[32:35]
    v_mfma_f32_16x16x32_bf16 v[36:39], a[4:7], v[76:79], v[36:39]
    v_mfma_f32_16x16x32_bf16 v[40:43], a[36:39], v[72:75], v[40:43]
    v_mfma_f32_16x16x32_bf16 v[44:47], a[36:39], v[76:79], v[44:47]
    v_mfma_f32_16x16x32_bf16 v[48:51], a[68:71], v[72:75], v[48:51]
    v_mfma_f32_16x16x32_bf16 v[52:55], a[68:71], v[76:79], v[52:55]
    v_mfma_f32_16x16x32_bf16 v[56:59], a[100:103], v[72:75], v[56:59]
    v_mfma_f32_16x16x32_bf16 v[60:63], a[100:103], v[76:79], v[60:63]
    s_waitcnt vmcnt(14)
    v_mfma_f32_16x16x32_bf16 v[32:35], a[8:11], v[80:83], v[32:35]
    v_mfma_f32_16x16x32_bf16 v[36:39], a[8:11], v[84:87], v[36:39]
    v_mfma_f32_16x16x32_bf16 v[40:43], a[40:43], v[80:83], v[40:43]
    v_mfma_f32_16x16x32_bf16 v[44:47], a[40:43], v[84:87], v[44:47]
    v_mfma_f32_16x16x32_bf16 v[48:51], a[72:75], v[80:83], v[48:51]
    v_mfma_f32_16x16x32_bf16 v[52:55], a[72:75], v[84:87], v[52:55]
    v_mfma_f32_16x16x32_bf16 v[56:59], a[104:107], v[80:83], v[56:59]
    v_mfma_f32_16x16x32_bf16 v[60:63], a[104:107], v[84:87], v[60:63]
    s_waitcnt vmcnt(12)
    v_mfma_f32_16x16x32_bf16 v[32:35], a[12:15], v[88:91], v[32:35]
    v_mfma_f32_16x16x32_bf16 v[36:39], a[12:15], v[92:95], v[36:39]
    v_mfma_f32_16x16x32_bf16 v[40:43], a[44:47], v[88:91], v[40:43]
    v_mfma_f32_16x16x32_bf16 v[44:47], a[44:47], v[92:95], v[44:47]
    v_mfma_f32_16x16x32_bf16 v[48:51], a[76:79], v[88:91], v[48:51]
    v_mfma_f32_16x16x32_bf16 v[52:55], a[76:79], v[92:95], v[52:55]
    v_mfma_f32_16x16x32_bf16 v[56:59], a[108:111], v[88:91], v[56:59]
    v_mfma_f32_16x16x32_bf16 v[60:63], a[108:111], v[92:95], v[60:63]
    s_waitcnt vmcnt(10)
    v_mfma_f32_16x16x32_bf16 v[32:35], a[16:19], v[96:99], v[32:35]
    v_mfma_f32_16x16x32_bf16 v[36:39], a[16:19], v[100:103], v[36:39]
    v_mfma_f32_16x16x32_bf16 v[40:43], a[48:51], v[96:99], v[40:43]
    v_mfma_f32_16x16x32_bf16 v[44:47], a[48:51], v[100:103], v[44:47]
    v_mfma_f32_16x16x32_bf16 v[48:51], a[80:83], v[96:99], v[48:51]
    v_mfma_f32_16x16x32_bf16 v[52:55], a[80:83], v[100:103], v[52:55]
    v_mfma_f32_16x16x32_bf16 v[56:59], a[112:115], v[96:99], v[56:59]
    v_mfma_f32_16x16x32_bf16 v[60:63], a[112:115], v[100:103], v[60:63]
    s_waitcnt vmcnt(8)
    v_mfma_f32_16x16x32_bf16 v[32:35], a[20:23], v[104:107], v[32:35]
    v_mfma_f32_16x16x32_bf16 v[36:39], a[20:23], v[108:111], v[36:39]
    v_mfma_f32_16x16x32_bf16 v[40:43], a[52:55], v[104:107], v[40:43]
    v_mfma_f32_16x16x32_bf16 v[44:47], a[52:55], v[108:111], v[44:47]
    v_mfma_f32_16x16x32_bf16 v[48:51], a[84:87], v[104:107], v[48:51]
    v_mfma_f32_16x16x32_bf16 v[52:55], a[84:87], v[108:111], v[52:55]
    v_mfma_f32_16x16x32_bf16 v[56:59], a[116:119], v[104:107], v[56:59]
    v_mfma_f32_16x16x32_bf16 v[60:63], a[116:119], v[108:111], v[60:63]
    s_waitcnt vmcnt(6)
    v_mfma_f32_16x16x32_bf16 v[32:35], a[24:27], v[112:115], v[32:35]
    v_mfma_f32_16x16x32_bf16 v[36:39], a[24:27], v[116:119], v[36:39]
    v_mfma_f32_16x16x32_bf16 v[40:43], a[56:59], v[112:115], v[40:43]
    v_mfma_f32_16x16x32_bf16 v[44:47], a[56:59], v[116:119], v[44:47]
    v_mfma_f32_16x16x32_bf16 v[48:51], a[88:91], v[112:115], v[48:51]
    v_mfma_f32_16x16x32_bf16 v[52:55], a[88:91], v[116:119], v[52:55]
    v_mfma_f32_16x16x32_bf16 v[56:59], a[120:123], v[112:115], v[56:59]
    v_mfma_f32_16x16x32_bf16 v[60:63], a[120:123], v[116:119], v[60:63]
    s_waitcnt vmcnt(4)
    v_mfma_f32_16x16x32_bf16 v[32:35], a[28:31], v[120:123], v[32:35]
    v_mfma_f32_16x16x32_bf16 v[36:39], a[28:31], v[124:127], v[36:39]
    v_mfma_f32_16x16x32_bf16 v[40:43], a[60:63], v[120:123], v[40:43]
    v_mfma_f32_16x16x32_bf16 v[44:47], a[60:63], v[124:127], v[44:47]
    v_mfma_f32_16x16x32_bf16 v[48:51], a[92:95], v[120:123], v[48:51]
    v_mfma_f32_16x16x32_bf16 v[52:55], a[92:95], v[124:127], v[52:55]
    v_mfma_f32_16x16x32_bf16 v[56:59], a[124:127], v[120:123], v[56:59]
    v_mfma_f32_16x16x32_bf16 v[60:63], a[124:127], v[124:127], v[60:63]
    s_add_u32 s34, s19, s18
    v_mov_b32 v13, 0
    s_mov_b32 s77, 0
    s_waitcnt vmcnt(0)
    s_branch PB_m
PB_n:
    s_mul_i32 s28, s19, 171
    s_lshr_b32 s28, s28, 9
    s_mul_i32 s76, s28, 3
    s_sub_u32 s76, s19, s76
    s_lshl_b32 s76, s76, 15
    s_add_u32 s28, s28, 4
    s_lshl_b32 s30, s28, 21
    s_add_u32 s30, s30, s76
    s_add_u32 s30, s30, 1972224
    s_lshr_b32 s29, s20, s28
    s_and_b32 s29, s29, 1
    s_lshl_b32 s29, s29, 13
    s_add_u32 s30, s30, s29
    s_xor_b32 s30, s30, 8192
    s_add_u32 s30, s30, s44
    s_mov_b32 s35, 0
W_29:
    buffer_load_dword v8, v9, s[4:7], s30 offen sc1
    s_waitcnt vmcnt(0)
    v_cmp_gt_u32 vcc, s58, v8
    s_cbranch_vccz G_30
    s_sleep 2
    s_add_u32 s35, s35, 1
    s_cmp_lt_u32 s35, 200000
    s_cbranch_scc1 W_29
    s_branch M_fail
G_30:
    s_mul_i32 s30, s19, 81920
    s_add_u32 s30, s30, 210763776
    s_lshl_b32 s31, s16, 11
    s_add_u32 s32, s30, s31
    s_add_u32 s32, s32, 32768
    s_lshl_b32 s31, s16, 13
    s_add_u32 s30, s30, s31
    s_add_u32 s30, s30, s66
    s_add_u32 s31, s30, 40960
    s_add_u32 s33, s32, 40960
    buffer_load_dwordx4 v[64:67], v2, s[4:7], s30 offen offset:0 sc1
    buffer_load_dwordx4 v[68:71], v2, s[4:7], s31 offen offset:0 sc1
    buffer_load_dwordx4 v[72:75], v2, s[4:7], s30 offen offset:1024 sc1
    buffer_load_dwordx4 v[76:79], v2, s[4:7], s31 offen offset:1024 sc1
    buffer_load_dwordx4 v[80:83], v2, s[4:7], s30 offen offset:2048 sc1
    buffer_load_dwordx4 v[84:87], v2, s[4:7], s31 offen offset:2048 sc1
    buffer_load_dwordx4 v[88:91], v2, s[4:7], s30 offen offset:3072 sc1
    buffer_load_dwordx4 v[92:95], v2, s[4:7], s31 offen offset:3072 sc1
    s_add_u32 s30, s30, s67
    s_add_u32 s31, s31, s67
    buffer_load_dwordx4 v[96:99], v2, s[4:7], s30 offen offset:0 sc1
    buffer_load_dwordx4 v[100:103], v2, s[4:7], s31 offen offset:0 sc1
    buffer_load_dwordx4 v[104:107], v2, s[4:7], s30 offen offset:1024 sc1
    buffer_load_dwordx4 v[108:111], v2, s[4:7], s31 offen offset:1024 sc1
    buffer_load_dwordx4 v[112:115], v2, s[4:7], s30 offen offset:2048 sc1
    buffer_load_dwordx4 v[116:119], v2, s[4:7], s31 offen offset:2048 sc1
    buffer_load_dwordx4 v[120:123], v2, s[4:7], s30 offen offset:3072 sc1
    buffer_load_dwordx4 v[124:127], v2, s[4:7], s31 offen offset:3072 sc1
    buffer_load_dwordx4 v[128:131], v2, s[4:7], s32 offen offset:0 sc1
    buffer_load_dwordx4 v[132:135], v2, s[4:7], s33 offen offset:0 sc1
    buffer_load_dwordx4 v[136:139], v2, s[4:7], s32 offen offset:1024 sc1
    buffer_load_dwordx4 v[140:143], v2, s[4:7], s33 offen offset:1024 sc1
    s_mul_i32 s30, s19, 40960
    s_lshl_b32 s31, s42, 5
    s_add_u32 s30, s30, s31
    s_add_u32 s31, s30, 20480
    buffer_load_dwordx2 v[24:25], v6, s[8:11], s30 offen
    buffer_load_dwordx2 v[26:27], v6, s[8:11], s31 offen
    s_mul_i32 s28, s19, 171
    s_lshr_b32 s28, s28, 9
    s_mul_i32 s27, s28, 3
    s_sub_u32 s27, s19, s27
    s_mul_i32 s27, s27, 655360
    s_add_u32 s28, s28, 4
    s_lshl_b32 s26, s28, 21
    s_add_u32 s26, s26, s27
    s_lshr_b32 s29, s20, s28
    s_and_b32 s29, s29, 1
    s_lshl_b32 s29, s29, 13
    s_add_u32 s26, s26, s29
    s_add_u32 s26, s26, s46
    s_add_u32 m0, s47, 0
    s_mov_b32 s27, s26
    s_lshr_b32 s29, s27, 5
    s_xor_b32 s29, s29, s21
    s_not_b32 s29, s29
    s_and_b32 s29, s29, 16384
    s_xor_b32 s27, s27, s29
    buffer_load_dwordx4 v2, s[4:7], s27 offen offset:0 sc1 lds
    buffer_load_dwordx4 v2, s[4:7], s27 offen offset:1024 sc1 lds
    s_add_u32 s26, s26, 16384
    s_add_u32 m0, s47, 2048
    s_mov_b32 s27, s26
    s_lshr_b32 s29, s27, 5
    s_xor_b32 s29, s29, s21
    s_not_b32 s29, s29
    s_and_b32 s29, s29, 16384
    s_xor_b32 s27, s27, s29
    buffer_load_dwordx4 v2, s[4:7], s27 offen offset:0 sc1 lds
    buffer_load_dwordx4 v2, s[4:7], s27 offen offset:1024 sc1 lds
    s_add_u32 s26, s26, 16384
    s_add_u32 m0, s47, 4096
    s_mov_b32 s27, s26
    s_lshr_b32 s29, s27, 5
    s_xor_b32 s29, s29, s21
    s_not_b32 s29, s29
    s_and_b32 s29, s29, 16384
    s_xor_b32 s27, s27, s29
    buffer_load_dwordx4 v2, s[4:7], s27 offen offset:0 sc1 lds
    buffer_load_dwordx4 v2, s[4:7], s27 offen offset:1024 sc1 lds
    s_add_u32 s26, s26, 16384
    s_add_u32 m0, s47, 6144
    s_mov_b32 s27, s26
    s_lshr_b32 s29, s27, 5
    s_xor_b32 s29, s29, s21
    s_not_b32 s29, s29
    s_and_b32 s29, s29, 16384
    s_xor_b32 s27, s27, s29
    buffer_load_dwordx4 v2, s[4:7], s27 offen offset:0 sc1 lds
    buffer_load_dwordx4 v2, s[4:7], s27 offen offset:1024 sc1 lds
    s_add_u32 s26, s26, 16384
PB_have:
    s_add_u32 s34, s19, s18
    s_waitcnt vmcnt(28)
    v_mfma_f32_16x16x32_bf16 v[32:35], a[0:3], v[64:67], 0
    v_mfma_f32_16x16x32_bf16 v[36:39], a[0:3], v[68:71], 0
    v_mfma_f32_16x16x32_bf16 v[40:43], a[32:35], v[64:67], 0
    v_mfma_f32_16x16x32_bf16 v[44:47], a[32:35], v[68:71], 0
    v_mfma_f32_16x16x32_bf16 v[48:51], a[64:67], v[64:67], 0
    v_mfma_f32_16x16x32_bf16 v[52:55], a[64:67], v[68:71], 0
    v_mfma_f32_16x16x32_bf16 v[56:59], a[96:99], v[64:67], 0
    v_mfma_f32_16x16x32_bf16 v[60:63], a[96:99], v[68:71], 0
    s_min_u32 s33, s34, 63
    s_lshl_b32 s30, s33, 9
    s_add_u32 s30, s30, s43
    buffer_load_dword v13, v12, s[4:7], s30 offen sc1
    s_mul_i32 s28, s33, 171
    s_lshr_b32 s28, s28, 9
    s_mul_i32 s76, s28, 3
    s_sub_u32 s76, s33, s76
    s_lshl_b32 s76, s76, 15
    s_add_u32 s28, s28, 4
    s_lshl_b32 s30, s28, 21
    s_add_u32 s30, s30, s76
    s_add_u32 s30, s30, 1972224
    s_lshr_b32 s29, s20, s28
    s_and_b32 s29, s29, 1
    s_lshl_b32 s29, s29, 13
    s_add_u32 s30, s30, s29
    s_xor_b32 s30, s30, 8192
    s_add_u32 s30, s30, s44
    buffer_load_dword v14, v9, s[4:7], s30 offen sc1
    s_waitcnt vmcnt(28)
    v_mfma_f32_16x16x32_bf16 v[32:35], a[4:7], v[72:75], v[32:35]
    v_mfma_f32_16x16x32_bf16 v[36:39], a[4:7], v[76:79], v[36:39]
    v_mfma_f32_16x16x32_bf16 v[40:43], a[36:39], v[72:75], v[40:43]
    v_mfma_f32_16x16x32_bf16 v[44:47], a[36:39], v[76:79], v[44:47]
    v_mfma_f32_16x16x32_bf16 v[48:51], a[68:71], v[72:75], v[48:51]
    v_mfma_f32_16x16x32_bf16 v[52:55], a[68:71], v[76:79], v[52:55]
    v_mfma_f32_16x16x32_bf16 v[56:59], a[100:103], v[72:75], v[56:59]
    v_mfma_f32_16x16x32_bf16 v[60:63], a[100:103], v[76:79], v[60:63]
    s_waitcnt vmcnt(26)
    v_mfma_f32_16x16x32_bf16 v[32:35], a[8:11], v[80:83], v[32:35]
    v_mfma_f32_16x16x32_bf16 v[36:39], a[8:11], v[84:87], v[36:39]
    v_mfma_f32_16x16x32_bf16 v[40:43], a[40:43], v[80:83], v[40:43]
    v_mfma_f32_16x16x32_bf16 v[44:47], a[40:43], v[84:87], v[44:47]
    v_mfma_f32_16x16x32_bf16 v[48:51], a[72:75], v[80:83], v[48:51]
    v_mfma_f32_16x16x32_bf16 v[52:55], a[72:75], v[84:87], v[52:55]
    v_mfma_f32_16x16x32_bf16 v[56:59], a[104:107], v[80:83], v[56:59]
    v_mfma_f32_16x16x32_bf16 v[60:63], a[104:107], v[84:87], v[60:63]
    s_waitcnt vmcnt(24)
    v_mfma_f32_16x16x32_bf16 v[32:35], a[12:15], v[88:91], v[32:35]
    v_mfma_f32_16x16x32_bf16 v[36:39], a[12:15], v[92:95], v[36:39]
    v_mfma_f32_16x16x32_bf16 v[40:43], a[44:47], v[88:91], v[40:43]
    v_mfma_f32_16x16x32_bf16 v[44:47], a[44:47], v[92:95], v[44:47]
    v_mfma_f32_16x16x32_bf16 v[48:51], a[76:79], v[88:91], v[48:51]
    v_mfma_f32_16x16x32_bf16 v[52:55], a[76:79], v[92:95], v[52:55]
    v_mfma_f32_16x16x32_bf16 v[56:59], a[108:111], v[88:91], v[56:59]
    v_mfma_f32_16x16x32_bf16 v[60:63], a[108:111], v[92:95], v[60:63]
    s_waitcnt vmcnt(22)
    v_mfma_f32_16x16x32_bf16 v[32:35], a[16:19], v[96:99], v[32:35]
    v_mfma_f32_16x16x32_bf16 v[36:39], a[16:19], v[100:103], v[36:39]
    v_mfma_f32_16x16x32_bf16 v[40:43], a[48:51], v[96:99], v[40:43]
    v_mfma_f32_16x16x32_bf16 v[44:47], a[48:51], v[100:103], v[44:47]
    v_mfma_f32_16x16x32_bf16 v[48:51], a[80:83], v[96:99], v[48:51]
    v_mfma_f32_16x16x32_bf16 v[52:55], a[80:83], v[100:103], v[52:55]
    v_mfma_f32_16x16x32_bf16 v[56:59], a[112:115], v[96:99], v[56:59]
    v_mfma_f32_16x16x32_bf16 v[60:63], a[112:115], v[100:103], v[60:63]
    s_waitcnt vmcnt(20)
    v_mfma_f32_16x16x32_bf16 v[32:35], a[20:23], v[104:107], v[32:35]
    v_mfma_f32_16x16x32_bf16 v[36:39], a[20:23], v[108:111], v[36:39]
    v_mfma_f32_16x16x32_bf16 v[40:43], a[52:55], v[104:107], v[40:43]
    v_mfma_f32_16x16x32_bf16 v[44:47], a[52:55], v[108:111], v[44:47]
    v_mfma_f32_16x16x32_bf16 v[48:51], a[84:87], v[104:107], v[48:51]
    v_mfma_f32_16x16x32_bf16 v[52:55], a[84:87], v[108:111], v[52:55]
    v_mfma_f32_16x16x32_bf16 v[56:59], a[116:119], v[104:107], v[56:59]
    v_mfma_f32_16x16x32_bf16 v[60:63], a[116:119], v[108:111], v[60:63]
    s_waitcnt vmcnt(18)
    v_mfma_f32_16x16x32_bf16 v[32:35], a[24:27], v[112:115], v[32:35]
    v_mfma_f32_16x16x32_bf16 v[36:39], a[24:27], v[116:119], v[36:39]
    v_mfma_f32_16x16x32_bf16 v[40:43], a[56:59], v[112:115], v[40:43]
    v_mfma_f32_16x16x32_bf16 v[44:47], a[56:59], v[116:119], v[44:47]
    v_mfma_f32_16x16x32_bf16 v[48:51], a[88:91], v[112:115], v[48:51]
    v_mfma_f32_16x16x32_bf16 v[52:55], a[88:91], v[116:119], v[52:55]
    v_mfma_f32_16x16x32_bf16 v[56:59], a[120:123], v[112:115], v[56:59]
    v_mfma_f32_16x16x32_bf16 v[60:63], a[120:123], v[116:119], v[60:63]
    s_waitcnt vmcnt(16)
    v_mfma_f32_16x16x32_bf16 v[32:35], a[28:31], v[120:123], v[32:35]
    v_mfma_f32_16x16x32_bf16 v[36:39], a[28:31], v[124:127], v[36:39]
    v_mfma_f32_16x16x32_bf16 v[40:43], a[60:63], v[120:123], v[40:43]
    v_mfma_f32_16x16x32_bf16 v[44:47], a[60:63], v[124:127], v[44:47]
    v_mfma_f32_16x16x32_bf16 v[48:51], a[92:95], v[120:123], v[48:51]
    v_mfma_f32_16x16x32_bf16 v[52:55], a[92:95], v[124:127], v[52:55]
    v_mfma_f32_16x16x32_bf16 v[56:59], a[124:127], v[120:123], v[56:59]
    v_mfma_f32_16x16x32_bf16 v[60:63], a[124:127], v[124:127], v[60:63]
    s_waitcnt vmcnt(0)
    v_cmp_eq_u32 vcc, 0, v13
    v_cmp_gt_u32 s[30:31], 2, v14
    v_mov_b32 v8, 2
    s_mov_b64 exec, 1
    buffer_store_dword v8, v2, s[4:7], s56 offen sc1
    s_mov_b64 exec, -1
    s_mov_b32 s56, 0x7ffffff0
    s_or_b64 s[30:31], s[30:31], vcc
    s_cselect_b32 s77, 0, 1
    s_cmp_lt_u32 s34, s59
    s_cselect_b32 s77, s77, 0
    s_cmp_eq_u32 s77, 0
    s_cbranch_scc1 PB_nu
    s_mul_i32 s30, s34, 1310720
    s_add_u32 s30, s30, s45
    s_add_u32 s30, s30, s66
    buffer_load_dwordx4 a[0:3], v2, s[4:7], s30 offen offset:0 sc1
    buffer_load_dwordx4 a[4:7], v2, s[4:7], s30 offen offset:1024 sc1
    buffer_load_dwordx4 a[8:11], v2, s[4:7], s30 offen offset:2048 sc1
    buffer_load_dwordx4 a[12:15], v2, s[4:7], s30 offen offset:3072 sc1
    s_add_u32 s30, s30, s67
    buffer_load_dwordx4 a[16:19], v2, s[4:7], s30 offen offset:0 sc1
    buffer_load_dwordx4 a[20:23], v2, s[4:7], s30 offen offset:1024 sc1
    buffer_load_dwordx4 a[24:27], v2, s[4:7], s30 offen offset:2048 sc1
    buffer_load_dwordx4 a[28:31], v2, s[4:7], s30 offen offset:3072 sc1
    s_add_u32 s30, s30, s68
    buffer_load_dwordx4 a[32:35], v2, s[4:7], s30 offen offset:0 sc1
    buffer_load_dwordx4 a[36:39], v2, s[4:7], s30 offen offset:1024 sc1
    buffer_load_dwordx4 a[40:43], v2, s[4:7], s30 offen offset:2048 sc1
    buffer_load_dwordx4 a[44:47], v2, s[4:7], s30 offen offset:3072 sc1
    s_add_u32 s30, s30, s67
    buffer_load_dwordx4 a[48:51], v2, s[4:7], s30 offen offset:0 sc1
    buffer_load_dwordx4 a[52:55], v2, s[4:7], s30 offen offset:1024 sc1
    buffer_load_dwordx4 a[56:59], v2, s[4:7], s30 offen offset:2048 sc1
    buffer_load_dwordx4 a[60:63], v2, s[4:7], s30 offen offset:3072 sc1
    s_add_u32 s30, s30, s68
    buffer_load_dwordx4 a[64:67], v2, s[4:7], s30 offen offset:0 sc1
    buffer_load_dwordx4 a[68:71], v2, s[4:7], s30 offen offset:1024 sc1
    buffer_load_dwordx4 a[72:75], v2, s[4:7], s30 offen offset:2048 sc1
    buffer_load_dwordx4 a[76:79], v2, s[4:7], s30 offen offset:3072 sc1
    s_add_u32 s30, s30, s67
    buffer_load_dwordx4 a[80:83], v2, s[4:7], s30 offen offset:0 sc1
    buffer_load_dwordx4 a[84:87], v2, s[4:7], s30 offen offset:1024 sc1
    buffer_load_dwordx4 a[88:91], v2, s[4:7], s30 offen offset:2048 sc1
    buffer_load_dwordx4 a[92:95], v2, s[4:7], s30 offen offset:3072 sc1
    s_add_u32 s30, s30, s68
    buffer_load_dwordx4 a[96:99], v2, s[4:7], s30 offen offset:0 sc1
    buffer_load_dwordx4 a[100:103], v2, s[4:7], s30 offen offset:1024 sc1
    buffer_load_dwordx4 a[104:107], v2, s[4:7], s30 offen offset:2048 sc1
    buffer_load_dwordx4 a[108:111], v2, s[4:7], s30 offen offset:3072 sc1
    s_add_u32 s30, s30, s67
    buffer_load_dwordx4 a[112:115], v2, s[4:7], s30 offen offset:0 sc1
    buffer_load_dwordx4 a[116:119], v2, s[4:7], s30 offen offset:1024 sc1
    buffer_load_dwordx4 a[120:123], v2, s[4:7], s30 offen offset:2048 sc1
    buffer_load_dwordx4 a[124:127], v2, s[4:7], s30 offen offset:3072 sc1
    s_add_u32 s30, s30, s68
PB_nu:
    s_mov_b32 s35, 0
    s_waitcnt vmcnt(63)
PB_zn:
    v_add_u32 v15, 0, v5
    ds_read2_b32 v[144:145], v15 offset0:0 offset1:16
    ds_read2_b32 v[146:147], v15 offset0:32 offset1:48
    v_add_u32 v15, 1024, v5
    ds_read2_b32 v[148:149], v15 offset0:0 offset1:16
    ds_read2_b32 v[150:151], v15 offset0:32 offset1:48
    v_add_u32 v15, 2048, v5
    ds_read2_b32 v[152:153], v15 offset0:0 offset1:16
    ds_read2_b32 v[154:155], v15 offset0:32 offset1:48
    v_add_u32 v15, 3072, v5
    ds_read2_b32 v[156:157], v15 offset0:0 offset1:16
    ds_read2_b32 v[158:159], v15 offset0:32 offset1:48
    v_add_u32 v15, 4096, v5
    ds_read2_b32 v[160:161], v15 offset0:0 offset1:16
    ds_read2_b32 v[162:163], v15 offset0:32 offset1:48
    v_add_u32 v15, 5120, v5
    ds_read2_b32 v[164:165], v15 offset0:0 offset1:16
    ds_read2_b32 v[166:167], v15 offset0:32 offset1:48
    v_add_u32 v15, 6144, v5
    ds_read2_b32 v[168:169], v15 offset0:0 offset1:16
    ds_read2_b32 v[170:171], v15 offset0:32 offset1:48
    v_add_u32 v15, 7168, v5
    ds_read2_b32 v[172:173], v15 offset0:0 offset1:16
    ds_read2_b32 v[174:175], v15 offset0:32 offset1:48
    s_waitcnt lgkmcnt(0)
    v_max3_u32 v176, v144, v145, v146
    v_max3_u32 v177, v147, v148, v149
    v_max3_u32 v178, v150, v151, v152
    v_max3_u32 v179, v153, v154, v155
    v_max3_u32 v180, v156, v157, v158
    v_max3_u32 v181, v159, v160, v161
    v_max3_u32 v182, v162, v163, v164
    v_max3_u32 v183, v165, v166, v167
    v_max3_u32 v184, v168, v169, v170
    v_max3_u32 v185, v171, v172, v173
    v_max_u32 v186, v174, v175
    v_max3_u32 v187, v176, v177, v178
    v_max3_u32 v188, v179, v180, v181
    v_max3_u32 v189, v182, v183, v184
    v_max_u32 v190, v185, v186
    v_max3_u32 v191, v187, v188, v189
    v_max_u32 v192, v191, v190
    v_cmp_eq_u32 vcc, -1, v192
    s_cbranch_vccz PB_zokn
    s_mul_i32 s28, s19, 171
    s_lshr_b32 s28, s28, 9
    s_mul_i32 s27, s28, 3
    s_sub_u32 s27, s19, s27
    s_mul_i32 s27, s27, 655360
    s_add_u32 s28, s28, 4
    s_lshl_b32 s26, s28, 21
    s_add_u32 s26, s26, s27
    s_lshr_b32 s29, s20, s28
    s_and_b32 s29, s29, 1
    s_lshl_b32 s29, s29, 13
    s_add_u32 s26, s26, s29
    s_add_u32 s26, s26, s46
    s_add_u32 m0, s47, 0
    s_mov_b32 s27, s26
    s_lshr_b32 s29, s27, 5
    s_xor_b32 s29, s29, s21
    s_not_b32 s29, s29
    s_and_b32 s29, s29, 16384
    s_xor_b32 s27, s27, s29
    buffer_load_dwordx4 v2, s[4:7], s27 offen offset:0 sc1 lds
    buffer_load_dwordx4 v2, s[4:7], s27 offen offset:1024 sc1 lds
    s_add_u32 s26, s26, 16384
    s_add_u32 m0, s47, 2048
    s_mov_b32 s27, s26
    s_lshr_b32 s29, s27, 5
    s_xor_b32 s29, s29, s21
    s_not_b32 s29, s29
    s_and_b32 s29, s29, 16384
    s_xor_b32 s27, s27, s29
    buffer_load_dwordx4 v2, s[4:7], s27 offen offset:0 sc1 lds
    buffer_load_dwordx4 v2, s[4:7], s27 offen offset:1024 sc1 lds
    s_add_u32 s26, s26, 16384
    s_add_u32 m0, s47, 4096
    s_mov_b32 s27, s26
    s_lshr_b32 s29, s27, 5
    s_xor_b32 s29, s29, s21
    s_not_b32 s29, s29
    s_and_b32 s29, s29, 16384
    s_xor_b32 s27, s27, s29
    buffer_load_dwordx4 v2, s[4:7], s27 offen offset:0 sc1 lds
    buffer_load_dwordx4 v2, s[4:7], s27 offen offset:1024 sc1 lds
    s_add_u32 s26, s26, 16384
    s_add_u32 m0, s47, 6144
    s_mov_b32 s27, s26
    s_lshr_b32 s29, s27, 5
    s_xor_b32 s29, s29, s21
    s_not_b32 s29, s29
    s_and_b32 s29, s29, 16384
    s_xor_b32 s27, s27, s29
    buffer_load_dwordx4 v2, s[4:7], s27 offen offset:0 sc1 lds
    buffer_load_dwordx4 v2, s[4:7], s27 offen offset:1024 sc1 lds
    s_add_u32 s26, s26, 16384
    s_waitcnt vmcnt(0)
    s_add_u32 s35, s35, 1
    s_cmp_lt_u32 s35, 200000
    s_cbranch_scc1 PB_zn
    s_branch M_fail
PB_zokn:
PB_m:
    s_mul_i32 s28, s19, 171
    s_lshr_b32 s28, s28, 9
    s_mul_i32 s76, s28, 3
    s_sub_u32 s76, s19, s76
    s_lshl_b32 s76, s76, 15
    s_add_u32 s28, s28, 4
    s_lshl_b32 s57, s28, 21
    s_add_u32 s57, s57, s76
    s_add_u32 s57, s57, 1982464
    s_lshr_b32 s29, s20, s28
    s_and_b32 s29, s29, 1
    s_lshl_b32 s29, s29, 13
    s_add_u32 s57, s57, s29
    s_xor_b32 s57, s57, 8192
    s_lshl_b32 s31, s42, 7
    s_add_u32 s57, s57, s31
    v_mfma_f32_16x16x32_bf16 v[32:35], v[144:147], v[128:131], v[32:35]
    v_mfma_f32_16x16x32_bf16 v[36:39], v[144:147], v[132:135], v[36:39]
    v_mfma_f32_16x16x32_bf16 v[40:43], v[152:155], v[128:131], v[40:43]
    v_mfma_f32_16x16x32_bf16 v[44:47], v[152:155], v[132:135], v[44:47]
    v_mfma_f32_16x16x32_bf16 v[48:51], v[160:163], v[128:131], v[48:51]
    v_mfma_f32_16x16x32_bf16 v[52:55], v[160:163], v[132:135], v[52:55]
    v_mfma_f32_16x16x32_bf16 v[56:59], v[168:171], v[128:131], v[56:59]
    v_mfma_f32_16x16x32_bf16 v[60:63], v[168:171], v[132:135], v[60:63]
    v_mfma_f32_16x16x32_bf16 v[32:35], v[148:151], v[136:139], v[32:35]
    v_mfma_f32_16x16x32_bf16 v[36:39], v[148:151], v[140:143], v[36:39]
    v_mfma_f32_16x16x32_bf16 v[40:43], v[156:159], v[136:139], v[40:43]
    v_mfma_f32_16x16x32_bf16 v[44:47], v[156:159], v[140:143], v[44:47]
    v_mfma_f32_16x16x32_bf16 v[48:51], v[164:167], v[136:139], v[48:51]
    v_mfma_f32_16x16x32_bf16 v[52:55], v[164:167], v[140:143], v[52:55]
    v_mfma_f32_16x16x32_bf16 v[56:59], v[172:175], v[136:139], v[56:59]
    v_mfma_f32_16x16x32_bf16 v[60:63], v[172:175], v[140:143], v[60:63]
    s_nop 1
    v_cmp_u_f32 vcc, v32, v36
    s_cbranch_vccz PB_ok
    s_cmp_eq_u32 s58, 2
    s_mov_b32 s58, 2
    s_cbranch_scc0 PB_n
PB_ok:
    ds_write_b128 v10, v[32:35] offset:0
    ds_write_b128 v10, v[36:39] offset:4096
    ds_write_b128 v10, v[40:43] offset:8192
    ds_write_b128 v10, v[44:47] offset:12288
    ds_write_b128 v10, v[48:51] offset:16384
    ds_write_b128 v10, v[52:55] offset:20480
    ds_write_b128 v10, v[56:59] offset:24576
    ds_write_b128 v10, v[60:63] offset:28672
    s_waitcnt lgkmcnt(0)
    s_barrier
    ds_read_b128 v[32:35], v11 offset:0
    ds_read_b128 v[36:39], v11 offset:1024
    ds_read_b128 v[40:43], v11 offset:2048
    ds_read_b128 v[44:47], v11 offset:3072
    ds_read_b128 v[48:51], v11 offset:4096
    ds_read_b128 v[52:55], v11 offset:5120
    ds_read_b128 v[56:59], v11 offset:6144
    ds_read_b128 v[60:63], v11 offset:7168
    s_waitcnt lgkmcnt(0)
    v_add_f32 v32, v32, v36
    v_add_f32 v40, v40, v44
    v_add_f32 v16, v32, v40
    v_add_f32 v33, v33, v37
    v_add_f32 v41, v41, v45
    v_add_f32 v17, v33, v41
    v_add_f32 v34, v34, v38
    v_add_f32 v42, v42, v46
    v_add_f32 v18, v34, v42
    v_add_f32 v35, v35, v39
    v_add_f32 v43, v43, v47
    v_add_f32 v19, v35, v43
    v_add_f32 v48, v48, v52
    v_add_f32 v56, v56, v60
    v_add_f32 v20, v48, v56
    v_add_f32 v49, v49, v53
    v_add_f32 v57, v57, v61
    v_add_f32 v21, v49, v57
    v_add_f32 v50, v50, v54
    v_add_f32 v58, v58, v62
    v_add_f32 v22, v50, v58
    v_add_f32 v51, v51, v55
    v_add_f32 v59, v59, v63
    v_add_f32 v23, v51, v59
    s_cmp_ge_u32 s19, 60
    s_cselect_b32 s33, s57, 0x7ffffff0
    v_mov_b32 v8, 1
    s_mov_b64 exec, 1
    buffer_store_dword v8, v2, s[4:7], s33 offen sc1
    s_mov_b64 exec, -1
    s_mul_i32 s30, s19, 40960
    s_lshl_b32 s31, s42, 9
    s_add_u32 s30, s30, s31
    s_add_u32 s30, s30, 217055232
    s_add_u32 s31, s30, 20480
    v_cvt_pk_bf16_f32 v28, v16, v17
    v_lshlrev_b32 v16, 16, v28
    v_and_b32 v17, 0xffff0000, v28
    v_lshlrev_b32 v28, 16, v24
    v_add_f32 v16, v16, v28
    v_and_b32 v28, 0xffff0000, v24
    v_add_f32 v17, v17, v28
    v_cvt_pk_bf16_f32 v28, v16, v17
    v_cvt_pk_bf16_f32 v29, v18, v19
    v_lshlrev_b32 v18, 16, v29
    v_and_b32 v19, 0xffff0000, v29
    v_lshlrev_b32 v29, 16, v25
    v_add_f32 v18, v18, v29
    v_and_b32 v29, 0xffff0000, v25
    v_add_f32 v19, v19, v29
    v_cvt_pk_bf16_f32 v29, v18, v19
    buffer_store_dwordx2 v[28:29], v7, s[4:7], s30 offen sc1
    v_cvt_pk_bf16_f32 v30, v20, v21
    v_lshlrev_b32 v20, 16, v30
    v_and_b32 v21, 0xffff0000, v30
    v_lshlrev_b32 v30, 16, v26
    v_add_f32 v20, v20, v30
    v_and_b32 v30, 0xffff0000, v26
    v_add_f32 v21, v21, v30
    v_cvt_pk_bf16_f32 v30, v20, v21
    v_cvt_pk_bf16_f32 v31, v22, v23
    v_lshlrev_b32 v22, 16, v31
    v_and_b32 v23, 0xffff0000, v31
    v_lshlrev_b32 v31, 16, v27
    v_add_f32 v22, v22, v31
    v_and_b32 v31, 0xffff0000, v27
    v_add_f32 v23, v23, v31
    v_cvt_pk_bf16_f32 v31, v22, v23
    buffer_store_dwordx2 v[30:31], v7, s[4:7], s31 offen sc1
    v_xor_b32 v10, 0x8000, v10
    v_xor_b32 v11, 0x8000, v11
    s_mov_b32 s19, s34
    s_cmp_eq_u32 s77, 0
    s_cbranch_scc1 PB_rt
    s_mov_b32 s58, 2
    s_mov_b32 s56, s57
    s_waitcnt vmcnt(30)
    s_mul_i32 s30, s19, 81920
    s_add_u32 s30, s30, 210763776
    s_lshl_b32 s31, s16, 11
    s_add_u32 s32, s30, s31
    s_add_u32 s32, s32, 32768
    s_lshl_b32 s31, s16, 13
    s_add_u32 s30, s30, s31
    s_add_u32 s30, s30, s66
    s_add_u32 s31, s30, 40960
    s_add_u32 s33, s32, 40960
    buffer_load_dwordx4 v[64:67], v2, s[4:7], s30 offen offset:0 sc1
    buffer_load_dwordx4 v[68:71], v2, s[4:7], s31 offen offset:0 sc1
    buffer_load_dwordx4 v[72:75], v2, s[4:7], s30 offen offset:1024 sc1
    buffer_load_dwordx4 v[76:79], v2, s[4:7], s31 offen offset:1024 sc1
    buffer_load_dwordx4 v[80:83], v2, s[4:7], s30 offen offset:2048 sc1
    buffer_load_dwordx4 v[84:87], v2, s[4:7], s31 offen offset:2048 sc1
    buffer_load_dwordx4 v[88:91], v2, s[4:7], s30 offen offset:3072 sc1
    buffer_load_dwordx4 v[92:95], v2, s[4:7], s31 offen offset:3072 sc1
    s_add_u32 s30, s30, s67
    s_add_u32 s31, s31, s67
    buffer_load_dwordx4 v[96:99], v2, s[4:7], s30 offen offset:0 sc1
    buffer_load_dwordx4 v[100:103], v2, s[4:7], s31 offen offset:0 sc1
    buffer_load_dwordx4 v[104:107], v2, s[4:7], s30 offen offset:1024 sc1
    buffer_load_dwordx4 v[108:111], v2, s[4:7], s31 offen offset:1024 sc1
    buffer_load_dwordx4 v[112:115], v2, s[4:7], s30 offen offset:2048 sc1
    buffer_load_dwordx4 v[116:119], v2, s[4:7], s31 offen offset:2048 sc1
    buffer_load_dwordx4 v[120:123], v2, s[4:7], s30 offen offset:3072 sc1
    buffer_load_dwordx4 v[124:127], v2, s[4:7], s31 offen offset:3072 sc1
    buffer_load_dwordx4 v[128:131], v2, s[4:7], s32 offen offset:0 sc1
    buffer_load_dwordx4 v[132:135], v2, s[4:7], s33 offen offset:0 sc1
    buffer_load_dwordx4 v[136:139], v2, s[4:7], s32 offen offset:1024 sc1
    buffer_load_dwordx4 v[140:143], v2, s[4:7], s33 offen offset:1024 sc1
    s_mul_i32 s30, s19, 40960
    s_lshl_b32 s31, s42, 5
    s_add_u32 s30, s30, s31
    s_add_u32 s31, s30, 20480
    buffer_load_dwordx2 v[24:25], v6, s[8:11], s30 offen
    buffer_load_dwordx2 v[26:27], v6, s[8:11], s31 offen
    s_mul_i32 s28, s19, 171
    s_lshr_b32 s28, s28, 9
    s_mul_i32 s27, s28, 3
    s_sub_u32 s27, s19, s27
    s_mul_i32 s27, s27, 655360
    s_add_u32 s28, s28, 4
    s_lshl_b32 s26, s28, 21
    s_add_u32 s26, s26, s27
    s_lshr_b32 s29, s20, s28
    s_and_b32 s29, s29, 1
    s_lshl_b32 s29, s29, 13
    s_add_u32 s26, s26, s29
    s_add_u32 s26, s26, s46
    s_add_u32 m0, s47, 0
    s_mov_b32 s27, s26
    s_lshr_b32 s29, s27, 5
    s_xor_b32 s29, s29, s21
    s_not_b32 s29, s29
    s_and_b32 s29, s29, 16384
    s_xor_b32 s27, s27, s29
    buffer_load_dwordx4 v2, s[4:7], s27 offen offset:0 sc1 lds
    buffer_load_dwordx4 v2, s[4:7], s27 offen offset:1024 sc1 lds
    s_add_u32 s26, s26, 16384
    s_add_u32 m0, s47, 2048
    s_mov_b32 s27, s26
    s_lshr_b32 s29, s27, 5
    s_xor_b32 s29, s29, s21
    s_not_b32 s29, s29
    s_and_b32 s29, s29, 16384
    s_xor_b32 s27, s27, s29
    buffer_load_dwordx4 v2, s[4:7], s27 offen offset:0 sc1 lds
    buffer_load_dwordx4 v2, s[4:7], s27 offen offset:1024 sc1 lds
    s_add_u32 s26, s26, 16384
    s_add_u32 m0, s47, 4096
    s_mov_b32 s27, s26
    s_lshr_b32 s29, s27, 5
    s_xor_b32 s29, s29, s21
    s_not_b32 s29, s29
    s_and_b32 s29, s29, 16384
    s_xor_b32 s27, s27, s29
    buffer_load_dwordx4 v2, s[4:7], s27 offen offset:0 sc1 lds
    buffer_load_dwordx4 v2, s[4:7], s27 offen offset:1024 sc1 lds
    s_add_u32 s26, s26, 16384
    s_add_u32 m0, s47, 6144
    s_mov_b32 s27, s26
    s_lshr_b32 s29, s27, 5
    s_xor_b32 s29, s29, s21
    s_not_b32 s29, s29
    s_and_b32 s29, s29, 16384
    s_xor_b32 s27, s27, s29
    buffer_load_dwordx4 v2, s[4:7], s27 offen offset:0 sc1 lds
    buffer_load_dwordx4 v2, s[4:7], s27 offen offset:1024 sc1 lds
    s_add_u32 s26, s26, 16384
    s_branch PB_have
PB_rt:
    v_cmp_eq_u32 vcc, 0, v13
    s_cmp_ge_u32 s19, s59
    s_cbranch_scc1 PB_end
    s_cbranch_vccnz PB_slow
    s_mul_i32 s30, s19, 1310720
    s_add_u32 s30, s30, s45
    s_add_u32 s30, s30, s66
    buffer_load_dwordx4 a[0:3], v2, s[4:7], s30 offen offset:0 sc1
    buffer_load_dwordx4 a[4:7], v2, s[4:7], s30 offen offset:1024 sc1
    buffer_load_dwordx4 a[8:11], v2, s[4:7], s30 offen offset:2048 sc1
    buffer_load_dwordx4 a[12:15], v2, s[4:7], s30 offen offset:3072 sc1
    s_add_u32 s30, s30, s67
    buffer_load_dwordx4 a[16:19], v2, s[4:7], s30 offen offset:0 sc1
    buffer_load_dwordx4 a[20:23], v2, s[4:7], s30 offen offset:1024 sc1
    buffer_load_dwordx4 a[24:27], v2, s[4:7], s30 offen offset:2048 sc1
    buffer_load_dwordx4 a[28:31], v2, s[4:7], s30 offen offset:3072 sc1
    s_add_u32 s30, s30, s68
    buffer_load_dwordx4 a[32:35], v2, s[4:7], s30 offen offset:0 sc1
    buffer_load_dwordx4 a[36:39], v2, s[4:7], s30 offen offset:1024 sc1
    buffer_load_dwordx4 a[40:43], v2, s[4:7], s30 offen offset:2048 sc1
    buffer_load_dwordx4 a[44:47], v2, s[4:7], s30 offen offset:3072 sc1
    s_add_u32 s30, s30, s67
    buffer_load_dwordx4 a[48:51], v2, s[4:7], s30 offen offset:0 sc1
    buffer_load_dwordx4 a[52:55], v2, s[4:7], s30 offen offset:1024 sc1
    buffer_load_dwordx4 a[56:59], v2, s[4:7], s30 offen offset:2048 sc1
    buffer_load_dwordx4 a[60:63], v2, s[4:7], s30 offen offset:3072 sc1
    s_add_u32 s30, s30, s68
    buffer_load_dwordx4 a[64:67], v2, s[4:7], s30 offen offset:0 sc1
    buffer_load_dwordx4 a[68:71], v2, s[4:7], s30 offen offset:1024 sc1
    buffer_load_dwordx4 a[72:75], v2, s[4:7], s30 offen offset:2048 sc1
    buffer_load_dwordx4 a[76:79], v2, s[4:7], s30 offen offset:3072 sc1
    s_add_u32 s30, s30, s67
    buffer_load_dwordx4 a[80:83], v2, s[4:7], s30 offen offset:0 sc1
    buffer_load_dwordx4 a[84:87], v2, s[4:7], s30 offen offset:1024 sc1
    buffer_load_dwordx4 a[88:91], v2, s[4:7], s30 offen offset:2048 sc1
    buffer_load_dwordx4 a[92:95], v2, s[4:7], s30 offen offset:3072 sc1
    s_add_u32 s30, s30, s68
    buffer_load_dwordx4 a[96:99], v2, s[4:7], s30 offen offset:0 sc1
    buffer_load_dwordx4 a[100:103], v2, s[4:7], s30 offen offset:1024 sc1
    buffer_load_dwordx4 a[104:107], v2, s[4:7], s30 offen offset:2048 sc1
    buffer_load_dwordx4 a[108:111], v2, s[4:7], s30 offen offset:3072 sc1
    s_add_u32 s30, s30, s67
    buffer_load_dwordx4 a[112:115], v2, s[4:7], s30 offen offset:0 sc1
    buffer_load_dwordx4 a[116:119], v2, s[4:7], s30 offen offset:1024 sc1
    buffer_load_dwordx4 a[120:123], v2, s[4:7], s30 offen offset:2048 sc1
    buffer_load_dwordx4 a[124:127], v2, s[4:7], s30 offen offset:3072 sc1
    s_add_u32 s30, s30, s68
    v_mov_b32 v8, 2
    s_waitcnt vmcnt(32)
    s_mov_b64 exec, 1
    buffer_store_dword v8, v2, s[4:7], s57 offen sc1
    s_mov_b64 exec, -1
    s_branch PB_seg
PB_slow:
    v_mov_b32 v8, 2
    s_waitcnt vmcnt(0)
    s_mov_b64 exec, 1
    buffer_store_dword v8, v2, s[4:7], s57 offen sc1
    s_mov_b64 exec, -1
    s_lshl_b32 s30, s19, 9
    s_add_u32 s30, s30, s43
    s_mov_b32 s35, 0
W_31:
    buffer_load_dword v8, v12, s[4:7], s30 offen sc1
    s_waitcnt vmcnt(0)
    v_cmp_gt_u32 vcc, 1, v8
    s_cbranch_vccz G_32
    s_sleep 2
    s_add_u32 s35, s35, 1
    s_cmp_lt_u32 s35, 200000
    s_cbranch_scc1 W_31
    s_branch M_fail
G_32:
    s_mul_i32 s30, s19, 1310720
    s_add_u32 s30, s30, s45
    s_add_u32 s30, s30, s66
    buffer_load_dwordx4 a[0:3], v2, s[4:7], s30 offen offset:0 sc1
    buffer_load_dwordx4 a[4:7], v2, s[4:7], s30 offen offset:1024 sc1
    buffer_load_dwordx4 a[8:11], v2, s[4:7], s30 offen offset:2048 sc1
    buffer_load_dwordx4 a[12:15], v2, s[4:7], s30 offen offset:3072 sc1
    s_add_u32 s30, s30, s67
    buffer_load_dwordx4 a[16:19], v2, s[4:7], s30 offen offset:0 sc1
    buffer_load_dwordx4 a[20:23], v2, s[4:7], s30 offen offset:1024 sc1
    buffer_load_dwordx4 a[24:27], v2, s[4:7], s30 offen offset:2048 sc1
    buffer_load_dwordx4 a[28:31], v2, s[4:7], s30 offen offset:3072 sc1
    s_add_u32 s30, s30, s68
    buffer_load_dwordx4 a[32:35], v2, s[4:7], s30 offen offset:0 sc1
    buffer_load_dwordx4 a[36:39], v2, s[4:7], s30 offen offset:1024 sc1
    buffer_load_dwordx4 a[40:43], v2, s[4:7], s30 offen offset:2048 sc1
    buffer_load_dwordx4 a[44:47], v2, s[4:7], s30 offen offset:3072 sc1
    s_add_u32 s30, s30, s67
    buffer_load_dwordx4 a[48:51], v2, s[4:7], s30 offen offset:0 sc1
    buffer_load_dwordx4 a[52:55], v2, s[4:7], s30 offen offset:1024 sc1
    buffer_load_dwordx4 a[56:59], v2, s[4:7], s30 offen offset:2048 sc1
    buffer_load_dwordx4 a[60:63], v2, s[4:7], s30 offen offset:3072 sc1
    s_add_u32 s30, s30, s68
    buffer_load_dwordx4 a[64:67], v2, s[4:7], s30 offen offset:0 sc1
    buffer_load_dwordx4 a[68:71], v2, s[4:7], s30 offen offset:1024 sc1
    buffer_load_dwordx4 a[72:75], v2, s[4:7], s30 offen offset:2048 sc1
    buffer_load_dwordx4 a[76:79], v2, s[4:7], s30 offen offset:3072 sc1
    s_add_u32 s30, s30, s67
    buffer_load_dwordx4 a[80:83], v2, s[4:7], s30 offen offset:0 sc1
    buffer_load_dwordx4 a[84:87], v2, s[4:7], s30 offen offset:1024 sc1
    buffer_load_dwordx4 a[88:91], v2, s[4:7], s30 offen offset:2048 sc1
    buffer_load_dwordx4 a[92:95], v2, s[4:7], s30 offen offset:3072 sc1
    s_add_u32 s30, s30, s68
    buffer_load_dwordx4 a[96:99], v2, s[4:7], s30 offen offset:0 sc1
    buffer_load_dwordx4 a[100:103], v2, s[4:7], s30 offen offset:1024 sc1
    buffer_load_dwordx4 a[104:107], v2, s[4:7], s30 offen offset:2048 sc1
    buffer_load_dwordx4 a[108:111], v2, s[4:7], s30 offen offset:3072 sc1
    s_add_u32 s30, s30, s67
    buffer_load_dwordx4 a[112:115], v2, s[4:7], s30 offen offset:0 sc1
    buffer_load_dwordx4 a[116:119], v2, s[4:7], s30 offen offset:1024 sc1
    buffer_load_dwordx4 a[120:123], v2, s[4:7], s30 offen offset:2048 sc1
    buffer_load_dwordx4 a[124:127], v2, s[4:7], s30 offen offset:3072 sc1
    s_add_u32 s30, s30, s68
    s_branch PB_seg
PB_end:
    v_mov_b32 v8, 2
    s_waitcnt vmcnt(0)
    s_mov_b64 exec, 1
    buffer_store_dword v8, v2, s[4:7], s57 offen sc1
    s_mov_b64 exec, -1
    s_endpgm
P_c:
    s_load_dwordx4 s[40:43], s[0:1], 64
    s_waitcnt lgkmcnt(0)
    s_mov_b32 s8, s42
    s_and_b32 s9, s43, 0xffff
    s_mov_b32 s10, 3072
    s_mov_b32 s11, 0x20000
    s_mov_b32 s12, s40
    s_and_b32 s13, s41, 0xffff
    s_mov_b32 s14, 1966080
    s_mov_b32 s15, 0x20000
    s_lshl_b32 s17, s17, 2
    s_add_u32 s17, s17, s16
    v_lshrrev_b32 v7, 4, v1
    v_lshlrev_b32 v7, 3, v7
    s_lshl_b32 s30, s17, 6
    buffer_load_dwordx2 v[32:33], v7, s[8:11], s30 offen
    buffer_load_dwordx2 v[34:35], v7, s[8:11], s30 offen offset:32
    v_lshrrev_b32 v8, 2, v1
    v_mul_u32_u24 v8, 3072, v8
    v_and_b32 v9, 3, v1
    v_lshlrev_b32 v10, 4, v9
    v_add_u32 v8, v8, v10
    s_mul_i32 s32, s16, 40960
    v_lshlrev_b32 v9, 3, v9
    v_and_b32 v10, 48, v1
    v_lshlrev_b32 v10, 5, v10
    v_add3_u32 v9, v9, v10, s32
    v_and_b32 v10, 12, v1
    v_lshlrev_b32 v10, 4, v10
    v_add_u32 v9, v9, v10
    s_add_u32 s60, s16, 0
    s_and_b32 s60, s60, 3
    s_mul_i32 s31, s60, 491520
    s_add_u32 s31, s31, s30
    s_mul_i32 s60, s60, 5120
    s_add_u32 m0, s32, 0
    s_nop 0
    buffer_load_dwordx4 v8, s[12:15], s31 offen lds
    s_add_u32 s31, s31, 49152
    s_add_u32 m0, s32, 1024
    s_nop 0
    buffer_load_dwordx4 v8, s[12:15], s31 offen lds
    s_add_u32 s31, s31, 49152
    s_add_u32 m0, s32, 2048
    s_nop 0
    buffer_load_dwordx4 v8, s[12:15], s31 offen lds
    s_add_u32 s31, s31, 49152
    s_add_u32 m0, s32, 3072
    s_nop 0
    buffer_load_dwordx4 v8, s[12:15], s31 offen lds
    s_add_u32 s31, s31, 49152
    s_add_u32 m0, s32, 4096
    s_nop 0
    buffer_load_dwordx4 v8, s[12:15], s31 offen lds
    s_add_u32 s31, s31, 49152
    s_add_u32 m0, s32, 5120
    s_nop 0
    buffer_load_dwordx4 v8, s[12:15], s31 offen lds
    s_add_u32 s31, s31, 49152
    s_add_u32 m0, s32, 6144
    s_nop 0
    buffer_load_dwordx4 v8, s[12:15], s31 offen lds
    s_add_u32 s31, s31, 49152
    s_add_u32 m0, s32, 7168
    s_nop 0
    buffer_load_dwordx4 v8, s[12:15], s31 offen lds
    s_add_u32 s31, s31, 49152
    s_add_u32 m0, s32, 8192
    s_nop 0
    buffer_load_dwordx4 v8, s[12:15], s31 offen lds
    s_add_u32 s31, s31, 49152
    s_add_u32 m0, s32, 9216
    s_nop 0
    buffer_load_dwordx4 v8, s[12:15], s31 offen lds
    s_add_u32 s31, s31, 49152
    v_add_u32 v44, s60, v2
    s_add_u32 s61, s16, 1
    s_and_b32 s61, s61, 3
    s_mul_i32 s31, s61, 491520
    s_add_u32 s31, s31, s30
    s_mul_i32 s61, s61, 5120
    s_add_u32 m0, s32, 10240
    s_nop 0
    buffer_load_dwordx4 v8, s[12:15], s31 offen lds
    s_add_u32 s31, s31, 49152
    s_add_u32 m0, s32, 11264
    s_nop 0
    buffer_load_dwordx4 v8, s[12:15], s31 offen lds
    s_add_u32 s31, s31, 49152
    s_add_u32 m0, s32, 12288
    s_nop 0
    buffer_load_dwordx4 v8, s[12:15], s31 offen lds
    s_add_u32 s31, s31, 49152
    s_add_u32 m0, s32, 13312
    s_nop 0
    buffer_load_dwordx4 v8, s[12:15], s31 offen lds
    s_add_u32 s31, s31, 49152
    s_add_u32 m0, s32, 14336
    s_nop 0
    buffer_load_dwordx4 v8, s[12:15], s31 offen lds
    s_add_u32 s31, s31, 49152
    s_add_u32 m0, s32, 15360
    s_nop 0
    buffer_load_dwordx4 v8, s[12:15], s31 offen lds
    s_add_u32 s31, s31, 49152
    s_add_u32 m0, s32, 16384
    s_nop 0
    buffer_load_dwordx4 v8, s[12:15], s31 offen lds
    s_add_u32 s31, s31, 49152
    s_add_u32 m0, s32, 17408
    s_nop 0
    buffer_load_dwordx4 v8, s[12:15], s31 offen lds
    s_add_u32 s31, s31, 49152
    s_add_u32 m0, s32, 18432
    s_nop 0
    buffer_load_dwordx4 v8, s[12:15], s31 offen lds
    s_add_u32 s31, s31, 49152
    s_add_u32 m0, s32, 19456
    s_nop 0
    buffer_load_dwordx4 v8, s[12:15], s31 offen lds
    s_add_u32 s31, s31, 49152
    v_add_u32 v45, s61, v2
    s_add_u32 s62, s16, 2
    s_and_b32 s62, s62, 3
    s_mul_i32 s31, s62, 491520
    s_add_u32 s31, s31, s30
    s_mul_i32 s62, s62, 5120
    s_add_u32 m0, s32, 20480
    s_nop 0
    buffer_load_dwordx4 v8, s[12:15], s31 offen lds
    s_add_u32 s31, s31, 49152
    s_add_u32 m0, s32, 21504
    s_nop 0
    buffer_load_dwordx4 v8, s[12:15], s31 offen lds
    s_add_u32 s31, s31, 49152
    s_add_u32 m0, s32, 22528
    s_nop 0
    buffer_load_dwordx4 v8, s[12:15], s31 offen lds
    s_add_u32 s31, s31, 49152
    s_add_u32 m0, s32, 23552
    s_nop 0
    buffer_load_dwordx4 v8, s[12:15], s31 offen lds
    s_add_u32 s31, s31, 49152
    s_add_u32 m0, s32, 24576
    s_nop 0
    buffer_load_dwordx4 v8, s[12:15], s31 offen lds
    s_add_u32 s31, s31, 49152
    s_add_u32 m0, s32, 25600
    s_nop 0
    buffer_load_dwordx4 v8, s[12:15], s31 offen lds
    s_add_u32 s31, s31, 49152
    s_add_u32 m0, s32, 26624
    s_nop 0
    buffer_load_dwordx4 v8, s[12:15], s31 offen lds
    s_add_u32 s31, s31, 49152
    s_add_u32 m0, s32, 27648
    s_nop 0
    buffer_load_dwordx4 v8, s[12:15], s31 offen lds
    s_add_u32 s31, s31, 49152
    s_add_u32 m0, s32, 28672
    s_nop 0
    buffer_load_dwordx4 v8, s[12:15], s31 offen lds
    s_add_u32 s31, s31, 49152
    s_add_u32 m0, s32, 29696
    s_nop 0
    buffer_load_dwordx4 v8, s[12:15], s31 offen lds
    s_add_u32 s31, s31, 49152
    v_add_u32 v46, s62, v2
    s_add_u32 s63, s16, 3
    s_and_b32 s63, s63, 3
    s_mul_i32 s31, s63, 491520
    s_add_u32 s31, s31, s30
    s_mul_i32 s63, s63, 5120
    s_add_u32 m0, s32, 30720
    s_nop 0
    buffer_load_dwordx4 v8, s[12:15], s31 offen lds
    s_add_u32 s31, s31, 49152
    s_add_u32 m0, s32, 31744
    s_nop 0
    buffer_load_dwordx4 v8, s[12:15], s31 offen lds
    s_add_u32 s31, s31, 49152
    s_add_u32 m0, s32, 32768
    s_nop 0
    buffer_load_dwordx4 v8, s[12:15], s31 offen lds
    s_add_u32 s31, s31, 49152
    s_add_u32 m0, s32, 33792
    s_nop 0
    buffer_load_dwordx4 v8, s[12:15], s31 offen lds
    s_add_u32 s31, s31, 49152
    s_add_u32 m0, s32, 34816
    s_nop 0
    buffer_load_dwordx4 v8, s[12:15], s31 offen lds
    s_add_u32 s31, s31, 49152
    s_add_u32 m0, s32, 35840
    s_nop 0
    buffer_load_dwordx4 v8, s[12:15], s31 offen lds
    s_add_u32 s31, s31, 49152
    s_add_u32 m0, s32, 36864
    s_nop 0
    buffer_load_dwordx4 v8, s[12:15], s31 offen lds
    s_add_u32 s31, s31, 49152
    s_add_u32 m0, s32, 37888
    s_nop 0
    buffer_load_dwordx4 v8, s[12:15], s31 offen lds
    s_add_u32 s31, s31, 49152
    s_add_u32 m0, s32, 38912
    s_nop 0
    buffer_load_dwordx4 v8, s[12:15], s31 offen lds
    s_add_u32 s31, s31, 49152
    s_add_u32 m0, s32, 39936
    s_nop 0
    buffer_load_dwordx4 v8, s[12:15], s31 offen lds
    s_add_u32 s31, s31, 49152
    v_add_u32 v47, s63, v2
    s_waitcnt vmcnt(0)
    ds_read_b64_tr_b16 a[0:1], v9 offset:0
    ds_read_b64_tr_b16 a[2:3], v9 offset:256
    ds_read_b64_tr_b16 a[4:5], v9 offset:32
    ds_read_b64_tr_b16 a[6:7], v9 offset:288
    ds_read_b64_tr_b16 a[8:9], v9 offset:2048
    ds_read_b64_tr_b16 a[10:11], v9 offset:2304
    ds_read_b64_tr_b16 a[12:13], v9 offset:2080
    ds_read_b64_tr_b16 a[14:15], v9 offset:2336
    ds_read_b64_tr_b16 a[16:17], v9 offset:4096
    ds_read_b64_tr_b16 a[18:19], v9 offset:4352
    ds_read_b64_tr_b16 a[20:21], v9 offset:4128
    ds_read_b64_tr_b16 a[22:23], v9 offset:4384
    ds_read_b64_tr_b16 a[24:25], v9 offset:6144
    ds_read_b64_tr_b16 a[26:27], v9 offset:6400
    ds_read_b64_tr_b16 a[28:29], v9 offset:6176
    ds_read_b64_tr_b16 a[30:31], v9 offset:6432
    ds_read_b64_tr_b16 a[32:33], v9 offset:8192
    ds_read_b64_tr_b16 a[34:35], v9 offset:8448
    ds_read_b64_tr_b16 a[36:37], v9 offset:8224
    ds_read_b64_tr_b16 a[38:39], v9 offset:8480
    ds_read_b64_tr_b16 a[40:41], v9 offset:10240
    ds_read_b64_tr_b16 a[42:43], v9 offset:10496
    ds_read_b64_tr_b16 a[44:45], v9 offset:10272
    ds_read_b64_tr_b16 a[46:47], v9 offset:10528
    ds_read_b64_tr_b16 a[48:49], v9 offset:12288
    ds_read_b64_tr_b16 a[50:51], v9 offset:12544
    ds_read_b64_tr_b16 a[52:53], v9 offset:12320
    ds_read_b64_tr_b16 a[54:55], v9 offset:12576
    ds_read_b64_tr_b16 a[56:57], v9 offset:14336
    ds_read_b64_tr_b16 a[58:59], v9 offset:14592
    ds_read_b64_tr_b16 a[60:61], v9 offset:14368
    ds_read_b64_tr_b16 a[62:63], v9 offset:14624
    ds_read_b64_tr_b16 a[64:65], v9 offset:16384
    ds_read_b64_tr_b16 a[66:67], v9 offset:16640
    ds_read_b64_tr_b16 a[68:69], v9 offset:16416
    ds_read_b64_tr_b16 a[70:71], v9 offset:16672
    ds_read_b64_tr_b16 a[72:73], v9 offset:18432
    ds_read_b64_tr_b16 a[74:75], v9 offset:18688
    ds_read_b64_tr_b16 a[76:77], v9 offset:18464
    ds_read_b64_tr_b16 a[78:79], v9 offset:18720
    ds_read_b64_tr_b16 a[80:81], v9 offset:20480
    ds_read_b64_tr_b16 a[82:83], v9 offset:20736
    ds_read_b64_tr_b16 a[84:85], v9 offset:20512
    ds_read_b64_tr_b16 a[86:87], v9 offset:20768
    ds_read_b64_tr_b16 a[88:89], v9 offset:22528
    ds_read_b64_tr_b16 a[90:91], v9 offset:22784
    ds_read_b64_tr_b16 a[92:93], v9 offset:22560
    ds_read_b64_tr_b16 a[94:95], v9 offset:22816
    ds_read_b64_tr_b16 a[96:97], v9 offset:24576
    ds_read_b64_tr_b16 a[98:99], v9 offset:24832
    ds_read_b64_tr_b16 a[100:101], v9 offset:24608
    ds_read_b64_tr_b16 a[102:103], v9 offset:24864
    ds_read_b64_tr_b16 a[104:105], v9 offset:26624
    ds_read_b64_tr_b16 a[106:107], v9 offset:26880
    ds_read_b64_tr_b16 a[108:109], v9 offset:26656
    ds_read_b64_tr_b16 a[110:111], v9 offset:26912
    ds_read_b64_tr_b16 a[112:113], v9 offset:28672
    ds_read_b64_tr_b16 a[114:115], v9 offset:28928
    ds_read_b64_tr_b16 a[116:117], v9 offset:28704
    ds_read_b64_tr_b16 a[118:119], v9 offset:28960
    ds_read_b64_tr_b16 a[120:121], v9 offset:30720
    ds_read_b64_tr_b16 a[122:123], v9 offset:30976
    ds_read_b64_tr_b16 a[124:125], v9 offset:30752
    ds_read_b64_tr_b16 a[126:127], v9 offset:31008
    ds_read_b64_tr_b16 a[128:129], v9 offset:32768
    ds_read_b64_tr_b16 a[130:131], v9 offset:33024
    ds_read_b64_tr_b16 a[132:133], v9 offset:32800
    ds_read_b64_tr_b16 a[134:135], v9 offset:33056
    ds_read_b64_tr_b16 a[136:137], v9 offset:34816
    ds_read_b64_tr_b16 a[138:139], v9 offset:35072
    ds_read_b64_tr_b16 a[140:141], v9 offset:34848
    ds_read_b64_tr_b16 a[142:143], v9 offset:35104
    ds_read_b64_tr_b16 a[144:145], v9 offset:36864
    ds_read_b64_tr_b16 a[146:147], v9 offset:37120
    ds_read_b64_tr_b16 a[148:149], v9 offset:36896
    ds_read_b64_tr_b16 a[150:151], v9 offset:37152
    ds_read_b64_tr_b16 a[152:153], v9 offset:38912
    ds_read_b64_tr_b16 a[154:155], v9 offset:39168
    ds_read_b64_tr_b16 a[156:157], v9 offset:38944
    ds_read_b64_tr_b16 a[158:159], v9 offset:39200
    s_waitcnt lgkmcnt(0)
    s_barrier
    s_mov_b32 s39, 0x3fb8aa3b
    s_mov_b32 s38, 0x422c0000
    s_mul_i32 s26, s16, 10240
    s_mov_b32 s47, 0x7ffffff0
    v_mov_b32 v12, 0x3f803f80
    v_mov_b32 v13, 0x3f803f80
    v_mov_b32 v14, 0x3f803f80
    v_mov_b32 v15, 0x3f803f80
    v_min_u32 v4, 39, v1
    v_lshlrev_b32 v4, 7, v4
    v_and_b32 v6, 0xff, v2
    v_add_u32 v6, 49152, v6
    s_lshl_b32 s30, s16, 8
    v_add_u32 v5, s30, v6
    s_mov_b32 s64, 0xaaaaaaaa
    s_mov_b32 s65, 0xaaaaaaaa
    s_mov_b32 s66, 0xcccccccc
    s_mov_b32 s67, 0xcccccccc
    s_mov_b32 s68, 0x00f0000f
    s_mov_b32 s69, 0xf0000f00
    s_waitcnt vmcnt(0)
    v_lshlrev_b32 v16, 16, v32
    v_and_b32 v17, 0xffff0000, v32
    v_lshlrev_b32 v18, 16, v33
    v_and_b32 v19, 0xffff0000, v33
    v_lshlrev_b32 v20, 16, v34
    v_and_b32 v21, 0xffff0000, v34
    v_lshlrev_b32 v22, 16, v35
    v_and_b32 v23, 0xffff0000, v35
    v_mfma_f32_16x16x32_bf16 v[24:27], a[0:3], v[12:15], 0
    v_mfma_f32_16x16x32_bf16 v[28:31], a[4:7], v[12:15], 0
    v_mfma_f32_16x16x32_bf16 v[24:27], a[8:11], v[12:15], v[24:27]
    v_mfma_f32_16x16x32_bf16 v[28:31], a[12:15], v[12:15], v[28:31]
    v_mfma_f32_16x16x32_bf16 v[24:27], a[16:19], v[12:15], v[24:27]
    v_mfma_f32_16x16x32_bf16 v[28:31], a[20:23], v[12:15], v[28:31]
    v_mfma_f32_16x16x32_bf16 v[24:27], a[24:27], v[12:15], v[24:27]
    v_mfma_f32_16x16x32_bf16 v[28:31], a[28:31], v[12:15], v[28:31]
    v_mfma_f32_16x16x32_bf16 v[24:27], a[32:35], v[12:15], v[24:27]
    v_mfma_f32_16x16x32_bf16 v[28:31], a[36:39], v[12:15], v[28:31]
    v_mfma_f32_16x16x32_bf16 v[24:27], a[40:43], v[12:15], v[24:27]
    v_mfma_f32_16x16x32_bf16 v[28:31], a[44:47], v[12:15], v[28:31]
    v_mfma_f32_16x16x32_bf16 v[24:27], a[48:51], v[12:15], v[24:27]
    v_mfma_f32_16x16x32_bf16 v[28:31], a[52:55], v[12:15], v[28:31]
    v_mfma_f32_16x16x32_bf16 v[24:27], a[56:59], v[12:15], v[24:27]
    v_mfma_f32_16x16x32_bf16 v[28:31], a[60:63], v[12:15], v[28:31]
    v_mfma_f32_16x16x32_bf16 v[24:27], a[64:67], v[12:15], v[24:27]
    v_mfma_f32_16x16x32_bf16 v[28:31], a[68:71], v[12:15], v[28:31]
    v_mfma_f32_16x16x32_bf16 v[24:27], a[72:75], v[12:15], v[24:27]
    v_mfma_f32_16x16x32_bf16 v[28:31], a[76:79], v[12:15], v[28:31]
    v_mfma_f32_16x16x32_bf16 v[24:27], a[80:83], v[12:15], v[24:27]
    v_mfma_f32_16x16x32_bf16 v[28:31], a[84:87], v[12:15], v[28:31]
    v_mfma_f32_16x16x32_bf16 v[24:27], a[88:91], v[12:15], v[24:27]
    v_mfma_f32_16x16x32_bf16 v[28:31], a[92:95], v[12:15], v[28:31]
    v_mfma_f32_16x16x32_bf16 v[24:27], a[96:99], v[12:15], v[24:27]
    v_mfma_f32_16x16x32_bf16 v[28:31], a[100:103], v[12:15], v[28:31]
    v_mfma_f32_16x16x32_bf16 v[24:27], a[104:107], v[12:15], v[24:27]
    v_mfma_f32_16x16x32_bf16 v[28:31], a[108:111], v[12:15], v[28:31]
    v_mfma_f32_16x16x32_bf16 v[24:27], a[112:115], v[12:15], v[24:27]
    v_mfma_f32_16x16x32_bf16 v[28:31], a[116:119], v[12:15], v[28:31]
    v_mfma_f32_16x16x32_bf16 v[24:27], a[120:123], v[12:15], v[24:27]
    v_mfma_f32_16x16x32_bf16 v[28:31], a[124:127], v[12:15], v[28:31]
    v_mfma_f32_16x16x32_bf16 v[24:27], a[128:131], v[12:15], v[24:27]
    v_mfma_f32_16x16x32_bf16 v[28:31], a[132:135], v[12:15], v[28:31]
    v_mfma_f32_16x16x32_bf16 v[24:27], a[136:139], v[12:15], v[24:27]
    v_mfma_f32_16x16x32_bf16 v[28:31], a[140:143], v[12:15], v[28:31]
    v_mfma_f32_16x16x32_bf16 v[24:27], a[144:147], v[12:15], v[24:27]
    v_mfma_f32_16x16x32_bf16 v[28:31], a[148:151], v[12:15], v[28:31]
    v_mfma_f32_16x16x32_bf16 v[24:27], a[152:155], v[12:15], v[24:27]
    v_mfma_f32_16x16x32_bf16 v[28:31], a[156:159], v[12:15], v[28:31]
    s_cmp_ge_u32 s19, 60
    s_cselect_b32 s58, 1, 2
PC_seg:
    v_mov_b32 v8, 2
    s_waitcnt vmcnt(0)
    s_mov_b64 exec, 1
    buffer_store_dword v8, v2, s[4:7], s47 offen sc1
    s_mov_b64 exec, -1
    s_mov_b32 s47, 0x7ffffff0
PC_redo:
    s_mul_i32 s28, s19, 171
    s_lshr_b32 s28, s28, 9
    s_mul_i32 s76, s28, 3
    s_sub_u32 s76, s19, s76
    s_lshl_b32 s76, s76, 15
    s_add_u32 s28, s28, 4
    s_lshl_b32 s30, s28, 21
    s_add_u32 s30, s30, s76
    s_add_u32 s30, s30, 1982464
    s_lshr_b32 s29, s20, s28
    s_and_b32 s29, s29, 1
    s_lshl_b32 s29, s29, 13
    s_add_u32 s30, s30, s29
    s_xor_b32 s30, s30, 8192
    s_mov_b32 s35, 0
W_33:
    buffer_load_dword v8, v4, s[4:7], s30 offen sc1
    s_waitcnt vmcnt(0)
    v_cmp_gt_u32 vcc, s58, v8
    s_cbranch_vccz G_34
    s_sleep 2
    s_add_u32 s35, s35, 1
    s_cmp_lt_u32 s35, 200000
    s_cbranch_scc1 W_33
    s_branch M_fail
G_34:
    s_mul_i32 s30, s19, 40960
    s_mul_i32 s31, s16, 10240
    s_add_u32 s30, s30, s31
    s_add_u32 s30, s30, 217055232
    s_add_u32 m0, s26, 0
    s_nop 0
    buffer_load_dwordx4 v2, s[4:7], s30 offen sc1 lds
    s_add_u32 s30, s30, 1024
    s_add_u32 m0, s26, 1024
    s_nop 0
    buffer_load_dwordx4 v2, s[4:7], s30 offen sc1 lds
    s_add_u32 s30, s30, 1024
    s_add_u32 m0, s26, 2048
    s_nop 0
    buffer_load_dwordx4 v2, s[4:7], s30 offen sc1 lds
    s_add_u32 s30, s30, 1024
    s_add_u32 m0, s26, 3072
    s_nop 0
    buffer_load_dwordx4 v2, s[4:7], s30 offen sc1 lds
    s_add_u32 s30, s30, 1024
    s_add_u32 m0, s26, 4096
    s_nop 0
    buffer_load_dwordx4 v2, s[4:7], s30 offen sc1 lds
    s_add_u32 s30, s30, 1024
    s_add_u32 m0, s26, 5120
    s_nop 0
    buffer_load_dwordx4 v2, s[4:7], s30 offen sc1 lds
    s_add_u32 s30, s30, 1024
    s_add_u32 m0, s26, 6144
    s_nop 0
    buffer_load_dwordx4 v2, s[4:7], s30 offen sc1 lds
    s_add_u32 s30, s30, 1024
    s_add_u32 m0, s26, 7168
    s_nop 0
    buffer_load_dwordx4 v2, s[4:7], s30 offen sc1 lds
    s_add_u32 s30, s30, 1024
    s_add_u32 m0, s26, 8192
    s_nop 0
    buffer_load_dwordx4 v2, s[4:7], s30 offen sc1 lds
    s_add_u32 s30, s30, 1024
    s_add_u32 m0, s26, 9216
    s_nop 0
    buffer_load_dwordx4 v2, s[4:7], s30 offen sc1 lds
    s_add_u32 s30, s30, 1024
    s_waitcnt vmcnt(0)
PC_have:
    s_waitcnt vmcnt(3)
    s_barrier
    ds_read_b128 v[64:67], v44 offset:0
    ds_read_b128 v[68:71], v44 offset:20480
    ds_read_b128 v[72:75], v44 offset:1024
    ds_read_b128 v[76:79], v44 offset:21504
    ds_read_b128 v[80:83], v44 offset:2048
    ds_read_b128 v[84:87], v44 offset:22528
    s_add_u32 s34, s19, s18
    s_min_u32 s30, s34, 63
    s_mul_i32 s28, s30, 171
    s_lshr_b32 s28, s28, 9
    s_mul_i32 s76, s28, 3
    s_sub_u32 s76, s30, s76
    s_lshl_b32 s76, s76, 15
    s_add_u32 s28, s28, 4
    s_lshl_b32 s46, s28, 21
    s_add_u32 s46, s46, s76
    s_add_u32 s46, s46, 1982464
    s_lshr_b32 s29, s20, s28
    s_and_b32 s29, s29, 1
    s_lshl_b32 s29, s29, 13
    s_add_u32 s46, s46, s29
    s_xor_b32 s46, s46, 8192
    buffer_load_dword v7, v4, s[4:7], s46 offen sc1
    s_waitcnt lgkmcnt(5)
    v_mfma_f32_16x16x32_bf16 v[120:123], v[12:15], v[64:67], 0
    ds_read_b128 v[88:91], v44 offset:3072
    v_mfma_f32_16x16x32_bf16 v[124:127], v[64:67], v[64:67], 0
    s_waitcnt lgkmcnt(5)
    s_mul_i32 s28, s19, 171
    s_lshr_b32 s28, s28, 9
    v_mfma_f32_16x16x32_bf16 v[128:131], v[12:15], v[68:71], 0
    ds_read_b128 v[92:95], v44 offset:23552
    v_mfma_f32_16x16x32_bf16 v[132:135], v[68:71], v[68:71], 0
    s_waitcnt lgkmcnt(5)
    s_mul_i32 s76, s28, 3
    s_sub_u32 s76, s19, s76
    v_mfma_f32_16x16x32_bf16 v[120:123], v[12:15], v[72:75], v[120:123]
    ds_read_b128 v[64:67], v44 offset:4096
    v_mfma_f32_16x16x32_bf16 v[124:127], v[72:75], v[72:75], v[124:127]
    s_waitcnt lgkmcnt(5)
    s_lshl_b32 s76, s76, 15
    s_add_u32 s28, s28, 4
    v_mfma_f32_16x16x32_bf16 v[128:131], v[12:15], v[76:79], v[128:131]
    ds_read_b128 v[68:71], v44 offset:24576
    v_mfma_f32_16x16x32_bf16 v[132:135], v[76:79], v[76:79], v[132:135]
    s_waitcnt lgkmcnt(5)
    s_lshl_b32 s57, s28, 21
    s_add_u32 s57, s57, s76
    v_mfma_f32_16x16x32_bf16 v[120:123], v[12:15], v[80:83], v[120:123]
    ds_read_b128 v[72:75], v44 offset:0
    v_mfma_f32_16x16x32_bf16 v[124:127], v[80:83], v[80:83], v[124:127]
    s_waitcnt lgkmcnt(5)
    s_add_u32 s57, s57, 1966080
    s_lshr_b32 s29, s20, s28
    v_mfma_f32_16x16x32_bf16 v[128:131], v[12:15], v[84:87], v[128:131]
    ds_read_b128 v[76:79], v44 offset:1024
    v_mfma_f32_16x16x32_bf16 v[132:135], v[84:87], v[84:87], v[132:135]
    s_waitcnt lgkmcnt(5)
    s_and_b32 s29, s29, 1
    s_lshl_b32 s29, s29, 13
    v_mfma_f32_16x16x32_bf16 v[120:123], v[12:15], v[88:91], v[120:123]
    ds_read_b128 v[80:83], v44 offset:2048
    v_mfma_f32_16x16x32_bf16 v[124:127], v[88:91], v[88:91], v[124:127]
    s_waitcnt lgkmcnt(5)
    s_add_u32 s57, s57, s29
    s_xor_b32 s57, s57, 8192
    v_mfma_f32_16x16x32_bf16 v[128:131], v[12:15], v[92:95], v[128:131]
    ds_read_b128 v[84:87], v44 offset:3072
    v_mfma_f32_16x16x32_bf16 v[132:135], v[92:95], v[92:95], v[132:135]
    s_waitcnt lgkmcnt(5)
    s_lshl_b32 s31, s17, 7
    s_add_u32 s57, s57, s31
    v_mfma_f32_16x16x32_bf16 v[120:123], v[12:15], v[64:67], v[120:123]
    ds_read_b128 v[88:91], v44 offset:4096
    v_mfma_f32_16x16x32_bf16 v[124:127], v[64:67], v[64:67], v[124:127]
    s_waitcnt lgkmcnt(5)
    s_mul_i32 s70, s19, 98304
    s_lshl_b32 s31, s17, 10
    v_mfma_f32_16x16x32_bf16 v[128:131], v[12:15], v[68:71], v[128:131]
    ds_read_b128 v[92:95], v45 offset:0
    v_mfma_f32_16x16x32_bf16 v[132:135], v[68:71], v[68:71], v[132:135]
    s_waitcnt lgkmcnt(5)
    s_add_u32 s70, s70, s31
    s_add_u32 s70, s70, 223346688
    v_mfma_f32_16x16x32_bf16 v[48:51], a[0:3], v[72:75], 0
    ds_read_b128 v[64:67], v45 offset:1024
    v_mfma_f32_16x16x32_bf16 v[52:55], a[4:7], v[72:75], 0
    s_waitcnt lgkmcnt(5)
    s_add_u32 s71, s70, 49152
    s_mul_i32 s72, s34, 40960
    v_mfma_f32_16x16x32_bf16 v[48:51], a[8:11], v[76:79], v[48:51]
    ds_read_b128 v[68:71], v45 offset:2048
    v_mfma_f32_16x16x32_bf16 v[52:55], a[12:15], v[76:79], v[52:55]
    s_waitcnt lgkmcnt(5)
    s_mul_i32 s31, s16, 10240
    s_add_u32 s72, s72, s31
    v_mfma_f32_16x16x32_bf16 v[48:51], a[16:19], v[80:83], v[48:51]
    ds_read_b128 v[72:75], v45 offset:3072
    v_cndmask_b32 v124, v124, v125, s[64:65]
    v_cndmask_b32 v126, v126, v127, s[64:65]
    v_mfma_f32_16x16x32_bf16 v[52:55], a[20:23], v[80:83], v[52:55]
    s_waitcnt lgkmcnt(5)
    s_add_u32 s72, s72, 217055232
    s_xor_b32 s26, s26, 0x10000
    v_cndmask_b32 v41, v124, v126, s[66:67]
    v_mov_b32 v40, v120
    v_mfma_f32_16x16x32_bf16 v[48:51], a[24:27], v[84:87], v[48:51]
    ds_read_b128 v[76:79], v45 offset:4096
    v_cndmask_b32 v132, v132, v133, s[64:65]
    v_cndmask_b32 v134, v134, v135, s[64:65]
    v_mfma_f32_16x16x32_bf16 v[52:55], a[28:31], v[84:87], v[52:55]
    s_waitcnt lgkmcnt(5)
    v_cndmask_b32 v43, v132, v134, s[66:67]
    v_mov_b32 v42, v128
    v_mfma_f32_16x16x32_bf16 v[48:51], a[32:35], v[88:91], v[48:51]
    ds_read_b128 v[80:83], v46 offset:0
    v_mfma_f32_16x16x32_bf16 v[52:55], a[36:39], v[88:91], v[52:55]
    s_waitcnt lgkmcnt(5)
    s_mov_b64 exec, s[68:69]
    ds_write_b128 v5, v[40:43]
    s_mov_b64 exec, -1
    v_mfma_f32_16x16x32_bf16 v[48:51], a[40:43], v[92:95], v[48:51]
    ds_read_b128 v[84:87], v46 offset:1024
    v_mfma_f32_16x16x32_bf16 v[52:55], a[44:47], v[92:95], v[52:55]
    s_waitcnt lgkmcnt(6)
    v_mfma_f32_16x16x32_bf16 v[48:51], a[48:51], v[64:67], v[48:51]
    ds_read_b128 v[88:91], v46 offset:2048
    v_mfma_f32_16x16x32_bf16 v[52:55], a[52:55], v[64:67], v[52:55]
    s_waitcnt lgkmcnt(6)
    v_mfma_f32_16x16x32_bf16 v[48:51], a[56:59], v[68:71], v[48:51]
    ds_read_b128 v[92:95], v46 offset:3072
    v_mfma_f32_16x16x32_bf16 v[52:55], a[60:63], v[68:71], v[52:55]
    s_waitcnt lgkmcnt(6)
    s_waitcnt lgkmcnt(3)
    s_barrier
    ds_read_b128 v[96:99], v6 offset:0
    v_mfma_f32_16x16x32_bf16 v[48:51], a[64:67], v[72:75], v[48:51]
    ds_read_b128 v[64:67], v46 offset:4096
    ds_read_b128 v[100:103], v6 offset:256
    v_mfma_f32_16x16x32_bf16 v[52:55], a[68:71], v[72:75], v[52:55]
    ds_read_b128 v[104:107], v6 offset:512
    v_mfma_f32_16x16x32_bf16 v[48:51], a[72:75], v[76:79], v[48:51]
    ds_read_b128 v[68:71], v47 offset:0
    ds_read_b128 v[108:111], v6 offset:768
    v_mfma_f32_16x16x32_bf16 v[52:55], a[76:79], v[76:79], v[52:55]
    s_waitcnt vmcnt(0)
    v_cmp_gt_u32 vcc, 2, v7
    v_mfma_f32_16x16x32_bf16 v[48:51], a[80:83], v[80:83], v[48:51]
    ds_read_b128 v[72:75], v47 offset:1024
    v_mfma_f32_16x16x32_bf16 v[52:55], a[84:87], v[80:83], v[52:55]
    s_waitcnt lgkmcnt(9)
    buffer_store_dword v12, off, s[4:7], s47 sc1
    v_mfma_f32_16x16x32_bf16 v[48:51], a[88:91], v[84:87], v[48:51]
    ds_read_b128 v[76:79], v47 offset:2048
    s_waitcnt lgkmcnt(2)
    v_add_f32 v96, v96, v100
    v_add_f32 v104, v104, v108
    v_mfma_f32_16x16x32_bf16 v[52:55], a[92:95], v[84:87], v[52:55]
    s_cmp_lt_u32 s34, s59
    s_cselect_b32 s27, 1, 0
    v_add_f32 v40, v96, v104
    v_mul_f32 v40, 0x3acccccd, v40
    v_mfma_f32_16x16x32_bf16 v[48:51], a[96:99], v[88:91], v[48:51]
    ds_read_b128 v[80:83], v47 offset:3072
    v_add_f32 v97, v97, v101
    v_add_f32 v105, v105, v109
    v_mfma_f32_16x16x32_bf16 v[52:55], a[100:103], v[88:91], v[52:55]
    s_cmp_eq_u64 vcc, 0
    s_cselect_b32 s27, s27, 0
    v_add_f32 v41, v97, v105
    v_mul_f32 v41, 0x3acccccd, v41
    v_mfma_f32_16x16x32_bf16 v[48:51], a[104:107], v[92:95], v[48:51]
    ds_read_b128 v[84:87], v47 offset:4096
    v_add_f32 v98, v98, v102
    v_add_f32 v106, v106, v110
    v_mfma_f32_16x16x32_bf16 v[52:55], a[108:111], v[92:95], v[52:55]
    s_cmp_lg_u32 s27, 0
    s_cselect_b32 s72, s72, 0x7ff00000
    v_add_f32 v42, v98, v106
    v_mul_f32 v42, 0x3acccccd, v42
    v_mfma_f32_16x16x32_bf16 v[48:51], a[112:115], v[64:67], v[48:51]
    ds_read_b128 v[88:91], v44 offset:20480
    v_add_f32 v99, v99, v103
    v_add_f32 v107, v107, v111
    v_mfma_f32_16x16x32_bf16 v[52:55], a[116:119], v[64:67], v[52:55]
    s_add_u32 m0, s26, 0
    v_add_f32 v43, v99, v107
    v_mul_f32 v43, 0x3acccccd, v43
    v_mfma_f32_16x16x32_bf16 v[48:51], a[120:123], v[68:71], v[48:51]
    ds_read_b128 v[92:95], v44 offset:21504
    v_fma_f32 v41, -v40, v40, v41
    v_fma_f32 v43, -v42, v42, v43
    v_mfma_f32_16x16x32_bf16 v[52:55], a[124:127], v[68:71], v[52:55]
    s_waitcnt lgkmcnt(5)
    buffer_load_dwordx4 v2, s[4:7], s72 offen sc1 lds
    v_max_f32 v41, 0, v41
    v_max_f32 v43, 0, v43
    v_mfma_f32_16x16x32_bf16 v[48:51], a[128:131], v[72:75], v[48:51]
    s_add_u32 s72, s72, 1024
    ds_read_b128 v[64:67], v44 offset:22528
    v_cvt_pk_bf16_f32 v40, v40, v40
    v_cvt_pk_bf16_f32 v42, v42, v42
    v_mfma_f32_16x16x32_bf16 v[52:55], a[132:135], v[72:75], v[52:55]
    s_waitcnt lgkmcnt(5)
    s_add_u32 m0, s26, 1024
    v_and_b32 v40, 0xffff0000, v40
    v_and_b32 v42, 0xffff0000, v42
    v_mfma_f32_16x16x32_bf16 v[48:51], a[136:139], v[76:79], v[48:51]
    ds_read_b128 v[68:71], v44 offset:23552
    v_cvt_pk_bf16_f32 v41, v41, v41
    v_cvt_pk_bf16_f32 v43, v43, v43
    v_mfma_f32_16x16x32_bf16 v[52:55], a[140:143], v[76:79], v[52:55]
    s_waitcnt lgkmcnt(5)
    buffer_load_dwordx4 v2, s[4:7], s72 offen sc1 lds
    v_and_b32 v41, 0xffff0000, v41
    v_and_b32 v43, 0xffff0000, v43
    v_mfma_f32_16x16x32_bf16 v[48:51], a[144:147], v[80:83], v[48:51]
    s_add_u32 s72, s72, 1024
    ds_read_b128 v[72:75], v44 offset:24576
    v_add_f32 v41, 0x3727c5ac, v41
    v_add_f32 v43, 0x3727c5ac, v43
    v_mfma_f32_16x16x32_bf16 v[52:55], a[148:151], v[80:83], v[52:55]
    s_waitcnt lgkmcnt(5)
    s_add_u32 m0, s26, 2048
    v_cvt_pk_bf16_f32 v41, v41, v41
    v_cvt_pk_bf16_f32 v43, v43, v43
    v_mfma_f32_16x16x32_bf16 v[48:51], a[152:155], v[84:87], v[48:51]
    ds_read_b128 v[76:79], v45 offset:20480
    v_and_b32 v41, 0xffff0000, v41
    v_and_b32 v43, 0xffff0000, v43
    v_mfma_f32_16x16x32_bf16 v[52:55], a[156:159], v[84:87], v[52:55]
    s_waitcnt lgkmcnt(5)
    buffer_load_dwordx4 v2, s[4:7], s72 offen sc1 lds
    v_sqrt_f32 v41, v41
    v_sqrt_f32 v43, v43
    v_mfma_f32_16x16x32_bf16 v[56:59], a[0:3], v[88:91], 0
    s_add_u32 s72, s72, 1024
    ds_read_b128 v[80:83], v45 offset:21504
    v_cvt_pk_bf16_f32 v41, v41, v41
    v_cvt_pk_bf16_f32 v43, v43, v43
    v_mfma_f32_16x16x32_bf16 v[60:63], a[4:7], v[88:91], 0
    s_waitcnt lgkmcnt(5)
    s_add_u32 m0, s26, 3072
    v_and_b32 v41, 0xffff0000, v41
    v_and_b32 v43, 0xffff0000, v43
    v_mfma_f32_16x16x32_bf16 v[56:59], a[8:11], v[92:95], v[56:59]
    ds_read_b128 v[84:87], v45 offset:22528
    v_rcp_f32 v41, v41
    v_rcp_f32 v43, v43
    v_mfma_f32_16x16x32_bf16 v[60:63], a[12:15], v[92:95], v[60:63]
    s_waitcnt lgkmcnt(5)
    buffer_load_dwordx4 v2, s[4:7], s72 offen sc1 lds
    v_mul_f32 v40, v40, v41
    v_mul_f32 v42, v42, v43
    v_mfma_f32_16x16x32_bf16 v[56:59], a[16:19], v[64:67], v[56:59]
    s_add_u32 s72, s72, 1024
    ds_read_b128 v[88:91], v45 offset:23552
    v_fma_f32 v96, -v40, v24, v16
    v_fma_f32 v97, -v40, v25, v17
    v_mfma_f32_16x16x32_bf16 v[60:63], a[20:23], v[64:67], v[60:63]
    s_waitcnt lgkmcnt(5)
    s_add_u32 m0, s26, 4096
    v_fma_f32 v98, -v40, v26, v18
    v_fma_f32 v99, -v40, v27, v19
    v_mfma_f32_16x16x32_bf16 v[56:59], a[24:27], v[68:71], v[56:59]
    ds_read_b128 v[92:95], v45 offset:24576
    v_fma_f32 v100, -v40, v28, v20
    v_fma_f32 v101, -v40, v29, v21
    v_mfma_f32_16x16x32_bf16 v[60:63], a[28:31], v[68:71], v[60:63]
    s_waitcnt lgkmcnt(5)
    buffer_load_dwordx4 v2, s[4:7], s72 offen sc1 lds
    v_fma_f32 v102, -v40, v30, v22
    v_fma_f32 v103, -v40, v31, v23
    v_mfma_f32_16x16x32_bf16 v[56:59], a[32:35], v[72:75], v[56:59]
    s_add_u32 s72, s72, 1024
    ds_read_b128 v[64:67], v46 offset:20480
    v_fma_f32 v48, v48, v41, v96
    v_fma_f32 v49, v49, v41, v97
    v_mfma_f32_16x16x32_bf16 v[60:63], a[36:39], v[72:75], v[60:63]
    s_waitcnt lgkmcnt(5)
    s_add_u32 m0, s26, 5120
    v_fma_f32 v50, v50, v41, v98
    v_fma_f32 v51, v51, v41, v99
    v_mfma_f32_16x16x32_bf16 v[56:59], a[40:43], v[76:79], v[56:59]
    ds_read_b128 v[68:71], v46 offset:21504
    v_fma_f32 v52, v52, v41, v100
    v_fma_f32 v53, v53, v41, v101
    v_mfma_f32_16x16x32_bf16 v[60:63], a[44:47], v[76:79], v[60:63]
    s_waitcnt lgkmcnt(5)
    buffer_load_dwordx4 v2, s[4:7], s72 offen sc1 lds
    v_fma_f32 v54, v54, v41, v102
    v_fma_f32 v55, v55, v41, v103
    v_mfma_f32_16x16x32_bf16 v[56:59], a[48:51], v[80:83], v[56:59]
    s_add_u32 s72, s72, 1024
    ds_read_b128 v[72:75], v46 offset:22528
    v_mul_f32 v96, s39, v48
    v_mul_f32 v97, s39, v49
    v_mfma_f32_16x16x32_bf16 v[60:63], a[52:55], v[80:83], v[60:63]
    s_waitcnt lgkmcnt(5)
    s_add_u32 m0, s26, 6144
    v_mul_f32 v98, s39, v50
    v_mul_f32 v99, s39, v51
    v_mfma_f32_16x16x32_bf16 v[56:59], a[56:59], v[84:87], v[56:59]
    ds_read_b128 v[76:79], v46 offset:23552
    v_mul_f32 v100, s39, v52
    v_mul_f32 v101, s39, v53
    v_mfma_f32_16x16x32_bf16 v[60:63], a[60:63], v[84:87], v[60:63]
    s_waitcnt lgkmcnt(5)
    buffer_load_dwordx4 v2, s[4:7], s72 offen sc1 lds
    v_mul_f32 v102, s39, v54
    v_mul_f32 v103, s39, v55
    v_mfma_f32_16x16x32_bf16 v[56:59], a[64:67], v[88:91], v[56:59]
    s_add_u32 s72, s72, 1024
    ds_read_b128 v[80:83], v46 offset:24576
    v_min_f32 v96, s38, v96
    v_min_f32 v97, s38, v97
    v_mfma_f32_16x16x32_bf16 v[60:63], a[68:71], v[88:91], v[60:63]
    s_waitcnt lgkmcnt(5)
    s_add_u32 m0, s26, 7168
    v_min_f32 v98, s38, v98
    v_min_f32 v99, s38, v99
    v_mfma_f32_16x16x32_bf16 v[56:59], a[72:75], v[92:95], v[56:59]
    ds_read_b128 v[84:87], v47 offset:20480
    v_min_f32 v100, s38, v100
    v_min_f32 v101, s38, v101
    v_mfma_f32_16x16x32_bf16 v[60:63], a[76:79], v[92:95], v[60:63]
    s_waitcnt lgkmcnt(5)
    buffer_load_dwordx4 v2, s[4:7], s72 offen sc1 lds
    v_min_f32 v102, s38, v102
    v_min_f32 v103, s38, v103
    v_mfma_f32_16x16x32_bf16 v[56:59], a[80:83], v[64:67], v[56:59]
    s_add_u32 s72, s72, 1024
    ds_read_b128 v[88:91], v47 offset:21504
    v_exp_f32 v96, v96
    v_mfma_f32_16x16x32_bf16 v[60:63], a[84:87], v[64:67], v[60:63]
    s_waitcnt lgkmcnt(5)
    s_add_u32 m0, s26, 8192
    v_exp_f32 v97, v97
    v_mfma_f32_16x16x32_bf16 v[56:59], a[88:91], v[68:71], v[56:59]
    ds_read_b128 v[92:95], v47 offset:22528
    v_exp_f32 v98, v98
    v_mfma_f32_16x16x32_bf16 v[60:63], a[92:95], v[68:71], v[60:63]
    s_waitcnt lgkmcnt(5)
    buffer_load_dwordx4 v2, s[4:7], s72 offen sc1 lds
    v_exp_f32 v99, v99
    v_mfma_f32_16x16x32_bf16 v[56:59], a[96:99], v[72:75], v[56:59]
    s_add_u32 s72, s72, 1024
    ds_read_b128 v[64:67], v47 offset:23552
    v_exp_f32 v100, v100
    v_mfma_f32_16x16x32_bf16 v[60:63], a[100:103], v[72:75], v[60:63]
    s_waitcnt lgkmcnt(5)
    s_add_u32 m0, s26, 9216
    v_exp_f32 v101, v101
    v_mfma_f32_16x16x32_bf16 v[56:59], a[104:107], v[76:79], v[56:59]
    ds_read_b128 v[68:71], v47 offset:24576
    v_exp_f32 v102, v102
    v_mfma_f32_16x16x32_bf16 v[60:63], a[108:111], v[76:79], v[60:63]
    s_waitcnt lgkmcnt(5)
    buffer_load_dwordx4 v2, s[4:7], s72 offen sc1 lds
    v_exp_f32 v103, v103
    v_mfma_f32_16x16x32_bf16 v[56:59], a[112:115], v[80:83], v[56:59]
    s_add_u32 s72, s72, 1024
    v_add_f32 v104, 2.0, v96
    v_add_f32 v105, 2.0, v97
    v_mfma_f32_16x16x32_bf16 v[60:63], a[116:119], v[80:83], v[60:63]
    s_waitcnt lgkmcnt(4)
    v_add_f32 v106, 2.0, v98
    v_add_f32 v107, 2.0, v99
    v_mfma_f32_16x16x32_bf16 v[56:59], a[120:123], v[84:87], v[56:59]
    v_add_f32 v108, 2.0, v100
    v_add_f32 v109, 2.0, v101
    v_mfma_f32_16x16x32_bf16 v[60:63], a[124:127], v[84:87], v[60:63]
    s_waitcnt lgkmcnt(3)
    v_add_f32 v110, 2.0, v102
    v_add_f32 v111, 2.0, v103
    v_mfma_f32_16x16x32_bf16 v[56:59], a[128:131], v[88:91], v[56:59]
    v_fma_f32 v112, v96, v104, 2.0
    v_fma_f32 v113, v97, v105, 2.0
    v_mfma_f32_16x16x32_bf16 v[60:63], a[132:135], v[88:91], v[60:63]
    s_waitcnt lgkmcnt(2)
    v_fma_f32 v114, v98, v106, 2.0
    v_fma_f32 v115, v99, v107, 2.0
    v_mfma_f32_16x16x32_bf16 v[56:59], a[136:139], v[92:95], v[56:59]
    v_fma_f32 v116, v100, v108, 2.0
    v_fma_f32 v117, v101, v109, 2.0
    v_mfma_f32_16x16x32_bf16 v[60:63], a[140:143], v[92:95], v[60:63]
    s_waitcnt lgkmcnt(1)
    v_fma_f32 v118, v102, v110, 2.0
    v_fma_f32 v119, v103, v111, 2.0
    v_mfma_f32_16x16x32_bf16 v[56:59], a[144:147], v[64:67], v[56:59]
    v_rcp_f32 v112, v112
    v_mfma_f32_16x16x32_bf16 v[60:63], a[148:151], v[64:67], v[60:63]
    s_waitcnt lgkmcnt(0)
    v_rcp_f32 v113, v113
    v_mfma_f32_16x16x32_bf16 v[56:59], a[152:155], v[68:71], v[56:59]
    v_rcp_f32 v114, v114
    v_mfma_f32_16x16x32_bf16 v[60:63], a[156:159], v[68:71], v[60:63]
    v_rcp_f32 v115, v115
    v_xor_b32 v44, 0x10000, v44
    v_xor_b32 v45, 0x10000, v45
    v_xor_b32 v46, 0x10000, v46
    v_xor_b32 v47, 0x10000, v47
    s_mov_b32 s47, 0x7ffffff0
    v_cmp_u_f32 vcc, v40, v42
    s_cbranch_vccz PC_ok
    s_cmp_eq_u32 s58, 2
    s_mov_b32 s58, 2
    s_cbranch_scc0 PC_redo
PC_ok:
    v_rcp_f32 v116, v116
    v_rcp_f32 v117, v117
    v_rcp_f32 v118, v118
    v_rcp_f32 v119, v119
    v_mul_f32 v96, v96, v104
    v_mul_f32 v97, v97, v105
    v_mul_f32 v98, v98, v106
    v_mul_f32 v99, v99, v107
    v_mul_f32 v100, v100, v108
    v_mul_f32 v101, v101, v109
    v_mul_f32 v102, v102, v110
    v_mul_f32 v103, v103, v111
    v_mul_f32 v96, v96, v112
    v_mul_f32 v97, v97, v113
    v_mul_f32 v98, v98, v114
    v_mul_f32 v99, v99, v115
    v_mul_f32 v100, v100, v116
    v_mul_f32 v101, v101, v117
    v_mul_f32 v102, v102, v118
    v_mul_f32 v103, v103, v119
    v_mul_f32 v48, v48, v96
    v_mul_f32 v49, v49, v97
    v_mul_f32 v50, v50, v98
    v_mul_f32 v51, v51, v99
    v_mul_f32 v52, v52, v100
    v_mul_f32 v53, v53, v101
    v_mul_f32 v54, v54, v102
    v_mul_f32 v55, v55, v103
    v_cvt_pk_bf16_f32 v32, v48, v49
    v_cvt_pk_bf16_f32 v33, v50, v51
    v_cvt_pk_bf16_f32 v34, v52, v53
    v_cvt_pk_bf16_f32 v35, v54, v55
    buffer_store_dwordx4 v[32:35], v2, s[4:7], s70 offen sc1
    v_fma_f32 v96, -v42, v24, v16
    v_fma_f32 v97, -v42, v25, v17
    v_fma_f32 v98, -v42, v26, v18
    v_fma_f32 v99, -v42, v27, v19
    v_fma_f32 v100, -v42, v28, v20
    v_fma_f32 v101, -v42, v29, v21
    v_fma_f32 v102, -v42, v30, v22
    v_fma_f32 v103, -v42, v31, v23
    v_fma_f32 v56, v56, v43, v96
    v_fma_f32 v57, v57, v43, v97
    v_fma_f32 v58, v58, v43, v98
    v_fma_f32 v59, v59, v43, v99
    v_fma_f32 v60, v60, v43, v100
    v_fma_f32 v61, v61, v43, v101
    v_fma_f32 v62, v62, v43, v102
    v_fma_f32 v63, v63, v43, v103
    v_mul_f32 v96, s39, v56
    v_mul_f32 v97, s39, v57
    v_mul_f32 v98, s39, v58
    v_mul_f32 v99, s39, v59
    v_mul_f32 v100, s39, v60
    v_mul_f32 v101, s39, v61
    v_mul_f32 v102, s39, v62
    v_mul_f32 v103, s39, v63
    v_min_f32 v96, s38, v96
    v_min_f32 v97, s38, v97
    v_min_f32 v98, s38, v98
    v_min_f32 v99, s38, v99
    v_min_f32 v100, s38, v100
    v_min_f32 v101, s38, v101
    v_min_f32 v102, s38, v102
    v_min_f32 v103, s38, v103
    v_exp_f32 v96, v96
    v_exp_f32 v97, v97
    v_exp_f32 v98, v98
    v_exp_f32 v99, v99
    v_exp_f32 v100, v100
    v_exp_f32 v101, v101
    v_exp_f32 v102, v102
    v_exp_f32 v103, v103
    v_add_f32 v104, 2.0, v96
    v_add_f32 v105, 2.0, v97
    v_add_f32 v106, 2.0, v98
    v_add_f32 v107, 2.0, v99
    v_add_f32 v108, 2.0, v100
    v_add_f32 v109, 2.0, v101
    v_add_f32 v110, 2.0, v102
    v_add_f32 v111, 2.0, v103
    v_fma_f32 v112, v96, v104, 2.0
    v_fma_f32 v113, v97, v105, 2.0
    v_fma_f32 v114, v98, v106, 2.0
    v_fma_f32 v115, v99, v107, 2.0
    v_fma_f32 v116, v100, v108, 2.0
    v_fma_f32 v117, v101, v109, 2.0
    v_fma_f32 v118, v102, v110, 2.0
    v_fma_f32 v119, v103, v111, 2.0
    s_cmp_ge_u32 s19, 60
    s_cselect_b32 s33, s57, 0x7ffffff0
    v_mov_b32 v8, 1
    s_mov_b64 exec, 1
    buffer_store_dword v8, v2, s[4:7], s33 offen sc1
    s_mov_b64 exec, -1
    v_rcp_f32 v112, v112
    v_rcp_f32 v113, v113
    v_rcp_f32 v114, v114
    v_rcp_f32 v115, v115
    v_rcp_f32 v116, v116
    v_rcp_f32 v117, v117
    v_rcp_f32 v118, v118
    v_rcp_f32 v119, v119
    v_mul_f32 v96, v96, v104
    v_mul_f32 v97, v97, v105
    v_mul_f32 v98, v98, v106
    v_mul_f32 v99, v99, v107
    v_mul_f32 v100, v100, v108
    v_mul_f32 v101, v101, v109
    v_mul_f32 v102, v102, v110
    v_mul_f32 v103, v103, v111
    v_mul_f32 v96, v96, v112
    v_mul_f32 v97, v97, v113
    v_mul_f32 v98, v98, v114
    v_mul_f32 v99, v99, v115
    v_mul_f32 v100, v100, v116
    v_mul_f32 v101, v101, v117
    v_mul_f32 v102, v102, v118
    v_mul_f32 v103, v103, v119
    v_mul_f32 v56, v56, v96
    v_mul_f32 v57, v57, v97
    v_mul_f32 v58, v58, v98
    v_mul_f32 v59, v59, v99
    v_mul_f32 v60, v60, v100
    v_mul_f32 v61, v61, v101
    v_mul_f32 v62, v62, v102
    v_mul_f32 v63, v63, v103
    v_cvt_pk_bf16_f32 v36, v56, v57
    v_cvt_pk_bf16_f32 v37, v58, v59
    v_cvt_pk_bf16_f32 v38, v60, v61
    v_cvt_pk_bf16_f32 v39, v62, v63
    buffer_store_dwordx4 v[36:39], v2, s[4:7], s71 offen sc1
    s_mov_b32 s47, s57
    s_mov_b32 s19, s34
    s_cmp_ge_u32 s19, 60
    s_cselect_b32 s58, 1, 2
    s_cmp_lg_u32 s27, 0
    s_cbranch_scc1 PC_have
    s_cmp_lt_u32 s19, s59
    s_cbranch_scc1 PC_seg
    v_mov_b32 v8, 2
    s_waitcnt vmcnt(0)
    s_mov_b64 exec, 1
    buffer_store_dword v8, v2, s[4:7], s47 offen sc1
    s_mov_b64 exec, -1
    s_endpgm
P_d:
    s_load_dwordx4 s[40:43], s[0:1], 80
    s_waitcnt lgkmcnt(0)
    s_mov_b32 s8, s42
    s_and_b32 s9, s43, 0xffff
    s_mov_b32 s10, 2621440
    s_mov_b32 s11, 0x20000
    s_mov_b32 s12, s40
    s_and_b32 s13, s41, 0xffff
    s_mov_b32 s14, 1966080
    s_mov_b32 s15, 0x20000
    s_lshl_b32 s30, s16, 10
    v_add_u32 v10, s30, v2
    s_lshl_b32 s30, s16, 13
    v_add_u32 v11, s30, v2
    v_and_b32 v6, 15, v1
    v_mul_u32_u24 v6, 1280, v6
    v_lshrrev_b32 v7, 4, v1
    v_lshlrev_b32 v7, 3, v7
    v_add_u32 v6, v6, v7
    v_and_b32 v7, 0xff, v2
    v_lshrrev_b32 v8, 5, v1
    v_lshlrev_b32 v8, 8, v8
    v_add_u32 v7, v7, v8
    v_and_b32 v8, 16, v1
    v_lshrrev_b32 v8, 1, v8
    v_add_u32 v7, v7, v8
    s_lshl_b32 s42, s17, 2
    s_mul_i32 s43, s16, 12288
    s_mul_i32 s31, s16, 491520
    s_lshl_b32 s30, s17, 7
    s_add_u32 s31, s31, s30
    s_mul_i32 s32, s16, 24576
    v_lshrrev_b32 v8, 3, v1
    v_mul_u32_u24 v8, 1280, v8
    v_and_b32 v9, 7, v1
    v_lshlrev_b32 v9, 4, v9
    v_add_u32 v8, v8, v9
    v_lshrrev_b32 v9, 2, v1
    v_lshlrev_b32 v9, 7, v9
    v_and_b32 v12, 3, v1
    v_lshlrev_b32 v12, 3, v12
    v_add3_u32 v9, v9, v12, s32
    s_mul_i32 s30, s17, 11
    s_lshr_b32 s30, s30, 5
    s_mul_i32 s30, s30, 3
    s_sub_u32 s30, s17, s30
    s_mov_b32 s30, 0
    s_add_u32 s33, s30, 0
    s_cmp_ge_u32 s33, 3
    s_cselect_b32 s34, 3, 0
    s_sub_u32 s33, s33, s34
    s_lshl_b32 s66, s33, 12
    s_add_u32 s33, s30, 1
    s_cmp_ge_u32 s33, 3
    s_cselect_b32 s34, 3, 0
    s_sub_u32 s33, s33, s34
    s_lshl_b32 s67, s33, 12
    s_add_u32 s33, s30, 2
    s_cmp_ge_u32 s33, 3
    s_cselect_b32 s34, 3, 0
    s_sub_u32 s33, s33, s34
    s_lshl_b32 s68, s33, 12
    s_mul_i32 s33, s66, 40
    s_add_u32 s33, s33, s31
    s_add_u32 m0, s32, 0
    s_nop 0
    buffer_load_dwordx4 v8, s[12:15], s33 offen lds
    s_add_u32 s33, s33, 10240
    s_add_u32 m0, s32, 1024
    s_nop 0
    buffer_load_dwordx4 v8, s[12:15], s33 offen lds
    s_add_u32 s33, s33, 10240
    s_add_u32 m0, s32, 2048
    s_nop 0
    buffer_load_dwordx4 v8, s[12:15], s33 offen lds
    s_add_u32 s33, s33, 10240
    s_add_u32 m0, s32, 3072
    s_nop 0
    buffer_load_dwordx4 v8, s[12:15], s33 offen lds
    s_add_u32 s33, s33, 10240
    s_add_u32 m0, s32, 4096
    s_nop 0
    buffer_load_dwordx4 v8, s[12:15], s33 offen lds
    s_add_u32 s33, s33, 10240
    s_add_u32 m0, s32, 5120
    s_nop 0
    buffer_load_dwordx4 v8, s[12:15], s33 offen lds
    s_add_u32 s33, s33, 10240
    s_add_u32 m0, s32, 6144
    s_nop 0
    buffer_load_dwordx4 v8, s[12:15], s33 offen lds
    s_add_u32 s33, s33, 10240
    s_add_u32 m0, s32, 7168
    s_nop 0
    buffer_load_dwordx4 v8, s[12:15], s33 offen lds
    s_add_u32 s33, s33, 10240
    s_add_u32 m0, s32, 8192
    s_nop 0
    buffer_load_dwordx4 v8, s[12:15], s33 offen lds
    s_add_u32 s33, s33, 10240
    s_add_u32 m0, s32, 9216
    s_nop 0
    buffer_load_dwordx4 v8, s[12:15], s33 offen lds
    s_add_u32 s33, s33, 10240
    s_add_u32 m0, s32, 10240
    s_nop 0
    buffer_load_dwordx4 v8, s[12:15], s33 offen lds
    s_add_u32 s33, s33, 10240
    s_add_u32 m0, s32, 11264
    s_nop 0
    buffer_load_dwordx4 v8, s[12:15], s33 offen lds
    s_add_u32 s33, s33, 10240
    s_add_u32 m0, s32, 12288
    s_nop 0
    buffer_load_dwordx4 v8, s[12:15], s33 offen lds
    s_add_u32 s33, s33, 10240
    s_add_u32 m0, s32, 13312
    s_nop 0
    buffer_load_dwordx4 v8, s[12:15], s33 offen lds
    s_add_u32 s33, s33, 10240
    s_add_u32 m0, s32, 14336
    s_nop 0
    buffer_load_dwordx4 v8, s[12:15], s33 offen lds
    s_add_u32 s33, s33, 10240
    s_add_u32 m0, s32, 15360
    s_nop 0
    buffer_load_dwordx4 v8, s[12:15], s33 offen lds
    s_add_u32 s33, s33, 10240
    s_waitcnt vmcnt(0)
    ds_read_b64_tr_b16 a[0:1], v9 offset:0
    ds_read_b64_tr_b16 a[2:3], v9 offset:2048
    ds_read_b64_tr_b16 a[48:49], v9 offset:32
    ds_read_b64_tr_b16 a[50:51], v9 offset:2080
    ds_read_b64_tr_b16 a[96:97], v9 offset:64
    ds_read_b64_tr_b16 a[98:99], v9 offset:2112
    ds_read_b64_tr_b16 a[144:145], v9 offset:96
    ds_read_b64_tr_b16 a[146:147], v9 offset:2144
    ds_read_b64_tr_b16 a[4:5], v9 offset:4096
    ds_read_b64_tr_b16 a[6:7], v9 offset:6144
    ds_read_b64_tr_b16 a[52:53], v9 offset:4128
    ds_read_b64_tr_b16 a[54:55], v9 offset:6176
    ds_read_b64_tr_b16 a[100:101], v9 offset:4160
    ds_read_b64_tr_b16 a[102:103], v9 offset:6208
    ds_read_b64_tr_b16 a[148:149], v9 offset:4192
    ds_read_b64_tr_b16 a[150:151], v9 offset:6240
    ds_read_b64_tr_b16 a[8:9], v9 offset:8192
    ds_read_b64_tr_b16 a[10:11], v9 offset:10240
    ds_read_b64_tr_b16 a[56:57], v9 offset:8224
    ds_read_b64_tr_b16 a[58:59], v9 offset:10272
    ds_read_b64_tr_b16 a[104:105], v9 offset:8256
    ds_read_b64_tr_b16 a[106:107], v9 offset:10304
    ds_read_b64_tr_b16 a[152:153], v9 offset:8288
    ds_read_b64_tr_b16 a[154:155], v9 offset:10336
    ds_read_b64_tr_b16 a[12:13], v9 offset:12288
    ds_read_b64_tr_b16 a[14:15], v9 offset:14336
    ds_read_b64_tr_b16 a[60:61], v9 offset:12320
    ds_read_b64_tr_b16 a[62:63], v9 offset:14368
    ds_read_b64_tr_b16 a[108:109], v9 offset:12352
    ds_read_b64_tr_b16 a[110:111], v9 offset:14400
    ds_read_b64_tr_b16 a[156:157], v9 offset:12384
    ds_read_b64_tr_b16 a[158:159], v9 offset:14432
    s_waitcnt lgkmcnt(0)
    s_mul_i32 s33, s67, 40
    s_add_u32 s33, s33, s31
    s_add_u32 m0, s32, 0
    s_nop 0
    buffer_load_dwordx4 v8, s[12:15], s33 offen lds
    s_add_u32 s33, s33, 10240
    s_add_u32 m0, s32, 1024
    s_nop 0
    buffer_load_dwordx4 v8, s[12:15], s33 offen lds
    s_add_u32 s33, s33, 10240
    s_add_u32 m0, s32, 2048
    s_nop 0
    buffer_load_dwordx4 v8, s[12:15], s33 offen lds
    s_add_u32 s33, s33, 10240
    s_add_u32 m0, s32, 3072
    s_nop 0
    buffer_load_dwordx4 v8, s[12:15], s33 offen lds
    s_add_u32 s33, s33, 10240
    s_add_u32 m0, s32, 4096
    s_nop 0
    buffer_load_dwordx4 v8, s[12:15], s33 offen lds
    s_add_u32 s33, s33, 10240
    s_add_u32 m0, s32, 5120
    s_nop 0
    buffer_load_dwordx4 v8, s[12:15], s33 offen lds
    s_add_u32 s33, s33, 10240
    s_add_u32 m0, s32, 6144
    s_nop 0
    buffer_load_dwordx4 v8, s[12:15], s33 offen lds
    s_add_u32 s33, s33, 10240
    s_add_u32 m0, s32, 7168
    s_nop 0
    buffer_load_dwordx4 v8, s[12:15], s33 offen lds
    s_add_u32 s33, s33, 10240
    s_add_u32 m0, s32, 8192
    s_nop 0
    buffer_load_dwordx4 v8, s[12:15], s33 offen lds
    s_add_u32 s33, s33, 10240
    s_add_u32 m0, s32, 9216
    s_nop 0
    buffer_load_dwordx4 v8, s[12:15], s33 offen lds
    s_add_u32 s33, s33, 10240
    s_add_u32 m0, s32, 10240
    s_nop 0
    buffer_load_dwordx4 v8, s[12:15], s33 offen lds
    s_add_u32 s33, s33, 10240
    s_add_u32 m0, s32, 11264
    s_nop 0
    buffer_load_dwordx4 v8, s[12:15], s33 offen lds
    s_add_u32 s33, s33, 10240
    s_add_u32 m0, s32, 12288
    s_nop 0
    buffer_load_dwordx4 v8, s[12:15], s33 offen lds
    s_add_u32 s33, s33, 10240
    s_add_u32 m0, s32, 13312
    s_nop 0
    buffer_load_dwordx4 v8, s[12:15], s33 offen lds
    s_add_u32 s33, s33, 10240
    s_add_u32 m0, s32, 14336
    s_nop 0
    buffer_load_dwordx4 v8, s[12:15], s33 offen lds
    s_add_u32 s33, s33, 10240
    s_add_u32 m0, s32, 15360
    s_nop 0
    buffer_load_dwordx4 v8, s[12:15], s33 offen lds
    s_add_u32 s33, s33, 10240
    s_waitcnt vmcnt(0)
    ds_read_b64_tr_b16 a[16:17], v9 offset:0
    ds_read_b64_tr_b16 a[18:19], v9 offset:2048
    ds_read_b64_tr_b16 a[64:65], v9 offset:32
    ds_read_b64_tr_b16 a[66:67], v9 offset:2080
    ds_read_b64_tr_b16 a[112:113], v9 offset:64
    ds_read_b64_tr_b16 a[114:115], v9 offset:2112
    ds_read_b64_tr_b16 a[160:161], v9 offset:96
    ds_read_b64_tr_b16 a[162:163], v9 offset:2144
    ds_read_b64_tr_b16 a[20:21], v9 offset:4096
    ds_read_b64_tr_b16 a[22:23], v9 offset:6144
    ds_read_b64_tr_b16 a[68:69], v9 offset:4128
    ds_read_b64_tr_b16 a[70:71], v9 offset:6176
    ds_read_b64_tr_b16 a[116:117], v9 offset:4160
    ds_read_b64_tr_b16 a[118:119], v9 offset:6208
    ds_read_b64_tr_b16 a[164:165], v9 offset:4192
    ds_read_b64_tr_b16 a[166:167], v9 offset:6240
    ds_read_b64_tr_b16 a[24:25], v9 offset:8192
    ds_read_b64_tr_b16 a[26:27], v9 offset:10240
    ds_read_b64_tr_b16 a[72:73], v9 offset:8224
    ds_read_b64_tr_b16 a[74:75], v9 offset:10272
    ds_read_b64_tr_b16 a[120:121], v9 offset:8256
    ds_read_b64_tr_b16 a[122:123], v9 offset:10304
    ds_read_b64_tr_b16 a[168:169], v9 offset:8288
    ds_read_b64_tr_b16 a[170:171], v9 offset:10336
    ds_read_b64_tr_b16 a[28:29], v9 offset:12288
    ds_read_b64_tr_b16 a[30:31], v9 offset:14336
    ds_read_b64_tr_b16 a[76:77], v9 offset:12320
    ds_read_b64_tr_b16 a[78:79], v9 offset:14368
    ds_read_b64_tr_b16 a[124:125], v9 offset:12352
    ds_read_b64_tr_b16 a[126:127], v9 offset:14400
    ds_read_b64_tr_b16 a[172:173], v9 offset:12384
    ds_read_b64_tr_b16 a[174:175], v9 offset:14432
    s_waitcnt lgkmcnt(0)
    s_mul_i32 s33, s68, 40
    s_add_u32 s33, s33, s31
    s_add_u32 m0, s32, 0
    s_nop 0
    buffer_load_dwordx4 v8, s[12:15], s33 offen lds
    s_add_u32 s33, s33, 10240
    s_add_u32 m0, s32, 1024
    s_nop 0
    buffer_load_dwordx4 v8, s[12:15], s33 offen lds
    s_add_u32 s33, s33, 10240
    s_add_u32 m0, s32, 2048
    s_nop 0
    buffer_load_dwordx4 v8, s[12:15], s33 offen lds
    s_add_u32 s33, s33, 10240
    s_add_u32 m0, s32, 3072
    s_nop 0
    buffer_load_dwordx4 v8, s[12:15], s33 offen lds
    s_add_u32 s33, s33, 10240
    s_add_u32 m0, s32, 4096
    s_nop 0
    buffer_load_dwordx4 v8, s[12:15], s33 offen lds
    s_add_u32 s33, s33, 10240
    s_add_u32 m0, s32, 5120
    s_nop 0
    buffer_load_dwordx4 v8, s[12:15], s33 offen lds
    s_add_u32 s33, s33, 10240
    s_add_u32 m0, s32, 6144
    s_nop 0
    buffer_load_dwordx4 v8, s[12:15], s33 offen lds
    s_add_u32 s33, s33, 10240
    s_add_u32 m0, s32, 7168
    s_nop 0
    buffer_load_dwordx4 v8, s[12:15], s33 offen lds
    s_add_u32 s33, s33, 10240
    s_add_u32 m0, s32, 8192
    s_nop 0
    buffer_load_dwordx4 v8, s[12:15], s33 offen lds
    s_add_u32 s33, s33, 10240
    s_add_u32 m0, s32, 9216
    s_nop 0
    buffer_load_dwordx4 v8, s[12:15], s33 offen lds
    s_add_u32 s33, s33, 10240
    s_add_u32 m0, s32, 10240
    s_nop 0
    buffer_load_dwordx4 v8, s[12:15], s33 offen lds
    s_add_u32 s33, s33, 10240
    s_add_u32 m0, s32, 11264
    s_nop 0
    buffer_load_dwordx4 v8, s[12:15], s33 offen lds
    s_add_u32 s33, s33, 10240
    s_add_u32 m0, s32, 12288
    s_nop 0
    buffer_load_dwordx4 v8, s[12:15], s33 offen lds
    s_add_u32 s33, s33, 10240
    s_add_u32 m0, s32, 13312
    s_nop 0
    buffer_load_dwordx4 v8, s[12:15], s33 offen lds
    s_add_u32 s33, s33, 10240
    s_add_u32 m0, s32, 14336
    s_nop 0
    buffer_load_dwordx4 v8, s[12:15], s33 offen lds
    s_add_u32 s33, s33, 10240
    s_add_u32 m0, s32, 15360
    s_nop 0
    buffer_load_dwordx4 v8, s[12:15], s33 offen lds
    s_add_u32 s33, s33, 10240
    s_waitcnt vmcnt(0)
    ds_read_b64_tr_b16 a[32:33], v9 offset:0
    ds_read_b64_tr_b16 a[34:35], v9 offset:2048
    ds_read_b64_tr_b16 a[80:81], v9 offset:32
    ds_read_b64_tr_b16 a[82:83], v9 offset:2080
    ds_read_b64_tr_b16 a[128:129], v9 offset:64
    ds_read_b64_tr_b16 a[130:131], v9 offset:2112
    ds_read_b64_tr_b16 a[176:177], v9 offset:96
    ds_read_b64_tr_b16 a[178:179], v9 offset:2144
    ds_read_b64_tr_b16 a[36:37], v9 offset:4096
    ds_read_b64_tr_b16 a[38:39], v9 offset:6144
    ds_read_b64_tr_b16 a[84:85], v9 offset:4128
    ds_read_b64_tr_b16 a[86:87], v9 offset:6176
    ds_read_b64_tr_b16 a[132:133], v9 offset:4160
    ds_read_b64_tr_b16 a[134:135], v9 offset:6208
    ds_read_b64_tr_b16 a[180:181], v9 offset:4192
    ds_read_b64_tr_b16 a[182:183], v9 offset:6240
    ds_read_b64_tr_b16 a[40:41], v9 offset:8192
    ds_read_b64_tr_b16 a[42:43], v9 offset:10240
    ds_read_b64_tr_b16 a[88:89], v9 offset:8224
    ds_read_b64_tr_b16 a[90:91], v9 offset:10272
    ds_read_b64_tr_b16 a[136:137], v9 offset:8256
    ds_read_b64_tr_b16 a[138:139], v9 offset:10304
    ds_read_b64_tr_b16 a[184:185], v9 offset:8288
    ds_read_b64_tr_b16 a[186:187], v9 offset:10336
    ds_read_b64_tr_b16 a[44:45], v9 offset:12288
    ds_read_b64_tr_b16 a[46:47], v9 offset:14336
    ds_read_b64_tr_b16 a[92:93], v9 offset:12320
    ds_read_b64_tr_b16 a[94:95], v9 offset:14368
    ds_read_b64_tr_b16 a[140:141], v9 offset:12352
    ds_read_b64_tr_b16 a[142:143], v9 offset:14400
    ds_read_b64_tr_b16 a[188:189], v9 offset:12384
    ds_read_b64_tr_b16 a[190:191], v9 offset:14432
    s_waitcnt lgkmcnt(0)
    s_barrier
    s_add_u32 s42, s42, s16
    v_min_u32 v9, 11, v1
    v_lshlrev_b32 v9, 7, v9
    s_mul_i32 s44, s16, 1536
    s_cmp_ge_u32 s19, 60
    s_cselect_b32 s58, 1, 2
PD_seg:
    s_mul_i32 s60, s19, 98304
    s_add_u32 s60, s60, s43
    s_add_u32 s60, s60, 223346688
    s_add_u32 s61, s60, s67
    s_add_u32 s62, s60, s68
    s_add_u32 s60, s60, s66
    s_add_u32 s63, s60, 49152
    s_add_u32 s64, s61, 49152
    s_add_u32 s65, s62, 49152
    s_add_u32 s34, s19, s18
    s_min_u32 s31, s34, 63
    s_mul_i32 s28, s31, 171
    s_lshr_b32 s28, s28, 9
    s_mul_i32 s76, s28, 3
    s_sub_u32 s76, s31, s76
    s_lshl_b32 s76, s76, 15
    s_add_u32 s28, s28, 4
    s_lshl_b32 s30, s28, 21
    s_add_u32 s30, s30, s76
    s_add_u32 s30, s30, 1966080
    s_lshr_b32 s29, s20, s28
    s_and_b32 s29, s29, 1
    s_lshl_b32 s29, s29, 13
    s_add_u32 s30, s30, s29
    s_xor_b32 s30, s30, 8192
    s_add_u32 s30, s30, s44
    buffer_load_dword v12, v9, s[4:7], s30 offen sc1
    s_mul_i32 s28, s19, 171
    s_lshr_b32 s28, s28, 9
    s_mul_i32 s76, s28, 3
    s_sub_u32 s76, s19, s76
    s_lshl_b32 s76, s76, 15
    s_add_u32 s28, s28, 4
    s_lshl_b32 s30, s28, 21
    s_add_u32 s30, s30, s76
    s_add_u32 s30, s30, 1966080
    s_lshr_b32 s29, s20, s28
    s_and_b32 s29, s29, 1
    s_lshl_b32 s29, s29, 13
    s_add_u32 s30, s30, s29
    s_xor_b32 s30, s30, 8192
    s_add_u32 s30, s30, s44
    s_mov_b32 s35, 0
W_35:
    buffer_load_dword v8, v9, s[4:7], s30 offen sc1
    s_waitcnt vmcnt(0)
    v_cmp_gt_u32 vcc, s58, v8
    s_cbranch_vccz G_36
    s_sleep 2
    s_add_u32 s35, s35, 1
    s_cmp_lt_u32 s35, 200000
    s_cbranch_scc1 W_35
    s_branch M_fail
G_36:
    buffer_load_dwordx4 v[64:67], v2, s[4:7], s60 offen offset:0 sc1
    buffer_load_dwordx4 v[68:71], v2, s[4:7], s63 offen offset:0 sc1
    buffer_load_dwordx4 v[72:75], v2, s[4:7], s60 offen offset:1024 sc1
    buffer_load_dwordx4 v[76:79], v2, s[4:7], s63 offen offset:1024 sc1
    buffer_load_dwordx4 v[80:83], v2, s[4:7], s60 offen offset:2048 sc1
    buffer_load_dwordx4 v[84:87], v2, s[4:7], s63 offen offset:2048 sc1
    buffer_load_dwordx4 v[88:91], v2, s[4:7], s60 offen offset:3072 sc1
    buffer_load_dwordx4 v[92:95], v2, s[4:7], s63 offen offset:3072 sc1
    buffer_load_dwordx4 v[96:99], v2, s[4:7], s61 offen offset:0 sc1
    buffer_load_dwordx4 v[100:103], v2, s[4:7], s64 offen offset:0 sc1
    buffer_load_dwordx4 v[104:107], v2, s[4:7], s61 offen offset:1024 sc1
    buffer_load_dwordx4 v[108:111], v2, s[4:7], s64 offen offset:1024 sc1
    buffer_load_dwordx4 v[112:115], v2, s[4:7], s61 offen offset:2048 sc1
    buffer_load_dwordx4 v[116:119], v2, s[4:7], s64 offen offset:2048 sc1
    buffer_load_dwordx4 v[120:123], v2, s[4:7], s61 offen offset:3072 sc1
    buffer_load_dwordx4 v[124:127], v2, s[4:7], s64 offen offset:3072 sc1
    buffer_load_dwordx4 v[128:131], v2, s[4:7], s62 offen offset:0 sc1
    buffer_load_dwordx4 v[132:135], v2, s[4:7], s65 offen offset:0 sc1
    buffer_load_dwordx4 v[136:139], v2, s[4:7], s62 offen offset:1024 sc1
    buffer_load_dwordx4 v[140:143], v2, s[4:7], s65 offen offset:1024 sc1
    buffer_load_dwordx4 v[144:147], v2, s[4:7], s62 offen offset:2048 sc1
    buffer_load_dwordx4 v[148:151], v2, s[4:7], s65 offen offset:2048 sc1
    buffer_load_dwordx4 v[152:155], v2, s[4:7], s62 offen offset:3072 sc1
    buffer_load_dwordx4 v[156:159], v2, s[4:7], s65 offen offset:3072 sc1
PD_have:
    s_mul_i32 s32, s19, 40960
    s_lshl_b32 s31, s42, 9
    s_add_u32 s30, s32, s31
    s_add_u32 s30, s30, 217055232
    s_add_u32 s31, s30, 20480
    buffer_load_dwordx2 v[24:25], v7, s[4:7], s30 offen sc1
    buffer_load_dwordx2 v[26:27], v7, s[4:7], s31 offen sc1
    s_add_u32 s34, s19, s18
    v_cmp_gt_u32 vcc, 2, v12
    s_mul_i32 s60, s34, 98304
    s_add_u32 s60, s60, s43
    s_add_u32 s60, s60, 223346688
    s_cmp_lt_u32 s34, s59
    s_cselect_b32 s27, 1, 0
    s_cmp_eq_u64 vcc, 0
    s_cselect_b32 s27, s27, 0
    s_cmp_lg_u32 s27, 0
    s_cselect_b32 s60, s60, 0x7ff00000
    s_add_u32 s61, s60, s67
    s_add_u32 s62, s60, s68
    s_add_u32 s60, s60, s66
    s_add_u32 s63, s60, 49152
    s_add_u32 s64, s61, 49152
    s_add_u32 s65, s62, 49152
    s_add_u32 s33, s34, s18
    s_min_u32 s31, s33, 63
    s_mul_i32 s28, s31, 171
    s_lshr_b32 s28, s28, 9
    s_mul_i32 s76, s28, 3
    s_sub_u32 s76, s31, s76
    s_lshl_b32 s76, s76, 15
    s_add_u32 s28, s28, 4
    s_lshl_b32 s30, s28, 21
    s_add_u32 s30, s30, s76
    s_add_u32 s30, s30, 1966080
    s_lshr_b32 s29, s20, s28
    s_and_b32 s29, s29, 1
    s_lshl_b32 s29, s29, 13
    s_add_u32 s30, s30, s29
    s_xor_b32 s30, s30, 8192
    s_add_u32 s30, s30, s44
    buffer_load_dword v12, v9, s[4:7], s30 offen sc1
    s_waitcnt vmcnt(25)
    v_mfma_f32_16x16x32_bf16 v[32:35], a[0:3], v[64:67], 0
    v_mfma_f32_16x16x32_bf16 v[36:39], a[0:3], v[68:71], 0
    v_mfma_f32_16x16x32_bf16 v[40:43], a[48:51], v[64:67], 0
    v_mfma_f32_16x16x32_bf16 v[44:47], a[48:51], v[68:71], 0
    v_mfma_f32_16x16x32_bf16 v[48:51], a[96:99], v[64:67], 0
    v_mfma_f32_16x16x32_bf16 v[52:55], a[96:99], v[68:71], 0
    v_mfma_f32_16x16x32_bf16 v[56:59], a[144:147], v[64:67], 0
    v_mfma_f32_16x16x32_bf16 v[60:63], a[144:147], v[68:71], 0
    buffer_load_dwordx4 v[64:67], v2, s[4:7], s60 offen offset:0 sc1
    buffer_load_dwordx4 v[68:71], v2, s[4:7], s63 offen offset:0 sc1
    s_waitcnt vmcnt(25)
    v_mfma_f32_16x16x32_bf16 v[32:35], a[4:7], v[72:75], v[32:35]
    v_mfma_f32_16x16x32_bf16 v[36:39], a[4:7], v[76:79], v[36:39]
    v_mfma_f32_16x16x32_bf16 v[40:43], a[52:55], v[72:75], v[40:43]
    v_mfma_f32_16x16x32_bf16 v[44:47], a[52:55], v[76:79], v[44:47]
    v_mfma_f32_16x16x32_bf16 v[48:51], a[100:103], v[72:75], v[48:51]
    v_mfma_f32_16x16x32_bf16 v[52:55], a[100:103], v[76:79], v[52:55]
    v_mfma_f32_16x16x32_bf16 v[56:59], a[148:151], v[72:75], v[56:59]
    v_mfma_f32_16x16x32_bf16 v[60:63], a[148:151], v[76:79], v[60:63]
    buffer_load_dwordx4 v[72:75], v2, s[4:7], s60 offen offset:1024 sc1
    buffer_load_dwordx4 v[76:79], v2, s[4:7], s63 offen offset:1024 sc1
    s_waitcnt vmcnt(25)
    v_mfma_f32_16x16x32_bf16 v[32:35], a[8:11], v[80:83], v[32:35]
    v_mfma_f32_16x16x32_bf16 v[36:39], a[8:11], v[84:87], v[36:39]
    v_mfma_f32_16x16x32_bf16 v[40:43], a[56:59], v[80:83], v[40:43]
    v_mfma_f32_16x16x32_bf16 v[44:47], a[56:59], v[84:87], v[44:47]
    v_mfma_f32_16x16x32_bf16 v[48:51], a[104:107], v[80:83], v[48:51]
    v_mfma_f32_16x16x32_bf16 v[52:55], a[104:107], v[84:87], v[52:55]
    v_mfma_f32_16x16x32_bf16 v[56:59], a[152:155], v[80:83], v[56:59]
    v_mfma_f32_16x16x32_bf16 v[60:63], a[152:155], v[84:87], v[60:63]
    buffer_load_dwordx4 v[80:83], v2, s[4:7], s60 offen offset:2048 sc1
    buffer_load_dwordx4 v[84:87], v2, s[4:7], s63 offen offset:2048 sc1
    s_waitcnt vmcnt(25)
    v_mfma_f32_16x16x32_bf16 v[32:35], a[12:15], v[88:91], v[32:35]
    v_mfma_f32_16x16x32_bf16 v[36:39], a[12:15], v[92:95], v[36:39]
    v_mfma_f32_16x16x32_bf16 v[40:43], a[60:63], v[88:91], v[40:43]
    v_mfma_f32_16x16x32_bf16 v[44:47], a[60:63], v[92:95], v[44:47]
    v_mfma_f32_16x16x32_bf16 v[48:51], a[108:111], v[88:91], v[48:51]
    v_mfma_f32_16x16x32_bf16 v[52:55], a[108:111], v[92:95], v[52:55]
    v_mfma_f32_16x16x32_bf16 v[56:59], a[156:159], v[88:91], v[56:59]
    v_mfma_f32_16x16x32_bf16 v[60:63], a[156:159], v[92:95], v[60:63]
    buffer_load_dwordx4 v[88:91], v2, s[4:7], s60 offen offset:3072 sc1
    buffer_load_dwordx4 v[92:95], v2, s[4:7], s63 offen offset:3072 sc1
    s_waitcnt vmcnt(25)
    v_mfma_f32_16x16x32_bf16 v[32:35], a[16:19], v[96:99], v[32:35]
    v_mfma_f32_16x16x32_bf16 v[36:39], a[16:19], v[100:103], v[36:39]
    v_mfma_f32_16x16x32_bf16 v[40:43], a[64:67], v[96:99], v[40:43]
    v_mfma_f32_16x16x32_bf16 v[44:47], a[64:67], v[100:103], v[44:47]
    v_mfma_f32_16x16x32_bf16 v[48:51], a[112:115], v[96:99], v[48:51]
    v_mfma_f32_16x16x32_bf16 v[52:55], a[112:115], v[100:103], v[52:55]
    v_mfma_f32_16x16x32_bf16 v[56:59], a[160:163], v[96:99], v[56:59]
    v_mfma_f32_16x16x32_bf16 v[60:63], a[160:163], v[100:103], v[60:63]
    buffer_load_dwordx4 v[96:99], v2, s[4:7], s61 offen offset:0 sc1
    buffer_load_dwordx4 v[100:103], v2, s[4:7], s64 offen offset:0 sc1
    s_waitcnt vmcnt(25)
    v_mfma_f32_16x16x32_bf16 v[32:35], a[20:23], v[104:107], v[32:35]
    v_mfma_f32_16x16x32_bf16 v[36:39], a[20:23], v[108:111], v[36:39]
    v_mfma_f32_16x16x32_bf16 v[40:43], a[68:71], v[104:107], v[40:43]
    v_mfma_f32_16x16x32_bf16 v[44:47], a[68:71], v[108:111], v[44:47]
    v_mfma_f32_16x16x32_bf16 v[48:51], a[116:119], v[104:107], v[48:51]
    v_mfma_f32_16x16x32_bf16 v[52:55], a[116:119], v[108:111], v[52:55]
    v_mfma_f32_16x16x32_bf16 v[56:59], a[164:167], v[104:107], v[56:59]
    v_mfma_f32_16x16x32_bf16 v[60:63], a[164:167], v[108:111], v[60:63]
    buffer_load_dwordx4 v[104:107], v2, s[4:7], s61 offen offset:1024 sc1
    buffer_load_dwordx4 v[108:111], v2, s[4:7], s64 offen offset:1024 sc1
    s_waitcnt vmcnt(25)
    v_mfma_f32_16x16x32_bf16 v[32:35], a[24:27], v[112:115], v[32:35]
    v_mfma_f32_16x16x32_bf16 v[36:39], a[24:27], v[116:119], v[36:39]
    v_mfma_f32_16x16x32_bf16 v[40:43], a[72:75], v[112:115], v[40:43]
    v_mfma_f32_16x16x32_bf16 v[44:47], a[72:75], v[116:119], v[44:47]
    v_mfma_f32_16x16x32_bf16 v[48:51], a[120:123], v[112:115], v[48:51]
    v_mfma_f32_16x16x32_bf16 v[52:55], a[120:123], v[116:119], v[52:55]
    v_mfma_f32_16x16x32_bf16 v[56:59], a[168:171], v[112:115], v[56:59]
    v_mfma_f32_16x16x32_bf16 v[60:63], a[168:171], v[116:119], v[60:63]
    buffer_load_dwordx4 v[112:115], v2, s[4:7], s61 offen offset:2048 sc1
    buffer_load_dwordx4 v[116:119], v2, s[4:7], s64 offen offset:2048 sc1
    s_waitcnt vmcnt(25)
    v_mfma_f32_16x16x32_bf16 v[32:35], a[28:31], v[120:123], v[32:35]
    v_mfma_f32_16x16x32_bf16 v[36:39], a[28:31], v[124:127], v[36:39]
    v_mfma_f32_16x16x32_bf16 v[40:43], a[76:79], v[120:123], v[40:43]
    v_mfma_f32_16x16x32_bf16 v[44:47], a[76:79], v[124:127], v[44:47]
    v_mfma_f32_16x16x32_bf16 v[48:51], a[124:127], v[120:123], v[48:51]
    v_mfma_f32_16x16x32_bf16 v[52:55], a[124:127], v[124:127], v[52:55]
    v_mfma_f32_16x16x32_bf16 v[56:59], a[172:175], v[120:123], v[56:59]
    v_mfma_f32_16x16x32_bf16 v[60:63], a[172:175], v[124:127], v[60:63]
    buffer_load_dwordx4 v[120:123], v2, s[4:7], s61 offen offset:3072 sc1
    buffer_load_dwordx4 v[124:127], v2, s[4:7], s64 offen offset:3072 sc1
    s_waitcnt vmcnt(25)
    v_mfma_f32_16x16x32_bf16 v[32:35], a[32:35], v[128:131], v[32:35]
    v_mfma_f32_16x16x32_bf16 v[36:39], a[32:35], v[132:135], v[36:39]
    v_mfma_f32_16x16x32_bf16 v[40:43], a[80:83], v[128:131], v[40:43]
    v_mfma_f32_16x16x32_bf16 v[44:47], a[80:83], v[132:135], v[44:47]
    v_mfma_f32_16x16x32_bf16 v[48:51], a[128:131], v[128:131], v[48:51]
    v_mfma_f32_16x16x32_bf16 v[52:55], a[128:131], v[132:135], v[52:55]
    v_mfma_f32_16x16x32_bf16 v[56:59], a[176:179], v[128:131], v[56:59]
    v_mfma_f32_16x16x32_bf16 v[60:63], a[176:179], v[132:135], v[60:63]
    buffer_load_dwordx4 v[128:131], v2, s[4:7], s62 offen offset:0 sc1
    buffer_load_dwordx4 v[132:135], v2, s[4:7], s65 offen offset:0 sc1
    s_waitcnt vmcnt(25)
    v_mfma_f32_16x16x32_bf16 v[32:35], a[36:39], v[136:139], v[32:35]
    v_mfma_f32_16x16x32_bf16 v[36:39], a[36:39], v[140:143], v[36:39]
    v_mfma_f32_16x16x32_bf16 v[40:43], a[84:87], v[136:139], v[40:43]
    v_mfma_f32_16x16x32_bf16 v[44:47], a[84:87], v[140:143], v[44:47]
    v_mfma_f32_16x16x32_bf16 v[48:51], a[132:135], v[136:139], v[48:51]
    v_mfma_f32_16x16x32_bf16 v[52:55], a[132:135], v[140:143], v[52:55]
    v_mfma_f32_16x16x32_bf16 v[56:59], a[180:183], v[136:139], v[56:59]
    v_mfma_f32_16x16x32_bf16 v[60:63], a[180:183], v[140:143], v[60:63]
    buffer_load_dwordx4 v[136:139], v2, s[4:7], s62 offen offset:1024 sc1
    buffer_load_dwordx4 v[140:143], v2, s[4:7], s65 offen offset:1024 sc1
    s_waitcnt vmcnt(25)
    v_mfma_f32_16x16x32_bf16 v[32:35], a[40:43], v[144:147], v[32:35]
    v_mfma_f32_16x16x32_bf16 v[36:39], a[40:43], v[148:151], v[36:39]
    v_mfma_f32_16x16x32_bf16 v[40:43], a[88:91], v[144:147], v[40:43]
    v_mfma_f32_16x16x32_bf16 v[44:47], a[88:91], v[148:151], v[44:47]
    v_mfma_f32_16x16x32_bf16 v[48:51], a[136:139], v[144:147], v[48:51]
    v_mfma_f32_16x16x32_bf16 v[52:55], a[136:139], v[148:151], v[52:55]
    v_mfma_f32_16x16x32_bf16 v[56:59], a[184:187], v[144:147], v[56:59]
    v_mfma_f32_16x16x32_bf16 v[60:63], a[184:187], v[148:151], v[60:63]
    buffer_load_dwordx4 v[144:147], v2, s[4:7], s62 offen offset:2048 sc1
    buffer_load_dwordx4 v[148:151], v2, s[4:7], s65 offen offset:2048 sc1
    s_waitcnt vmcnt(25)
    v_mfma_f32_16x16x32_bf16 v[32:35], a[44:47], v[152:155], v[32:35]
    v_mfma_f32_16x16x32_bf16 v[36:39], a[44:47], v[156:159], v[36:39]
    v_mfma_f32_16x16x32_bf16 v[40:43], a[92:95], v[152:155], v[40:43]
    v_mfma_f32_16x16x32_bf16 v[44:47], a[92:95], v[156:159], v[44:47]
    v_mfma_f32_16x16x32_bf16 v[48:51], a[140:143], v[152:155], v[48:51]
    v_mfma_f32_16x16x32_bf16 v[52:55], a[140:143], v[156:159], v[52:55]
    v_mfma_f32_16x16x32_bf16 v[56:59], a[188:191], v[152:155], v[56:59]
    v_mfma_f32_16x16x32_bf16 v[60:63], a[188:191], v[156:159], v[60:63]
    buffer_load_dwordx4 v[152:155], v2, s[4:7], s62 offen offset:3072 sc1
    buffer_load_dwordx4 v[156:159], v2, s[4:7], s65 offen offset:3072 sc1
    v_cmp_u_f32 vcc, v32, v36
    s_cbranch_vccz PD_ok
    s_cmp_eq_u32 s58, 2
    s_mov_b32 s58, 2
    s_cbranch_scc0 PD_seg
PD_ok:
    ds_write_b128 v10, v[32:35] offset:0
    ds_write_b128 v10, v[36:39] offset:4096
    ds_write_b128 v10, v[40:43] offset:8192
    ds_write_b128 v10, v[44:47] offset:12288
    ds_write_b128 v10, v[48:51] offset:16384
    ds_write_b128 v10, v[52:55] offset:20480
    ds_write_b128 v10, v[56:59] offset:24576
    ds_write_b128 v10, v[60:63] offset:28672
    s_waitcnt lgkmcnt(0)
    s_barrier
    ds_read_b128 v[32:35], v11 offset:0
    ds_read_b128 v[36:39], v11 offset:1024
    ds_read_b128 v[40:43], v11 offset:2048
    ds_read_b128 v[44:47], v11 offset:3072
    ds_read_b128 v[48:51], v11 offset:4096
    ds_read_b128 v[52:55], v11 offset:5120
    ds_read_b128 v[56:59], v11 offset:6144
    ds_read_b128 v[60:63], v11 offset:7168
    s_waitcnt lgkmcnt(0)
    v_add_f32 v32, v32, v36
    v_add_f32 v40, v40, v44
    v_add_f32 v16, v32, v40
    v_add_f32 v33, v33, v37
    v_add_f32 v41, v41, v45
    v_add_f32 v17, v33, v41
    v_add_f32 v34, v34, v38
    v_add_f32 v42, v42, v46
    v_add_f32 v18, v34, v42
    v_add_f32 v35, v35, v39
    v_add_f32 v43, v43, v47
    v_add_f32 v19, v35, v43
    v_add_f32 v48, v48, v52
    v_add_f32 v56, v56, v60
    v_add_f32 v20, v48, v56
    v_add_f32 v49, v49, v53
    v_add_f32 v57, v57, v61
    v_add_f32 v21, v49, v57
    v_add_f32 v50, v50, v54
    v_add_f32 v58, v58, v62
    v_add_f32 v22, v50, v58
    v_add_f32 v51, v51, v55
    v_add_f32 v59, v59, v63
    v_add_f32 v23, v51, v59
    s_lshl_b32 s31, s42, 5
    s_add_u32 s30, s32, s31
    s_add_u32 s31, s30, 20480
    s_waitcnt vmcnt(24)
    v_cvt_pk_bf16_f32 v28, v16, v17
    v_lshlrev_b32 v16, 16, v28
    v_and_b32 v17, 0xffff0000, v28
    v_lshlrev_b32 v28, 16, v24
    v_add_f32 v16, v16, v28
    v_and_b32 v28, 0xffff0000, v24
    v_add_f32 v17, v17, v28
    v_cvt_pk_bf16_f32 v28, v16, v17
    v_cvt_pk_bf16_f32 v29, v18, v19
    v_lshlrev_b32 v18, 16, v29
    v_and_b32 v19, 0xffff0000, v29
    v_lshlrev_b32 v29, 16, v25
    v_add_f32 v18, v18, v29
    v_and_b32 v29, 0xffff0000, v25
    v_add_f32 v19, v19, v29
    v_cvt_pk_bf16_f32 v29, v18, v19
    buffer_store_dwordx2 v[28:29], v6, s[8:11], s30 offen
    v_cvt_pk_bf16_f32 v30, v20, v21
    v_lshlrev_b32 v20, 16, v30
    v_and_b32 v21, 0xffff0000, v30
    v_lshlrev_b32 v30, 16, v26
    v_add_f32 v20, v20, v30
    v_and_b32 v30, 0xffff0000, v26
    v_add_f32 v21, v21, v30
    v_cvt_pk_bf16_f32 v30, v20, v21
    v_cvt_pk_bf16_f32 v31, v22, v23
    v_lshlrev_b32 v22, 16, v31
    v_and_b32 v23, 0xffff0000, v31
    v_lshlrev_b32 v31, 16, v27
    v_add_f32 v22, v22, v31
    v_and_b32 v31, 0xffff0000, v27
    v_add_f32 v23, v23, v31
    v_cvt_pk_bf16_f32 v31, v22, v23
    buffer_store_dwordx2 v[30:31], v6, s[8:11], s31 offen
    v_xor_b32 v10, 0x8000, v10
    v_xor_b32 v11, 0x8000, v11
    s_mov_b32 s19, s34
    s_cmp_ge_u32 s19, 60
    s_cselect_b32 s58, 1, 2
    s_cmp_lg_u32 s27, 0
    s_cbranch_scc1 PD_have
    s_cmp_lt_u32 s19, s59
    s_cbranch_scc1 PD_seg
    s_endpgm
.p2align 3
.type M_table,@object
M_table:
  .long 0x1030000, 0x0, 0x10000, 0x0, 0x2030014, 0x0, 0x10010, 0x0
  .long 0x40000, 0x28009f00, 0x40008, 0x28009f08, 0x40010, 0x28009f86, 0x40018, 0x38005f84
  .long 0x3030001, 0x0, 0x10001, 0x0, 0x4030015, 0x0, 0x10011, 0x0
  .long 0x40001, 0x28009f01, 0x40009, 0x28009f09, 0x40011, 0x28009f87, 0x40019, 0x38005f85
  .long 0x5030002, 0x0, 0x10002, 0x0, 0x6030016, 0x0, 0x10012, 0x0
  .long 0x40002, 0x28009f02, 0x4000a, 0x28009f80, 0x40012, 0x28009f88, 0x4001a, 0x38005f86
  .long 0x7030003, 0x0, 0x10003, 0x0, 0x8030017, 0x0, 0x10013, 0x0
  .long 0x40003, 0x28009f03, 0x4000b, 0x28009f81, 0x40013, 0x28009f89, 0x4001b, 0x38005f87
  .long 0x9030004, 0x0, 0x10004, 0x0, 0xa030018, 0x0, 0x10014, 0x0
  .long 0x40004, 0x28009f04, 0x4000c, 0x28009f82, 0x40014, 0x38005f80, 0x4001c, 0x38005f88
  .long 0xb030005, 0x0, 0x10005, 0x0, 0xc030019, 0x0, 0x10015, 0x0
  .long 0x40005, 0x28009f05, 0x4000d, 0x28009f83, 0x40015, 0x38005f81, 0x4001d, 0x38005f89
  .long 0xd030006, 0x0, 0x10006, 0x0, 0xe03001a, 0x0, 0x10016, 0x0
  .long 0x40006, 0x28009f06, 0x4000e, 0x28009f84, 0x40016, 0x38005f82, 0x4001e, 0x38005f8a
  .long 0xf030007, 0x0, 0x10007, 0x0, 0x1003001b, 0x0, 0x10017, 0x0
  .long 0x40007, 0x28009f07, 0x4000f, 0x28009f85, 0x40017, 0x38005f83, 0x4001f, 0x38005f8b
  .long 0x11030008, 0x0, 0x10008, 0x0, 0x1203001c, 0x0, 0x10018, 0x0
  .long 0x41040100, 0x27c0c000, 0x42040108, 0x27c0c008, 0x43040110, 0x27c0c086, 0x44040118, 0x27c0c104
  .long 0x13030009, 0x0, 0x10009, 0x0, 0x1403001d, 0x0, 0x10019, 0x0
  .long 0x45040101, 0x27c0c001, 0x46040109, 0x27c0c009, 0x47040111, 0x27c0c087, 0x48040119, 0x27c0c105
  .long 0x1503000a, 0x0, 0x1000a, 0x0, 0x1603001e, 0x0, 0x1001a, 0x0
  .long 0x49040102, 0x27c0c002, 0x4a04010a, 0x27c0c080, 0x4b040112, 0x27c0c088, 0x4c04011a, 0x27c0c106
  .long 0x1703000b, 0x0, 0x1000b, 0x0, 0x1803001f, 0x0, 0x1001b, 0x0
  .long 0x4d040103, 0x27c0c003, 0x4e04010b, 0x27c0c081, 0x4f040113, 0x27c0c089, 0x5004011b, 0x27c0c107
  .long 0x1903000c, 0x0, 0x1000c, 0x0, 0x1a030020, 0x0, 0x1001c, 0x0
  .long 0x51040104, 0x27c0c004, 0x5204010c, 0x27c0c082, 0x53040114, 0x27c0c100, 0x5404011c, 0x27c0c108
  .long 0x1b03000d, 0x0, 0x1000d, 0x0, 0x1c030021, 0x0, 0x1001d, 0x0
  .long 0x55040105, 0x27c0c005, 0x5604010d, 0x27c0c083, 0x57040115, 0x27c0c101, 0x5804011d, 0x27c0c109
  .long 0x1d03000e, 0x0, 0x1000e, 0x0, 0x1e030022, 0x0, 0x1001e, 0x0
  .long 0x59040106, 0x27c0c006, 0x5a04010e, 0x27c0c084, 0x5b040116, 0x27c0c102, 0x5c04011e, 0x43e04008
  .long 0x1f03000f, 0x0, 0x1000f, 0x0, 0x20030023, 0x0, 0x1001f, 0x0
  .long 0x5d040107, 0x27c0c007, 0x5e04010f, 0x27c0c085, 0x5f040117, 0x27c0c103, 0x6004011f, 0x43e04009
  .long 0x21030010, 0x0, 0x20000, 0x0, 0x22030024, 0x0, 0x20010, 0x0
  .long 0x50008, 0x4800cf80, 0x50010, 0x4800cf88, 0x50018, 0x4800d006, 0x50000, 0x4800d084
  .long 0x23030011, 0x0, 0x20001, 0x0, 0x24030025, 0x0, 0x20011, 0x0
  .long 0x50009, 0x4800cf81, 0x50011, 0x4800cf89, 0x50019, 0x4800d007, 0x50001, 0x4800d085
  .long 0x25030012, 0x0, 0x20002, 0x0, 0x26030026, 0x0, 0x20012, 0x0
  .long 0x5000a, 0x4800cf82, 0x50012, 0x4800d000, 0x5001a, 0x4800d008, 0x50002, 0x4800d086
  .long 0x27030013, 0x0, 0x20003, 0x0, 0x28030027, 0x0, 0x20013, 0x0
  .long 0x5000b, 0x4800cf83, 0x50013, 0x4800d001, 0x5001b, 0x4800d009, 0x50003, 0x4800d087
  .long 0x29000000, 0x1800c000, 0x20004, 0x0, 0x2a000000, 0x1800c084, 0x20014, 0x0
  .long 0x5000c, 0x4800cf84, 0x50014, 0x4800d002, 0x5001c, 0x4800d080, 0x50004, 0x4800d088
  .long 0x2b000000, 0x1800c001, 0x20005, 0x0, 0x2c000000, 0x1800c085, 0x20015, 0x0
  .long 0x5000d, 0x4800cf85, 0x50015, 0x4800d003, 0x5001d, 0x4800d081, 0x50005, 0x4800d089
  .long 0x2d000000, 0x1800c002, 0x20006, 0x0, 0x2e000000, 0x1800c086, 0x20016, 0x0
  .long 0x5000e, 0x4800cf86, 0x50016, 0x4800d004, 0x5001e, 0x4800d082, 0x50006, 0x0
  .long 0x2f000000, 0x1800c003, 0x20007, 0x0, 0x30000000, 0x1800c087, 0x20017, 0x0
  .long 0x5000f, 0x4800cf87, 0x50017, 0x4800d005, 0x5001f, 0x4800d083, 0x50007, 0x0
  .long 0x31000000, 0x1800c004, 0x20008, 0x0, 0x32000000, 0x1800c100, 0x20018, 0x0
  .long 0x61050108, 0x37e08000, 0x62050110, 0x37e08008, 0x63050118, 0x37e08084, 0x64050100, 0x43e04000
  .long 0x33000000, 0x1800c005, 0x20009, 0x0, 0x34000000, 0x1800c101, 0x20019, 0x0
  .long 0x65050109, 0x37e08001, 0x66050111, 0x37e08009, 0x67050119, 0x37e08085, 0x68050101, 0x43e04001
  .long 0x35000000, 0x1800c006, 0x2000a, 0x0, 0x36000000, 0x1800c102, 0x2001a, 0x0
  .long 0x6905010a, 0x37e08002, 0x6a050112, 0x37e0800a, 0x6b05011a, 0x37e08086, 0x6c050102, 0x43e04002
  .long 0x37000000, 0x1800c007, 0x2000b, 0x0, 0x38000000, 0x1800c103, 0x2001b, 0x0
  .long 0x6d05010b, 0x37e08003, 0x6e050113, 0x37e0800b, 0x6f05011b, 0x37e08087, 0x70050103, 0x43e04003
  .long 0x39000000, 0x1800c080, 0x2000c, 0x0, 0x3a000000, 0x1800c104, 0x2001c, 0x0
  .long 0x7105010c, 0x37e08004, 0x72050114, 0x37e08080, 0x7305011c, 0x37e08088, 0x74050104, 0x43e04004
  .long 0x3b000000, 0x1800c081, 0x2000d, 0x0, 0x3c000000, 0x1800c105, 0x2001d, 0x0
  .long 0x7505010d, 0x37e08005, 0x76050115, 0x37e08081, 0x7705011d, 0x37e08089, 0x78050105, 0x43e04005
  .long 0x3d000000, 0x1800c082, 0x2000e, 0x0, 0x3e000000, 0x1800c106, 0x2001e, 0x0
  .long 0x7905010e, 0x37e08006, 0x7a050116, 0x37e08082, 0x7b05011e, 0x37e0808a, 0x7c050106, 0x43e04006
  .long 0x3f000000, 0x1800c083, 0x2000f, 0x0, 0x40000000, 0x1800c107, 0x2001f, 0x0
  .long 0x7d05010f, 0x37e08007, 0x7e050117, 0x37e08083, 0x7f05011f, 0x37e0808b, 0x80050107, 0x43e04007
.section .rodata,"a"
.p2align 6
.amdhsa_kernel sequential_preLN__memory_aug_recurrent_mem_tr__dense_activation_mish__prompt_kernel
  .amdhsa_next_free_vgpr 512
  .amdhsa_next_free_sgpr 102
  .amdhsa_accum_offset 256
  .amdhsa_group_segment_fixed_size 0
  .amdhsa_kernarg_size 112
  .amdhsa_user_sgpr_count 2
  .amdhsa_user_sgpr_kernarg_segment_ptr 1
  .amdhsa_system_sgpr_workgroup_id_x 1
.end_amdhsa_kernel
```
